```python
import torch

def _softmax(x, axis=-1):
    return torch.softmax(x, dim=axis)
def _gelu(x):
    return torch.nn.functional.gelu(x, approximate="tanh")
def _silu(x):
    return torch.nn.functional.silu(x)
def _sigmoid(x):
    return torch.sigmoid(x)
def _layernorm(x, axis=-1, eps=1e-5):
    m = x.mean(dim=axis, keepdim=True)
    v = x.var(dim=axis, keepdim=True, unbiased=False)
    return (x - m) / torch.sqrt(v + eps)
def _scatter_add(tgt, idx, src, axis=0):
    return tgt.clone().index_add_(axis, idx, src)
def _segment_sum(src, seg, n):
    out = torch.zeros((n,) + src.shape[1:], dtype=src.dtype)
    return out.index_add_(0, seg, src)
def _pad(x, pw):
    flat = tuple(v for pair in reversed(pw) for v in pair)
    return torch.nn.functional.pad(x, flat)

kernel_name = 'gated_mix__spectral_fnet__softmax_full_mha__prompt'

def setup_inputs():

    _w = (lambda a: (lambda t: t.to(torch.bfloat16) if t.is_floating_point() else t)(torch.as_tensor(a)))
    def _A_setup():
        B, S, D = 1, 2048, 1024
        ns = torch.arange(S)[:, None] * torch.arange(S)[None, :]
        nd = torch.arange(D)[:, None] * torch.arange(D)[None, :]
        Ws_re = torch.cos(-2.0 * torch.pi * ns / S).to(float)
        Ws_im = torch.sin(-2.0 * torch.pi * ns / S).to(float)
        Wd_re = torch.cos(-2.0 * torch.pi * nd / D).to(float)
        Wd_im = torch.sin(-2.0 * torch.pi * nd / D).to(float)
        return {
            "x": _w((lambda *s: torch.randn(*s, dtype=torch.bfloat16) * 0.05)(B, S, D)),
            "dft_seq_re": _w(Ws_re),
            "dft_seq_im": _w(Ws_im),
            "dft_hid_re": _w(Wd_re),
            "dft_hid_im": _w(Wd_im),
        }
    _A_in = _A_setup()

    def _B_setup():
        B, S, D = 1, 2048, 1024
        return {
            "x": _w((lambda *s: torch.randn(*s, dtype=torch.bfloat16) * 0.05)(B, S, D)),
            "wqkv": _w((lambda *s: torch.randn(*s, dtype=torch.bfloat16) * 1.6)(D, 3 * D)),
            "wo": _w((lambda *s: torch.randn(*s, dtype=torch.bfloat16) * 0.2)(D, D)),
        }
    _B_in = _B_setup()

    return {
        "A_x": _A_in["x"],
        "A_dft_seq_re": _A_in["dft_seq_re"],
        "A_dft_seq_im": _A_in["dft_seq_im"],
        "A_dft_hid_re": _A_in["dft_hid_re"],
        "A_dft_hid_im": _A_in["dft_hid_im"],
        "B_x": _B_in["x"],
        "B_wqkv": _B_in["wqkv"],
        "B_wo": _B_in["wo"],
        "gate_w": _w((lambda *s: torch.randn(*s, dtype=torch.bfloat16) * 0.05)(1024) * 16.0),
    }

def reference(A_x, A_dft_seq_re, A_dft_seq_im, A_dft_hid_re, A_dft_hid_im, B_x, B_wqkv, B_wo, gate_w):
    def _A_ref(x, dft_seq_re, dft_seq_im, dft_hid_re, dft_hid_im):
        a = torch.einsum("bsd,ed->bse", x, dft_hid_re)
        b = torch.einsum("bsd,ed->bse", x, dft_hid_im)
        y = torch.einsum("ts,bse->bte", dft_seq_re, a) - torch.einsum("ts,bse->bte", dft_seq_im, b)
        return y

    def _B_ref(x, wqkv, wo):
        B, S, D = x.shape
        H = 32; Dh = D // H
        qkv = (lambda x, *d: x.permute(*d))((x @ wqkv).reshape(B, S, 3, H, Dh), 2, 0, 3, 1, 4)
        q, k, v = qkv[0], qkv[1], qkv[2]
        scale = Dh ** -0.5
        scores = torch.einsum("bhqd,bhkd->bhqk", q, k) * scale
        p = _softmax(scores, axis=-1)
        o = torch.einsum("bhqk,bhkd->bhqd", p, v)
        return (lambda x, *d: x.permute(*d))(o, 0, 2, 1, 3).reshape(B, S, D) @ wo

    x = A_x
    g = _sigmoid((x * gate_w).sum(-1, keepdims=True))
    a = _A_ref(x, A_dft_seq_re, A_dft_seq_im, A_dft_hid_re, A_dft_hid_im)
    b = _B_ref(x, B_wqkv, B_wo)
    return g * a + (1 - g) * b
```

```asm
; @launch kernel=k1_proj_kernel grid=(256,1,1) block=(256,1,1) lds=159744
; @launch kernel=k2_attn_seqdft_kernel grid=(512,1,1) block=(256,1,1) lds=81920
; @launch kernel=k4_out_kernel grid=(256,1,1) block=(256,1,1) lds=131072
.amdgcn_target "amdgcn-amd-amdhsa--gfx950"
.text
    .globl k1_proj_kernel
    .p2align 8
    .type k1_proj_kernel,@function
k1_proj_kernel:
    s_cmp_ge_u32 s2, 256
    s_cbranch_scc1 K1_END
    s_load_dwordx2 s[48:49], s[0:1], 0
    s_load_dwordx4 s[52:55], s[0:1], 24
    s_load_dwordx2 s[56:57], s[0:1], 48
    s_load_dwordx2 s[58:59], s[0:1], 64
    s_load_dwordx2 s[60:61], s[0:1], 88
    v_and_b32 v1, 63, v0
    v_lshrrev_b32 v2, 6, v0
    v_lshrrev_b32 v3, 4, v1
    v_readfirstlane_b32 s32, v2
    s_and_b32 s33, s2, 1
    s_lshl_b32 s33, s33, 2
    s_bfe_u32 s46, s2, 0x20003
    s_add_u32 s33, s33, s46
    s_bfe_u32 s34, s2, 0x20001
    s_lshl_b32 s34, s34, 3
    s_lshr_b32 s46, s2, 5
    s_add_u32 s34, s34, s46
    v_lshrrev_b32 v2, 3, v1
    v_and_b32 v4, 7, v1
    v_xor_b32 v5, v4, v3
    v_xor_b32 v6, 4, v5
    v_lshlrev_b32 v5, 4, v5
    v_lshlrev_b32 v6, 4, v6
    v_lshl_add_u32 v5, v2, 11, v5
    v_lshl_add_u32 v6, v2, 11, v6
    s_lshl_b32 s44, s33, 8
    s_lshl_b32 s45, s32, 6
    s_add_u32 s44, s44, s45
    s_lshl_b32 s44, s44, 11
    s_add_u32 s45, s44, 0
    v_add_u32 v8, s45, v5
    s_add_u32 s45, s44, 16384
    v_add_u32 v9, s45, v6
    s_add_u32 s45, s44, 32768
    v_add_u32 v10, s45, v5
    s_add_u32 s45, s44, 49152
    v_add_u32 v11, s45, v6
    s_add_u32 s45, s44, 65536
    v_add_u32 v12, s45, v5
    s_add_u32 s45, s44, 81920
    v_add_u32 v13, s45, v6
    s_add_u32 s45, s44, 98304
    v_add_u32 v14, s45, v5
    s_add_u32 s45, s44, 114688
    v_add_u32 v15, s45, v6
    s_lshl_b32 s44, s34, 5
    s_lshl_b32 s45, s32, 3
    s_add_u32 s44, s44, s45
    s_lshl_b32 s44, s44, 11
    s_bitcmp1_b32 s32, 0
    s_cselect_b64 vcc, -1, 0
    v_cndmask_b32 v7, v5, v6, vcc
    v_add_u32 v16, s44, v7
    v_lshrrev_b32 v2, 2, v1
    s_lshl_b32 s44, s32, 4
    v_add_u32 v2, s44, v2
    v_mul_u32_u24 v2, 6144, v2
    v_and_b32 v3, 3, v1
    v_lshrrev_b32 v4, 5, v1
    v_lshlrev_b32 v4, 1, v4
    v_xor_b32 v3, v3, v4
    v_lshl_add_u32 v2, v3, 4, v2
    s_lshl_b32 s44, s34, 6
    v_add_u32 v17, s44, v2
    v_add_u32 v18, 2048, v17
    v_add_u32 v19, 2048, v18
    s_lshl_b32 s37, s32, 13
    s_and_b32 s41, s2, 7
    s_lshl_b32 s41, s41, 1
    s_bfe_u32 s44, s2, 0x10003
    s_add_u32 s41, s41, s44
    s_lshl_b32 s38, s32, 10
    s_waitcnt lgkmcnt(0)
    s_mov_b32 s8, s48
    s_and_b32 s9, s49, 0xffff
    s_mov_b32 s10, 4194304
    s_mov_b32 s11, 0x00020000
    s_mov_b32 s12, s52
    s_and_b32 s13, s53, 0xffff
    s_mov_b32 s14, 2097152
    s_mov_b32 s15, 0x00020000
    s_mov_b32 s16, s54
    s_and_b32 s17, s55, 0xffff
    s_mov_b32 s18, 2097152
    s_mov_b32 s19, 0x00020000
    s_mov_b32 s20, s56
    s_and_b32 s21, s57, 0xffff
    s_mov_b32 s22, 6291456
    s_mov_b32 s23, 0x00020000
    s_add_u32 s35, s41, 0
    s_and_b32 s35, s35, 15
    s_mul_i32 s36, s35, 393216
    s_lshl_b32 s35, s35, 7
    s_add_u32 m0, s37, 0
    s_nop 0
    buffer_load_dwordx4 v8, s[8:11], s35 offen lds
    s_add_u32 m0, s37, 1024
    s_nop 0
    buffer_load_dwordx4 v9, s[8:11], s35 offen lds
    s_add_u32 m0, s37, 2048
    s_nop 0
    buffer_load_dwordx4 v10, s[8:11], s35 offen lds
    s_add_u32 m0, s37, 3072
    s_nop 0
    buffer_load_dwordx4 v11, s[8:11], s35 offen lds
    s_add_u32 m0, s37, 4096
    s_nop 0
    buffer_load_dwordx4 v12, s[8:11], s35 offen lds
    s_add_u32 m0, s37, 5120
    s_nop 0
    buffer_load_dwordx4 v13, s[8:11], s35 offen lds
    s_add_u32 m0, s37, 6144
    s_nop 0
    buffer_load_dwordx4 v14, s[8:11], s35 offen lds
    s_add_u32 m0, s37, 7168
    s_nop 0
    buffer_load_dwordx4 v15, s[8:11], s35 offen lds
    s_add_u32 m0, s38, 32768
    s_nop 0
    buffer_load_dwordx4 v16, s[12:15], s35 offen lds
    s_add_u32 m0, s38, 36864
    s_nop 0
    buffer_load_dwordx4 v16, s[16:19], s35 offen lds
    s_add_u32 m0, s38, 40960
    s_nop 0
    buffer_load_dwordx4 v17, s[20:23], s36 offen lds
    s_add_u32 m0, s38, 45056
    s_nop 0
    buffer_load_dwordx4 v18, s[20:23], s36 offen lds
    s_add_u32 m0, s38, 49152
    s_nop 0
    buffer_load_dwordx4 v19, s[20:23], s36 offen lds
    s_add_u32 s35, s41, 1
    s_and_b32 s35, s35, 15
    s_mul_i32 s36, s35, 393216
    s_lshl_b32 s35, s35, 7
    s_add_u32 m0, s37, 53248
    s_nop 0
    buffer_load_dwordx4 v8, s[8:11], s35 offen lds
    s_add_u32 m0, s37, 54272
    s_nop 0
    buffer_load_dwordx4 v9, s[8:11], s35 offen lds
    s_add_u32 m0, s37, 55296
    s_nop 0
    buffer_load_dwordx4 v10, s[8:11], s35 offen lds
    s_add_u32 m0, s37, 56320
    s_nop 0
    buffer_load_dwordx4 v11, s[8:11], s35 offen lds
    s_add_u32 m0, s37, 57344
    s_nop 0
    buffer_load_dwordx4 v12, s[8:11], s35 offen lds
    s_add_u32 m0, s37, 58368
    s_nop 0
    buffer_load_dwordx4 v13, s[8:11], s35 offen lds
    s_add_u32 m0, s37, 59392
    s_nop 0
    buffer_load_dwordx4 v14, s[8:11], s35 offen lds
    s_add_u32 m0, s37, 60416
    s_nop 0
    buffer_load_dwordx4 v15, s[8:11], s35 offen lds
    s_add_u32 m0, s38, 86016
    s_nop 0
    buffer_load_dwordx4 v16, s[12:15], s35 offen lds
    s_add_u32 m0, s38, 90112
    s_nop 0
    buffer_load_dwordx4 v16, s[16:19], s35 offen lds
    s_add_u32 m0, s38, 94208
    s_nop 0
    buffer_load_dwordx4 v17, s[20:23], s36 offen lds
    s_add_u32 m0, s38, 98304
    s_nop 0
    buffer_load_dwordx4 v18, s[20:23], s36 offen lds
    s_add_u32 m0, s38, 102400
    s_nop 0
    buffer_load_dwordx4 v19, s[20:23], s36 offen lds
    s_mov_b32 s28, s58
    s_and_b32 s29, s59, 0xffff
    s_mov_b32 s30, 2048
    s_mov_b32 s31, 0x00020000
    s_mov_b32 s24, s60
    s_and_b32 s25, s61, 0xffff
    s_mov_b32 s26, 37748736
    s_mov_b32 s27, 0x00020000
    v_and_b32 v2, 15, v1
    v_lshrrev_b32 v3, 4, v1
    v_bfe_u32 v4, v1, 1, 3
    v_add_u32 v5, 0, v3
    v_xor_b32 v5, v5, v4
    v_lshlrev_b32 v5, 4, v5
    v_lshl_add_u32 v5, v2, 7, v5
    v_add_u32 v20, s37, v5
    v_add_u32 v22, 32768, v5
    v_add_u32 v240, 106496, v20
    v_add_u32 v242, 106496, v22
    v_add_u32 v5, 4, v3
    v_xor_b32 v5, v5, v4
    v_lshlrev_b32 v5, 4, v5
    v_lshl_add_u32 v5, v2, 7, v5
    v_add_u32 v21, s37, v5
    v_add_u32 v23, 32768, v5
    v_add_u32 v241, 106496, v21
    v_add_u32 v243, 106496, v23
    v_bfe_u32 v4, v1, 2, 2
    v_lshl_add_u32 v4, v3, 3, v4
    v_lshlrev_b32 v4, 6, v4
    v_and_b32 v5, 3, v1
    v_lshl_add_u32 v4, v5, 3, v4
    v_and_b32 v5, 1, v3
    v_lshl_add_u32 v6, v5, 5, v4
    v_add_u32 v24, 40960, v6
    v_xor_b32 v25, 32, v24
    v_add_u32 v244, 106496, v24
    v_add_u32 v245, 106496, v25
    v_lshrrev_b32 v6, 1, v3
    v_lshl_add_u32 v6, v5, 1, v6
    v_lshlrev_b32 v6, 8, v6
    v_lshl_add_u32 v26, v2, 4, v6
    v_lshlrev_b32 v6, 4, v2
    v_lshl_add_u32 v27, v3, 9, v6
    v_lshlrev_b32 v28, 4, v1
    s_lshl_b32 s44, s2, 3
    s_lshl_b32 s45, s32, 1
    s_add_u32 s44, s44, s45
    s_lshl_b32 s45, s44, 11
    v_lshlrev_b32 v2, 5, v1
    buffer_load_dwordx4 v[192:195], v2, s[8:11], s45 offen offset:0
    buffer_load_dwordx4 v[196:199], v2, s[8:11], s45 offen offset:16
    buffer_load_dwordx4 v[200:203], v2, s[8:11], s45 offen offset:2048
    buffer_load_dwordx4 v[204:207], v2, s[8:11], s45 offen offset:2064
    buffer_load_dwordx4 v[208:211], v2, s[28:31], 0 offen
    buffer_load_dwordx4 v[212:215], v2, s[28:31], 0 offen offset:16
    s_lshl_b32 s47, s44, 2
    s_waitcnt vmcnt(19)
    s_barrier
    ds_read_b128 a[0:3], v20 offset:0
    ds_read_b128 a[4:7], v20 offset:2048
    ds_read_b128 a[8:11], v20 offset:4096
    ds_read_b128 a[12:15], v20 offset:6144
    ds_read_b128 a[16:19], v22 offset:0
    ds_read_b128 a[20:23], v22 offset:2048
    ds_read_b128 a[24:27], v22 offset:4096
    ds_read_b128 a[28:31], v22 offset:6144
    ds_read_b64_tr_b16 a[32:33], v24 offset:0
    ds_read_b64_tr_b16 a[34:35], v24 offset:256
    ds_read_b64_tr_b16 a[36:37], v25 offset:0
    ds_read_b64_tr_b16 a[38:39], v25 offset:256
    ds_read_b64_tr_b16 a[40:41], v24 offset:4096
    ds_read_b64_tr_b16 a[42:43], v24 offset:4352
    ds_read_b64_tr_b16 a[44:45], v25 offset:4096
    ds_read_b64_tr_b16 a[46:47], v25 offset:4352
    ds_read_b64_tr_b16 a[48:49], v24 offset:8192
    ds_read_b64_tr_b16 a[50:51], v24 offset:8448
    ds_read_b64_tr_b16 a[52:53], v25 offset:8192
    ds_read_b64_tr_b16 a[54:55], v25 offset:8448
    s_waitcnt lgkmcnt(0)
    v_mfma_f32_16x16x32_bf16 v[32:35], a[0:3], a[16:19], 0
    ds_read_b128 a[56:59], v21 offset:0
    v_mfma_f32_16x16x32_bf16 v[72:75], a[4:7], a[16:19], 0
    ds_read_b128 a[60:63], v21 offset:2048
    v_mfma_f32_16x16x32_bf16 v[112:115], a[8:11], a[16:19], 0
    ds_read_b128 a[64:67], v21 offset:4096
    v_mfma_f32_16x16x32_bf16 v[152:155], a[12:15], a[16:19], 0
    ds_read_b128 a[68:71], v21 offset:6144
    v_mfma_f32_16x16x32_bf16 v[36:39], a[0:3], a[20:23], 0
    ds_read_b128 a[72:75], v23 offset:0
    v_mfma_f32_16x16x32_bf16 v[76:79], a[4:7], a[20:23], 0
    ds_read_b128 a[76:79], v23 offset:2048
    v_mfma_f32_16x16x32_bf16 v[116:119], a[8:11], a[20:23], 0
    ds_read_b128 a[80:83], v23 offset:4096
    v_mfma_f32_16x16x32_bf16 v[156:159], a[12:15], a[20:23], 0
    ds_read_b128 a[84:87], v23 offset:6144
    v_mfma_f32_16x16x32_bf16 v[40:43], a[0:3], a[24:27], 0
    ds_read_b64_tr_b16 a[88:89], v24 offset:2048
    s_add_u32 s35, s41, 2
    v_mfma_f32_16x16x32_bf16 v[80:83], a[4:7], a[24:27], 0
    ds_read_b64_tr_b16 a[90:91], v24 offset:2304
    s_and_b32 s35, s35, 15
    v_mfma_f32_16x16x32_bf16 v[120:123], a[8:11], a[24:27], 0
    ds_read_b64_tr_b16 a[92:93], v25 offset:2048
    s_mul_i32 s36, s35, 393216
    v_mfma_f32_16x16x32_bf16 v[160:163], a[12:15], a[24:27], 0
    ds_read_b64_tr_b16 a[94:95], v25 offset:2304
    s_lshl_b32 s35, s35, 7
    v_mfma_f32_16x16x32_bf16 v[44:47], a[0:3], a[28:31], 0
    ds_read_b64_tr_b16 a[96:97], v24 offset:6144
    s_add_u32 m0, s37, 106496
    v_mfma_f32_16x16x32_bf16 v[84:87], a[4:7], a[28:31], 0
    ds_read_b64_tr_b16 a[98:99], v24 offset:6400
    buffer_load_dwordx4 v8, s[8:11], s35 offen lds
    v_mfma_f32_16x16x32_bf16 v[124:127], a[8:11], a[28:31], 0
    ds_read_b64_tr_b16 a[100:101], v25 offset:6144
    s_add_u32 m0, s37, 107520
    v_mfma_f32_16x16x32_bf16 v[164:167], a[12:15], a[28:31], 0
    ds_read_b64_tr_b16 a[102:103], v25 offset:6400
    buffer_load_dwordx4 v9, s[8:11], s35 offen lds
    v_mfma_f32_16x16x32_bf16 v[48:51], a[32:35], a[0:3], 0
    ds_read_b64_tr_b16 a[104:105], v24 offset:10240
    s_add_u32 m0, s37, 108544
    v_mfma_f32_16x16x32_bf16 v[88:91], a[32:35], a[4:7], 0
    ds_read_b64_tr_b16 a[106:107], v24 offset:10496
    buffer_load_dwordx4 v10, s[8:11], s35 offen lds
    v_mfma_f32_16x16x32_bf16 v[128:131], a[32:35], a[8:11], 0
    ds_read_b64_tr_b16 a[108:109], v25 offset:10240
    s_add_u32 m0, s37, 109568
    v_mfma_f32_16x16x32_bf16 v[168:171], a[32:35], a[12:15], 0
    ds_read_b64_tr_b16 a[110:111], v25 offset:10496
    buffer_load_dwordx4 v11, s[8:11], s35 offen lds
    v_mfma_f32_16x16x32_bf16 v[52:55], a[36:39], a[0:3], 0
    s_add_u32 m0, s37, 110592
    v_mfma_f32_16x16x32_bf16 v[92:95], a[36:39], a[4:7], 0
    buffer_load_dwordx4 v12, s[8:11], s35 offen lds
    v_mfma_f32_16x16x32_bf16 v[132:135], a[36:39], a[8:11], 0
    s_add_u32 m0, s37, 111616
    v_mfma_f32_16x16x32_bf16 v[172:175], a[36:39], a[12:15], 0
    buffer_load_dwordx4 v13, s[8:11], s35 offen lds
    v_mfma_f32_16x16x32_bf16 v[56:59], a[40:43], a[0:3], 0
    s_add_u32 m0, s37, 112640
    v_mfma_f32_16x16x32_bf16 v[96:99], a[40:43], a[4:7], 0
    buffer_load_dwordx4 v14, s[8:11], s35 offen lds
    v_mfma_f32_16x16x32_bf16 v[136:139], a[40:43], a[8:11], 0
    s_add_u32 m0, s37, 113664
    v_mfma_f32_16x16x32_bf16 v[176:179], a[40:43], a[12:15], 0
    buffer_load_dwordx4 v15, s[8:11], s35 offen lds
    v_mfma_f32_16x16x32_bf16 v[60:63], a[44:47], a[0:3], 0
    s_add_u32 m0, s38, 139264
    v_mfma_f32_16x16x32_bf16 v[100:103], a[44:47], a[4:7], 0
    buffer_load_dwordx4 v16, s[12:15], s35 offen lds
    v_mfma_f32_16x16x32_bf16 v[140:143], a[44:47], a[8:11], 0
    s_add_u32 m0, s38, 143360
    v_mfma_f32_16x16x32_bf16 v[180:183], a[44:47], a[12:15], 0
    buffer_load_dwordx4 v16, s[16:19], s35 offen lds
    v_mfma_f32_16x16x32_bf16 v[64:67], a[0:3], a[48:51], 0
    s_add_u32 m0, s38, 147456
    v_mfma_f32_16x16x32_bf16 v[104:107], a[4:7], a[48:51], 0
    buffer_load_dwordx4 v17, s[20:23], s36 offen lds
    v_mfma_f32_16x16x32_bf16 v[144:147], a[8:11], a[48:51], 0
    s_add_u32 m0, s38, 151552
    v_mfma_f32_16x16x32_bf16 v[184:187], a[12:15], a[48:51], 0
    buffer_load_dwordx4 v18, s[20:23], s36 offen lds
    v_mfma_f32_16x16x32_bf16 v[68:71], a[0:3], a[52:55], 0
    s_add_u32 m0, s38, 155648
    v_mfma_f32_16x16x32_bf16 v[108:111], a[4:7], a[52:55], 0
    buffer_load_dwordx4 v19, s[20:23], s36 offen lds
    v_mfma_f32_16x16x32_bf16 v[148:151], a[8:11], a[52:55], 0
    v_mfma_f32_16x16x32_bf16 v[188:191], a[12:15], a[52:55], 0
    s_waitcnt lgkmcnt(0)
    s_waitcnt vmcnt(19)
    s_barrier
    v_mfma_f32_16x16x32_bf16 v[32:35], a[56:59], a[72:75], v[32:35]
    ds_read_b128 a[0:3], v20 offset:53248
    v_mfma_f32_16x16x32_bf16 v[72:75], a[60:63], a[72:75], v[72:75]
    ds_read_b128 a[4:7], v20 offset:55296
    v_mfma_f32_16x16x32_bf16 v[112:115], a[64:67], a[72:75], v[112:115]
    ds_read_b128 a[8:11], v20 offset:57344
    v_mfma_f32_16x16x32_bf16 v[152:155], a[68:71], a[72:75], v[152:155]
    ds_read_b128 a[12:15], v20 offset:59392
    v_mfma_f32_16x16x32_bf16 v[36:39], a[56:59], a[76:79], v[36:39]
    ds_read_b128 a[16:19], v22 offset:53248
    v_mfma_f32_16x16x32_bf16 v[76:79], a[60:63], a[76:79], v[76:79]
    ds_read_b128 a[20:23], v22 offset:55296
    v_mfma_f32_16x16x32_bf16 v[116:119], a[64:67], a[76:79], v[116:119]
    ds_read_b128 a[24:27], v22 offset:57344
    v_mfma_f32_16x16x32_bf16 v[156:159], a[68:71], a[76:79], v[156:159]
    ds_read_b128 a[28:31], v22 offset:59392
    v_mfma_f32_16x16x32_bf16 v[40:43], a[56:59], a[80:83], v[40:43]
    ds_read_b64_tr_b16 a[32:33], v24 offset:53248
    v_mfma_f32_16x16x32_bf16 v[80:83], a[60:63], a[80:83], v[80:83]
    ds_read_b64_tr_b16 a[34:35], v24 offset:53504
    v_mfma_f32_16x16x32_bf16 v[120:123], a[64:67], a[80:83], v[120:123]
    ds_read_b64_tr_b16 a[36:37], v25 offset:53248
    v_mfma_f32_16x16x32_bf16 v[160:163], a[68:71], a[80:83], v[160:163]
    ds_read_b64_tr_b16 a[38:39], v25 offset:53504
    v_mfma_f32_16x16x32_bf16 v[44:47], a[56:59], a[84:87], v[44:47]
    ds_read_b64_tr_b16 a[40:41], v24 offset:57344
    v_mfma_f32_16x16x32_bf16 v[84:87], a[60:63], a[84:87], v[84:87]
    ds_read_b64_tr_b16 a[42:43], v24 offset:57600
    v_mfma_f32_16x16x32_bf16 v[124:127], a[64:67], a[84:87], v[124:127]
    ds_read_b64_tr_b16 a[44:45], v25 offset:57344
    v_mfma_f32_16x16x32_bf16 v[164:167], a[68:71], a[84:87], v[164:167]
    ds_read_b64_tr_b16 a[46:47], v25 offset:57600
    v_mfma_f32_16x16x32_bf16 v[48:51], a[88:91], a[56:59], v[48:51]
    ds_read_b64_tr_b16 a[48:49], v24 offset:61440
    v_mfma_f32_16x16x32_bf16 v[88:91], a[88:91], a[60:63], v[88:91]
    ds_read_b64_tr_b16 a[50:51], v24 offset:61696
    v_mfma_f32_16x16x32_bf16 v[128:131], a[88:91], a[64:67], v[128:131]
    ds_read_b64_tr_b16 a[52:53], v25 offset:61440
    v_mfma_f32_16x16x32_bf16 v[168:171], a[88:91], a[68:71], v[168:171]
    ds_read_b64_tr_b16 a[54:55], v25 offset:61696
    v_mfma_f32_16x16x32_bf16 v[52:55], a[92:95], a[56:59], v[52:55]
    s_add_u32 s35, s41, 3
    v_mfma_f32_16x16x32_bf16 v[92:95], a[92:95], a[60:63], v[92:95]
    s_and_b32 s35, s35, 15
    v_mfma_f32_16x16x32_bf16 v[132:135], a[92:95], a[64:67], v[132:135]
    s_mul_i32 s36, s35, 393216
    v_mfma_f32_16x16x32_bf16 v[172:175], a[92:95], a[68:71], v[172:175]
    s_lshl_b32 s35, s35, 7
    v_mfma_f32_16x16x32_bf16 v[56:59], a[96:99], a[56:59], v[56:59]
    s_add_u32 m0, s37, 0
    v_mfma_f32_16x16x32_bf16 v[96:99], a[96:99], a[60:63], v[96:99]
    buffer_load_dwordx4 v8, s[8:11], s35 offen lds
    v_mfma_f32_16x16x32_bf16 v[136:139], a[96:99], a[64:67], v[136:139]
    s_add_u32 m0, s37, 1024
    v_mfma_f32_16x16x32_bf16 v[176:179], a[96:99], a[68:71], v[176:179]
    buffer_load_dwordx4 v9, s[8:11], s35 offen lds
    v_mfma_f32_16x16x32_bf16 v[60:63], a[100:103], a[56:59], v[60:63]
    s_add_u32 m0, s37, 2048
    v_mfma_f32_16x16x32_bf16 v[100:103], a[100:103], a[60:63], v[100:103]
    buffer_load_dwordx4 v10, s[8:11], s35 offen lds
    v_mfma_f32_16x16x32_bf16 v[140:143], a[100:103], a[64:67], v[140:143]
    s_add_u32 m0, s37, 3072
    v_mfma_f32_16x16x32_bf16 v[180:183], a[100:103], a[68:71], v[180:183]
    buffer_load_dwordx4 v11, s[8:11], s35 offen lds
    v_mfma_f32_16x16x32_bf16 v[64:67], a[56:59], a[104:107], v[64:67]
    s_add_u32 m0, s37, 4096
    v_mfma_f32_16x16x32_bf16 v[104:107], a[60:63], a[104:107], v[104:107]
    buffer_load_dwordx4 v12, s[8:11], s35 offen lds
    v_mfma_f32_16x16x32_bf16 v[144:147], a[64:67], a[104:107], v[144:147]
    s_add_u32 m0, s37, 5120
    v_mfma_f32_16x16x32_bf16 v[184:187], a[68:71], a[104:107], v[184:187]
    buffer_load_dwordx4 v13, s[8:11], s35 offen lds
    v_mfma_f32_16x16x32_bf16 v[68:71], a[56:59], a[108:111], v[68:71]
    v_mfma_f32_16x16x32_bf16 v[108:111], a[60:63], a[108:111], v[108:111]
    v_mfma_f32_16x16x32_bf16 v[148:151], a[64:67], a[108:111], v[148:151]
    v_mfma_f32_16x16x32_bf16 v[188:191], a[68:71], a[108:111], v[188:191]
    s_waitcnt lgkmcnt(0)
    v_mfma_f32_16x16x32_bf16 v[32:35], a[0:3], a[16:19], v[32:35]
    ds_read_b128 a[56:59], v21 offset:53248
    v_mfma_f32_16x16x32_bf16 v[72:75], a[4:7], a[16:19], v[72:75]
    ds_read_b128 a[60:63], v21 offset:55296
    v_mfma_f32_16x16x32_bf16 v[112:115], a[8:11], a[16:19], v[112:115]
    ds_read_b128 a[64:67], v21 offset:57344
    v_mfma_f32_16x16x32_bf16 v[152:155], a[12:15], a[16:19], v[152:155]
    ds_read_b128 a[68:71], v21 offset:59392
    v_mfma_f32_16x16x32_bf16 v[36:39], a[0:3], a[20:23], v[36:39]
    ds_read_b128 a[72:75], v23 offset:53248
    v_mfma_f32_16x16x32_bf16 v[76:79], a[4:7], a[20:23], v[76:79]
    ds_read_b128 a[76:79], v23 offset:55296
    v_mfma_f32_16x16x32_bf16 v[116:119], a[8:11], a[20:23], v[116:119]
    ds_read_b128 a[80:83], v23 offset:57344
    v_mfma_f32_16x16x32_bf16 v[156:159], a[12:15], a[20:23], v[156:159]
    ds_read_b128 a[84:87], v23 offset:59392
    v_mfma_f32_16x16x32_bf16 v[40:43], a[0:3], a[24:27], v[40:43]
    ds_read_b64_tr_b16 a[88:89], v24 offset:55296
    v_mfma_f32_16x16x32_bf16 v[80:83], a[4:7], a[24:27], v[80:83]
    ds_read_b64_tr_b16 a[90:91], v24 offset:55552
    v_mfma_f32_16x16x32_bf16 v[120:123], a[8:11], a[24:27], v[120:123]
    ds_read_b64_tr_b16 a[92:93], v25 offset:55296
    v_mfma_f32_16x16x32_bf16 v[160:163], a[12:15], a[24:27], v[160:163]
    ds_read_b64_tr_b16 a[94:95], v25 offset:55552
    v_mfma_f32_16x16x32_bf16 v[44:47], a[0:3], a[28:31], v[44:47]
    ds_read_b64_tr_b16 a[96:97], v24 offset:59392
    v_mfma_f32_16x16x32_bf16 v[84:87], a[4:7], a[28:31], v[84:87]
    ds_read_b64_tr_b16 a[98:99], v24 offset:59648
    v_mfma_f32_16x16x32_bf16 v[124:127], a[8:11], a[28:31], v[124:127]
    ds_read_b64_tr_b16 a[100:101], v25 offset:59392
    v_mfma_f32_16x16x32_bf16 v[164:167], a[12:15], a[28:31], v[164:167]
    ds_read_b64_tr_b16 a[102:103], v25 offset:59648
    v_mfma_f32_16x16x32_bf16 v[48:51], a[32:35], a[0:3], v[48:51]
    ds_read_b64_tr_b16 a[104:105], v24 offset:63488
    v_mfma_f32_16x16x32_bf16 v[88:91], a[32:35], a[4:7], v[88:91]
    ds_read_b64_tr_b16 a[106:107], v24 offset:63744
    v_mfma_f32_16x16x32_bf16 v[128:131], a[32:35], a[8:11], v[128:131]
    ds_read_b64_tr_b16 a[108:109], v25 offset:63488
    v_mfma_f32_16x16x32_bf16 v[168:171], a[32:35], a[12:15], v[168:171]
    ds_read_b64_tr_b16 a[110:111], v25 offset:63744
    v_mfma_f32_16x16x32_bf16 v[52:55], a[36:39], a[0:3], v[52:55]
    s_add_u32 m0, s37, 6144
    v_mfma_f32_16x16x32_bf16 v[92:95], a[36:39], a[4:7], v[92:95]
    buffer_load_dwordx4 v14, s[8:11], s35 offen lds
    v_mfma_f32_16x16x32_bf16 v[132:135], a[36:39], a[8:11], v[132:135]
    s_add_u32 m0, s37, 7168
    v_mfma_f32_16x16x32_bf16 v[172:175], a[36:39], a[12:15], v[172:175]
    buffer_load_dwordx4 v15, s[8:11], s35 offen lds
    v_mfma_f32_16x16x32_bf16 v[56:59], a[40:43], a[0:3], v[56:59]
    s_add_u32 m0, s38, 32768
    v_mfma_f32_16x16x32_bf16 v[96:99], a[40:43], a[4:7], v[96:99]
    buffer_load_dwordx4 v16, s[12:15], s35 offen lds
    v_mfma_f32_16x16x32_bf16 v[136:139], a[40:43], a[8:11], v[136:139]
    s_add_u32 m0, s38, 36864
    v_mfma_f32_16x16x32_bf16 v[176:179], a[40:43], a[12:15], v[176:179]
    buffer_load_dwordx4 v16, s[16:19], s35 offen lds
    v_mfma_f32_16x16x32_bf16 v[60:63], a[44:47], a[0:3], v[60:63]
    s_add_u32 m0, s38, 40960
    v_mfma_f32_16x16x32_bf16 v[100:103], a[44:47], a[4:7], v[100:103]
    buffer_load_dwordx4 v17, s[20:23], s36 offen lds
    v_mfma_f32_16x16x32_bf16 v[140:143], a[44:47], a[8:11], v[140:143]
    s_add_u32 m0, s38, 45056
    v_mfma_f32_16x16x32_bf16 v[180:183], a[44:47], a[12:15], v[180:183]
    buffer_load_dwordx4 v18, s[20:23], s36 offen lds
    v_mfma_f32_16x16x32_bf16 v[64:67], a[0:3], a[48:51], v[64:67]
    s_add_u32 m0, s38, 49152
    v_mfma_f32_16x16x32_bf16 v[104:107], a[4:7], a[48:51], v[104:107]
    buffer_load_dwordx4 v19, s[20:23], s36 offen lds
    v_mfma_f32_16x16x32_bf16 v[144:147], a[8:11], a[48:51], v[144:147]
    v_mfma_f32_16x16x32_bf16 v[184:187], a[12:15], a[48:51], v[184:187]
    v_mfma_f32_16x16x32_bf16 v[68:71], a[0:3], a[52:55], v[68:71]
    v_mfma_f32_16x16x32_bf16 v[108:111], a[4:7], a[52:55], v[108:111]
    v_mfma_f32_16x16x32_bf16 v[148:151], a[8:11], a[52:55], v[148:151]
    v_mfma_f32_16x16x32_bf16 v[188:191], a[12:15], a[52:55], v[188:191]
    s_waitcnt lgkmcnt(0)
    s_waitcnt vmcnt(13)
    s_barrier
    v_mfma_f32_16x16x32_bf16 v[32:35], a[56:59], a[72:75], v[32:35]
    ds_read_b128 a[0:3], v240 offset:0
    v_mfma_f32_16x16x32_bf16 v[72:75], a[60:63], a[72:75], v[72:75]
    ds_read_b128 a[4:7], v240 offset:2048
    v_mfma_f32_16x16x32_bf16 v[112:115], a[64:67], a[72:75], v[112:115]
    ds_read_b128 a[8:11], v240 offset:4096
    v_mfma_f32_16x16x32_bf16 v[152:155], a[68:71], a[72:75], v[152:155]
    ds_read_b128 a[12:15], v240 offset:6144
    v_mfma_f32_16x16x32_bf16 v[36:39], a[56:59], a[76:79], v[36:39]
    ds_read_b128 a[16:19], v242 offset:0
    v_mfma_f32_16x16x32_bf16 v[76:79], a[60:63], a[76:79], v[76:79]
    ds_read_b128 a[20:23], v242 offset:2048
    v_mfma_f32_16x16x32_bf16 v[116:119], a[64:67], a[76:79], v[116:119]
    ds_read_b128 a[24:27], v242 offset:4096
    v_mfma_f32_16x16x32_bf16 v[156:159], a[68:71], a[76:79], v[156:159]
    ds_read_b128 a[28:31], v242 offset:6144
    v_mfma_f32_16x16x32_bf16 v[40:43], a[56:59], a[80:83], v[40:43]
    ds_read_b64_tr_b16 a[32:33], v244 offset:0
    v_mfma_f32_16x16x32_bf16 v[80:83], a[60:63], a[80:83], v[80:83]
    ds_read_b64_tr_b16 a[34:35], v244 offset:256
    v_mfma_f32_16x16x32_bf16 v[120:123], a[64:67], a[80:83], v[120:123]
    ds_read_b64_tr_b16 a[36:37], v245 offset:0
    v_mfma_f32_16x16x32_bf16 v[160:163], a[68:71], a[80:83], v[160:163]
    ds_read_b64_tr_b16 a[38:39], v245 offset:256
    v_mfma_f32_16x16x32_bf16 v[44:47], a[56:59], a[84:87], v[44:47]
    ds_read_b64_tr_b16 a[40:41], v244 offset:4096
    v_mfma_f32_16x16x32_bf16 v[84:87], a[60:63], a[84:87], v[84:87]
    ds_read_b64_tr_b16 a[42:43], v244 offset:4352
    v_mfma_f32_16x16x32_bf16 v[124:127], a[64:67], a[84:87], v[124:127]
    ds_read_b64_tr_b16 a[44:45], v245 offset:4096
    v_mfma_f32_16x16x32_bf16 v[164:167], a[68:71], a[84:87], v[164:167]
    ds_read_b64_tr_b16 a[46:47], v245 offset:4352
    v_mfma_f32_16x16x32_bf16 v[48:51], a[88:91], a[56:59], v[48:51]
    ds_read_b64_tr_b16 a[48:49], v244 offset:8192
    v_mfma_f32_16x16x32_bf16 v[88:91], a[88:91], a[60:63], v[88:91]
    ds_read_b64_tr_b16 a[50:51], v244 offset:8448
    v_mfma_f32_16x16x32_bf16 v[128:131], a[88:91], a[64:67], v[128:131]
    ds_read_b64_tr_b16 a[52:53], v245 offset:8192
    v_mfma_f32_16x16x32_bf16 v[168:171], a[88:91], a[68:71], v[168:171]
    ds_read_b64_tr_b16 a[54:55], v245 offset:8448
    v_mfma_f32_16x16x32_bf16 v[52:55], a[92:95], a[56:59], v[52:55]
    s_add_u32 s35, s41, 4
    v_mfma_f32_16x16x32_bf16 v[92:95], a[92:95], a[60:63], v[92:95]
    s_and_b32 s35, s35, 15
    v_mfma_f32_16x16x32_bf16 v[132:135], a[92:95], a[64:67], v[132:135]
    s_mul_i32 s36, s35, 393216
    v_mfma_f32_16x16x32_bf16 v[172:175], a[92:95], a[68:71], v[172:175]
    s_lshl_b32 s35, s35, 7
    v_mfma_f32_16x16x32_bf16 v[56:59], a[96:99], a[56:59], v[56:59]
    s_add_u32 m0, s37, 53248
    v_mfma_f32_16x16x32_bf16 v[96:99], a[96:99], a[60:63], v[96:99]
    buffer_load_dwordx4 v8, s[8:11], s35 offen lds
    v_mfma_f32_16x16x32_bf16 v[136:139], a[96:99], a[64:67], v[136:139]
    s_add_u32 m0, s37, 54272
    v_mfma_f32_16x16x32_bf16 v[176:179], a[96:99], a[68:71], v[176:179]
    buffer_load_dwordx4 v9, s[8:11], s35 offen lds
    v_mfma_f32_16x16x32_bf16 v[60:63], a[100:103], a[56:59], v[60:63]
    s_add_u32 m0, s37, 55296
    v_mfma_f32_16x16x32_bf16 v[100:103], a[100:103], a[60:63], v[100:103]
    buffer_load_dwordx4 v10, s[8:11], s35 offen lds
    v_mfma_f32_16x16x32_bf16 v[140:143], a[100:103], a[64:67], v[140:143]
    s_add_u32 m0, s37, 56320
    v_mfma_f32_16x16x32_bf16 v[180:183], a[100:103], a[68:71], v[180:183]
    buffer_load_dwordx4 v11, s[8:11], s35 offen lds
    v_mfma_f32_16x16x32_bf16 v[64:67], a[56:59], a[104:107], v[64:67]
    s_add_u32 m0, s37, 57344
    v_mfma_f32_16x16x32_bf16 v[104:107], a[60:63], a[104:107], v[104:107]
    buffer_load_dwordx4 v12, s[8:11], s35 offen lds
    v_mfma_f32_16x16x32_bf16 v[144:147], a[64:67], a[104:107], v[144:147]
    s_add_u32 m0, s37, 58368
    v_mfma_f32_16x16x32_bf16 v[184:187], a[68:71], a[104:107], v[184:187]
    buffer_load_dwordx4 v13, s[8:11], s35 offen lds
    v_mfma_f32_16x16x32_bf16 v[68:71], a[56:59], a[108:111], v[68:71]
    v_mfma_f32_16x16x32_bf16 v[108:111], a[60:63], a[108:111], v[108:111]
    v_mfma_f32_16x16x32_bf16 v[148:151], a[64:67], a[108:111], v[148:151]
    v_mfma_f32_16x16x32_bf16 v[188:191], a[68:71], a[108:111], v[188:191]
    s_waitcnt lgkmcnt(0)
    v_mfma_f32_16x16x32_bf16 v[32:35], a[0:3], a[16:19], v[32:35]
    ds_read_b128 a[56:59], v241 offset:0
    v_mfma_f32_16x16x32_bf16 v[72:75], a[4:7], a[16:19], v[72:75]
    ds_read_b128 a[60:63], v241 offset:2048
    v_mfma_f32_16x16x32_bf16 v[112:115], a[8:11], a[16:19], v[112:115]
    ds_read_b128 a[64:67], v241 offset:4096
    v_mfma_f32_16x16x32_bf16 v[152:155], a[12:15], a[16:19], v[152:155]
    ds_read_b128 a[68:71], v241 offset:6144
    v_mfma_f32_16x16x32_bf16 v[36:39], a[0:3], a[20:23], v[36:39]
    ds_read_b128 a[72:75], v243 offset:0
    v_mfma_f32_16x16x32_bf16 v[76:79], a[4:7], a[20:23], v[76:79]
    ds_read_b128 a[76:79], v243 offset:2048
    v_mfma_f32_16x16x32_bf16 v[116:119], a[8:11], a[20:23], v[116:119]
    ds_read_b128 a[80:83], v243 offset:4096
    v_mfma_f32_16x16x32_bf16 v[156:159], a[12:15], a[20:23], v[156:159]
    ds_read_b128 a[84:87], v243 offset:6144
    v_mfma_f32_16x16x32_bf16 v[40:43], a[0:3], a[24:27], v[40:43]
    ds_read_b64_tr_b16 a[88:89], v244 offset:2048
    v_mfma_f32_16x16x32_bf16 v[80:83], a[4:7], a[24:27], v[80:83]
    ds_read_b64_tr_b16 a[90:91], v244 offset:2304
    v_mfma_f32_16x16x32_bf16 v[120:123], a[8:11], a[24:27], v[120:123]
    ds_read_b64_tr_b16 a[92:93], v245 offset:2048
    v_mfma_f32_16x16x32_bf16 v[160:163], a[12:15], a[24:27], v[160:163]
    ds_read_b64_tr_b16 a[94:95], v245 offset:2304
    v_mfma_f32_16x16x32_bf16 v[44:47], a[0:3], a[28:31], v[44:47]
    ds_read_b64_tr_b16 a[96:97], v244 offset:6144
    v_mfma_f32_16x16x32_bf16 v[84:87], a[4:7], a[28:31], v[84:87]
    ds_read_b64_tr_b16 a[98:99], v244 offset:6400
    v_mfma_f32_16x16x32_bf16 v[124:127], a[8:11], a[28:31], v[124:127]
    ds_read_b64_tr_b16 a[100:101], v245 offset:6144
    v_mfma_f32_16x16x32_bf16 v[164:167], a[12:15], a[28:31], v[164:167]
    ds_read_b64_tr_b16 a[102:103], v245 offset:6400
    v_mfma_f32_16x16x32_bf16 v[48:51], a[32:35], a[0:3], v[48:51]
    ds_read_b64_tr_b16 a[104:105], v244 offset:10240
    v_mfma_f32_16x16x32_bf16 v[88:91], a[32:35], a[4:7], v[88:91]
    ds_read_b64_tr_b16 a[106:107], v244 offset:10496
    v_mfma_f32_16x16x32_bf16 v[128:131], a[32:35], a[8:11], v[128:131]
    ds_read_b64_tr_b16 a[108:109], v245 offset:10240
    v_mfma_f32_16x16x32_bf16 v[168:171], a[32:35], a[12:15], v[168:171]
    ds_read_b64_tr_b16 a[110:111], v245 offset:10496
    v_mfma_f32_16x16x32_bf16 v[52:55], a[36:39], a[0:3], v[52:55]
    s_add_u32 m0, s37, 59392
    v_mfma_f32_16x16x32_bf16 v[92:95], a[36:39], a[4:7], v[92:95]
    buffer_load_dwordx4 v14, s[8:11], s35 offen lds
    v_mfma_f32_16x16x32_bf16 v[132:135], a[36:39], a[8:11], v[132:135]
    s_add_u32 m0, s37, 60416
    v_mfma_f32_16x16x32_bf16 v[172:175], a[36:39], a[12:15], v[172:175]
    buffer_load_dwordx4 v15, s[8:11], s35 offen lds
    v_mfma_f32_16x16x32_bf16 v[56:59], a[40:43], a[0:3], v[56:59]
    s_add_u32 m0, s38, 86016
    v_mfma_f32_16x16x32_bf16 v[96:99], a[40:43], a[4:7], v[96:99]
    buffer_load_dwordx4 v16, s[12:15], s35 offen lds
    v_mfma_f32_16x16x32_bf16 v[136:139], a[40:43], a[8:11], v[136:139]
    s_add_u32 m0, s38, 90112
    v_mfma_f32_16x16x32_bf16 v[176:179], a[40:43], a[12:15], v[176:179]
    buffer_load_dwordx4 v16, s[16:19], s35 offen lds
    v_mfma_f32_16x16x32_bf16 v[60:63], a[44:47], a[0:3], v[60:63]
    s_add_u32 m0, s38, 94208
    v_mfma_f32_16x16x32_bf16 v[100:103], a[44:47], a[4:7], v[100:103]
    buffer_load_dwordx4 v17, s[20:23], s36 offen lds
    v_mfma_f32_16x16x32_bf16 v[140:143], a[44:47], a[8:11], v[140:143]
    s_add_u32 m0, s38, 98304
    v_mfma_f32_16x16x32_bf16 v[180:183], a[44:47], a[12:15], v[180:183]
    buffer_load_dwordx4 v18, s[20:23], s36 offen lds
    v_mfma_f32_16x16x32_bf16 v[64:67], a[0:3], a[48:51], v[64:67]
    s_add_u32 m0, s38, 102400
    v_mfma_f32_16x16x32_bf16 v[104:107], a[4:7], a[48:51], v[104:107]
    buffer_load_dwordx4 v19, s[20:23], s36 offen lds
    v_mfma_f32_16x16x32_bf16 v[144:147], a[8:11], a[48:51], v[144:147]
    v_mfma_f32_16x16x32_bf16 v[184:187], a[12:15], a[48:51], v[184:187]
    v_mfma_f32_16x16x32_bf16 v[68:71], a[0:3], a[52:55], v[68:71]
    v_mfma_f32_16x16x32_bf16 v[108:111], a[4:7], a[52:55], v[108:111]
    v_mfma_f32_16x16x32_bf16 v[148:151], a[8:11], a[52:55], v[148:151]
    v_mfma_f32_16x16x32_bf16 v[188:191], a[12:15], a[52:55], v[188:191]
    s_waitcnt lgkmcnt(0)
    s_waitcnt vmcnt(13)
    s_barrier
    v_mfma_f32_16x16x32_bf16 v[32:35], a[56:59], a[72:75], v[32:35]
    ds_read_b128 a[0:3], v20 offset:0
    s_waitcnt vmcnt(39)
    v_mfma_f32_16x16x32_bf16 v[72:75], a[60:63], a[72:75], v[72:75]
    ds_read_b128 a[4:7], v20 offset:2048
    v_lshlrev_b32 v216, 16, v208
    v_mfma_f32_16x16x32_bf16 v[112:115], a[64:67], a[72:75], v[112:115]
    ds_read_b128 a[8:11], v20 offset:4096
    v_and_b32 v217, 0xffff0000, v208
    v_mfma_f32_16x16x32_bf16 v[152:155], a[68:71], a[72:75], v[152:155]
    ds_read_b128 a[12:15], v20 offset:6144
    v_lshlrev_b32 v218, 16, v209
    v_mfma_f32_16x16x32_bf16 v[36:39], a[56:59], a[76:79], v[36:39]
    ds_read_b128 a[16:19], v22 offset:0
    v_and_b32 v219, 0xffff0000, v209
    v_mfma_f32_16x16x32_bf16 v[76:79], a[60:63], a[76:79], v[76:79]
    ds_read_b128 a[20:23], v22 offset:2048
    v_lshlrev_b32 v220, 16, v210
    v_mfma_f32_16x16x32_bf16 v[116:119], a[64:67], a[76:79], v[116:119]
    ds_read_b128 a[24:27], v22 offset:4096
    v_and_b32 v221, 0xffff0000, v210
    v_mfma_f32_16x16x32_bf16 v[156:159], a[68:71], a[76:79], v[156:159]
    ds_read_b128 a[28:31], v22 offset:6144
    v_lshlrev_b32 v222, 16, v211
    v_mfma_f32_16x16x32_bf16 v[40:43], a[56:59], a[80:83], v[40:43]
    ds_read_b64_tr_b16 a[32:33], v24 offset:0
    v_and_b32 v223, 0xffff0000, v211
    v_mfma_f32_16x16x32_bf16 v[80:83], a[60:63], a[80:83], v[80:83]
    ds_read_b64_tr_b16 a[34:35], v24 offset:256
    v_lshlrev_b32 v224, 16, v212
    v_mfma_f32_16x16x32_bf16 v[120:123], a[64:67], a[80:83], v[120:123]
    ds_read_b64_tr_b16 a[36:37], v25 offset:0
    v_mfma_f32_16x16x32_bf16 v[160:163], a[68:71], a[80:83], v[160:163]
    ds_read_b64_tr_b16 a[38:39], v25 offset:256
    v_mfma_f32_16x16x32_bf16 v[44:47], a[56:59], a[84:87], v[44:47]
    ds_read_b64_tr_b16 a[40:41], v24 offset:4096
    v_mfma_f32_16x16x32_bf16 v[84:87], a[60:63], a[84:87], v[84:87]
    ds_read_b64_tr_b16 a[42:43], v24 offset:4352
    v_mfma_f32_16x16x32_bf16 v[124:127], a[64:67], a[84:87], v[124:127]
    ds_read_b64_tr_b16 a[44:45], v25 offset:4096
    v_mfma_f32_16x16x32_bf16 v[164:167], a[68:71], a[84:87], v[164:167]
    ds_read_b64_tr_b16 a[46:47], v25 offset:4352
    v_mfma_f32_16x16x32_bf16 v[48:51], a[88:91], a[56:59], v[48:51]
    ds_read_b64_tr_b16 a[48:49], v24 offset:8192
    v_mfma_f32_16x16x32_bf16 v[88:91], a[88:91], a[60:63], v[88:91]
    ds_read_b64_tr_b16 a[50:51], v24 offset:8448
    v_mfma_f32_16x16x32_bf16 v[128:131], a[88:91], a[64:67], v[128:131]
    ds_read_b64_tr_b16 a[52:53], v25 offset:8192
    v_mfma_f32_16x16x32_bf16 v[168:171], a[88:91], a[68:71], v[168:171]
    ds_read_b64_tr_b16 a[54:55], v25 offset:8448
    v_mfma_f32_16x16x32_bf16 v[52:55], a[92:95], a[56:59], v[52:55]
    s_add_u32 s35, s41, 5
    v_mfma_f32_16x16x32_bf16 v[92:95], a[92:95], a[60:63], v[92:95]
    s_and_b32 s35, s35, 15
    v_mfma_f32_16x16x32_bf16 v[132:135], a[92:95], a[64:67], v[132:135]
    s_mul_i32 s36, s35, 393216
    v_mfma_f32_16x16x32_bf16 v[172:175], a[92:95], a[68:71], v[172:175]
    s_lshl_b32 s35, s35, 7
    v_mfma_f32_16x16x32_bf16 v[56:59], a[96:99], a[56:59], v[56:59]
    s_add_u32 m0, s37, 106496
    v_mfma_f32_16x16x32_bf16 v[96:99], a[96:99], a[60:63], v[96:99]
    buffer_load_dwordx4 v8, s[8:11], s35 offen lds
    v_mfma_f32_16x16x32_bf16 v[136:139], a[96:99], a[64:67], v[136:139]
    s_add_u32 m0, s37, 107520
    v_mfma_f32_16x16x32_bf16 v[176:179], a[96:99], a[68:71], v[176:179]
    buffer_load_dwordx4 v9, s[8:11], s35 offen lds
    v_mfma_f32_16x16x32_bf16 v[60:63], a[100:103], a[56:59], v[60:63]
    s_add_u32 m0, s37, 108544
    v_mfma_f32_16x16x32_bf16 v[100:103], a[100:103], a[60:63], v[100:103]
    buffer_load_dwordx4 v10, s[8:11], s35 offen lds
    v_mfma_f32_16x16x32_bf16 v[140:143], a[100:103], a[64:67], v[140:143]
    s_add_u32 m0, s37, 109568
    v_mfma_f32_16x16x32_bf16 v[180:183], a[100:103], a[68:71], v[180:183]
    buffer_load_dwordx4 v11, s[8:11], s35 offen lds
    v_mfma_f32_16x16x32_bf16 v[64:67], a[56:59], a[104:107], v[64:67]
    s_add_u32 m0, s37, 110592
    v_mfma_f32_16x16x32_bf16 v[104:107], a[60:63], a[104:107], v[104:107]
    buffer_load_dwordx4 v12, s[8:11], s35 offen lds
    v_mfma_f32_16x16x32_bf16 v[144:147], a[64:67], a[104:107], v[144:147]
    s_add_u32 m0, s37, 111616
    v_mfma_f32_16x16x32_bf16 v[184:187], a[68:71], a[104:107], v[184:187]
    buffer_load_dwordx4 v13, s[8:11], s35 offen lds
    v_mfma_f32_16x16x32_bf16 v[68:71], a[56:59], a[108:111], v[68:71]
    v_mfma_f32_16x16x32_bf16 v[108:111], a[60:63], a[108:111], v[108:111]
    v_mfma_f32_16x16x32_bf16 v[148:151], a[64:67], a[108:111], v[148:151]
    v_mfma_f32_16x16x32_bf16 v[188:191], a[68:71], a[108:111], v[188:191]
    s_waitcnt lgkmcnt(0)
    v_mfma_f32_16x16x32_bf16 v[32:35], a[0:3], a[16:19], v[32:35]
    ds_read_b128 a[56:59], v21 offset:0
    v_and_b32 v225, 0xffff0000, v212
    v_mfma_f32_16x16x32_bf16 v[72:75], a[4:7], a[16:19], v[72:75]
    ds_read_b128 a[60:63], v21 offset:2048
    v_lshlrev_b32 v226, 16, v213
    v_mfma_f32_16x16x32_bf16 v[112:115], a[8:11], a[16:19], v[112:115]
    ds_read_b128 a[64:67], v21 offset:4096
    v_and_b32 v227, 0xffff0000, v213
    v_mfma_f32_16x16x32_bf16 v[152:155], a[12:15], a[16:19], v[152:155]
    ds_read_b128 a[68:71], v21 offset:6144
    v_lshlrev_b32 v228, 16, v214
    v_mfma_f32_16x16x32_bf16 v[36:39], a[0:3], a[20:23], v[36:39]
    ds_read_b128 a[72:75], v23 offset:0
    v_and_b32 v229, 0xffff0000, v214
    v_mfma_f32_16x16x32_bf16 v[76:79], a[4:7], a[20:23], v[76:79]
    ds_read_b128 a[76:79], v23 offset:2048
    v_lshlrev_b32 v230, 16, v215
    v_mfma_f32_16x16x32_bf16 v[116:119], a[8:11], a[20:23], v[116:119]
    ds_read_b128 a[80:83], v23 offset:4096
    v_and_b32 v231, 0xffff0000, v215
    v_mfma_f32_16x16x32_bf16 v[156:159], a[12:15], a[20:23], v[156:159]
    ds_read_b128 a[84:87], v23 offset:6144
    v_mov_b32 v236, 0
    v_mfma_f32_16x16x32_bf16 v[40:43], a[0:3], a[24:27], v[40:43]
    ds_read_b64_tr_b16 a[88:89], v24 offset:2048
    v_mov_b32 v237, 0
    v_mfma_f32_16x16x32_bf16 v[80:83], a[4:7], a[24:27], v[80:83]
    ds_read_b64_tr_b16 a[90:91], v24 offset:2304
    v_lshlrev_b32 v232, 16, v192
    v_mfma_f32_16x16x32_bf16 v[120:123], a[8:11], a[24:27], v[120:123]
    ds_read_b64_tr_b16 a[92:93], v25 offset:2048
    v_mfma_f32_16x16x32_bf16 v[160:163], a[12:15], a[24:27], v[160:163]
    ds_read_b64_tr_b16 a[94:95], v25 offset:2304
    v_mfma_f32_16x16x32_bf16 v[44:47], a[0:3], a[28:31], v[44:47]
    ds_read_b64_tr_b16 a[96:97], v24 offset:6144
    v_mfma_f32_16x16x32_bf16 v[84:87], a[4:7], a[28:31], v[84:87]
    ds_read_b64_tr_b16 a[98:99], v24 offset:6400
    v_mfma_f32_16x16x32_bf16 v[124:127], a[8:11], a[28:31], v[124:127]
    ds_read_b64_tr_b16 a[100:101], v25 offset:6144
    v_mfma_f32_16x16x32_bf16 v[164:167], a[12:15], a[28:31], v[164:167]
    ds_read_b64_tr_b16 a[102:103], v25 offset:6400
    v_mfma_f32_16x16x32_bf16 v[48:51], a[32:35], a[0:3], v[48:51]
    ds_read_b64_tr_b16 a[104:105], v24 offset:10240
    v_mfma_f32_16x16x32_bf16 v[88:91], a[32:35], a[4:7], v[88:91]
    ds_read_b64_tr_b16 a[106:107], v24 offset:10496
    v_mfma_f32_16x16x32_bf16 v[128:131], a[32:35], a[8:11], v[128:131]
    ds_read_b64_tr_b16 a[108:109], v25 offset:10240
    v_mfma_f32_16x16x32_bf16 v[168:171], a[32:35], a[12:15], v[168:171]
    ds_read_b64_tr_b16 a[110:111], v25 offset:10496
    v_mfma_f32_16x16x32_bf16 v[52:55], a[36:39], a[0:3], v[52:55]
    s_add_u32 m0, s37, 112640
    v_mfma_f32_16x16x32_bf16 v[92:95], a[36:39], a[4:7], v[92:95]
    buffer_load_dwordx4 v14, s[8:11], s35 offen lds
    v_mfma_f32_16x16x32_bf16 v[132:135], a[36:39], a[8:11], v[132:135]
    s_add_u32 m0, s37, 113664
    v_mfma_f32_16x16x32_bf16 v[172:175], a[36:39], a[12:15], v[172:175]
    buffer_load_dwordx4 v15, s[8:11], s35 offen lds
    v_mfma_f32_16x16x32_bf16 v[56:59], a[40:43], a[0:3], v[56:59]
    s_add_u32 m0, s38, 139264
    v_mfma_f32_16x16x32_bf16 v[96:99], a[40:43], a[4:7], v[96:99]
    buffer_load_dwordx4 v16, s[12:15], s35 offen lds
    v_mfma_f32_16x16x32_bf16 v[136:139], a[40:43], a[8:11], v[136:139]
    s_add_u32 m0, s38, 143360
    v_mfma_f32_16x16x32_bf16 v[176:179], a[40:43], a[12:15], v[176:179]
    buffer_load_dwordx4 v16, s[16:19], s35 offen lds
    v_mfma_f32_16x16x32_bf16 v[60:63], a[44:47], a[0:3], v[60:63]
    s_add_u32 m0, s38, 147456
    v_mfma_f32_16x16x32_bf16 v[100:103], a[44:47], a[4:7], v[100:103]
    buffer_load_dwordx4 v17, s[20:23], s36 offen lds
    v_mfma_f32_16x16x32_bf16 v[140:143], a[44:47], a[8:11], v[140:143]
    s_add_u32 m0, s38, 151552
    v_mfma_f32_16x16x32_bf16 v[180:183], a[44:47], a[12:15], v[180:183]
    buffer_load_dwordx4 v18, s[20:23], s36 offen lds
    v_mfma_f32_16x16x32_bf16 v[64:67], a[0:3], a[48:51], v[64:67]
    s_add_u32 m0, s38, 155648
    v_mfma_f32_16x16x32_bf16 v[104:107], a[4:7], a[48:51], v[104:107]
    buffer_load_dwordx4 v19, s[20:23], s36 offen lds
    v_mfma_f32_16x16x32_bf16 v[144:147], a[8:11], a[48:51], v[144:147]
    v_mfma_f32_16x16x32_bf16 v[184:187], a[12:15], a[48:51], v[184:187]
    v_mfma_f32_16x16x32_bf16 v[68:71], a[0:3], a[52:55], v[68:71]
    v_mfma_f32_16x16x32_bf16 v[108:111], a[4:7], a[52:55], v[108:111]
    v_mfma_f32_16x16x32_bf16 v[148:151], a[8:11], a[52:55], v[148:151]
    v_mfma_f32_16x16x32_bf16 v[188:191], a[12:15], a[52:55], v[188:191]
    s_waitcnt lgkmcnt(0)
    s_waitcnt vmcnt(13)
    s_barrier
    v_mfma_f32_16x16x32_bf16 v[32:35], a[56:59], a[72:75], v[32:35]
    ds_read_b128 a[0:3], v20 offset:53248
    v_and_b32 v233, 0xffff0000, v192
    v_mfma_f32_16x16x32_bf16 v[72:75], a[60:63], a[72:75], v[72:75]
    ds_read_b128 a[4:7], v20 offset:55296
    v_mul_f32 v232, v232, v216
    v_mfma_f32_16x16x32_bf16 v[112:115], a[64:67], a[72:75], v[112:115]
    ds_read_b128 a[8:11], v20 offset:57344
    v_mul_f32 v233, v233, v217
    v_mfma_f32_16x16x32_bf16 v[152:155], a[68:71], a[72:75], v[152:155]
    ds_read_b128 a[12:15], v20 offset:59392
    v_cvt_pk_bf16_f32 v234, v232, v233
    v_mfma_f32_16x16x32_bf16 v[36:39], a[56:59], a[76:79], v[36:39]
    ds_read_b128 a[16:19], v22 offset:53248
    v_lshlrev_b32 v232, 16, v234
    v_mfma_f32_16x16x32_bf16 v[76:79], a[60:63], a[76:79], v[76:79]
    ds_read_b128 a[20:23], v22 offset:55296
    v_and_b32 v233, 0xffff0000, v234
    v_mfma_f32_16x16x32_bf16 v[116:119], a[64:67], a[76:79], v[116:119]
    ds_read_b128 a[24:27], v22 offset:57344
    v_add_f32 v236, v236, v232
    v_mfma_f32_16x16x32_bf16 v[156:159], a[68:71], a[76:79], v[156:159]
    ds_read_b128 a[28:31], v22 offset:59392
    v_add_f32 v236, v236, v233
    v_mfma_f32_16x16x32_bf16 v[40:43], a[56:59], a[80:83], v[40:43]
    ds_read_b64_tr_b16 a[32:33], v24 offset:53248
    v_lshlrev_b32 v232, 16, v193
    v_mfma_f32_16x16x32_bf16 v[80:83], a[60:63], a[80:83], v[80:83]
    ds_read_b64_tr_b16 a[34:35], v24 offset:53504
    v_and_b32 v233, 0xffff0000, v193
    v_mfma_f32_16x16x32_bf16 v[120:123], a[64:67], a[80:83], v[120:123]
    ds_read_b64_tr_b16 a[36:37], v25 offset:53248
    v_mfma_f32_16x16x32_bf16 v[160:163], a[68:71], a[80:83], v[160:163]
    ds_read_b64_tr_b16 a[38:39], v25 offset:53504
    v_mfma_f32_16x16x32_bf16 v[44:47], a[56:59], a[84:87], v[44:47]
    ds_read_b64_tr_b16 a[40:41], v24 offset:57344
    v_mfma_f32_16x16x32_bf16 v[84:87], a[60:63], a[84:87], v[84:87]
    ds_read_b64_tr_b16 a[42:43], v24 offset:57600
    v_mfma_f32_16x16x32_bf16 v[124:127], a[64:67], a[84:87], v[124:127]
    ds_read_b64_tr_b16 a[44:45], v25 offset:57344
    v_mfma_f32_16x16x32_bf16 v[164:167], a[68:71], a[84:87], v[164:167]
    ds_read_b64_tr_b16 a[46:47], v25 offset:57600
    v_mfma_f32_16x16x32_bf16 v[48:51], a[88:91], a[56:59], v[48:51]
    ds_read_b64_tr_b16 a[48:49], v24 offset:61440
    v_mfma_f32_16x16x32_bf16 v[88:91], a[88:91], a[60:63], v[88:91]
    ds_read_b64_tr_b16 a[50:51], v24 offset:61696
    v_mfma_f32_16x16x32_bf16 v[128:131], a[88:91], a[64:67], v[128:131]
    ds_read_b64_tr_b16 a[52:53], v25 offset:61440
    v_mfma_f32_16x16x32_bf16 v[168:171], a[88:91], a[68:71], v[168:171]
    ds_read_b64_tr_b16 a[54:55], v25 offset:61696
    v_mfma_f32_16x16x32_bf16 v[52:55], a[92:95], a[56:59], v[52:55]
    s_add_u32 s35, s41, 6
    v_mfma_f32_16x16x32_bf16 v[92:95], a[92:95], a[60:63], v[92:95]
    s_and_b32 s35, s35, 15
    v_mfma_f32_16x16x32_bf16 v[132:135], a[92:95], a[64:67], v[132:135]
    s_mul_i32 s36, s35, 393216
    v_mfma_f32_16x16x32_bf16 v[172:175], a[92:95], a[68:71], v[172:175]
    s_lshl_b32 s35, s35, 7
    v_mfma_f32_16x16x32_bf16 v[56:59], a[96:99], a[56:59], v[56:59]
    s_add_u32 m0, s37, 0
    v_mfma_f32_16x16x32_bf16 v[96:99], a[96:99], a[60:63], v[96:99]
    buffer_load_dwordx4 v8, s[8:11], s35 offen lds
    v_mfma_f32_16x16x32_bf16 v[136:139], a[96:99], a[64:67], v[136:139]
    s_add_u32 m0, s37, 1024
    v_mfma_f32_16x16x32_bf16 v[176:179], a[96:99], a[68:71], v[176:179]
    buffer_load_dwordx4 v9, s[8:11], s35 offen lds
    v_mfma_f32_16x16x32_bf16 v[60:63], a[100:103], a[56:59], v[60:63]
    s_add_u32 m0, s37, 2048
    v_mfma_f32_16x16x32_bf16 v[100:103], a[100:103], a[60:63], v[100:103]
    buffer_load_dwordx4 v10, s[8:11], s35 offen lds
    v_mfma_f32_16x16x32_bf16 v[140:143], a[100:103], a[64:67], v[140:143]
    s_add_u32 m0, s37, 3072
    v_mfma_f32_16x16x32_bf16 v[180:183], a[100:103], a[68:71], v[180:183]
    buffer_load_dwordx4 v11, s[8:11], s35 offen lds
    v_mfma_f32_16x16x32_bf16 v[64:67], a[56:59], a[104:107], v[64:67]
    s_add_u32 m0, s37, 4096
    v_mfma_f32_16x16x32_bf16 v[104:107], a[60:63], a[104:107], v[104:107]
    buffer_load_dwordx4 v12, s[8:11], s35 offen lds
    v_mfma_f32_16x16x32_bf16 v[144:147], a[64:67], a[104:107], v[144:147]
    s_add_u32 m0, s37, 5120
    v_mfma_f32_16x16x32_bf16 v[184:187], a[68:71], a[104:107], v[184:187]
    buffer_load_dwordx4 v13, s[8:11], s35 offen lds
    v_mfma_f32_16x16x32_bf16 v[68:71], a[56:59], a[108:111], v[68:71]
    v_mfma_f32_16x16x32_bf16 v[108:111], a[60:63], a[108:111], v[108:111]
    v_mfma_f32_16x16x32_bf16 v[148:151], a[64:67], a[108:111], v[148:151]
    v_mfma_f32_16x16x32_bf16 v[188:191], a[68:71], a[108:111], v[188:191]
    s_waitcnt lgkmcnt(0)
    v_mfma_f32_16x16x32_bf16 v[32:35], a[0:3], a[16:19], v[32:35]
    ds_read_b128 a[56:59], v21 offset:53248
    v_mul_f32 v232, v232, v218
    v_mfma_f32_16x16x32_bf16 v[72:75], a[4:7], a[16:19], v[72:75]
    ds_read_b128 a[60:63], v21 offset:55296
    v_mul_f32 v233, v233, v219
    v_mfma_f32_16x16x32_bf16 v[112:115], a[8:11], a[16:19], v[112:115]
    ds_read_b128 a[64:67], v21 offset:57344
    v_cvt_pk_bf16_f32 v234, v232, v233
    v_mfma_f32_16x16x32_bf16 v[152:155], a[12:15], a[16:19], v[152:155]
    ds_read_b128 a[68:71], v21 offset:59392
    v_lshlrev_b32 v232, 16, v234
    v_mfma_f32_16x16x32_bf16 v[36:39], a[0:3], a[20:23], v[36:39]
    ds_read_b128 a[72:75], v23 offset:53248
    v_and_b32 v233, 0xffff0000, v234
    v_mfma_f32_16x16x32_bf16 v[76:79], a[4:7], a[20:23], v[76:79]
    ds_read_b128 a[76:79], v23 offset:55296
    v_add_f32 v236, v236, v232
    v_mfma_f32_16x16x32_bf16 v[116:119], a[8:11], a[20:23], v[116:119]
    ds_read_b128 a[80:83], v23 offset:57344
    v_add_f32 v236, v236, v233
    v_mfma_f32_16x16x32_bf16 v[156:159], a[12:15], a[20:23], v[156:159]
    ds_read_b128 a[84:87], v23 offset:59392
    v_lshlrev_b32 v232, 16, v194
    v_mfma_f32_16x16x32_bf16 v[40:43], a[0:3], a[24:27], v[40:43]
    ds_read_b64_tr_b16 a[88:89], v24 offset:55296
    v_and_b32 v233, 0xffff0000, v194
    v_mfma_f32_16x16x32_bf16 v[80:83], a[4:7], a[24:27], v[80:83]
    ds_read_b64_tr_b16 a[90:91], v24 offset:55552
    v_mul_f32 v232, v232, v220
    v_mfma_f32_16x16x32_bf16 v[120:123], a[8:11], a[24:27], v[120:123]
    ds_read_b64_tr_b16 a[92:93], v25 offset:55296
    v_mfma_f32_16x16x32_bf16 v[160:163], a[12:15], a[24:27], v[160:163]
    ds_read_b64_tr_b16 a[94:95], v25 offset:55552
    v_mfma_f32_16x16x32_bf16 v[44:47], a[0:3], a[28:31], v[44:47]
    ds_read_b64_tr_b16 a[96:97], v24 offset:59392
    v_mfma_f32_16x16x32_bf16 v[84:87], a[4:7], a[28:31], v[84:87]
    ds_read_b64_tr_b16 a[98:99], v24 offset:59648
    v_mfma_f32_16x16x32_bf16 v[124:127], a[8:11], a[28:31], v[124:127]
    ds_read_b64_tr_b16 a[100:101], v25 offset:59392
    v_mfma_f32_16x16x32_bf16 v[164:167], a[12:15], a[28:31], v[164:167]
    ds_read_b64_tr_b16 a[102:103], v25 offset:59648
    v_mfma_f32_16x16x32_bf16 v[48:51], a[32:35], a[0:3], v[48:51]
    ds_read_b64_tr_b16 a[104:105], v24 offset:63488
    v_mfma_f32_16x16x32_bf16 v[88:91], a[32:35], a[4:7], v[88:91]
    ds_read_b64_tr_b16 a[106:107], v24 offset:63744
    v_mfma_f32_16x16x32_bf16 v[128:131], a[32:35], a[8:11], v[128:131]
    ds_read_b64_tr_b16 a[108:109], v25 offset:63488
    v_mfma_f32_16x16x32_bf16 v[168:171], a[32:35], a[12:15], v[168:171]
    ds_read_b64_tr_b16 a[110:111], v25 offset:63744
    v_mfma_f32_16x16x32_bf16 v[52:55], a[36:39], a[0:3], v[52:55]
    s_add_u32 m0, s37, 6144
    v_mfma_f32_16x16x32_bf16 v[92:95], a[36:39], a[4:7], v[92:95]
    buffer_load_dwordx4 v14, s[8:11], s35 offen lds
    v_mfma_f32_16x16x32_bf16 v[132:135], a[36:39], a[8:11], v[132:135]
    s_add_u32 m0, s37, 7168
    v_mfma_f32_16x16x32_bf16 v[172:175], a[36:39], a[12:15], v[172:175]
    buffer_load_dwordx4 v15, s[8:11], s35 offen lds
    v_mfma_f32_16x16x32_bf16 v[56:59], a[40:43], a[0:3], v[56:59]
    s_add_u32 m0, s38, 32768
    v_mfma_f32_16x16x32_bf16 v[96:99], a[40:43], a[4:7], v[96:99]
    buffer_load_dwordx4 v16, s[12:15], s35 offen lds
    v_mfma_f32_16x16x32_bf16 v[136:139], a[40:43], a[8:11], v[136:139]
    s_add_u32 m0, s38, 36864
    v_mfma_f32_16x16x32_bf16 v[176:179], a[40:43], a[12:15], v[176:179]
    buffer_load_dwordx4 v16, s[16:19], s35 offen lds
    v_mfma_f32_16x16x32_bf16 v[60:63], a[44:47], a[0:3], v[60:63]
    s_add_u32 m0, s38, 40960
    v_mfma_f32_16x16x32_bf16 v[100:103], a[44:47], a[4:7], v[100:103]
    buffer_load_dwordx4 v17, s[20:23], s36 offen lds
    v_mfma_f32_16x16x32_bf16 v[140:143], a[44:47], a[8:11], v[140:143]
    s_add_u32 m0, s38, 45056
    v_mfma_f32_16x16x32_bf16 v[180:183], a[44:47], a[12:15], v[180:183]
    buffer_load_dwordx4 v18, s[20:23], s36 offen lds
    v_mfma_f32_16x16x32_bf16 v[64:67], a[0:3], a[48:51], v[64:67]
    s_add_u32 m0, s38, 49152
    v_mfma_f32_16x16x32_bf16 v[104:107], a[4:7], a[48:51], v[104:107]
    buffer_load_dwordx4 v19, s[20:23], s36 offen lds
    v_mfma_f32_16x16x32_bf16 v[144:147], a[8:11], a[48:51], v[144:147]
    v_mfma_f32_16x16x32_bf16 v[184:187], a[12:15], a[48:51], v[184:187]
    v_mfma_f32_16x16x32_bf16 v[68:71], a[0:3], a[52:55], v[68:71]
    v_mfma_f32_16x16x32_bf16 v[108:111], a[4:7], a[52:55], v[108:111]
    v_mfma_f32_16x16x32_bf16 v[148:151], a[8:11], a[52:55], v[148:151]
    v_mfma_f32_16x16x32_bf16 v[188:191], a[12:15], a[52:55], v[188:191]
    s_waitcnt lgkmcnt(0)
    s_waitcnt vmcnt(13)
    s_barrier
    v_mfma_f32_16x16x32_bf16 v[32:35], a[56:59], a[72:75], v[32:35]
    ds_read_b128 a[0:3], v240 offset:0
    v_mul_f32 v233, v233, v221
    v_mfma_f32_16x16x32_bf16 v[72:75], a[60:63], a[72:75], v[72:75]
    ds_read_b128 a[4:7], v240 offset:2048
    v_cvt_pk_bf16_f32 v234, v232, v233
    v_mfma_f32_16x16x32_bf16 v[112:115], a[64:67], a[72:75], v[112:115]
    ds_read_b128 a[8:11], v240 offset:4096
    v_lshlrev_b32 v232, 16, v234
    v_mfma_f32_16x16x32_bf16 v[152:155], a[68:71], a[72:75], v[152:155]
    ds_read_b128 a[12:15], v240 offset:6144
    v_and_b32 v233, 0xffff0000, v234
    v_mfma_f32_16x16x32_bf16 v[36:39], a[56:59], a[76:79], v[36:39]
    ds_read_b128 a[16:19], v242 offset:0
    v_add_f32 v236, v236, v232
    v_mfma_f32_16x16x32_bf16 v[76:79], a[60:63], a[76:79], v[76:79]
    ds_read_b128 a[20:23], v242 offset:2048
    v_add_f32 v236, v236, v233
    v_mfma_f32_16x16x32_bf16 v[116:119], a[64:67], a[76:79], v[116:119]
    ds_read_b128 a[24:27], v242 offset:4096
    v_lshlrev_b32 v232, 16, v195
    v_mfma_f32_16x16x32_bf16 v[156:159], a[68:71], a[76:79], v[156:159]
    ds_read_b128 a[28:31], v242 offset:6144
    v_and_b32 v233, 0xffff0000, v195
    v_mfma_f32_16x16x32_bf16 v[40:43], a[56:59], a[80:83], v[40:43]
    ds_read_b64_tr_b16 a[32:33], v244 offset:0
    v_mul_f32 v232, v232, v222
    v_mfma_f32_16x16x32_bf16 v[80:83], a[60:63], a[80:83], v[80:83]
    ds_read_b64_tr_b16 a[34:35], v244 offset:256
    v_mul_f32 v233, v233, v223
    v_mfma_f32_16x16x32_bf16 v[120:123], a[64:67], a[80:83], v[120:123]
    ds_read_b64_tr_b16 a[36:37], v245 offset:0
    v_mfma_f32_16x16x32_bf16 v[160:163], a[68:71], a[80:83], v[160:163]
    ds_read_b64_tr_b16 a[38:39], v245 offset:256
    v_mfma_f32_16x16x32_bf16 v[44:47], a[56:59], a[84:87], v[44:47]
    ds_read_b64_tr_b16 a[40:41], v244 offset:4096
    v_mfma_f32_16x16x32_bf16 v[84:87], a[60:63], a[84:87], v[84:87]
    ds_read_b64_tr_b16 a[42:43], v244 offset:4352
    v_mfma_f32_16x16x32_bf16 v[124:127], a[64:67], a[84:87], v[124:127]
    ds_read_b64_tr_b16 a[44:45], v245 offset:4096
    v_mfma_f32_16x16x32_bf16 v[164:167], a[68:71], a[84:87], v[164:167]
    ds_read_b64_tr_b16 a[46:47], v245 offset:4352
    v_mfma_f32_16x16x32_bf16 v[48:51], a[88:91], a[56:59], v[48:51]
    ds_read_b64_tr_b16 a[48:49], v244 offset:8192
    v_mfma_f32_16x16x32_bf16 v[88:91], a[88:91], a[60:63], v[88:91]
    ds_read_b64_tr_b16 a[50:51], v244 offset:8448
    v_mfma_f32_16x16x32_bf16 v[128:131], a[88:91], a[64:67], v[128:131]
    ds_read_b64_tr_b16 a[52:53], v245 offset:8192
    v_mfma_f32_16x16x32_bf16 v[168:171], a[88:91], a[68:71], v[168:171]
    ds_read_b64_tr_b16 a[54:55], v245 offset:8448
    v_mfma_f32_16x16x32_bf16 v[52:55], a[92:95], a[56:59], v[52:55]
    s_add_u32 s35, s41, 7
    v_mfma_f32_16x16x32_bf16 v[92:95], a[92:95], a[60:63], v[92:95]
    s_and_b32 s35, s35, 15
    v_mfma_f32_16x16x32_bf16 v[132:135], a[92:95], a[64:67], v[132:135]
    s_mul_i32 s36, s35, 393216
    v_mfma_f32_16x16x32_bf16 v[172:175], a[92:95], a[68:71], v[172:175]
    s_lshl_b32 s35, s35, 7
    v_mfma_f32_16x16x32_bf16 v[56:59], a[96:99], a[56:59], v[56:59]
    s_add_u32 m0, s37, 53248
    v_mfma_f32_16x16x32_bf16 v[96:99], a[96:99], a[60:63], v[96:99]
    buffer_load_dwordx4 v8, s[8:11], s35 offen lds
    v_mfma_f32_16x16x32_bf16 v[136:139], a[96:99], a[64:67], v[136:139]
    s_add_u32 m0, s37, 54272
    v_mfma_f32_16x16x32_bf16 v[176:179], a[96:99], a[68:71], v[176:179]
    buffer_load_dwordx4 v9, s[8:11], s35 offen lds
    v_mfma_f32_16x16x32_bf16 v[60:63], a[100:103], a[56:59], v[60:63]
    s_add_u32 m0, s37, 55296
    v_mfma_f32_16x16x32_bf16 v[100:103], a[100:103], a[60:63], v[100:103]
    buffer_load_dwordx4 v10, s[8:11], s35 offen lds
    v_mfma_f32_16x16x32_bf16 v[140:143], a[100:103], a[64:67], v[140:143]
    s_add_u32 m0, s37, 56320
    v_mfma_f32_16x16x32_bf16 v[180:183], a[100:103], a[68:71], v[180:183]
    buffer_load_dwordx4 v11, s[8:11], s35 offen lds
    v_mfma_f32_16x16x32_bf16 v[64:67], a[56:59], a[104:107], v[64:67]
    s_add_u32 m0, s37, 57344
    v_mfma_f32_16x16x32_bf16 v[104:107], a[60:63], a[104:107], v[104:107]
    buffer_load_dwordx4 v12, s[8:11], s35 offen lds
    v_mfma_f32_16x16x32_bf16 v[144:147], a[64:67], a[104:107], v[144:147]
    s_add_u32 m0, s37, 58368
    v_mfma_f32_16x16x32_bf16 v[184:187], a[68:71], a[104:107], v[184:187]
    buffer_load_dwordx4 v13, s[8:11], s35 offen lds
    v_mfma_f32_16x16x32_bf16 v[68:71], a[56:59], a[108:111], v[68:71]
    v_mfma_f32_16x16x32_bf16 v[108:111], a[60:63], a[108:111], v[108:111]
    v_mfma_f32_16x16x32_bf16 v[148:151], a[64:67], a[108:111], v[148:151]
    v_mfma_f32_16x16x32_bf16 v[188:191], a[68:71], a[108:111], v[188:191]
    s_waitcnt lgkmcnt(0)
    v_mfma_f32_16x16x32_bf16 v[32:35], a[0:3], a[16:19], v[32:35]
    ds_read_b128 a[56:59], v241 offset:0
    v_cvt_pk_bf16_f32 v234, v232, v233
    v_mfma_f32_16x16x32_bf16 v[72:75], a[4:7], a[16:19], v[72:75]
    ds_read_b128 a[60:63], v241 offset:2048
    v_lshlrev_b32 v232, 16, v234
    v_mfma_f32_16x16x32_bf16 v[112:115], a[8:11], a[16:19], v[112:115]
    ds_read_b128 a[64:67], v241 offset:4096
    v_and_b32 v233, 0xffff0000, v234
    v_mfma_f32_16x16x32_bf16 v[152:155], a[12:15], a[16:19], v[152:155]
    ds_read_b128 a[68:71], v241 offset:6144
    v_add_f32 v236, v236, v232
    v_mfma_f32_16x16x32_bf16 v[36:39], a[0:3], a[20:23], v[36:39]
    ds_read_b128 a[72:75], v243 offset:0
    v_add_f32 v236, v236, v233
    v_mfma_f32_16x16x32_bf16 v[76:79], a[4:7], a[20:23], v[76:79]
    ds_read_b128 a[76:79], v243 offset:2048
    v_lshlrev_b32 v232, 16, v196
    v_mfma_f32_16x16x32_bf16 v[116:119], a[8:11], a[20:23], v[116:119]
    ds_read_b128 a[80:83], v243 offset:4096
    v_and_b32 v233, 0xffff0000, v196
    v_mfma_f32_16x16x32_bf16 v[156:159], a[12:15], a[20:23], v[156:159]
    ds_read_b128 a[84:87], v243 offset:6144
    v_mul_f32 v232, v232, v224
    v_mfma_f32_16x16x32_bf16 v[40:43], a[0:3], a[24:27], v[40:43]
    ds_read_b64_tr_b16 a[88:89], v244 offset:2048
    v_mul_f32 v233, v233, v225
    v_mfma_f32_16x16x32_bf16 v[80:83], a[4:7], a[24:27], v[80:83]
    ds_read_b64_tr_b16 a[90:91], v244 offset:2304
    v_cvt_pk_bf16_f32 v234, v232, v233
    v_mfma_f32_16x16x32_bf16 v[120:123], a[8:11], a[24:27], v[120:123]
    ds_read_b64_tr_b16 a[92:93], v245 offset:2048
    v_mfma_f32_16x16x32_bf16 v[160:163], a[12:15], a[24:27], v[160:163]
    ds_read_b64_tr_b16 a[94:95], v245 offset:2304
    v_mfma_f32_16x16x32_bf16 v[44:47], a[0:3], a[28:31], v[44:47]
    ds_read_b64_tr_b16 a[96:97], v244 offset:6144
    v_mfma_f32_16x16x32_bf16 v[84:87], a[4:7], a[28:31], v[84:87]
    ds_read_b64_tr_b16 a[98:99], v244 offset:6400
    v_mfma_f32_16x16x32_bf16 v[124:127], a[8:11], a[28:31], v[124:127]
    ds_read_b64_tr_b16 a[100:101], v245 offset:6144
    v_mfma_f32_16x16x32_bf16 v[164:167], a[12:15], a[28:31], v[164:167]
    ds_read_b64_tr_b16 a[102:103], v245 offset:6400
    v_mfma_f32_16x16x32_bf16 v[48:51], a[32:35], a[0:3], v[48:51]
    ds_read_b64_tr_b16 a[104:105], v244 offset:10240
    v_mfma_f32_16x16x32_bf16 v[88:91], a[32:35], a[4:7], v[88:91]
    ds_read_b64_tr_b16 a[106:107], v244 offset:10496
    v_mfma_f32_16x16x32_bf16 v[128:131], a[32:35], a[8:11], v[128:131]
    ds_read_b64_tr_b16 a[108:109], v245 offset:10240
    v_mfma_f32_16x16x32_bf16 v[168:171], a[32:35], a[12:15], v[168:171]
    ds_read_b64_tr_b16 a[110:111], v245 offset:10496
    v_mfma_f32_16x16x32_bf16 v[52:55], a[36:39], a[0:3], v[52:55]
    s_add_u32 m0, s37, 59392
    v_mfma_f32_16x16x32_bf16 v[92:95], a[36:39], a[4:7], v[92:95]
    buffer_load_dwordx4 v14, s[8:11], s35 offen lds
    v_mfma_f32_16x16x32_bf16 v[132:135], a[36:39], a[8:11], v[132:135]
    s_add_u32 m0, s37, 60416
    v_mfma_f32_16x16x32_bf16 v[172:175], a[36:39], a[12:15], v[172:175]
    buffer_load_dwordx4 v15, s[8:11], s35 offen lds
    v_mfma_f32_16x16x32_bf16 v[56:59], a[40:43], a[0:3], v[56:59]
    s_add_u32 m0, s38, 86016
    v_mfma_f32_16x16x32_bf16 v[96:99], a[40:43], a[4:7], v[96:99]
    buffer_load_dwordx4 v16, s[12:15], s35 offen lds
    v_mfma_f32_16x16x32_bf16 v[136:139], a[40:43], a[8:11], v[136:139]
    s_add_u32 m0, s38, 90112
    v_mfma_f32_16x16x32_bf16 v[176:179], a[40:43], a[12:15], v[176:179]
    buffer_load_dwordx4 v16, s[16:19], s35 offen lds
    v_mfma_f32_16x16x32_bf16 v[60:63], a[44:47], a[0:3], v[60:63]
    s_add_u32 m0, s38, 94208
    v_mfma_f32_16x16x32_bf16 v[100:103], a[44:47], a[4:7], v[100:103]
    buffer_load_dwordx4 v17, s[20:23], s36 offen lds
    v_mfma_f32_16x16x32_bf16 v[140:143], a[44:47], a[8:11], v[140:143]
    s_add_u32 m0, s38, 98304
    v_mfma_f32_16x16x32_bf16 v[180:183], a[44:47], a[12:15], v[180:183]
    buffer_load_dwordx4 v18, s[20:23], s36 offen lds
    v_mfma_f32_16x16x32_bf16 v[64:67], a[0:3], a[48:51], v[64:67]
    s_add_u32 m0, s38, 102400
    v_mfma_f32_16x16x32_bf16 v[104:107], a[4:7], a[48:51], v[104:107]
    buffer_load_dwordx4 v19, s[20:23], s36 offen lds
    v_mfma_f32_16x16x32_bf16 v[144:147], a[8:11], a[48:51], v[144:147]
    v_mfma_f32_16x16x32_bf16 v[184:187], a[12:15], a[48:51], v[184:187]
    v_mfma_f32_16x16x32_bf16 v[68:71], a[0:3], a[52:55], v[68:71]
    v_mfma_f32_16x16x32_bf16 v[108:111], a[4:7], a[52:55], v[108:111]
    v_mfma_f32_16x16x32_bf16 v[148:151], a[8:11], a[52:55], v[148:151]
    v_mfma_f32_16x16x32_bf16 v[188:191], a[12:15], a[52:55], v[188:191]
    s_waitcnt lgkmcnt(0)
    s_waitcnt vmcnt(13)
    s_barrier
    v_mfma_f32_16x16x32_bf16 v[32:35], a[56:59], a[72:75], v[32:35]
    ds_read_b128 a[0:3], v20 offset:0
    v_lshlrev_b32 v232, 16, v234
    v_mfma_f32_16x16x32_bf16 v[72:75], a[60:63], a[72:75], v[72:75]
    ds_read_b128 a[4:7], v20 offset:2048
    v_and_b32 v233, 0xffff0000, v234
    v_mfma_f32_16x16x32_bf16 v[112:115], a[64:67], a[72:75], v[112:115]
    ds_read_b128 a[8:11], v20 offset:4096
    v_add_f32 v236, v236, v232
    v_mfma_f32_16x16x32_bf16 v[152:155], a[68:71], a[72:75], v[152:155]
    ds_read_b128 a[12:15], v20 offset:6144
    v_add_f32 v236, v236, v233
    v_mfma_f32_16x16x32_bf16 v[36:39], a[56:59], a[76:79], v[36:39]
    ds_read_b128 a[16:19], v22 offset:0
    v_lshlrev_b32 v232, 16, v197
    v_mfma_f32_16x16x32_bf16 v[76:79], a[60:63], a[76:79], v[76:79]
    ds_read_b128 a[20:23], v22 offset:2048
    v_and_b32 v233, 0xffff0000, v197
    v_mfma_f32_16x16x32_bf16 v[116:119], a[64:67], a[76:79], v[116:119]
    ds_read_b128 a[24:27], v22 offset:4096
    v_mul_f32 v232, v232, v226
    v_mfma_f32_16x16x32_bf16 v[156:159], a[68:71], a[76:79], v[156:159]
    ds_read_b128 a[28:31], v22 offset:6144
    v_mul_f32 v233, v233, v227
    v_mfma_f32_16x16x32_bf16 v[40:43], a[56:59], a[80:83], v[40:43]
    ds_read_b64_tr_b16 a[32:33], v24 offset:0
    v_cvt_pk_bf16_f32 v234, v232, v233
    v_mfma_f32_16x16x32_bf16 v[80:83], a[60:63], a[80:83], v[80:83]
    ds_read_b64_tr_b16 a[34:35], v24 offset:256
    v_lshlrev_b32 v232, 16, v234
    v_mfma_f32_16x16x32_bf16 v[120:123], a[64:67], a[80:83], v[120:123]
    ds_read_b64_tr_b16 a[36:37], v25 offset:0
    v_mfma_f32_16x16x32_bf16 v[160:163], a[68:71], a[80:83], v[160:163]
    ds_read_b64_tr_b16 a[38:39], v25 offset:256
    v_mfma_f32_16x16x32_bf16 v[44:47], a[56:59], a[84:87], v[44:47]
    ds_read_b64_tr_b16 a[40:41], v24 offset:4096
    v_mfma_f32_16x16x32_bf16 v[84:87], a[60:63], a[84:87], v[84:87]
    ds_read_b64_tr_b16 a[42:43], v24 offset:4352
    v_mfma_f32_16x16x32_bf16 v[124:127], a[64:67], a[84:87], v[124:127]
    ds_read_b64_tr_b16 a[44:45], v25 offset:4096
    v_mfma_f32_16x16x32_bf16 v[164:167], a[68:71], a[84:87], v[164:167]
    ds_read_b64_tr_b16 a[46:47], v25 offset:4352
    v_mfma_f32_16x16x32_bf16 v[48:51], a[88:91], a[56:59], v[48:51]
    ds_read_b64_tr_b16 a[48:49], v24 offset:8192
    v_mfma_f32_16x16x32_bf16 v[88:91], a[88:91], a[60:63], v[88:91]
    ds_read_b64_tr_b16 a[50:51], v24 offset:8448
    v_mfma_f32_16x16x32_bf16 v[128:131], a[88:91], a[64:67], v[128:131]
    ds_read_b64_tr_b16 a[52:53], v25 offset:8192
    v_mfma_f32_16x16x32_bf16 v[168:171], a[88:91], a[68:71], v[168:171]
    ds_read_b64_tr_b16 a[54:55], v25 offset:8448
    v_mfma_f32_16x16x32_bf16 v[52:55], a[92:95], a[56:59], v[52:55]
    s_add_u32 s35, s41, 8
    v_mfma_f32_16x16x32_bf16 v[92:95], a[92:95], a[60:63], v[92:95]
    s_and_b32 s35, s35, 15
    v_mfma_f32_16x16x32_bf16 v[132:135], a[92:95], a[64:67], v[132:135]
    s_mul_i32 s36, s35, 393216
    v_mfma_f32_16x16x32_bf16 v[172:175], a[92:95], a[68:71], v[172:175]
    s_lshl_b32 s35, s35, 7
    v_mfma_f32_16x16x32_bf16 v[56:59], a[96:99], a[56:59], v[56:59]
    s_add_u32 m0, s37, 106496
    v_mfma_f32_16x16x32_bf16 v[96:99], a[96:99], a[60:63], v[96:99]
    buffer_load_dwordx4 v8, s[8:11], s35 offen lds
    v_mfma_f32_16x16x32_bf16 v[136:139], a[96:99], a[64:67], v[136:139]
    s_add_u32 m0, s37, 107520
    v_mfma_f32_16x16x32_bf16 v[176:179], a[96:99], a[68:71], v[176:179]
    buffer_load_dwordx4 v9, s[8:11], s35 offen lds
    v_mfma_f32_16x16x32_bf16 v[60:63], a[100:103], a[56:59], v[60:63]
    s_add_u32 m0, s37, 108544
    v_mfma_f32_16x16x32_bf16 v[100:103], a[100:103], a[60:63], v[100:103]
    buffer_load_dwordx4 v10, s[8:11], s35 offen lds
    v_mfma_f32_16x16x32_bf16 v[140:143], a[100:103], a[64:67], v[140:143]
    s_add_u32 m0, s37, 109568
    v_mfma_f32_16x16x32_bf16 v[180:183], a[100:103], a[68:71], v[180:183]
    buffer_load_dwordx4 v11, s[8:11], s35 offen lds
    v_mfma_f32_16x16x32_bf16 v[64:67], a[56:59], a[104:107], v[64:67]
    s_add_u32 m0, s37, 110592
    v_mfma_f32_16x16x32_bf16 v[104:107], a[60:63], a[104:107], v[104:107]
    buffer_load_dwordx4 v12, s[8:11], s35 offen lds
    v_mfma_f32_16x16x32_bf16 v[144:147], a[64:67], a[104:107], v[144:147]
    s_add_u32 m0, s37, 111616
    v_mfma_f32_16x16x32_bf16 v[184:187], a[68:71], a[104:107], v[184:187]
    buffer_load_dwordx4 v13, s[8:11], s35 offen lds
    v_mfma_f32_16x16x32_bf16 v[68:71], a[56:59], a[108:111], v[68:71]
    v_mfma_f32_16x16x32_bf16 v[108:111], a[60:63], a[108:111], v[108:111]
    v_mfma_f32_16x16x32_bf16 v[148:151], a[64:67], a[108:111], v[148:151]
    v_mfma_f32_16x16x32_bf16 v[188:191], a[68:71], a[108:111], v[188:191]
    s_waitcnt lgkmcnt(0)
    v_mfma_f32_16x16x32_bf16 v[32:35], a[0:3], a[16:19], v[32:35]
    ds_read_b128 a[56:59], v21 offset:0
    v_and_b32 v233, 0xffff0000, v234
    v_mfma_f32_16x16x32_bf16 v[72:75], a[4:7], a[16:19], v[72:75]
    ds_read_b128 a[60:63], v21 offset:2048
    v_add_f32 v236, v236, v232
    v_mfma_f32_16x16x32_bf16 v[112:115], a[8:11], a[16:19], v[112:115]
    ds_read_b128 a[64:67], v21 offset:4096
    v_add_f32 v236, v236, v233
    v_mfma_f32_16x16x32_bf16 v[152:155], a[12:15], a[16:19], v[152:155]
    ds_read_b128 a[68:71], v21 offset:6144
    v_lshlrev_b32 v232, 16, v198
    v_mfma_f32_16x16x32_bf16 v[36:39], a[0:3], a[20:23], v[36:39]
    ds_read_b128 a[72:75], v23 offset:0
    v_and_b32 v233, 0xffff0000, v198
    v_mfma_f32_16x16x32_bf16 v[76:79], a[4:7], a[20:23], v[76:79]
    ds_read_b128 a[76:79], v23 offset:2048
    v_mul_f32 v232, v232, v228
    v_mfma_f32_16x16x32_bf16 v[116:119], a[8:11], a[20:23], v[116:119]
    ds_read_b128 a[80:83], v23 offset:4096
    v_mul_f32 v233, v233, v229
    v_mfma_f32_16x16x32_bf16 v[156:159], a[12:15], a[20:23], v[156:159]
    ds_read_b128 a[84:87], v23 offset:6144
    v_cvt_pk_bf16_f32 v234, v232, v233
    v_mfma_f32_16x16x32_bf16 v[40:43], a[0:3], a[24:27], v[40:43]
    ds_read_b64_tr_b16 a[88:89], v24 offset:2048
    v_lshlrev_b32 v232, 16, v234
    v_mfma_f32_16x16x32_bf16 v[80:83], a[4:7], a[24:27], v[80:83]
    ds_read_b64_tr_b16 a[90:91], v24 offset:2304
    v_and_b32 v233, 0xffff0000, v234
    v_mfma_f32_16x16x32_bf16 v[120:123], a[8:11], a[24:27], v[120:123]
    ds_read_b64_tr_b16 a[92:93], v25 offset:2048
    v_mfma_f32_16x16x32_bf16 v[160:163], a[12:15], a[24:27], v[160:163]
    ds_read_b64_tr_b16 a[94:95], v25 offset:2304
    v_mfma_f32_16x16x32_bf16 v[44:47], a[0:3], a[28:31], v[44:47]
    ds_read_b64_tr_b16 a[96:97], v24 offset:6144
    v_mfma_f32_16x16x32_bf16 v[84:87], a[4:7], a[28:31], v[84:87]
    ds_read_b64_tr_b16 a[98:99], v24 offset:6400
    v_mfma_f32_16x16x32_bf16 v[124:127], a[8:11], a[28:31], v[124:127]
    ds_read_b64_tr_b16 a[100:101], v25 offset:6144
    v_mfma_f32_16x16x32_bf16 v[164:167], a[12:15], a[28:31], v[164:167]
    ds_read_b64_tr_b16 a[102:103], v25 offset:6400
    v_mfma_f32_16x16x32_bf16 v[48:51], a[32:35], a[0:3], v[48:51]
    ds_read_b64_tr_b16 a[104:105], v24 offset:10240
    v_mfma_f32_16x16x32_bf16 v[88:91], a[32:35], a[4:7], v[88:91]
    ds_read_b64_tr_b16 a[106:107], v24 offset:10496
    v_mfma_f32_16x16x32_bf16 v[128:131], a[32:35], a[8:11], v[128:131]
    ds_read_b64_tr_b16 a[108:109], v25 offset:10240
    v_mfma_f32_16x16x32_bf16 v[168:171], a[32:35], a[12:15], v[168:171]
    ds_read_b64_tr_b16 a[110:111], v25 offset:10496
    v_mfma_f32_16x16x32_bf16 v[52:55], a[36:39], a[0:3], v[52:55]
    s_add_u32 m0, s37, 112640
    v_mfma_f32_16x16x32_bf16 v[92:95], a[36:39], a[4:7], v[92:95]
    buffer_load_dwordx4 v14, s[8:11], s35 offen lds
    v_mfma_f32_16x16x32_bf16 v[132:135], a[36:39], a[8:11], v[132:135]
    s_add_u32 m0, s37, 113664
    v_mfma_f32_16x16x32_bf16 v[172:175], a[36:39], a[12:15], v[172:175]
    buffer_load_dwordx4 v15, s[8:11], s35 offen lds
    v_mfma_f32_16x16x32_bf16 v[56:59], a[40:43], a[0:3], v[56:59]
    s_add_u32 m0, s38, 139264
    v_mfma_f32_16x16x32_bf16 v[96:99], a[40:43], a[4:7], v[96:99]
    buffer_load_dwordx4 v16, s[12:15], s35 offen lds
    v_mfma_f32_16x16x32_bf16 v[136:139], a[40:43], a[8:11], v[136:139]
    s_add_u32 m0, s38, 143360
    v_mfma_f32_16x16x32_bf16 v[176:179], a[40:43], a[12:15], v[176:179]
    buffer_load_dwordx4 v16, s[16:19], s35 offen lds
    v_mfma_f32_16x16x32_bf16 v[60:63], a[44:47], a[0:3], v[60:63]
    s_add_u32 m0, s38, 147456
    v_mfma_f32_16x16x32_bf16 v[100:103], a[44:47], a[4:7], v[100:103]
    buffer_load_dwordx4 v17, s[20:23], s36 offen lds
    v_mfma_f32_16x16x32_bf16 v[140:143], a[44:47], a[8:11], v[140:143]
    s_add_u32 m0, s38, 151552
    v_mfma_f32_16x16x32_bf16 v[180:183], a[44:47], a[12:15], v[180:183]
    buffer_load_dwordx4 v18, s[20:23], s36 offen lds
    v_mfma_f32_16x16x32_bf16 v[64:67], a[0:3], a[48:51], v[64:67]
    s_add_u32 m0, s38, 155648
    v_mfma_f32_16x16x32_bf16 v[104:107], a[4:7], a[48:51], v[104:107]
    buffer_load_dwordx4 v19, s[20:23], s36 offen lds
    v_mfma_f32_16x16x32_bf16 v[144:147], a[8:11], a[48:51], v[144:147]
    v_mfma_f32_16x16x32_bf16 v[184:187], a[12:15], a[48:51], v[184:187]
    v_mfma_f32_16x16x32_bf16 v[68:71], a[0:3], a[52:55], v[68:71]
    v_mfma_f32_16x16x32_bf16 v[108:111], a[4:7], a[52:55], v[108:111]
    v_mfma_f32_16x16x32_bf16 v[148:151], a[8:11], a[52:55], v[148:151]
    v_mfma_f32_16x16x32_bf16 v[188:191], a[12:15], a[52:55], v[188:191]
    s_waitcnt lgkmcnt(0)
    s_waitcnt vmcnt(13)
    s_barrier
    v_mfma_f32_16x16x32_bf16 v[32:35], a[56:59], a[72:75], v[32:35]
    ds_read_b128 a[0:3], v20 offset:53248
    v_add_f32 v236, v236, v232
    v_mfma_f32_16x16x32_bf16 v[72:75], a[60:63], a[72:75], v[72:75]
    ds_read_b128 a[4:7], v20 offset:55296
    v_add_f32 v236, v236, v233
    v_mfma_f32_16x16x32_bf16 v[112:115], a[64:67], a[72:75], v[112:115]
    ds_read_b128 a[8:11], v20 offset:57344
    v_lshlrev_b32 v232, 16, v199
    v_mfma_f32_16x16x32_bf16 v[152:155], a[68:71], a[72:75], v[152:155]
    ds_read_b128 a[12:15], v20 offset:59392
    v_and_b32 v233, 0xffff0000, v199
    v_mfma_f32_16x16x32_bf16 v[36:39], a[56:59], a[76:79], v[36:39]
    ds_read_b128 a[16:19], v22 offset:53248
    v_mul_f32 v232, v232, v230
    v_mfma_f32_16x16x32_bf16 v[76:79], a[60:63], a[76:79], v[76:79]
    ds_read_b128 a[20:23], v22 offset:55296
    v_mul_f32 v233, v233, v231
    v_mfma_f32_16x16x32_bf16 v[116:119], a[64:67], a[76:79], v[116:119]
    ds_read_b128 a[24:27], v22 offset:57344
    v_cvt_pk_bf16_f32 v234, v232, v233
    v_mfma_f32_16x16x32_bf16 v[156:159], a[68:71], a[76:79], v[156:159]
    ds_read_b128 a[28:31], v22 offset:59392
    v_lshlrev_b32 v232, 16, v234
    v_mfma_f32_16x16x32_bf16 v[40:43], a[56:59], a[80:83], v[40:43]
    ds_read_b64_tr_b16 a[32:33], v24 offset:53248
    v_and_b32 v233, 0xffff0000, v234
    v_mfma_f32_16x16x32_bf16 v[80:83], a[60:63], a[80:83], v[80:83]
    ds_read_b64_tr_b16 a[34:35], v24 offset:53504
    v_add_f32 v236, v236, v232
    v_mfma_f32_16x16x32_bf16 v[120:123], a[64:67], a[80:83], v[120:123]
    ds_read_b64_tr_b16 a[36:37], v25 offset:53248
    v_mfma_f32_16x16x32_bf16 v[160:163], a[68:71], a[80:83], v[160:163]
    ds_read_b64_tr_b16 a[38:39], v25 offset:53504
    v_mfma_f32_16x16x32_bf16 v[44:47], a[56:59], a[84:87], v[44:47]
    ds_read_b64_tr_b16 a[40:41], v24 offset:57344
    v_mfma_f32_16x16x32_bf16 v[84:87], a[60:63], a[84:87], v[84:87]
    ds_read_b64_tr_b16 a[42:43], v24 offset:57600
    v_mfma_f32_16x16x32_bf16 v[124:127], a[64:67], a[84:87], v[124:127]
    ds_read_b64_tr_b16 a[44:45], v25 offset:57344
    v_mfma_f32_16x16x32_bf16 v[164:167], a[68:71], a[84:87], v[164:167]
    ds_read_b64_tr_b16 a[46:47], v25 offset:57600
    v_mfma_f32_16x16x32_bf16 v[48:51], a[88:91], a[56:59], v[48:51]
    ds_read_b64_tr_b16 a[48:49], v24 offset:61440
    v_mfma_f32_16x16x32_bf16 v[88:91], a[88:91], a[60:63], v[88:91]
    ds_read_b64_tr_b16 a[50:51], v24 offset:61696
    v_mfma_f32_16x16x32_bf16 v[128:131], a[88:91], a[64:67], v[128:131]
    ds_read_b64_tr_b16 a[52:53], v25 offset:61440
    v_mfma_f32_16x16x32_bf16 v[168:171], a[88:91], a[68:71], v[168:171]
    ds_read_b64_tr_b16 a[54:55], v25 offset:61696
    v_mfma_f32_16x16x32_bf16 v[52:55], a[92:95], a[56:59], v[52:55]
    s_add_u32 s35, s41, 9
    v_mfma_f32_16x16x32_bf16 v[92:95], a[92:95], a[60:63], v[92:95]
    s_and_b32 s35, s35, 15
    v_mfma_f32_16x16x32_bf16 v[132:135], a[92:95], a[64:67], v[132:135]
    s_mul_i32 s36, s35, 393216
    v_mfma_f32_16x16x32_bf16 v[172:175], a[92:95], a[68:71], v[172:175]
    s_lshl_b32 s35, s35, 7
    v_mfma_f32_16x16x32_bf16 v[56:59], a[96:99], a[56:59], v[56:59]
    s_add_u32 m0, s37, 0
    v_mfma_f32_16x16x32_bf16 v[96:99], a[96:99], a[60:63], v[96:99]
    buffer_load_dwordx4 v8, s[8:11], s35 offen lds
    v_mfma_f32_16x16x32_bf16 v[136:139], a[96:99], a[64:67], v[136:139]
    s_add_u32 m0, s37, 1024
    v_mfma_f32_16x16x32_bf16 v[176:179], a[96:99], a[68:71], v[176:179]
    buffer_load_dwordx4 v9, s[8:11], s35 offen lds
    v_mfma_f32_16x16x32_bf16 v[60:63], a[100:103], a[56:59], v[60:63]
    s_add_u32 m0, s37, 2048
    v_mfma_f32_16x16x32_bf16 v[100:103], a[100:103], a[60:63], v[100:103]
    buffer_load_dwordx4 v10, s[8:11], s35 offen lds
    v_mfma_f32_16x16x32_bf16 v[140:143], a[100:103], a[64:67], v[140:143]
    s_add_u32 m0, s37, 3072
    v_mfma_f32_16x16x32_bf16 v[180:183], a[100:103], a[68:71], v[180:183]
    buffer_load_dwordx4 v11, s[8:11], s35 offen lds
    v_mfma_f32_16x16x32_bf16 v[64:67], a[56:59], a[104:107], v[64:67]
    s_add_u32 m0, s37, 4096
    v_mfma_f32_16x16x32_bf16 v[104:107], a[60:63], a[104:107], v[104:107]
    buffer_load_dwordx4 v12, s[8:11], s35 offen lds
    v_mfma_f32_16x16x32_bf16 v[144:147], a[64:67], a[104:107], v[144:147]
    s_add_u32 m0, s37, 5120
    v_mfma_f32_16x16x32_bf16 v[184:187], a[68:71], a[104:107], v[184:187]
    buffer_load_dwordx4 v13, s[8:11], s35 offen lds
    v_mfma_f32_16x16x32_bf16 v[68:71], a[56:59], a[108:111], v[68:71]
    v_mfma_f32_16x16x32_bf16 v[108:111], a[60:63], a[108:111], v[108:111]
    v_mfma_f32_16x16x32_bf16 v[148:151], a[64:67], a[108:111], v[148:151]
    v_mfma_f32_16x16x32_bf16 v[188:191], a[68:71], a[108:111], v[188:191]
    s_waitcnt lgkmcnt(0)
    v_mfma_f32_16x16x32_bf16 v[32:35], a[0:3], a[16:19], v[32:35]
    ds_read_b128 a[56:59], v21 offset:53248
    v_add_f32 v236, v236, v233
    v_mfma_f32_16x16x32_bf16 v[72:75], a[4:7], a[16:19], v[72:75]
    ds_read_b128 a[60:63], v21 offset:55296
    v_lshlrev_b32 v232, 16, v200
    v_mfma_f32_16x16x32_bf16 v[112:115], a[8:11], a[16:19], v[112:115]
    ds_read_b128 a[64:67], v21 offset:57344
    v_and_b32 v233, 0xffff0000, v200
    v_mfma_f32_16x16x32_bf16 v[152:155], a[12:15], a[16:19], v[152:155]
    ds_read_b128 a[68:71], v21 offset:59392
    v_mul_f32 v232, v232, v216
    v_mfma_f32_16x16x32_bf16 v[36:39], a[0:3], a[20:23], v[36:39]
    ds_read_b128 a[72:75], v23 offset:53248
    v_mul_f32 v233, v233, v217
    v_mfma_f32_16x16x32_bf16 v[76:79], a[4:7], a[20:23], v[76:79]
    ds_read_b128 a[76:79], v23 offset:55296
    v_cvt_pk_bf16_f32 v234, v232, v233
    v_mfma_f32_16x16x32_bf16 v[116:119], a[8:11], a[20:23], v[116:119]
    ds_read_b128 a[80:83], v23 offset:57344
    v_lshlrev_b32 v232, 16, v234
    v_mfma_f32_16x16x32_bf16 v[156:159], a[12:15], a[20:23], v[156:159]
    ds_read_b128 a[84:87], v23 offset:59392
    v_and_b32 v233, 0xffff0000, v234
    v_mfma_f32_16x16x32_bf16 v[40:43], a[0:3], a[24:27], v[40:43]
    ds_read_b64_tr_b16 a[88:89], v24 offset:55296
    v_add_f32 v237, v237, v232
    v_mfma_f32_16x16x32_bf16 v[80:83], a[4:7], a[24:27], v[80:83]
    ds_read_b64_tr_b16 a[90:91], v24 offset:55552
    v_add_f32 v237, v237, v233
    v_mfma_f32_16x16x32_bf16 v[120:123], a[8:11], a[24:27], v[120:123]
    ds_read_b64_tr_b16 a[92:93], v25 offset:55296
    v_mfma_f32_16x16x32_bf16 v[160:163], a[12:15], a[24:27], v[160:163]
    ds_read_b64_tr_b16 a[94:95], v25 offset:55552
    v_mfma_f32_16x16x32_bf16 v[44:47], a[0:3], a[28:31], v[44:47]
    ds_read_b64_tr_b16 a[96:97], v24 offset:59392
    v_mfma_f32_16x16x32_bf16 v[84:87], a[4:7], a[28:31], v[84:87]
    ds_read_b64_tr_b16 a[98:99], v24 offset:59648
    v_mfma_f32_16x16x32_bf16 v[124:127], a[8:11], a[28:31], v[124:127]
    ds_read_b64_tr_b16 a[100:101], v25 offset:59392
    v_mfma_f32_16x16x32_bf16 v[164:167], a[12:15], a[28:31], v[164:167]
    ds_read_b64_tr_b16 a[102:103], v25 offset:59648
    v_mfma_f32_16x16x32_bf16 v[48:51], a[32:35], a[0:3], v[48:51]
    ds_read_b64_tr_b16 a[104:105], v24 offset:63488
    v_mfma_f32_16x16x32_bf16 v[88:91], a[32:35], a[4:7], v[88:91]
    ds_read_b64_tr_b16 a[106:107], v24 offset:63744
    v_mfma_f32_16x16x32_bf16 v[128:131], a[32:35], a[8:11], v[128:131]
    ds_read_b64_tr_b16 a[108:109], v25 offset:63488
    v_mfma_f32_16x16x32_bf16 v[168:171], a[32:35], a[12:15], v[168:171]
    ds_read_b64_tr_b16 a[110:111], v25 offset:63744
    v_mfma_f32_16x16x32_bf16 v[52:55], a[36:39], a[0:3], v[52:55]
    s_add_u32 m0, s37, 6144
    v_mfma_f32_16x16x32_bf16 v[92:95], a[36:39], a[4:7], v[92:95]
    buffer_load_dwordx4 v14, s[8:11], s35 offen lds
    v_mfma_f32_16x16x32_bf16 v[132:135], a[36:39], a[8:11], v[132:135]
    s_add_u32 m0, s37, 7168
    v_mfma_f32_16x16x32_bf16 v[172:175], a[36:39], a[12:15], v[172:175]
    buffer_load_dwordx4 v15, s[8:11], s35 offen lds
    v_mfma_f32_16x16x32_bf16 v[56:59], a[40:43], a[0:3], v[56:59]
    s_add_u32 m0, s38, 32768
    v_mfma_f32_16x16x32_bf16 v[96:99], a[40:43], a[4:7], v[96:99]
    buffer_load_dwordx4 v16, s[12:15], s35 offen lds
    v_mfma_f32_16x16x32_bf16 v[136:139], a[40:43], a[8:11], v[136:139]
    s_add_u32 m0, s38, 36864
    v_mfma_f32_16x16x32_bf16 v[176:179], a[40:43], a[12:15], v[176:179]
    buffer_load_dwordx4 v16, s[16:19], s35 offen lds
    v_mfma_f32_16x16x32_bf16 v[60:63], a[44:47], a[0:3], v[60:63]
    s_add_u32 m0, s38, 40960
    v_mfma_f32_16x16x32_bf16 v[100:103], a[44:47], a[4:7], v[100:103]
    buffer_load_dwordx4 v17, s[20:23], s36 offen lds
    v_mfma_f32_16x16x32_bf16 v[140:143], a[44:47], a[8:11], v[140:143]
    s_add_u32 m0, s38, 45056
    v_mfma_f32_16x16x32_bf16 v[180:183], a[44:47], a[12:15], v[180:183]
    buffer_load_dwordx4 v18, s[20:23], s36 offen lds
    v_mfma_f32_16x16x32_bf16 v[64:67], a[0:3], a[48:51], v[64:67]
    s_add_u32 m0, s38, 49152
    v_mfma_f32_16x16x32_bf16 v[104:107], a[4:7], a[48:51], v[104:107]
    buffer_load_dwordx4 v19, s[20:23], s36 offen lds
    v_mfma_f32_16x16x32_bf16 v[144:147], a[8:11], a[48:51], v[144:147]
    v_mfma_f32_16x16x32_bf16 v[184:187], a[12:15], a[48:51], v[184:187]
    v_mfma_f32_16x16x32_bf16 v[68:71], a[0:3], a[52:55], v[68:71]
    v_mfma_f32_16x16x32_bf16 v[108:111], a[4:7], a[52:55], v[108:111]
    v_mfma_f32_16x16x32_bf16 v[148:151], a[8:11], a[52:55], v[148:151]
    v_mfma_f32_16x16x32_bf16 v[188:191], a[12:15], a[52:55], v[188:191]
    s_waitcnt lgkmcnt(0)
    s_waitcnt vmcnt(13)
    s_barrier
    v_mfma_f32_16x16x32_bf16 v[32:35], a[56:59], a[72:75], v[32:35]
    ds_read_b128 a[0:3], v240 offset:0
    v_lshlrev_b32 v232, 16, v201
    v_mfma_f32_16x16x32_bf16 v[72:75], a[60:63], a[72:75], v[72:75]
    ds_read_b128 a[4:7], v240 offset:2048
    v_and_b32 v233, 0xffff0000, v201
    v_mfma_f32_16x16x32_bf16 v[112:115], a[64:67], a[72:75], v[112:115]
    ds_read_b128 a[8:11], v240 offset:4096
    v_mul_f32 v232, v232, v218
    v_mfma_f32_16x16x32_bf16 v[152:155], a[68:71], a[72:75], v[152:155]
    ds_read_b128 a[12:15], v240 offset:6144
    v_mul_f32 v233, v233, v219
    v_mfma_f32_16x16x32_bf16 v[36:39], a[56:59], a[76:79], v[36:39]
    ds_read_b128 a[16:19], v242 offset:0
    v_cvt_pk_bf16_f32 v234, v232, v233
    v_mfma_f32_16x16x32_bf16 v[76:79], a[60:63], a[76:79], v[76:79]
    ds_read_b128 a[20:23], v242 offset:2048
    v_lshlrev_b32 v232, 16, v234
    v_mfma_f32_16x16x32_bf16 v[116:119], a[64:67], a[76:79], v[116:119]
    ds_read_b128 a[24:27], v242 offset:4096
    v_and_b32 v233, 0xffff0000, v234
    v_mfma_f32_16x16x32_bf16 v[156:159], a[68:71], a[76:79], v[156:159]
    ds_read_b128 a[28:31], v242 offset:6144
    v_add_f32 v237, v237, v232
    v_mfma_f32_16x16x32_bf16 v[40:43], a[56:59], a[80:83], v[40:43]
    ds_read_b64_tr_b16 a[32:33], v244 offset:0
    v_add_f32 v237, v237, v233
    v_mfma_f32_16x16x32_bf16 v[80:83], a[60:63], a[80:83], v[80:83]
    ds_read_b64_tr_b16 a[34:35], v244 offset:256
    v_lshlrev_b32 v232, 16, v202
    v_mfma_f32_16x16x32_bf16 v[120:123], a[64:67], a[80:83], v[120:123]
    ds_read_b64_tr_b16 a[36:37], v245 offset:0
    v_mfma_f32_16x16x32_bf16 v[160:163], a[68:71], a[80:83], v[160:163]
    ds_read_b64_tr_b16 a[38:39], v245 offset:256
    v_mfma_f32_16x16x32_bf16 v[44:47], a[56:59], a[84:87], v[44:47]
    ds_read_b64_tr_b16 a[40:41], v244 offset:4096
    v_mfma_f32_16x16x32_bf16 v[84:87], a[60:63], a[84:87], v[84:87]
    ds_read_b64_tr_b16 a[42:43], v244 offset:4352
    v_mfma_f32_16x16x32_bf16 v[124:127], a[64:67], a[84:87], v[124:127]
    ds_read_b64_tr_b16 a[44:45], v245 offset:4096
    v_mfma_f32_16x16x32_bf16 v[164:167], a[68:71], a[84:87], v[164:167]
    ds_read_b64_tr_b16 a[46:47], v245 offset:4352
    v_mfma_f32_16x16x32_bf16 v[48:51], a[88:91], a[56:59], v[48:51]
    ds_read_b64_tr_b16 a[48:49], v244 offset:8192
    v_mfma_f32_16x16x32_bf16 v[88:91], a[88:91], a[60:63], v[88:91]
    ds_read_b64_tr_b16 a[50:51], v244 offset:8448
    v_mfma_f32_16x16x32_bf16 v[128:131], a[88:91], a[64:67], v[128:131]
    ds_read_b64_tr_b16 a[52:53], v245 offset:8192
    v_mfma_f32_16x16x32_bf16 v[168:171], a[88:91], a[68:71], v[168:171]
    ds_read_b64_tr_b16 a[54:55], v245 offset:8448
    v_mfma_f32_16x16x32_bf16 v[52:55], a[92:95], a[56:59], v[52:55]
    s_add_u32 s35, s41, 10
    v_mfma_f32_16x16x32_bf16 v[92:95], a[92:95], a[60:63], v[92:95]
    s_and_b32 s35, s35, 15
    v_mfma_f32_16x16x32_bf16 v[132:135], a[92:95], a[64:67], v[132:135]
    s_mul_i32 s36, s35, 393216
    v_mfma_f32_16x16x32_bf16 v[172:175], a[92:95], a[68:71], v[172:175]
    s_lshl_b32 s35, s35, 7
    v_mfma_f32_16x16x32_bf16 v[56:59], a[96:99], a[56:59], v[56:59]
    s_add_u32 m0, s37, 53248
    v_mfma_f32_16x16x32_bf16 v[96:99], a[96:99], a[60:63], v[96:99]
    buffer_load_dwordx4 v8, s[8:11], s35 offen lds
    v_mfma_f32_16x16x32_bf16 v[136:139], a[96:99], a[64:67], v[136:139]
    s_add_u32 m0, s37, 54272
    v_mfma_f32_16x16x32_bf16 v[176:179], a[96:99], a[68:71], v[176:179]
    buffer_load_dwordx4 v9, s[8:11], s35 offen lds
    v_mfma_f32_16x16x32_bf16 v[60:63], a[100:103], a[56:59], v[60:63]
    s_add_u32 m0, s37, 55296
    v_mfma_f32_16x16x32_bf16 v[100:103], a[100:103], a[60:63], v[100:103]
    buffer_load_dwordx4 v10, s[8:11], s35 offen lds
    v_mfma_f32_16x16x32_bf16 v[140:143], a[100:103], a[64:67], v[140:143]
    s_add_u32 m0, s37, 56320
    v_mfma_f32_16x16x32_bf16 v[180:183], a[100:103], a[68:71], v[180:183]
    buffer_load_dwordx4 v11, s[8:11], s35 offen lds
    v_mfma_f32_16x16x32_bf16 v[64:67], a[56:59], a[104:107], v[64:67]
    s_add_u32 m0, s37, 57344
    v_mfma_f32_16x16x32_bf16 v[104:107], a[60:63], a[104:107], v[104:107]
    buffer_load_dwordx4 v12, s[8:11], s35 offen lds
    v_mfma_f32_16x16x32_bf16 v[144:147], a[64:67], a[104:107], v[144:147]
    s_add_u32 m0, s37, 58368
    v_mfma_f32_16x16x32_bf16 v[184:187], a[68:71], a[104:107], v[184:187]
    buffer_load_dwordx4 v13, s[8:11], s35 offen lds
    v_mfma_f32_16x16x32_bf16 v[68:71], a[56:59], a[108:111], v[68:71]
    v_mfma_f32_16x16x32_bf16 v[108:111], a[60:63], a[108:111], v[108:111]
    v_mfma_f32_16x16x32_bf16 v[148:151], a[64:67], a[108:111], v[148:151]
    v_mfma_f32_16x16x32_bf16 v[188:191], a[68:71], a[108:111], v[188:191]
    s_waitcnt lgkmcnt(0)
    v_mfma_f32_16x16x32_bf16 v[32:35], a[0:3], a[16:19], v[32:35]
    ds_read_b128 a[56:59], v241 offset:0
    v_and_b32 v233, 0xffff0000, v202
    v_mfma_f32_16x16x32_bf16 v[72:75], a[4:7], a[16:19], v[72:75]
    ds_read_b128 a[60:63], v241 offset:2048
    v_mul_f32 v232, v232, v220
    v_mfma_f32_16x16x32_bf16 v[112:115], a[8:11], a[16:19], v[112:115]
    ds_read_b128 a[64:67], v241 offset:4096
    v_mul_f32 v233, v233, v221
    v_mfma_f32_16x16x32_bf16 v[152:155], a[12:15], a[16:19], v[152:155]
    ds_read_b128 a[68:71], v241 offset:6144
    v_cvt_pk_bf16_f32 v234, v232, v233
    v_mfma_f32_16x16x32_bf16 v[36:39], a[0:3], a[20:23], v[36:39]
    ds_read_b128 a[72:75], v243 offset:0
    v_lshlrev_b32 v232, 16, v234
    v_mfma_f32_16x16x32_bf16 v[76:79], a[4:7], a[20:23], v[76:79]
    ds_read_b128 a[76:79], v243 offset:2048
    v_and_b32 v233, 0xffff0000, v234
    v_mfma_f32_16x16x32_bf16 v[116:119], a[8:11], a[20:23], v[116:119]
    ds_read_b128 a[80:83], v243 offset:4096
    v_add_f32 v237, v237, v232
    v_mfma_f32_16x16x32_bf16 v[156:159], a[12:15], a[20:23], v[156:159]
    ds_read_b128 a[84:87], v243 offset:6144
    v_add_f32 v237, v237, v233
    v_mfma_f32_16x16x32_bf16 v[40:43], a[0:3], a[24:27], v[40:43]
    ds_read_b64_tr_b16 a[88:89], v244 offset:2048
    v_lshlrev_b32 v232, 16, v203
    v_mfma_f32_16x16x32_bf16 v[80:83], a[4:7], a[24:27], v[80:83]
    ds_read_b64_tr_b16 a[90:91], v244 offset:2304
    v_and_b32 v233, 0xffff0000, v203
    v_mfma_f32_16x16x32_bf16 v[120:123], a[8:11], a[24:27], v[120:123]
    ds_read_b64_tr_b16 a[92:93], v245 offset:2048
    v_mfma_f32_16x16x32_bf16 v[160:163], a[12:15], a[24:27], v[160:163]
    ds_read_b64_tr_b16 a[94:95], v245 offset:2304
    v_mfma_f32_16x16x32_bf16 v[44:47], a[0:3], a[28:31], v[44:47]
    ds_read_b64_tr_b16 a[96:97], v244 offset:6144
    v_mfma_f32_16x16x32_bf16 v[84:87], a[4:7], a[28:31], v[84:87]
    ds_read_b64_tr_b16 a[98:99], v244 offset:6400
    v_mfma_f32_16x16x32_bf16 v[124:127], a[8:11], a[28:31], v[124:127]
    ds_read_b64_tr_b16 a[100:101], v245 offset:6144
    v_mfma_f32_16x16x32_bf16 v[164:167], a[12:15], a[28:31], v[164:167]
    ds_read_b64_tr_b16 a[102:103], v245 offset:6400
    v_mfma_f32_16x16x32_bf16 v[48:51], a[32:35], a[0:3], v[48:51]
    ds_read_b64_tr_b16 a[104:105], v244 offset:10240
    v_mfma_f32_16x16x32_bf16 v[88:91], a[32:35], a[4:7], v[88:91]
    ds_read_b64_tr_b16 a[106:107], v244 offset:10496
    v_mfma_f32_16x16x32_bf16 v[128:131], a[32:35], a[8:11], v[128:131]
    ds_read_b64_tr_b16 a[108:109], v245 offset:10240
    v_mfma_f32_16x16x32_bf16 v[168:171], a[32:35], a[12:15], v[168:171]
    ds_read_b64_tr_b16 a[110:111], v245 offset:10496
    v_mfma_f32_16x16x32_bf16 v[52:55], a[36:39], a[0:3], v[52:55]
    s_add_u32 m0, s37, 59392
    v_mfma_f32_16x16x32_bf16 v[92:95], a[36:39], a[4:7], v[92:95]
    buffer_load_dwordx4 v14, s[8:11], s35 offen lds
    v_mfma_f32_16x16x32_bf16 v[132:135], a[36:39], a[8:11], v[132:135]
    s_add_u32 m0, s37, 60416
    v_mfma_f32_16x16x32_bf16 v[172:175], a[36:39], a[12:15], v[172:175]
    buffer_load_dwordx4 v15, s[8:11], s35 offen lds
    v_mfma_f32_16x16x32_bf16 v[56:59], a[40:43], a[0:3], v[56:59]
    s_add_u32 m0, s38, 86016
    v_mfma_f32_16x16x32_bf16 v[96:99], a[40:43], a[4:7], v[96:99]
    buffer_load_dwordx4 v16, s[12:15], s35 offen lds
    v_mfma_f32_16x16x32_bf16 v[136:139], a[40:43], a[8:11], v[136:139]
    s_add_u32 m0, s38, 90112
    v_mfma_f32_16x16x32_bf16 v[176:179], a[40:43], a[12:15], v[176:179]
    buffer_load_dwordx4 v16, s[16:19], s35 offen lds
    v_mfma_f32_16x16x32_bf16 v[60:63], a[44:47], a[0:3], v[60:63]
    s_add_u32 m0, s38, 94208
    v_mfma_f32_16x16x32_bf16 v[100:103], a[44:47], a[4:7], v[100:103]
    buffer_load_dwordx4 v17, s[20:23], s36 offen lds
    v_mfma_f32_16x16x32_bf16 v[140:143], a[44:47], a[8:11], v[140:143]
    s_add_u32 m0, s38, 98304
    v_mfma_f32_16x16x32_bf16 v[180:183], a[44:47], a[12:15], v[180:183]
    buffer_load_dwordx4 v18, s[20:23], s36 offen lds
    v_mfma_f32_16x16x32_bf16 v[64:67], a[0:3], a[48:51], v[64:67]
    s_add_u32 m0, s38, 102400
    v_mfma_f32_16x16x32_bf16 v[104:107], a[4:7], a[48:51], v[104:107]
    buffer_load_dwordx4 v19, s[20:23], s36 offen lds
    v_mfma_f32_16x16x32_bf16 v[144:147], a[8:11], a[48:51], v[144:147]
    v_mfma_f32_16x16x32_bf16 v[184:187], a[12:15], a[48:51], v[184:187]
    v_mfma_f32_16x16x32_bf16 v[68:71], a[0:3], a[52:55], v[68:71]
    v_mfma_f32_16x16x32_bf16 v[108:111], a[4:7], a[52:55], v[108:111]
    v_mfma_f32_16x16x32_bf16 v[148:151], a[8:11], a[52:55], v[148:151]
    v_mfma_f32_16x16x32_bf16 v[188:191], a[12:15], a[52:55], v[188:191]
    s_waitcnt lgkmcnt(0)
    s_waitcnt vmcnt(13)
    s_barrier
    v_mfma_f32_16x16x32_bf16 v[32:35], a[56:59], a[72:75], v[32:35]
    ds_read_b128 a[0:3], v20 offset:0
    v_mul_f32 v232, v232, v222
    v_mfma_f32_16x16x32_bf16 v[72:75], a[60:63], a[72:75], v[72:75]
    ds_read_b128 a[4:7], v20 offset:2048
    v_mul_f32 v233, v233, v223
    v_mfma_f32_16x16x32_bf16 v[112:115], a[64:67], a[72:75], v[112:115]
    ds_read_b128 a[8:11], v20 offset:4096
    v_cvt_pk_bf16_f32 v234, v232, v233
    v_mfma_f32_16x16x32_bf16 v[152:155], a[68:71], a[72:75], v[152:155]
    ds_read_b128 a[12:15], v20 offset:6144
    v_lshlrev_b32 v232, 16, v234
    v_mfma_f32_16x16x32_bf16 v[36:39], a[56:59], a[76:79], v[36:39]
    ds_read_b128 a[16:19], v22 offset:0
    v_and_b32 v233, 0xffff0000, v234
    v_mfma_f32_16x16x32_bf16 v[76:79], a[60:63], a[76:79], v[76:79]
    ds_read_b128 a[20:23], v22 offset:2048
    v_add_f32 v237, v237, v232
    v_mfma_f32_16x16x32_bf16 v[116:119], a[64:67], a[76:79], v[116:119]
    ds_read_b128 a[24:27], v22 offset:4096
    v_add_f32 v237, v237, v233
    v_mfma_f32_16x16x32_bf16 v[156:159], a[68:71], a[76:79], v[156:159]
    ds_read_b128 a[28:31], v22 offset:6144
    v_lshlrev_b32 v232, 16, v204
    v_mfma_f32_16x16x32_bf16 v[40:43], a[56:59], a[80:83], v[40:43]
    ds_read_b64_tr_b16 a[32:33], v24 offset:0
    v_and_b32 v233, 0xffff0000, v204
    v_mfma_f32_16x16x32_bf16 v[80:83], a[60:63], a[80:83], v[80:83]
    ds_read_b64_tr_b16 a[34:35], v24 offset:256
    v_mul_f32 v232, v232, v224
    v_mfma_f32_16x16x32_bf16 v[120:123], a[64:67], a[80:83], v[120:123]
    ds_read_b64_tr_b16 a[36:37], v25 offset:0
    v_mfma_f32_16x16x32_bf16 v[160:163], a[68:71], a[80:83], v[160:163]
    ds_read_b64_tr_b16 a[38:39], v25 offset:256
    v_mfma_f32_16x16x32_bf16 v[44:47], a[56:59], a[84:87], v[44:47]
    ds_read_b64_tr_b16 a[40:41], v24 offset:4096
    v_mfma_f32_16x16x32_bf16 v[84:87], a[60:63], a[84:87], v[84:87]
    ds_read_b64_tr_b16 a[42:43], v24 offset:4352
    v_mfma_f32_16x16x32_bf16 v[124:127], a[64:67], a[84:87], v[124:127]
    ds_read_b64_tr_b16 a[44:45], v25 offset:4096
    v_mfma_f32_16x16x32_bf16 v[164:167], a[68:71], a[84:87], v[164:167]
    ds_read_b64_tr_b16 a[46:47], v25 offset:4352
    v_mfma_f32_16x16x32_bf16 v[48:51], a[88:91], a[56:59], v[48:51]
    ds_read_b64_tr_b16 a[48:49], v24 offset:8192
    v_mfma_f32_16x16x32_bf16 v[88:91], a[88:91], a[60:63], v[88:91]
    ds_read_b64_tr_b16 a[50:51], v24 offset:8448
    v_mfma_f32_16x16x32_bf16 v[128:131], a[88:91], a[64:67], v[128:131]
    ds_read_b64_tr_b16 a[52:53], v25 offset:8192
    v_mfma_f32_16x16x32_bf16 v[168:171], a[88:91], a[68:71], v[168:171]
    ds_read_b64_tr_b16 a[54:55], v25 offset:8448
    v_mfma_f32_16x16x32_bf16 v[52:55], a[92:95], a[56:59], v[52:55]
    s_add_u32 s35, s41, 11
    v_mfma_f32_16x16x32_bf16 v[92:95], a[92:95], a[60:63], v[92:95]
    s_and_b32 s35, s35, 15
    v_mfma_f32_16x16x32_bf16 v[132:135], a[92:95], a[64:67], v[132:135]
    s_mul_i32 s36, s35, 393216
    v_mfma_f32_16x16x32_bf16 v[172:175], a[92:95], a[68:71], v[172:175]
    s_lshl_b32 s35, s35, 7
    v_mfma_f32_16x16x32_bf16 v[56:59], a[96:99], a[56:59], v[56:59]
    s_add_u32 m0, s37, 106496
    v_mfma_f32_16x16x32_bf16 v[96:99], a[96:99], a[60:63], v[96:99]
    buffer_load_dwordx4 v8, s[8:11], s35 offen lds
    v_mfma_f32_16x16x32_bf16 v[136:139], a[96:99], a[64:67], v[136:139]
    s_add_u32 m0, s37, 107520
    v_mfma_f32_16x16x32_bf16 v[176:179], a[96:99], a[68:71], v[176:179]
    buffer_load_dwordx4 v9, s[8:11], s35 offen lds
    v_mfma_f32_16x16x32_bf16 v[60:63], a[100:103], a[56:59], v[60:63]
    s_add_u32 m0, s37, 108544
    v_mfma_f32_16x16x32_bf16 v[100:103], a[100:103], a[60:63], v[100:103]
    buffer_load_dwordx4 v10, s[8:11], s35 offen lds
    v_mfma_f32_16x16x32_bf16 v[140:143], a[100:103], a[64:67], v[140:143]
    s_add_u32 m0, s37, 109568
    v_mfma_f32_16x16x32_bf16 v[180:183], a[100:103], a[68:71], v[180:183]
    buffer_load_dwordx4 v11, s[8:11], s35 offen lds
    v_mfma_f32_16x16x32_bf16 v[64:67], a[56:59], a[104:107], v[64:67]
    s_add_u32 m0, s37, 110592
    v_mfma_f32_16x16x32_bf16 v[104:107], a[60:63], a[104:107], v[104:107]
    buffer_load_dwordx4 v12, s[8:11], s35 offen lds
    v_mfma_f32_16x16x32_bf16 v[144:147], a[64:67], a[104:107], v[144:147]
    s_add_u32 m0, s37, 111616
    v_mfma_f32_16x16x32_bf16 v[184:187], a[68:71], a[104:107], v[184:187]
    buffer_load_dwordx4 v13, s[8:11], s35 offen lds
    v_mfma_f32_16x16x32_bf16 v[68:71], a[56:59], a[108:111], v[68:71]
    v_mfma_f32_16x16x32_bf16 v[108:111], a[60:63], a[108:111], v[108:111]
    v_mfma_f32_16x16x32_bf16 v[148:151], a[64:67], a[108:111], v[148:151]
    v_mfma_f32_16x16x32_bf16 v[188:191], a[68:71], a[108:111], v[188:191]
    s_waitcnt lgkmcnt(0)
    v_mfma_f32_16x16x32_bf16 v[32:35], a[0:3], a[16:19], v[32:35]
    ds_read_b128 a[56:59], v21 offset:0
    v_mul_f32 v233, v233, v225
    v_mfma_f32_16x16x32_bf16 v[72:75], a[4:7], a[16:19], v[72:75]
    ds_read_b128 a[60:63], v21 offset:2048
    v_cvt_pk_bf16_f32 v234, v232, v233
    v_mfma_f32_16x16x32_bf16 v[112:115], a[8:11], a[16:19], v[112:115]
    ds_read_b128 a[64:67], v21 offset:4096
    v_lshlrev_b32 v232, 16, v234
    v_mfma_f32_16x16x32_bf16 v[152:155], a[12:15], a[16:19], v[152:155]
    ds_read_b128 a[68:71], v21 offset:6144
    v_and_b32 v233, 0xffff0000, v234
    v_mfma_f32_16x16x32_bf16 v[36:39], a[0:3], a[20:23], v[36:39]
    ds_read_b128 a[72:75], v23 offset:0
    v_add_f32 v237, v237, v232
    v_mfma_f32_16x16x32_bf16 v[76:79], a[4:7], a[20:23], v[76:79]
    ds_read_b128 a[76:79], v23 offset:2048
    v_add_f32 v237, v237, v233
    v_mfma_f32_16x16x32_bf16 v[116:119], a[8:11], a[20:23], v[116:119]
    ds_read_b128 a[80:83], v23 offset:4096
    v_lshlrev_b32 v232, 16, v205
    v_mfma_f32_16x16x32_bf16 v[156:159], a[12:15], a[20:23], v[156:159]
    ds_read_b128 a[84:87], v23 offset:6144
    v_and_b32 v233, 0xffff0000, v205
    v_mfma_f32_16x16x32_bf16 v[40:43], a[0:3], a[24:27], v[40:43]
    ds_read_b64_tr_b16 a[88:89], v24 offset:2048
    v_mul_f32 v232, v232, v226
    v_mfma_f32_16x16x32_bf16 v[80:83], a[4:7], a[24:27], v[80:83]
    ds_read_b64_tr_b16 a[90:91], v24 offset:2304
    v_mul_f32 v233, v233, v227
    v_mfma_f32_16x16x32_bf16 v[120:123], a[8:11], a[24:27], v[120:123]
    ds_read_b64_tr_b16 a[92:93], v25 offset:2048
    v_mfma_f32_16x16x32_bf16 v[160:163], a[12:15], a[24:27], v[160:163]
    ds_read_b64_tr_b16 a[94:95], v25 offset:2304
    v_mfma_f32_16x16x32_bf16 v[44:47], a[0:3], a[28:31], v[44:47]
    ds_read_b64_tr_b16 a[96:97], v24 offset:6144
    v_mfma_f32_16x16x32_bf16 v[84:87], a[4:7], a[28:31], v[84:87]
    ds_read_b64_tr_b16 a[98:99], v24 offset:6400
    v_mfma_f32_16x16x32_bf16 v[124:127], a[8:11], a[28:31], v[124:127]
    ds_read_b64_tr_b16 a[100:101], v25 offset:6144
    v_mfma_f32_16x16x32_bf16 v[164:167], a[12:15], a[28:31], v[164:167]
    ds_read_b64_tr_b16 a[102:103], v25 offset:6400
    v_mfma_f32_16x16x32_bf16 v[48:51], a[32:35], a[0:3], v[48:51]
    ds_read_b64_tr_b16 a[104:105], v24 offset:10240
    v_mfma_f32_16x16x32_bf16 v[88:91], a[32:35], a[4:7], v[88:91]
    ds_read_b64_tr_b16 a[106:107], v24 offset:10496
    v_mfma_f32_16x16x32_bf16 v[128:131], a[32:35], a[8:11], v[128:131]
    ds_read_b64_tr_b16 a[108:109], v25 offset:10240
    v_mfma_f32_16x16x32_bf16 v[168:171], a[32:35], a[12:15], v[168:171]
    ds_read_b64_tr_b16 a[110:111], v25 offset:10496
    v_mfma_f32_16x16x32_bf16 v[52:55], a[36:39], a[0:3], v[52:55]
    s_add_u32 m0, s37, 112640
    v_mfma_f32_16x16x32_bf16 v[92:95], a[36:39], a[4:7], v[92:95]
    buffer_load_dwordx4 v14, s[8:11], s35 offen lds
    v_mfma_f32_16x16x32_bf16 v[132:135], a[36:39], a[8:11], v[132:135]
    s_add_u32 m0, s37, 113664
    v_mfma_f32_16x16x32_bf16 v[172:175], a[36:39], a[12:15], v[172:175]
    buffer_load_dwordx4 v15, s[8:11], s35 offen lds
    v_mfma_f32_16x16x32_bf16 v[56:59], a[40:43], a[0:3], v[56:59]
    s_add_u32 m0, s38, 139264
    v_mfma_f32_16x16x32_bf16 v[96:99], a[40:43], a[4:7], v[96:99]
    buffer_load_dwordx4 v16, s[12:15], s35 offen lds
    v_mfma_f32_16x16x32_bf16 v[136:139], a[40:43], a[8:11], v[136:139]
    s_add_u32 m0, s38, 143360
    v_mfma_f32_16x16x32_bf16 v[176:179], a[40:43], a[12:15], v[176:179]
    buffer_load_dwordx4 v16, s[16:19], s35 offen lds
    v_mfma_f32_16x16x32_bf16 v[60:63], a[44:47], a[0:3], v[60:63]
    s_add_u32 m0, s38, 147456
    v_mfma_f32_16x16x32_bf16 v[100:103], a[44:47], a[4:7], v[100:103]
    buffer_load_dwordx4 v17, s[20:23], s36 offen lds
    v_mfma_f32_16x16x32_bf16 v[140:143], a[44:47], a[8:11], v[140:143]
    s_add_u32 m0, s38, 151552
    v_mfma_f32_16x16x32_bf16 v[180:183], a[44:47], a[12:15], v[180:183]
    buffer_load_dwordx4 v18, s[20:23], s36 offen lds
    v_mfma_f32_16x16x32_bf16 v[64:67], a[0:3], a[48:51], v[64:67]
    s_add_u32 m0, s38, 155648
    v_mfma_f32_16x16x32_bf16 v[104:107], a[4:7], a[48:51], v[104:107]
    buffer_load_dwordx4 v19, s[20:23], s36 offen lds
    v_mfma_f32_16x16x32_bf16 v[144:147], a[8:11], a[48:51], v[144:147]
    v_mfma_f32_16x16x32_bf16 v[184:187], a[12:15], a[48:51], v[184:187]
    v_mfma_f32_16x16x32_bf16 v[68:71], a[0:3], a[52:55], v[68:71]
    v_mfma_f32_16x16x32_bf16 v[108:111], a[4:7], a[52:55], v[108:111]
    v_mfma_f32_16x16x32_bf16 v[148:151], a[8:11], a[52:55], v[148:151]
    v_mfma_f32_16x16x32_bf16 v[188:191], a[12:15], a[52:55], v[188:191]
    s_waitcnt lgkmcnt(0)
    s_waitcnt vmcnt(13)
    s_barrier
    v_mfma_f32_16x16x32_bf16 v[32:35], a[56:59], a[72:75], v[32:35]
    ds_read_b128 a[0:3], v20 offset:53248
    v_cvt_pk_bf16_f32 v234, v232, v233
    v_mfma_f32_16x16x32_bf16 v[72:75], a[60:63], a[72:75], v[72:75]
    ds_read_b128 a[4:7], v20 offset:55296
    v_lshlrev_b32 v232, 16, v234
    v_mfma_f32_16x16x32_bf16 v[112:115], a[64:67], a[72:75], v[112:115]
    ds_read_b128 a[8:11], v20 offset:57344
    v_and_b32 v233, 0xffff0000, v234
    v_mfma_f32_16x16x32_bf16 v[152:155], a[68:71], a[72:75], v[152:155]
    ds_read_b128 a[12:15], v20 offset:59392
    v_add_f32 v237, v237, v232
    v_mfma_f32_16x16x32_bf16 v[36:39], a[56:59], a[76:79], v[36:39]
    ds_read_b128 a[16:19], v22 offset:53248
    v_add_f32 v237, v237, v233
    v_mfma_f32_16x16x32_bf16 v[76:79], a[60:63], a[76:79], v[76:79]
    ds_read_b128 a[20:23], v22 offset:55296
    v_lshlrev_b32 v232, 16, v206
    v_mfma_f32_16x16x32_bf16 v[116:119], a[64:67], a[76:79], v[116:119]
    ds_read_b128 a[24:27], v22 offset:57344
    v_and_b32 v233, 0xffff0000, v206
    v_mfma_f32_16x16x32_bf16 v[156:159], a[68:71], a[76:79], v[156:159]
    ds_read_b128 a[28:31], v22 offset:59392
    v_mul_f32 v232, v232, v228
    v_mfma_f32_16x16x32_bf16 v[40:43], a[56:59], a[80:83], v[40:43]
    ds_read_b64_tr_b16 a[32:33], v24 offset:53248
    v_mul_f32 v233, v233, v229
    v_mfma_f32_16x16x32_bf16 v[80:83], a[60:63], a[80:83], v[80:83]
    ds_read_b64_tr_b16 a[34:35], v24 offset:53504
    v_cvt_pk_bf16_f32 v234, v232, v233
    v_mfma_f32_16x16x32_bf16 v[120:123], a[64:67], a[80:83], v[120:123]
    ds_read_b64_tr_b16 a[36:37], v25 offset:53248
    v_mfma_f32_16x16x32_bf16 v[160:163], a[68:71], a[80:83], v[160:163]
    ds_read_b64_tr_b16 a[38:39], v25 offset:53504
    v_mfma_f32_16x16x32_bf16 v[44:47], a[56:59], a[84:87], v[44:47]
    ds_read_b64_tr_b16 a[40:41], v24 offset:57344
    v_mfma_f32_16x16x32_bf16 v[84:87], a[60:63], a[84:87], v[84:87]
    ds_read_b64_tr_b16 a[42:43], v24 offset:57600
    v_mfma_f32_16x16x32_bf16 v[124:127], a[64:67], a[84:87], v[124:127]
    ds_read_b64_tr_b16 a[44:45], v25 offset:57344
    v_mfma_f32_16x16x32_bf16 v[164:167], a[68:71], a[84:87], v[164:167]
    ds_read_b64_tr_b16 a[46:47], v25 offset:57600
    v_mfma_f32_16x16x32_bf16 v[48:51], a[88:91], a[56:59], v[48:51]
    ds_read_b64_tr_b16 a[48:49], v24 offset:61440
    v_mfma_f32_16x16x32_bf16 v[88:91], a[88:91], a[60:63], v[88:91]
    ds_read_b64_tr_b16 a[50:51], v24 offset:61696
    v_mfma_f32_16x16x32_bf16 v[128:131], a[88:91], a[64:67], v[128:131]
    ds_read_b64_tr_b16 a[52:53], v25 offset:61440
    v_mfma_f32_16x16x32_bf16 v[168:171], a[88:91], a[68:71], v[168:171]
    ds_read_b64_tr_b16 a[54:55], v25 offset:61696
    v_mfma_f32_16x16x32_bf16 v[52:55], a[92:95], a[56:59], v[52:55]
    s_add_u32 s35, s41, 12
    v_mfma_f32_16x16x32_bf16 v[92:95], a[92:95], a[60:63], v[92:95]
    s_and_b32 s35, s35, 15
    v_mfma_f32_16x16x32_bf16 v[132:135], a[92:95], a[64:67], v[132:135]
    s_mul_i32 s36, s35, 393216
    v_mfma_f32_16x16x32_bf16 v[172:175], a[92:95], a[68:71], v[172:175]
    s_lshl_b32 s35, s35, 7
    v_mfma_f32_16x16x32_bf16 v[56:59], a[96:99], a[56:59], v[56:59]
    s_add_u32 m0, s37, 0
    v_mfma_f32_16x16x32_bf16 v[96:99], a[96:99], a[60:63], v[96:99]
    buffer_load_dwordx4 v8, s[8:11], s35 offen lds
    v_mfma_f32_16x16x32_bf16 v[136:139], a[96:99], a[64:67], v[136:139]
    s_add_u32 m0, s37, 1024
    v_mfma_f32_16x16x32_bf16 v[176:179], a[96:99], a[68:71], v[176:179]
    buffer_load_dwordx4 v9, s[8:11], s35 offen lds
    v_mfma_f32_16x16x32_bf16 v[60:63], a[100:103], a[56:59], v[60:63]
    s_add_u32 m0, s37, 2048
    v_mfma_f32_16x16x32_bf16 v[100:103], a[100:103], a[60:63], v[100:103]
    buffer_load_dwordx4 v10, s[8:11], s35 offen lds
    v_mfma_f32_16x16x32_bf16 v[140:143], a[100:103], a[64:67], v[140:143]
    s_add_u32 m0, s37, 3072
    v_mfma_f32_16x16x32_bf16 v[180:183], a[100:103], a[68:71], v[180:183]
    buffer_load_dwordx4 v11, s[8:11], s35 offen lds
    v_mfma_f32_16x16x32_bf16 v[64:67], a[56:59], a[104:107], v[64:67]
    s_add_u32 m0, s37, 4096
    v_mfma_f32_16x16x32_bf16 v[104:107], a[60:63], a[104:107], v[104:107]
    buffer_load_dwordx4 v12, s[8:11], s35 offen lds
    v_mfma_f32_16x16x32_bf16 v[144:147], a[64:67], a[104:107], v[144:147]
    s_add_u32 m0, s37, 5120
    v_mfma_f32_16x16x32_bf16 v[184:187], a[68:71], a[104:107], v[184:187]
    buffer_load_dwordx4 v13, s[8:11], s35 offen lds
    v_mfma_f32_16x16x32_bf16 v[68:71], a[56:59], a[108:111], v[68:71]
    v_mfma_f32_16x16x32_bf16 v[108:111], a[60:63], a[108:111], v[108:111]
    v_mfma_f32_16x16x32_bf16 v[148:151], a[64:67], a[108:111], v[148:151]
    v_mfma_f32_16x16x32_bf16 v[188:191], a[68:71], a[108:111], v[188:191]
    s_waitcnt lgkmcnt(0)
    v_mfma_f32_16x16x32_bf16 v[32:35], a[0:3], a[16:19], v[32:35]
    ds_read_b128 a[56:59], v21 offset:53248
    v_lshlrev_b32 v232, 16, v234
    v_mfma_f32_16x16x32_bf16 v[72:75], a[4:7], a[16:19], v[72:75]
    ds_read_b128 a[60:63], v21 offset:55296
    v_and_b32 v233, 0xffff0000, v234
    v_mfma_f32_16x16x32_bf16 v[112:115], a[8:11], a[16:19], v[112:115]
    ds_read_b128 a[64:67], v21 offset:57344
    v_add_f32 v237, v237, v232
    v_mfma_f32_16x16x32_bf16 v[152:155], a[12:15], a[16:19], v[152:155]
    ds_read_b128 a[68:71], v21 offset:59392
    v_add_f32 v237, v237, v233
    v_mfma_f32_16x16x32_bf16 v[36:39], a[0:3], a[20:23], v[36:39]
    ds_read_b128 a[72:75], v23 offset:53248
    v_lshlrev_b32 v232, 16, v207
    v_mfma_f32_16x16x32_bf16 v[76:79], a[4:7], a[20:23], v[76:79]
    ds_read_b128 a[76:79], v23 offset:55296
    v_and_b32 v233, 0xffff0000, v207
    v_mfma_f32_16x16x32_bf16 v[116:119], a[8:11], a[20:23], v[116:119]
    ds_read_b128 a[80:83], v23 offset:57344
    v_mul_f32 v232, v232, v230
    v_mfma_f32_16x16x32_bf16 v[156:159], a[12:15], a[20:23], v[156:159]
    ds_read_b128 a[84:87], v23 offset:59392
    v_mul_f32 v233, v233, v231
    v_mfma_f32_16x16x32_bf16 v[40:43], a[0:3], a[24:27], v[40:43]
    ds_read_b64_tr_b16 a[88:89], v24 offset:55296
    v_cvt_pk_bf16_f32 v234, v232, v233
    v_mfma_f32_16x16x32_bf16 v[80:83], a[4:7], a[24:27], v[80:83]
    ds_read_b64_tr_b16 a[90:91], v24 offset:55552
    v_lshlrev_b32 v232, 16, v234
    v_mfma_f32_16x16x32_bf16 v[120:123], a[8:11], a[24:27], v[120:123]
    ds_read_b64_tr_b16 a[92:93], v25 offset:55296
    v_mfma_f32_16x16x32_bf16 v[160:163], a[12:15], a[24:27], v[160:163]
    ds_read_b64_tr_b16 a[94:95], v25 offset:55552
    v_mfma_f32_16x16x32_bf16 v[44:47], a[0:3], a[28:31], v[44:47]
    ds_read_b64_tr_b16 a[96:97], v24 offset:59392
    v_mfma_f32_16x16x32_bf16 v[84:87], a[4:7], a[28:31], v[84:87]
    ds_read_b64_tr_b16 a[98:99], v24 offset:59648
    v_mfma_f32_16x16x32_bf16 v[124:127], a[8:11], a[28:31], v[124:127]
    ds_read_b64_tr_b16 a[100:101], v25 offset:59392
    v_mfma_f32_16x16x32_bf16 v[164:167], a[12:15], a[28:31], v[164:167]
    ds_read_b64_tr_b16 a[102:103], v25 offset:59648
    v_mfma_f32_16x16x32_bf16 v[48:51], a[32:35], a[0:3], v[48:51]
    ds_read_b64_tr_b16 a[104:105], v24 offset:63488
    v_mfma_f32_16x16x32_bf16 v[88:91], a[32:35], a[4:7], v[88:91]
    ds_read_b64_tr_b16 a[106:107], v24 offset:63744
    v_mfma_f32_16x16x32_bf16 v[128:131], a[32:35], a[8:11], v[128:131]
    ds_read_b64_tr_b16 a[108:109], v25 offset:63488
    v_mfma_f32_16x16x32_bf16 v[168:171], a[32:35], a[12:15], v[168:171]
    ds_read_b64_tr_b16 a[110:111], v25 offset:63744
    v_mfma_f32_16x16x32_bf16 v[52:55], a[36:39], a[0:3], v[52:55]
    s_add_u32 m0, s37, 6144
    v_mfma_f32_16x16x32_bf16 v[92:95], a[36:39], a[4:7], v[92:95]
    buffer_load_dwordx4 v14, s[8:11], s35 offen lds
    v_mfma_f32_16x16x32_bf16 v[132:135], a[36:39], a[8:11], v[132:135]
    s_add_u32 m0, s37, 7168
    v_mfma_f32_16x16x32_bf16 v[172:175], a[36:39], a[12:15], v[172:175]
    buffer_load_dwordx4 v15, s[8:11], s35 offen lds
    v_mfma_f32_16x16x32_bf16 v[56:59], a[40:43], a[0:3], v[56:59]
    s_add_u32 m0, s38, 32768
    v_mfma_f32_16x16x32_bf16 v[96:99], a[40:43], a[4:7], v[96:99]
    buffer_load_dwordx4 v16, s[12:15], s35 offen lds
    v_mfma_f32_16x16x32_bf16 v[136:139], a[40:43], a[8:11], v[136:139]
    s_add_u32 m0, s38, 36864
    v_mfma_f32_16x16x32_bf16 v[176:179], a[40:43], a[12:15], v[176:179]
    buffer_load_dwordx4 v16, s[16:19], s35 offen lds
    v_mfma_f32_16x16x32_bf16 v[60:63], a[44:47], a[0:3], v[60:63]
    s_add_u32 m0, s38, 40960
    v_mfma_f32_16x16x32_bf16 v[100:103], a[44:47], a[4:7], v[100:103]
    buffer_load_dwordx4 v17, s[20:23], s36 offen lds
    v_mfma_f32_16x16x32_bf16 v[140:143], a[44:47], a[8:11], v[140:143]
    s_add_u32 m0, s38, 45056
    v_mfma_f32_16x16x32_bf16 v[180:183], a[44:47], a[12:15], v[180:183]
    buffer_load_dwordx4 v18, s[20:23], s36 offen lds
    v_mfma_f32_16x16x32_bf16 v[64:67], a[0:3], a[48:51], v[64:67]
    s_add_u32 m0, s38, 49152
    v_mfma_f32_16x16x32_bf16 v[104:107], a[4:7], a[48:51], v[104:107]
    buffer_load_dwordx4 v19, s[20:23], s36 offen lds
    v_mfma_f32_16x16x32_bf16 v[144:147], a[8:11], a[48:51], v[144:147]
    v_mfma_f32_16x16x32_bf16 v[184:187], a[12:15], a[48:51], v[184:187]
    v_mfma_f32_16x16x32_bf16 v[68:71], a[0:3], a[52:55], v[68:71]
    v_mfma_f32_16x16x32_bf16 v[108:111], a[4:7], a[52:55], v[108:111]
    v_mfma_f32_16x16x32_bf16 v[148:151], a[8:11], a[52:55], v[148:151]
    v_mfma_f32_16x16x32_bf16 v[188:191], a[12:15], a[52:55], v[188:191]
    s_waitcnt lgkmcnt(0)
    s_waitcnt vmcnt(13)
    s_barrier
    v_mfma_f32_16x16x32_bf16 v[32:35], a[56:59], a[72:75], v[32:35]
    ds_read_b128 a[0:3], v240 offset:0
    v_and_b32 v233, 0xffff0000, v234
    v_mfma_f32_16x16x32_bf16 v[72:75], a[60:63], a[72:75], v[72:75]
    ds_read_b128 a[4:7], v240 offset:2048
    v_add_f32 v237, v237, v232
    v_mfma_f32_16x16x32_bf16 v[112:115], a[64:67], a[72:75], v[112:115]
    ds_read_b128 a[8:11], v240 offset:4096
    v_add_f32 v237, v237, v233
    v_mfma_f32_16x16x32_bf16 v[152:155], a[68:71], a[72:75], v[152:155]
    ds_read_b128 a[12:15], v240 offset:6144
    s_nop 1
    v_mfma_f32_16x16x32_bf16 v[36:39], a[56:59], a[76:79], v[36:39]
    ds_read_b128 a[16:19], v242 offset:0
    v_add_f32_dpp v236, v236, v236 row_shr:1 row_mask:0xf bank_mask:0xf bound_ctrl:0
    v_mfma_f32_16x16x32_bf16 v[76:79], a[60:63], a[76:79], v[76:79]
    ds_read_b128 a[20:23], v242 offset:2048
    v_add_f32_dpp v237, v237, v237 row_shr:1 row_mask:0xf bank_mask:0xf bound_ctrl:0
    v_mfma_f32_16x16x32_bf16 v[116:119], a[64:67], a[76:79], v[116:119]
    ds_read_b128 a[24:27], v242 offset:4096
    s_nop 1
    v_mfma_f32_16x16x32_bf16 v[156:159], a[68:71], a[76:79], v[156:159]
    ds_read_b128 a[28:31], v242 offset:6144
    v_add_f32_dpp v236, v236, v236 row_shr:2 row_mask:0xf bank_mask:0xf bound_ctrl:0
    v_mfma_f32_16x16x32_bf16 v[40:43], a[56:59], a[80:83], v[40:43]
    ds_read_b64_tr_b16 a[32:33], v244 offset:0
    v_add_f32_dpp v237, v237, v237 row_shr:2 row_mask:0xf bank_mask:0xf bound_ctrl:0
    v_mfma_f32_16x16x32_bf16 v[80:83], a[60:63], a[80:83], v[80:83]
    ds_read_b64_tr_b16 a[34:35], v244 offset:256
    s_nop 1
    v_mfma_f32_16x16x32_bf16 v[120:123], a[64:67], a[80:83], v[120:123]
    ds_read_b64_tr_b16 a[36:37], v245 offset:0
    v_mfma_f32_16x16x32_bf16 v[160:163], a[68:71], a[80:83], v[160:163]
    ds_read_b64_tr_b16 a[38:39], v245 offset:256
    v_mfma_f32_16x16x32_bf16 v[44:47], a[56:59], a[84:87], v[44:47]
    ds_read_b64_tr_b16 a[40:41], v244 offset:4096
    v_mfma_f32_16x16x32_bf16 v[84:87], a[60:63], a[84:87], v[84:87]
    ds_read_b64_tr_b16 a[42:43], v244 offset:4352
    v_mfma_f32_16x16x32_bf16 v[124:127], a[64:67], a[84:87], v[124:127]
    ds_read_b64_tr_b16 a[44:45], v245 offset:4096
    v_mfma_f32_16x16x32_bf16 v[164:167], a[68:71], a[84:87], v[164:167]
    ds_read_b64_tr_b16 a[46:47], v245 offset:4352
    v_mfma_f32_16x16x32_bf16 v[48:51], a[88:91], a[56:59], v[48:51]
    ds_read_b64_tr_b16 a[48:49], v244 offset:8192
    v_mfma_f32_16x16x32_bf16 v[88:91], a[88:91], a[60:63], v[88:91]
    ds_read_b64_tr_b16 a[50:51], v244 offset:8448
    v_mfma_f32_16x16x32_bf16 v[128:131], a[88:91], a[64:67], v[128:131]
    ds_read_b64_tr_b16 a[52:53], v245 offset:8192
    v_mfma_f32_16x16x32_bf16 v[168:171], a[88:91], a[68:71], v[168:171]
    ds_read_b64_tr_b16 a[54:55], v245 offset:8448
    v_mfma_f32_16x16x32_bf16 v[52:55], a[92:95], a[56:59], v[52:55]
    s_add_u32 s35, s41, 13
    v_mfma_f32_16x16x32_bf16 v[92:95], a[92:95], a[60:63], v[92:95]
    s_and_b32 s35, s35, 15
    v_mfma_f32_16x16x32_bf16 v[132:135], a[92:95], a[64:67], v[132:135]
    s_mul_i32 s36, s35, 393216
    v_mfma_f32_16x16x32_bf16 v[172:175], a[92:95], a[68:71], v[172:175]
    s_lshl_b32 s35, s35, 7
    v_mfma_f32_16x16x32_bf16 v[56:59], a[96:99], a[56:59], v[56:59]
    s_add_u32 m0, s37, 53248
    v_mfma_f32_16x16x32_bf16 v[96:99], a[96:99], a[60:63], v[96:99]
    buffer_load_dwordx4 v8, s[8:11], s35 offen lds
    v_mfma_f32_16x16x32_bf16 v[136:139], a[96:99], a[64:67], v[136:139]
    s_add_u32 m0, s37, 54272
    v_mfma_f32_16x16x32_bf16 v[176:179], a[96:99], a[68:71], v[176:179]
    buffer_load_dwordx4 v9, s[8:11], s35 offen lds
    v_mfma_f32_16x16x32_bf16 v[60:63], a[100:103], a[56:59], v[60:63]
    s_add_u32 m0, s37, 55296
    v_mfma_f32_16x16x32_bf16 v[100:103], a[100:103], a[60:63], v[100:103]
    buffer_load_dwordx4 v10, s[8:11], s35 offen lds
    v_mfma_f32_16x16x32_bf16 v[140:143], a[100:103], a[64:67], v[140:143]
    s_add_u32 m0, s37, 56320
    v_mfma_f32_16x16x32_bf16 v[180:183], a[100:103], a[68:71], v[180:183]
    buffer_load_dwordx4 v11, s[8:11], s35 offen lds
    v_mfma_f32_16x16x32_bf16 v[64:67], a[56:59], a[104:107], v[64:67]
    s_add_u32 m0, s37, 57344
    v_mfma_f32_16x16x32_bf16 v[104:107], a[60:63], a[104:107], v[104:107]
    buffer_load_dwordx4 v12, s[8:11], s35 offen lds
    v_mfma_f32_16x16x32_bf16 v[144:147], a[64:67], a[104:107], v[144:147]
    s_add_u32 m0, s37, 58368
    v_mfma_f32_16x16x32_bf16 v[184:187], a[68:71], a[104:107], v[184:187]
    buffer_load_dwordx4 v13, s[8:11], s35 offen lds
    v_mfma_f32_16x16x32_bf16 v[68:71], a[56:59], a[108:111], v[68:71]
    v_mfma_f32_16x16x32_bf16 v[108:111], a[60:63], a[108:111], v[108:111]
    v_mfma_f32_16x16x32_bf16 v[148:151], a[64:67], a[108:111], v[148:151]
    v_mfma_f32_16x16x32_bf16 v[188:191], a[68:71], a[108:111], v[188:191]
    s_waitcnt lgkmcnt(0)
    v_mfma_f32_16x16x32_bf16 v[32:35], a[0:3], a[16:19], v[32:35]
    ds_read_b128 a[56:59], v241 offset:0
    v_add_f32_dpp v236, v236, v236 row_shr:4 row_mask:0xf bank_mask:0xf bound_ctrl:0
    v_mfma_f32_16x16x32_bf16 v[72:75], a[4:7], a[16:19], v[72:75]
    ds_read_b128 a[60:63], v241 offset:2048
    v_add_f32_dpp v237, v237, v237 row_shr:4 row_mask:0xf bank_mask:0xf bound_ctrl:0
    v_mfma_f32_16x16x32_bf16 v[112:115], a[8:11], a[16:19], v[112:115]
    ds_read_b128 a[64:67], v241 offset:4096
    s_nop 1
    v_mfma_f32_16x16x32_bf16 v[152:155], a[12:15], a[16:19], v[152:155]
    ds_read_b128 a[68:71], v241 offset:6144
    v_add_f32_dpp v236, v236, v236 row_shr:8 row_mask:0xf bank_mask:0xf bound_ctrl:0
    v_mfma_f32_16x16x32_bf16 v[36:39], a[0:3], a[20:23], v[36:39]
    ds_read_b128 a[72:75], v243 offset:0
    v_add_f32_dpp v237, v237, v237 row_shr:8 row_mask:0xf bank_mask:0xf bound_ctrl:0
    v_mfma_f32_16x16x32_bf16 v[76:79], a[4:7], a[20:23], v[76:79]
    ds_read_b128 a[76:79], v243 offset:2048
    s_nop 1
    v_mfma_f32_16x16x32_bf16 v[116:119], a[8:11], a[20:23], v[116:119]
    ds_read_b128 a[80:83], v243 offset:4096
    v_add_f32_dpp v236, v236, v236 row_bcast:15 row_mask:0xa bank_mask:0xf
    v_mfma_f32_16x16x32_bf16 v[156:159], a[12:15], a[20:23], v[156:159]
    ds_read_b128 a[84:87], v243 offset:6144
    v_add_f32_dpp v237, v237, v237 row_bcast:15 row_mask:0xa bank_mask:0xf
    v_mfma_f32_16x16x32_bf16 v[40:43], a[0:3], a[24:27], v[40:43]
    ds_read_b64_tr_b16 a[88:89], v244 offset:2048
    s_nop 1
    v_mfma_f32_16x16x32_bf16 v[80:83], a[4:7], a[24:27], v[80:83]
    ds_read_b64_tr_b16 a[90:91], v244 offset:2304
    v_add_f32_dpp v236, v236, v236 row_bcast:31 row_mask:0xc bank_mask:0xf
    v_mfma_f32_16x16x32_bf16 v[120:123], a[8:11], a[24:27], v[120:123]
    ds_read_b64_tr_b16 a[92:93], v245 offset:2048
    v_mfma_f32_16x16x32_bf16 v[160:163], a[12:15], a[24:27], v[160:163]
    ds_read_b64_tr_b16 a[94:95], v245 offset:2304
    v_mfma_f32_16x16x32_bf16 v[44:47], a[0:3], a[28:31], v[44:47]
    ds_read_b64_tr_b16 a[96:97], v244 offset:6144
    v_mfma_f32_16x16x32_bf16 v[84:87], a[4:7], a[28:31], v[84:87]
    ds_read_b64_tr_b16 a[98:99], v244 offset:6400
    v_mfma_f32_16x16x32_bf16 v[124:127], a[8:11], a[28:31], v[124:127]
    ds_read_b64_tr_b16 a[100:101], v245 offset:6144
    v_mfma_f32_16x16x32_bf16 v[164:167], a[12:15], a[28:31], v[164:167]
    ds_read_b64_tr_b16 a[102:103], v245 offset:6400
    v_mfma_f32_16x16x32_bf16 v[48:51], a[32:35], a[0:3], v[48:51]
    ds_read_b64_tr_b16 a[104:105], v244 offset:10240
    v_mfma_f32_16x16x32_bf16 v[88:91], a[32:35], a[4:7], v[88:91]
    ds_read_b64_tr_b16 a[106:107], v244 offset:10496
    v_mfma_f32_16x16x32_bf16 v[128:131], a[32:35], a[8:11], v[128:131]
    ds_read_b64_tr_b16 a[108:109], v245 offset:10240
    v_mfma_f32_16x16x32_bf16 v[168:171], a[32:35], a[12:15], v[168:171]
    ds_read_b64_tr_b16 a[110:111], v245 offset:10496
    v_mfma_f32_16x16x32_bf16 v[52:55], a[36:39], a[0:3], v[52:55]
    s_add_u32 m0, s37, 59392
    v_mfma_f32_16x16x32_bf16 v[92:95], a[36:39], a[4:7], v[92:95]
    buffer_load_dwordx4 v14, s[8:11], s35 offen lds
    v_mfma_f32_16x16x32_bf16 v[132:135], a[36:39], a[8:11], v[132:135]
    s_add_u32 m0, s37, 60416
    v_mfma_f32_16x16x32_bf16 v[172:175], a[36:39], a[12:15], v[172:175]
    buffer_load_dwordx4 v15, s[8:11], s35 offen lds
    v_mfma_f32_16x16x32_bf16 v[56:59], a[40:43], a[0:3], v[56:59]
    s_add_u32 m0, s38, 86016
    v_mfma_f32_16x16x32_bf16 v[96:99], a[40:43], a[4:7], v[96:99]
    buffer_load_dwordx4 v16, s[12:15], s35 offen lds
    v_mfma_f32_16x16x32_bf16 v[136:139], a[40:43], a[8:11], v[136:139]
    s_add_u32 m0, s38, 90112
    v_mfma_f32_16x16x32_bf16 v[176:179], a[40:43], a[12:15], v[176:179]
    buffer_load_dwordx4 v16, s[16:19], s35 offen lds
    v_mfma_f32_16x16x32_bf16 v[60:63], a[44:47], a[0:3], v[60:63]
    s_add_u32 m0, s38, 94208
    v_mfma_f32_16x16x32_bf16 v[100:103], a[44:47], a[4:7], v[100:103]
    buffer_load_dwordx4 v17, s[20:23], s36 offen lds
    v_mfma_f32_16x16x32_bf16 v[140:143], a[44:47], a[8:11], v[140:143]
    s_add_u32 m0, s38, 98304
    v_mfma_f32_16x16x32_bf16 v[180:183], a[44:47], a[12:15], v[180:183]
    buffer_load_dwordx4 v18, s[20:23], s36 offen lds
    v_mfma_f32_16x16x32_bf16 v[64:67], a[0:3], a[48:51], v[64:67]
    s_add_u32 m0, s38, 102400
    v_mfma_f32_16x16x32_bf16 v[104:107], a[4:7], a[48:51], v[104:107]
    buffer_load_dwordx4 v19, s[20:23], s36 offen lds
    v_mfma_f32_16x16x32_bf16 v[144:147], a[8:11], a[48:51], v[144:147]
    v_mfma_f32_16x16x32_bf16 v[184:187], a[12:15], a[48:51], v[184:187]
    v_mfma_f32_16x16x32_bf16 v[68:71], a[0:3], a[52:55], v[68:71]
    v_mfma_f32_16x16x32_bf16 v[108:111], a[4:7], a[52:55], v[108:111]
    v_mfma_f32_16x16x32_bf16 v[148:151], a[8:11], a[52:55], v[148:151]
    v_mfma_f32_16x16x32_bf16 v[188:191], a[12:15], a[52:55], v[188:191]
    s_waitcnt lgkmcnt(0)
    s_waitcnt vmcnt(13)
    s_barrier
    v_mfma_f32_16x16x32_bf16 v[32:35], a[56:59], a[72:75], v[32:35]
    ds_read_b128 a[0:3], v20 offset:0
    v_add_f32_dpp v237, v237, v237 row_bcast:31 row_mask:0xc bank_mask:0xf
    v_mfma_f32_16x16x32_bf16 v[72:75], a[60:63], a[72:75], v[72:75]
    ds_read_b128 a[4:7], v20 offset:2048
    v_cvt_pk_bf16_f32 v232, v236, v237
    v_mfma_f32_16x16x32_bf16 v[112:115], a[64:67], a[72:75], v[112:115]
    ds_read_b128 a[8:11], v20 offset:4096
    v_lshlrev_b32 v236, 16, v232
    v_mfma_f32_16x16x32_bf16 v[152:155], a[68:71], a[72:75], v[152:155]
    ds_read_b128 a[12:15], v20 offset:6144
    v_and_b32 v237, 0xffff0000, v232
    v_mfma_f32_16x16x32_bf16 v[36:39], a[56:59], a[76:79], v[36:39]
    ds_read_b128 a[16:19], v22 offset:0
    v_mul_f32 v236, 3216550459, v236
    v_mfma_f32_16x16x32_bf16 v[76:79], a[60:63], a[76:79], v[76:79]
    ds_read_b128 a[20:23], v22 offset:2048
    v_mul_f32 v237, 3216550459, v237
    v_mfma_f32_16x16x32_bf16 v[116:119], a[64:67], a[76:79], v[116:119]
    ds_read_b128 a[24:27], v22 offset:4096
    v_exp_f32 v236, v236
    v_mfma_f32_16x16x32_bf16 v[156:159], a[68:71], a[76:79], v[156:159]
    ds_read_b128 a[28:31], v22 offset:6144
    v_exp_f32 v237, v237
    v_mfma_f32_16x16x32_bf16 v[40:43], a[56:59], a[80:83], v[40:43]
    ds_read_b64_tr_b16 a[32:33], v24 offset:0
    s_nop 0
    v_mfma_f32_16x16x32_bf16 v[80:83], a[60:63], a[80:83], v[80:83]
    ds_read_b64_tr_b16 a[34:35], v24 offset:256
    v_add_f32 v236, 1.0, v236
    v_mfma_f32_16x16x32_bf16 v[120:123], a[64:67], a[80:83], v[120:123]
    ds_read_b64_tr_b16 a[36:37], v25 offset:0
    v_mfma_f32_16x16x32_bf16 v[160:163], a[68:71], a[80:83], v[160:163]
    ds_read_b64_tr_b16 a[38:39], v25 offset:256
    v_mfma_f32_16x16x32_bf16 v[44:47], a[56:59], a[84:87], v[44:47]
    ds_read_b64_tr_b16 a[40:41], v24 offset:4096
    v_mfma_f32_16x16x32_bf16 v[84:87], a[60:63], a[84:87], v[84:87]
    ds_read_b64_tr_b16 a[42:43], v24 offset:4352
    v_mfma_f32_16x16x32_bf16 v[124:127], a[64:67], a[84:87], v[124:127]
    ds_read_b64_tr_b16 a[44:45], v25 offset:4096
    v_mfma_f32_16x16x32_bf16 v[164:167], a[68:71], a[84:87], v[164:167]
    ds_read_b64_tr_b16 a[46:47], v25 offset:4352
    v_mfma_f32_16x16x32_bf16 v[48:51], a[88:91], a[56:59], v[48:51]
    ds_read_b64_tr_b16 a[48:49], v24 offset:8192
    v_mfma_f32_16x16x32_bf16 v[88:91], a[88:91], a[60:63], v[88:91]
    ds_read_b64_tr_b16 a[50:51], v24 offset:8448
    v_mfma_f32_16x16x32_bf16 v[128:131], a[88:91], a[64:67], v[128:131]
    ds_read_b64_tr_b16 a[52:53], v25 offset:8192
    v_mfma_f32_16x16x32_bf16 v[168:171], a[88:91], a[68:71], v[168:171]
    ds_read_b64_tr_b16 a[54:55], v25 offset:8448
    v_mfma_f32_16x16x32_bf16 v[52:55], a[92:95], a[56:59], v[52:55]
    s_add_u32 s35, s41, 14
    v_mfma_f32_16x16x32_bf16 v[92:95], a[92:95], a[60:63], v[92:95]
    s_and_b32 s35, s35, 15
    v_mfma_f32_16x16x32_bf16 v[132:135], a[92:95], a[64:67], v[132:135]
    s_mul_i32 s36, s35, 393216
    v_mfma_f32_16x16x32_bf16 v[172:175], a[92:95], a[68:71], v[172:175]
    s_lshl_b32 s35, s35, 7
    v_mfma_f32_16x16x32_bf16 v[56:59], a[96:99], a[56:59], v[56:59]
    s_add_u32 m0, s37, 106496
    v_mfma_f32_16x16x32_bf16 v[96:99], a[96:99], a[60:63], v[96:99]
    buffer_load_dwordx4 v8, s[8:11], s35 offen lds
    v_mfma_f32_16x16x32_bf16 v[136:139], a[96:99], a[64:67], v[136:139]
    s_add_u32 m0, s37, 107520
    v_mfma_f32_16x16x32_bf16 v[176:179], a[96:99], a[68:71], v[176:179]
    buffer_load_dwordx4 v9, s[8:11], s35 offen lds
    v_mfma_f32_16x16x32_bf16 v[60:63], a[100:103], a[56:59], v[60:63]
    s_add_u32 m0, s37, 108544
    v_mfma_f32_16x16x32_bf16 v[100:103], a[100:103], a[60:63], v[100:103]
    buffer_load_dwordx4 v10, s[8:11], s35 offen lds
    v_mfma_f32_16x16x32_bf16 v[140:143], a[100:103], a[64:67], v[140:143]
    s_add_u32 m0, s37, 109568
    v_mfma_f32_16x16x32_bf16 v[180:183], a[100:103], a[68:71], v[180:183]
    buffer_load_dwordx4 v11, s[8:11], s35 offen lds
    v_mfma_f32_16x16x32_bf16 v[64:67], a[56:59], a[104:107], v[64:67]
    s_add_u32 m0, s37, 110592
    v_mfma_f32_16x16x32_bf16 v[104:107], a[60:63], a[104:107], v[104:107]
    buffer_load_dwordx4 v12, s[8:11], s35 offen lds
    v_mfma_f32_16x16x32_bf16 v[144:147], a[64:67], a[104:107], v[144:147]
    s_add_u32 m0, s37, 111616
    v_mfma_f32_16x16x32_bf16 v[184:187], a[68:71], a[104:107], v[184:187]
    buffer_load_dwordx4 v13, s[8:11], s35 offen lds
    v_mfma_f32_16x16x32_bf16 v[68:71], a[56:59], a[108:111], v[68:71]
    v_mfma_f32_16x16x32_bf16 v[108:111], a[60:63], a[108:111], v[108:111]
    v_mfma_f32_16x16x32_bf16 v[148:151], a[64:67], a[108:111], v[148:151]
    v_mfma_f32_16x16x32_bf16 v[188:191], a[68:71], a[108:111], v[188:191]
    s_waitcnt lgkmcnt(0)
    v_mfma_f32_16x16x32_bf16 v[32:35], a[0:3], a[16:19], v[32:35]
    ds_read_b128 a[56:59], v21 offset:0
    v_add_f32 v237, 1.0, v237
    v_mfma_f32_16x16x32_bf16 v[72:75], a[4:7], a[16:19], v[72:75]
    ds_read_b128 a[60:63], v21 offset:2048
    v_rcp_f32 v236, v236
    v_mfma_f32_16x16x32_bf16 v[112:115], a[8:11], a[16:19], v[112:115]
    ds_read_b128 a[64:67], v21 offset:4096
    v_rcp_f32 v237, v237
    v_mfma_f32_16x16x32_bf16 v[152:155], a[12:15], a[16:19], v[152:155]
    ds_read_b128 a[68:71], v21 offset:6144
    s_nop 0
    v_mfma_f32_16x16x32_bf16 v[36:39], a[0:3], a[20:23], v[36:39]
    ds_read_b128 a[72:75], v23 offset:0
    v_cvt_pk_bf16_f32 v232, v236, v237
    v_mfma_f32_16x16x32_bf16 v[76:79], a[4:7], a[20:23], v[76:79]
    ds_read_b128 a[76:79], v23 offset:2048
    v_lshlrev_b32 v236, 16, v232
    v_mfma_f32_16x16x32_bf16 v[116:119], a[8:11], a[20:23], v[116:119]
    ds_read_b128 a[80:83], v23 offset:4096
    v_and_b32 v237, 0xffff0000, v232
    v_mfma_f32_16x16x32_bf16 v[156:159], a[12:15], a[20:23], v[156:159]
    ds_read_b128 a[84:87], v23 offset:6144
    v_sub_f32 v238, 1.0, v236
    v_mfma_f32_16x16x32_bf16 v[40:43], a[0:3], a[24:27], v[40:43]
    ds_read_b64_tr_b16 a[88:89], v24 offset:2048
    v_sub_f32 v239, 1.0, v237
    v_mfma_f32_16x16x32_bf16 v[80:83], a[4:7], a[24:27], v[80:83]
    ds_read_b64_tr_b16 a[90:91], v24 offset:2304
    v_cvt_pk_bf16_f32 v232, v238, v239
    v_mfma_f32_16x16x32_bf16 v[120:123], a[8:11], a[24:27], v[120:123]
    ds_read_b64_tr_b16 a[92:93], v25 offset:2048
    v_mfma_f32_16x16x32_bf16 v[160:163], a[12:15], a[24:27], v[160:163]
    ds_read_b64_tr_b16 a[94:95], v25 offset:2304
    v_mfma_f32_16x16x32_bf16 v[44:47], a[0:3], a[28:31], v[44:47]
    ds_read_b64_tr_b16 a[96:97], v24 offset:6144
    v_mfma_f32_16x16x32_bf16 v[84:87], a[4:7], a[28:31], v[84:87]
    ds_read_b64_tr_b16 a[98:99], v24 offset:6400
    v_mfma_f32_16x16x32_bf16 v[124:127], a[8:11], a[28:31], v[124:127]
    ds_read_b64_tr_b16 a[100:101], v25 offset:6144
    v_mfma_f32_16x16x32_bf16 v[164:167], a[12:15], a[28:31], v[164:167]
    ds_read_b64_tr_b16 a[102:103], v25 offset:6400
    v_mfma_f32_16x16x32_bf16 v[48:51], a[32:35], a[0:3], v[48:51]
    ds_read_b64_tr_b16 a[104:105], v24 offset:10240
    v_mfma_f32_16x16x32_bf16 v[88:91], a[32:35], a[4:7], v[88:91]
    ds_read_b64_tr_b16 a[106:107], v24 offset:10496
    v_mfma_f32_16x16x32_bf16 v[128:131], a[32:35], a[8:11], v[128:131]
    ds_read_b64_tr_b16 a[108:109], v25 offset:10240
    v_mfma_f32_16x16x32_bf16 v[168:171], a[32:35], a[12:15], v[168:171]
    ds_read_b64_tr_b16 a[110:111], v25 offset:10496
    v_mfma_f32_16x16x32_bf16 v[52:55], a[36:39], a[0:3], v[52:55]
    s_add_u32 m0, s37, 112640
    v_mfma_f32_16x16x32_bf16 v[92:95], a[36:39], a[4:7], v[92:95]
    buffer_load_dwordx4 v14, s[8:11], s35 offen lds
    v_mfma_f32_16x16x32_bf16 v[132:135], a[36:39], a[8:11], v[132:135]
    s_add_u32 m0, s37, 113664
    v_mfma_f32_16x16x32_bf16 v[172:175], a[36:39], a[12:15], v[172:175]
    buffer_load_dwordx4 v15, s[8:11], s35 offen lds
    v_mfma_f32_16x16x32_bf16 v[56:59], a[40:43], a[0:3], v[56:59]
    s_add_u32 m0, s38, 139264
    v_mfma_f32_16x16x32_bf16 v[96:99], a[40:43], a[4:7], v[96:99]
    buffer_load_dwordx4 v16, s[12:15], s35 offen lds
    v_mfma_f32_16x16x32_bf16 v[136:139], a[40:43], a[8:11], v[136:139]
    s_add_u32 m0, s38, 143360
    v_mfma_f32_16x16x32_bf16 v[176:179], a[40:43], a[12:15], v[176:179]
    buffer_load_dwordx4 v16, s[16:19], s35 offen lds
    v_mfma_f32_16x16x32_bf16 v[60:63], a[44:47], a[0:3], v[60:63]
    s_add_u32 m0, s38, 147456
    v_mfma_f32_16x16x32_bf16 v[100:103], a[44:47], a[4:7], v[100:103]
    buffer_load_dwordx4 v17, s[20:23], s36 offen lds
    v_mfma_f32_16x16x32_bf16 v[140:143], a[44:47], a[8:11], v[140:143]
    s_add_u32 m0, s38, 151552
    v_mfma_f32_16x16x32_bf16 v[180:183], a[44:47], a[12:15], v[180:183]
    buffer_load_dwordx4 v18, s[20:23], s36 offen lds
    v_mfma_f32_16x16x32_bf16 v[64:67], a[0:3], a[48:51], v[64:67]
    s_add_u32 m0, s38, 155648
    v_mfma_f32_16x16x32_bf16 v[104:107], a[4:7], a[48:51], v[104:107]
    buffer_load_dwordx4 v19, s[20:23], s36 offen lds
    v_mfma_f32_16x16x32_bf16 v[144:147], a[8:11], a[48:51], v[144:147]
    v_mfma_f32_16x16x32_bf16 v[184:187], a[12:15], a[48:51], v[184:187]
    v_mfma_f32_16x16x32_bf16 v[68:71], a[0:3], a[52:55], v[68:71]
    v_mfma_f32_16x16x32_bf16 v[108:111], a[4:7], a[52:55], v[108:111]
    v_mfma_f32_16x16x32_bf16 v[148:151], a[8:11], a[52:55], v[148:151]
    v_mfma_f32_16x16x32_bf16 v[188:191], a[12:15], a[52:55], v[188:191]
    s_waitcnt lgkmcnt(0)
    s_waitcnt vmcnt(13)
    s_barrier
    v_mfma_f32_16x16x32_bf16 v[32:35], a[56:59], a[72:75], v[32:35]
    ds_read_b128 a[0:3], v20 offset:53248
    v_lshlrev_b32 v238, 16, v232
    v_mfma_f32_16x16x32_bf16 v[72:75], a[60:63], a[72:75], v[72:75]
    ds_read_b128 a[4:7], v20 offset:55296
    v_and_b32 v239, 0xffff0000, v232
    v_mfma_f32_16x16x32_bf16 v[112:115], a[64:67], a[72:75], v[112:115]
    ds_read_b128 a[8:11], v20 offset:57344
    v_mov_b32 v2, s47
    v_mfma_f32_16x16x32_bf16 v[152:155], a[68:71], a[72:75], v[152:155]
    ds_read_b128 a[12:15], v20 offset:59392
    v_cmp_eq_u32 vcc, 63, v1
    v_mfma_f32_16x16x32_bf16 v[36:39], a[56:59], a[76:79], v[36:39]
    ds_read_b128 a[16:19], v22 offset:53248
    v_mov_b32 v3, 0x7fffffff
    v_mfma_f32_16x16x32_bf16 v[76:79], a[60:63], a[76:79], v[76:79]
    ds_read_b128 a[20:23], v22 offset:55296
    s_nop 0
    v_mfma_f32_16x16x32_bf16 v[116:119], a[64:67], a[76:79], v[116:119]
    ds_read_b128 a[24:27], v22 offset:57344
    v_cndmask_b32 v2, v3, v2, vcc
    v_mfma_f32_16x16x32_bf16 v[156:159], a[68:71], a[76:79], v[156:159]
    ds_read_b128 a[28:31], v22 offset:59392
    s_mov_b32 s44, 20971520
    v_mfma_f32_16x16x32_bf16 v[40:43], a[56:59], a[80:83], v[40:43]
    ds_read_b64_tr_b16 a[32:33], v24 offset:53248
    s_mov_b32 s45, 20979712
    v_mfma_f32_16x16x32_bf16 v[80:83], a[60:63], a[80:83], v[80:83]
    ds_read_b64_tr_b16 a[34:35], v24 offset:53504
    buffer_store_dwordx2 v[236:237], v2, s[24:27], s44 offen
    v_mfma_f32_16x16x32_bf16 v[120:123], a[64:67], a[80:83], v[120:123]
    ds_read_b64_tr_b16 a[36:37], v25 offset:53248
    v_mfma_f32_16x16x32_bf16 v[160:163], a[68:71], a[80:83], v[160:163]
    ds_read_b64_tr_b16 a[38:39], v25 offset:53504
    v_mfma_f32_16x16x32_bf16 v[44:47], a[56:59], a[84:87], v[44:47]
    ds_read_b64_tr_b16 a[40:41], v24 offset:57344
    v_mfma_f32_16x16x32_bf16 v[84:87], a[60:63], a[84:87], v[84:87]
    ds_read_b64_tr_b16 a[42:43], v24 offset:57600
    v_mfma_f32_16x16x32_bf16 v[124:127], a[64:67], a[84:87], v[124:127]
    ds_read_b64_tr_b16 a[44:45], v25 offset:57344
    v_mfma_f32_16x16x32_bf16 v[164:167], a[68:71], a[84:87], v[164:167]
    ds_read_b64_tr_b16 a[46:47], v25 offset:57600
    v_mfma_f32_16x16x32_bf16 v[48:51], a[88:91], a[56:59], v[48:51]
    ds_read_b64_tr_b16 a[48:49], v24 offset:61440
    v_mfma_f32_16x16x32_bf16 v[88:91], a[88:91], a[60:63], v[88:91]
    ds_read_b64_tr_b16 a[50:51], v24 offset:61696
    v_mfma_f32_16x16x32_bf16 v[128:131], a[88:91], a[64:67], v[128:131]
    ds_read_b64_tr_b16 a[52:53], v25 offset:61440
    v_mfma_f32_16x16x32_bf16 v[168:171], a[88:91], a[68:71], v[168:171]
    ds_read_b64_tr_b16 a[54:55], v25 offset:61696
    v_mfma_f32_16x16x32_bf16 v[52:55], a[92:95], a[56:59], v[52:55]
    s_add_u32 s35, s41, 15
    v_mfma_f32_16x16x32_bf16 v[92:95], a[92:95], a[60:63], v[92:95]
    s_and_b32 s35, s35, 15
    v_mfma_f32_16x16x32_bf16 v[132:135], a[92:95], a[64:67], v[132:135]
    s_mul_i32 s36, s35, 393216
    v_mfma_f32_16x16x32_bf16 v[172:175], a[92:95], a[68:71], v[172:175]
    s_lshl_b32 s35, s35, 7
    v_mfma_f32_16x16x32_bf16 v[56:59], a[96:99], a[56:59], v[56:59]
    s_add_u32 m0, s37, 0
    v_mfma_f32_16x16x32_bf16 v[96:99], a[96:99], a[60:63], v[96:99]
    buffer_load_dwordx4 v8, s[8:11], s35 offen lds
    v_mfma_f32_16x16x32_bf16 v[136:139], a[96:99], a[64:67], v[136:139]
    s_add_u32 m0, s37, 1024
    v_mfma_f32_16x16x32_bf16 v[176:179], a[96:99], a[68:71], v[176:179]
    buffer_load_dwordx4 v9, s[8:11], s35 offen lds
    v_mfma_f32_16x16x32_bf16 v[60:63], a[100:103], a[56:59], v[60:63]
    s_add_u32 m0, s37, 2048
    v_mfma_f32_16x16x32_bf16 v[100:103], a[100:103], a[60:63], v[100:103]
    buffer_load_dwordx4 v10, s[8:11], s35 offen lds
    v_mfma_f32_16x16x32_bf16 v[140:143], a[100:103], a[64:67], v[140:143]
    s_add_u32 m0, s37, 3072
    v_mfma_f32_16x16x32_bf16 v[180:183], a[100:103], a[68:71], v[180:183]
    buffer_load_dwordx4 v11, s[8:11], s35 offen lds
    v_mfma_f32_16x16x32_bf16 v[64:67], a[56:59], a[104:107], v[64:67]
    s_add_u32 m0, s37, 4096
    v_mfma_f32_16x16x32_bf16 v[104:107], a[60:63], a[104:107], v[104:107]
    buffer_load_dwordx4 v12, s[8:11], s35 offen lds
    v_mfma_f32_16x16x32_bf16 v[144:147], a[64:67], a[104:107], v[144:147]
    s_add_u32 m0, s37, 5120
    v_mfma_f32_16x16x32_bf16 v[184:187], a[68:71], a[104:107], v[184:187]
    buffer_load_dwordx4 v13, s[8:11], s35 offen lds
    v_mfma_f32_16x16x32_bf16 v[68:71], a[56:59], a[108:111], v[68:71]
    v_mfma_f32_16x16x32_bf16 v[108:111], a[60:63], a[108:111], v[108:111]
    v_mfma_f32_16x16x32_bf16 v[148:151], a[64:67], a[108:111], v[148:151]
    v_mfma_f32_16x16x32_bf16 v[188:191], a[68:71], a[108:111], v[188:191]
    s_waitcnt lgkmcnt(0)
    v_mfma_f32_16x16x32_bf16 v[32:35], a[0:3], a[16:19], v[32:35]
    ds_read_b128 a[56:59], v21 offset:53248
    buffer_store_dwordx2 v[238:239], v2, s[24:27], s45 offen
    v_mfma_f32_16x16x32_bf16 v[72:75], a[4:7], a[16:19], v[72:75]
    ds_read_b128 a[60:63], v21 offset:55296
    v_mfma_f32_16x16x32_bf16 v[112:115], a[8:11], a[16:19], v[112:115]
    ds_read_b128 a[64:67], v21 offset:57344
    v_mfma_f32_16x16x32_bf16 v[152:155], a[12:15], a[16:19], v[152:155]
    ds_read_b128 a[68:71], v21 offset:59392
    v_mfma_f32_16x16x32_bf16 v[36:39], a[0:3], a[20:23], v[36:39]
    ds_read_b128 a[72:75], v23 offset:53248
    v_mfma_f32_16x16x32_bf16 v[76:79], a[4:7], a[20:23], v[76:79]
    ds_read_b128 a[76:79], v23 offset:55296
    v_mfma_f32_16x16x32_bf16 v[116:119], a[8:11], a[20:23], v[116:119]
    ds_read_b128 a[80:83], v23 offset:57344
    v_mfma_f32_16x16x32_bf16 v[156:159], a[12:15], a[20:23], v[156:159]
    ds_read_b128 a[84:87], v23 offset:59392
    v_mfma_f32_16x16x32_bf16 v[40:43], a[0:3], a[24:27], v[40:43]
    ds_read_b64_tr_b16 a[88:89], v24 offset:55296
    v_mfma_f32_16x16x32_bf16 v[80:83], a[4:7], a[24:27], v[80:83]
    ds_read_b64_tr_b16 a[90:91], v24 offset:55552
    v_mfma_f32_16x16x32_bf16 v[120:123], a[8:11], a[24:27], v[120:123]
    ds_read_b64_tr_b16 a[92:93], v25 offset:55296
    v_mfma_f32_16x16x32_bf16 v[160:163], a[12:15], a[24:27], v[160:163]
    ds_read_b64_tr_b16 a[94:95], v25 offset:55552
    v_mfma_f32_16x16x32_bf16 v[44:47], a[0:3], a[28:31], v[44:47]
    ds_read_b64_tr_b16 a[96:97], v24 offset:59392
    v_mfma_f32_16x16x32_bf16 v[84:87], a[4:7], a[28:31], v[84:87]
    ds_read_b64_tr_b16 a[98:99], v24 offset:59648
    v_mfma_f32_16x16x32_bf16 v[124:127], a[8:11], a[28:31], v[124:127]
    ds_read_b64_tr_b16 a[100:101], v25 offset:59392
    v_mfma_f32_16x16x32_bf16 v[164:167], a[12:15], a[28:31], v[164:167]
    ds_read_b64_tr_b16 a[102:103], v25 offset:59648
    v_mfma_f32_16x16x32_bf16 v[48:51], a[32:35], a[0:3], v[48:51]
    ds_read_b64_tr_b16 a[104:105], v24 offset:63488
    v_mfma_f32_16x16x32_bf16 v[88:91], a[32:35], a[4:7], v[88:91]
    ds_read_b64_tr_b16 a[106:107], v24 offset:63744
    v_mfma_f32_16x16x32_bf16 v[128:131], a[32:35], a[8:11], v[128:131]
    ds_read_b64_tr_b16 a[108:109], v25 offset:63488
    v_mfma_f32_16x16x32_bf16 v[168:171], a[32:35], a[12:15], v[168:171]
    ds_read_b64_tr_b16 a[110:111], v25 offset:63744
    v_mfma_f32_16x16x32_bf16 v[52:55], a[36:39], a[0:3], v[52:55]
    s_add_u32 m0, s37, 6144
    v_mfma_f32_16x16x32_bf16 v[92:95], a[36:39], a[4:7], v[92:95]
    buffer_load_dwordx4 v14, s[8:11], s35 offen lds
    v_mfma_f32_16x16x32_bf16 v[132:135], a[36:39], a[8:11], v[132:135]
    s_add_u32 m0, s37, 7168
    v_mfma_f32_16x16x32_bf16 v[172:175], a[36:39], a[12:15], v[172:175]
    buffer_load_dwordx4 v15, s[8:11], s35 offen lds
    v_mfma_f32_16x16x32_bf16 v[56:59], a[40:43], a[0:3], v[56:59]
    s_add_u32 m0, s38, 32768
    v_mfma_f32_16x16x32_bf16 v[96:99], a[40:43], a[4:7], v[96:99]
    buffer_load_dwordx4 v16, s[12:15], s35 offen lds
    v_mfma_f32_16x16x32_bf16 v[136:139], a[40:43], a[8:11], v[136:139]
    s_add_u32 m0, s38, 36864
    v_mfma_f32_16x16x32_bf16 v[176:179], a[40:43], a[12:15], v[176:179]
    buffer_load_dwordx4 v16, s[16:19], s35 offen lds
    v_mfma_f32_16x16x32_bf16 v[60:63], a[44:47], a[0:3], v[60:63]
    s_add_u32 m0, s38, 40960
    v_mfma_f32_16x16x32_bf16 v[100:103], a[44:47], a[4:7], v[100:103]
    buffer_load_dwordx4 v17, s[20:23], s36 offen lds
    v_mfma_f32_16x16x32_bf16 v[140:143], a[44:47], a[8:11], v[140:143]
    s_add_u32 m0, s38, 45056
    v_mfma_f32_16x16x32_bf16 v[180:183], a[44:47], a[12:15], v[180:183]
    buffer_load_dwordx4 v18, s[20:23], s36 offen lds
    v_mfma_f32_16x16x32_bf16 v[64:67], a[0:3], a[48:51], v[64:67]
    s_add_u32 m0, s38, 49152
    v_mfma_f32_16x16x32_bf16 v[104:107], a[4:7], a[48:51], v[104:107]
    buffer_load_dwordx4 v19, s[20:23], s36 offen lds
    v_mfma_f32_16x16x32_bf16 v[144:147], a[8:11], a[48:51], v[144:147]
    v_mfma_f32_16x16x32_bf16 v[184:187], a[12:15], a[48:51], v[184:187]
    v_mfma_f32_16x16x32_bf16 v[68:71], a[0:3], a[52:55], v[68:71]
    v_mfma_f32_16x16x32_bf16 v[108:111], a[4:7], a[52:55], v[108:111]
    v_mfma_f32_16x16x32_bf16 v[148:151], a[8:11], a[52:55], v[148:151]
    v_mfma_f32_16x16x32_bf16 v[188:191], a[12:15], a[52:55], v[188:191]
    s_waitcnt lgkmcnt(0)
    s_waitcnt vmcnt(15)
    s_barrier
    v_mfma_f32_16x16x32_bf16 v[32:35], a[56:59], a[72:75], v[32:35]
    ds_read_b128 a[0:3], v240 offset:0
    v_mfma_f32_16x16x32_bf16 v[72:75], a[60:63], a[72:75], v[72:75]
    ds_read_b128 a[4:7], v240 offset:2048
    v_mfma_f32_16x16x32_bf16 v[112:115], a[64:67], a[72:75], v[112:115]
    ds_read_b128 a[8:11], v240 offset:4096
    v_mfma_f32_16x16x32_bf16 v[152:155], a[68:71], a[72:75], v[152:155]
    ds_read_b128 a[12:15], v240 offset:6144
    v_mfma_f32_16x16x32_bf16 v[36:39], a[56:59], a[76:79], v[36:39]
    ds_read_b128 a[16:19], v242 offset:0
    v_mfma_f32_16x16x32_bf16 v[76:79], a[60:63], a[76:79], v[76:79]
    ds_read_b128 a[20:23], v242 offset:2048
    v_mfma_f32_16x16x32_bf16 v[116:119], a[64:67], a[76:79], v[116:119]
    ds_read_b128 a[24:27], v242 offset:4096
    v_mfma_f32_16x16x32_bf16 v[156:159], a[68:71], a[76:79], v[156:159]
    ds_read_b128 a[28:31], v242 offset:6144
    v_mfma_f32_16x16x32_bf16 v[40:43], a[56:59], a[80:83], v[40:43]
    ds_read_b64_tr_b16 a[32:33], v244 offset:0
    v_mfma_f32_16x16x32_bf16 v[80:83], a[60:63], a[80:83], v[80:83]
    ds_read_b64_tr_b16 a[34:35], v244 offset:256
    v_mfma_f32_16x16x32_bf16 v[120:123], a[64:67], a[80:83], v[120:123]
    ds_read_b64_tr_b16 a[36:37], v245 offset:0
    v_mfma_f32_16x16x32_bf16 v[160:163], a[68:71], a[80:83], v[160:163]
    ds_read_b64_tr_b16 a[38:39], v245 offset:256
    v_mfma_f32_16x16x32_bf16 v[44:47], a[56:59], a[84:87], v[44:47]
    ds_read_b64_tr_b16 a[40:41], v244 offset:4096
    v_mfma_f32_16x16x32_bf16 v[84:87], a[60:63], a[84:87], v[84:87]
    ds_read_b64_tr_b16 a[42:43], v244 offset:4352
    v_mfma_f32_16x16x32_bf16 v[124:127], a[64:67], a[84:87], v[124:127]
    ds_read_b64_tr_b16 a[44:45], v245 offset:4096
    v_mfma_f32_16x16x32_bf16 v[164:167], a[68:71], a[84:87], v[164:167]
    ds_read_b64_tr_b16 a[46:47], v245 offset:4352
    v_mfma_f32_16x16x32_bf16 v[48:51], a[88:91], a[56:59], v[48:51]
    ds_read_b64_tr_b16 a[48:49], v244 offset:8192
    v_mfma_f32_16x16x32_bf16 v[88:91], a[88:91], a[60:63], v[88:91]
    ds_read_b64_tr_b16 a[50:51], v244 offset:8448
    v_mfma_f32_16x16x32_bf16 v[128:131], a[88:91], a[64:67], v[128:131]
    ds_read_b64_tr_b16 a[52:53], v245 offset:8192
    v_mfma_f32_16x16x32_bf16 v[168:171], a[88:91], a[68:71], v[168:171]
    ds_read_b64_tr_b16 a[54:55], v245 offset:8448
    v_mfma_f32_16x16x32_bf16 v[52:55], a[92:95], a[56:59], v[52:55]
    v_mfma_f32_16x16x32_bf16 v[92:95], a[92:95], a[60:63], v[92:95]
    v_mfma_f32_16x16x32_bf16 v[132:135], a[92:95], a[64:67], v[132:135]
    v_mfma_f32_16x16x32_bf16 v[172:175], a[92:95], a[68:71], v[172:175]
    v_mfma_f32_16x16x32_bf16 v[56:59], a[96:99], a[56:59], v[56:59]
    v_mfma_f32_16x16x32_bf16 v[96:99], a[96:99], a[60:63], v[96:99]
    v_mfma_f32_16x16x32_bf16 v[136:139], a[96:99], a[64:67], v[136:139]
    v_mfma_f32_16x16x32_bf16 v[176:179], a[96:99], a[68:71], v[176:179]
    v_mfma_f32_16x16x32_bf16 v[60:63], a[100:103], a[56:59], v[60:63]
    v_mfma_f32_16x16x32_bf16 v[100:103], a[100:103], a[60:63], v[100:103]
    v_mfma_f32_16x16x32_bf16 v[140:143], a[100:103], a[64:67], v[140:143]
    v_mfma_f32_16x16x32_bf16 v[180:183], a[100:103], a[68:71], v[180:183]
    v_mfma_f32_16x16x32_bf16 v[64:67], a[56:59], a[104:107], v[64:67]
    v_mfma_f32_16x16x32_bf16 v[104:107], a[60:63], a[104:107], v[104:107]
    v_mfma_f32_16x16x32_bf16 v[144:147], a[64:67], a[104:107], v[144:147]
    v_mfma_f32_16x16x32_bf16 v[184:187], a[68:71], a[104:107], v[184:187]
    v_mfma_f32_16x16x32_bf16 v[68:71], a[56:59], a[108:111], v[68:71]
    v_mfma_f32_16x16x32_bf16 v[108:111], a[60:63], a[108:111], v[108:111]
    v_mfma_f32_16x16x32_bf16 v[148:151], a[64:67], a[108:111], v[148:151]
    v_mfma_f32_16x16x32_bf16 v[188:191], a[68:71], a[108:111], v[188:191]
    s_waitcnt lgkmcnt(0)
    v_mfma_f32_16x16x32_bf16 v[32:35], a[0:3], a[16:19], v[32:35]
    ds_read_b128 a[56:59], v241 offset:0
    v_mfma_f32_16x16x32_bf16 v[72:75], a[4:7], a[16:19], v[72:75]
    ds_read_b128 a[60:63], v241 offset:2048
    v_mfma_f32_16x16x32_bf16 v[112:115], a[8:11], a[16:19], v[112:115]
    ds_read_b128 a[64:67], v241 offset:4096
    v_mfma_f32_16x16x32_bf16 v[152:155], a[12:15], a[16:19], v[152:155]
    ds_read_b128 a[68:71], v241 offset:6144
    v_mfma_f32_16x16x32_bf16 v[36:39], a[0:3], a[20:23], v[36:39]
    ds_read_b128 a[72:75], v243 offset:0
    v_mfma_f32_16x16x32_bf16 v[76:79], a[4:7], a[20:23], v[76:79]
    ds_read_b128 a[76:79], v243 offset:2048
    v_mfma_f32_16x16x32_bf16 v[116:119], a[8:11], a[20:23], v[116:119]
    ds_read_b128 a[80:83], v243 offset:4096
    v_mfma_f32_16x16x32_bf16 v[156:159], a[12:15], a[20:23], v[156:159]
    ds_read_b128 a[84:87], v243 offset:6144
    v_mfma_f32_16x16x32_bf16 v[40:43], a[0:3], a[24:27], v[40:43]
    ds_read_b64_tr_b16 a[88:89], v244 offset:2048
    v_mfma_f32_16x16x32_bf16 v[80:83], a[4:7], a[24:27], v[80:83]
    ds_read_b64_tr_b16 a[90:91], v244 offset:2304
    v_mfma_f32_16x16x32_bf16 v[120:123], a[8:11], a[24:27], v[120:123]
    ds_read_b64_tr_b16 a[92:93], v245 offset:2048
    v_mfma_f32_16x16x32_bf16 v[160:163], a[12:15], a[24:27], v[160:163]
    ds_read_b64_tr_b16 a[94:95], v245 offset:2304
    v_mfma_f32_16x16x32_bf16 v[44:47], a[0:3], a[28:31], v[44:47]
    ds_read_b64_tr_b16 a[96:97], v244 offset:6144
    v_mfma_f32_16x16x32_bf16 v[84:87], a[4:7], a[28:31], v[84:87]
    ds_read_b64_tr_b16 a[98:99], v244 offset:6400
    v_mfma_f32_16x16x32_bf16 v[124:127], a[8:11], a[28:31], v[124:127]
    ds_read_b64_tr_b16 a[100:101], v245 offset:6144
    v_mfma_f32_16x16x32_bf16 v[164:167], a[12:15], a[28:31], v[164:167]
    ds_read_b64_tr_b16 a[102:103], v245 offset:6400
    v_mfma_f32_16x16x32_bf16 v[48:51], a[32:35], a[0:3], v[48:51]
    ds_read_b64_tr_b16 a[104:105], v244 offset:10240
    v_mfma_f32_16x16x32_bf16 v[88:91], a[32:35], a[4:7], v[88:91]
    ds_read_b64_tr_b16 a[106:107], v244 offset:10496
    v_mfma_f32_16x16x32_bf16 v[128:131], a[32:35], a[8:11], v[128:131]
    ds_read_b64_tr_b16 a[108:109], v245 offset:10240
    v_mfma_f32_16x16x32_bf16 v[168:171], a[32:35], a[12:15], v[168:171]
    ds_read_b64_tr_b16 a[110:111], v245 offset:10496
    v_mfma_f32_16x16x32_bf16 v[52:55], a[36:39], a[0:3], v[52:55]
    v_mfma_f32_16x16x32_bf16 v[92:95], a[36:39], a[4:7], v[92:95]
    v_mfma_f32_16x16x32_bf16 v[132:135], a[36:39], a[8:11], v[132:135]
    v_mfma_f32_16x16x32_bf16 v[172:175], a[36:39], a[12:15], v[172:175]
    v_mfma_f32_16x16x32_bf16 v[56:59], a[40:43], a[0:3], v[56:59]
    v_mfma_f32_16x16x32_bf16 v[96:99], a[40:43], a[4:7], v[96:99]
    v_mfma_f32_16x16x32_bf16 v[136:139], a[40:43], a[8:11], v[136:139]
    v_mfma_f32_16x16x32_bf16 v[176:179], a[40:43], a[12:15], v[176:179]
    v_mfma_f32_16x16x32_bf16 v[60:63], a[44:47], a[0:3], v[60:63]
    v_mfma_f32_16x16x32_bf16 v[100:103], a[44:47], a[4:7], v[100:103]
    v_mfma_f32_16x16x32_bf16 v[140:143], a[44:47], a[8:11], v[140:143]
    v_mfma_f32_16x16x32_bf16 v[180:183], a[44:47], a[12:15], v[180:183]
    v_mfma_f32_16x16x32_bf16 v[64:67], a[0:3], a[48:51], v[64:67]
    v_mfma_f32_16x16x32_bf16 v[104:107], a[4:7], a[48:51], v[104:107]
    v_mfma_f32_16x16x32_bf16 v[144:147], a[8:11], a[48:51], v[144:147]
    v_mfma_f32_16x16x32_bf16 v[184:187], a[12:15], a[48:51], v[184:187]
    v_mfma_f32_16x16x32_bf16 v[68:71], a[0:3], a[52:55], v[68:71]
    v_mfma_f32_16x16x32_bf16 v[108:111], a[4:7], a[52:55], v[108:111]
    v_mfma_f32_16x16x32_bf16 v[148:151], a[8:11], a[52:55], v[148:151]
    v_mfma_f32_16x16x32_bf16 v[188:191], a[12:15], a[52:55], v[188:191]
    s_waitcnt lgkmcnt(0)
    s_lshl_b32 s44, s33, 3
    s_lshl_b32 s45, s32, 1
    s_add_u32 s44, s44, s45
    s_lshl_b32 s47, s34, 17
    s_lshl_b32 s45, s44, 11
    s_add_u32 s47, s47, s45
    s_add_u32 s50, s47, 4194304
    s_lshl_b32 s48, s34, 17
    s_add_u32 s48, s48, s45
    s_add_u32 s48, s48, 8388608
    s_lshl_b32 s49, s34, 18
    s_lshl_b32 s45, s44, 12
    s_add_u32 s49, s49, s45
    s_add_u32 s49, s49, 12582912
    s_add_u32 s51, s49, 4096
    s_mov_b32 s52, 1048744942
    s_waitcnt vmcnt(0)
    s_barrier
    v_mfma_f32_16x16x32_bf16 v[32:35], a[56:59], a[72:75], v[32:35]
    ds_read_b128 a[0:3], v20 offset:0
    v_mfma_f32_16x16x32_bf16 v[72:75], a[60:63], a[72:75], v[72:75]
    ds_read_b128 a[4:7], v20 offset:2048
    v_mfma_f32_16x16x32_bf16 v[112:115], a[64:67], a[72:75], v[112:115]
    ds_read_b128 a[16:19], v22 offset:0
    v_mfma_f32_16x16x32_bf16 v[152:155], a[68:71], a[72:75], v[152:155]
    ds_read_b128 a[20:23], v22 offset:2048
    v_mfma_f32_16x16x32_bf16 v[36:39], a[56:59], a[76:79], v[36:39]
    ds_read_b128 a[112:115], v21 offset:0
    v_mfma_f32_16x16x32_bf16 v[76:79], a[60:63], a[76:79], v[76:79]
    ds_read_b128 a[116:119], v21 offset:2048
    v_mfma_f32_16x16x32_bf16 v[116:119], a[64:67], a[76:79], v[116:119]
    ds_read_b128 a[128:131], v23 offset:0
    v_mfma_f32_16x16x32_bf16 v[156:159], a[68:71], a[76:79], v[156:159]
    ds_read_b128 a[132:135], v23 offset:2048
    v_mfma_f32_16x16x32_bf16 v[40:43], a[56:59], a[80:83], v[40:43]
    ds_read_b128 a[24:27], v22 offset:4096
    v_mfma_f32_16x16x32_bf16 v[80:83], a[60:63], a[80:83], v[80:83]
    ds_read_b128 a[28:31], v22 offset:6144
    v_mfma_f32_16x16x32_bf16 v[120:123], a[64:67], a[80:83], v[120:123]
    ds_read_b128 a[136:139], v23 offset:4096
    v_mfma_f32_16x16x32_bf16 v[160:163], a[68:71], a[80:83], v[160:163]
    ds_read_b128 a[140:143], v23 offset:6144
    v_mfma_f32_16x16x32_bf16 v[44:47], a[56:59], a[84:87], v[44:47]
    ds_read_b64_tr_b16 a[32:33], v24 offset:0
    v_mfma_f32_16x16x32_bf16 v[84:87], a[60:63], a[84:87], v[84:87]
    ds_read_b64_tr_b16 a[34:35], v24 offset:256
    v_mfma_f32_16x16x32_bf16 v[124:127], a[64:67], a[84:87], v[124:127]
    ds_read_b64_tr_b16 a[36:37], v25 offset:0
    v_mfma_f32_16x16x32_bf16 v[164:167], a[68:71], a[84:87], v[164:167]
    ds_read_b64_tr_b16 a[38:39], v25 offset:256
    v_mfma_f32_16x16x32_bf16 v[48:51], a[88:91], a[56:59], v[48:51]
    ds_read_b64_tr_b16 a[144:145], v24 offset:2048
    v_mfma_f32_16x16x32_bf16 v[88:91], a[88:91], a[60:63], v[88:91]
    ds_read_b64_tr_b16 a[146:147], v24 offset:2304
    v_mfma_f32_16x16x32_bf16 v[128:131], a[88:91], a[64:67], v[128:131]
    ds_read_b64_tr_b16 a[148:149], v25 offset:2048
    v_mfma_f32_16x16x32_bf16 v[168:171], a[88:91], a[68:71], v[168:171]
    ds_read_b64_tr_b16 a[150:151], v25 offset:2304
    v_mfma_f32_16x16x32_bf16 v[52:55], a[92:95], a[56:59], v[52:55]
    ds_read_b64_tr_b16 a[40:41], v24 offset:4096
    v_mfma_f32_16x16x32_bf16 v[92:95], a[92:95], a[60:63], v[92:95]
    ds_read_b64_tr_b16 a[42:43], v24 offset:4352
    v_mfma_f32_16x16x32_bf16 v[132:135], a[92:95], a[64:67], v[132:135]
    ds_read_b64_tr_b16 a[44:45], v25 offset:4096
    v_mfma_f32_16x16x32_bf16 v[172:175], a[92:95], a[68:71], v[172:175]
    ds_read_b64_tr_b16 a[46:47], v25 offset:4352
    v_mfma_f32_16x16x32_bf16 v[56:59], a[96:99], a[56:59], v[56:59]
    ds_read_b64_tr_b16 a[152:153], v24 offset:6144
    v_mfma_f32_16x16x32_bf16 v[96:99], a[96:99], a[60:63], v[96:99]
    ds_read_b64_tr_b16 a[154:155], v24 offset:6400
    v_mfma_f32_16x16x32_bf16 v[136:139], a[96:99], a[64:67], v[136:139]
    ds_read_b64_tr_b16 a[156:157], v25 offset:6144
    v_mfma_f32_16x16x32_bf16 v[176:179], a[96:99], a[68:71], v[176:179]
    ds_read_b64_tr_b16 a[158:159], v25 offset:6400
    v_mfma_f32_16x16x32_bf16 v[60:63], a[100:103], a[56:59], v[60:63]
    ds_read_b64_tr_b16 a[48:49], v24 offset:8192
    v_mfma_f32_16x16x32_bf16 v[100:103], a[100:103], a[60:63], v[100:103]
    ds_read_b64_tr_b16 a[50:51], v24 offset:8448
    v_mfma_f32_16x16x32_bf16 v[140:143], a[100:103], a[64:67], v[140:143]
    ds_read_b64_tr_b16 a[52:53], v25 offset:8192
    v_mfma_f32_16x16x32_bf16 v[180:183], a[100:103], a[68:71], v[180:183]
    ds_read_b64_tr_b16 a[54:55], v25 offset:8448
    v_mfma_f32_16x16x32_bf16 v[64:67], a[56:59], a[104:107], v[64:67]
    ds_read_b64_tr_b16 a[160:161], v24 offset:10240
    v_mfma_f32_16x16x32_bf16 v[104:107], a[60:63], a[104:107], v[104:107]
    ds_read_b64_tr_b16 a[162:163], v24 offset:10496
    v_mfma_f32_16x16x32_bf16 v[144:147], a[64:67], a[104:107], v[144:147]
    ds_read_b64_tr_b16 a[164:165], v25 offset:10240
    v_mfma_f32_16x16x32_bf16 v[184:187], a[68:71], a[104:107], v[184:187]
    ds_read_b64_tr_b16 a[166:167], v25 offset:10496
    v_mfma_f32_16x16x32_bf16 v[68:71], a[56:59], a[108:111], v[68:71]
    ds_read_b128 a[8:11], v20 offset:4096
    v_mfma_f32_16x16x32_bf16 v[108:111], a[60:63], a[108:111], v[108:111]
    ds_read_b128 a[12:15], v20 offset:6144
    v_mfma_f32_16x16x32_bf16 v[148:151], a[64:67], a[108:111], v[148:151]
    ds_read_b128 a[120:123], v21 offset:4096
    v_mfma_f32_16x16x32_bf16 v[188:191], a[68:71], a[108:111], v[188:191]
    ds_read_b128 a[124:127], v21 offset:6144
    s_waitcnt lgkmcnt(15)
    v_mfma_f32_16x16x32_bf16 v[32:35], a[0:3], a[16:19], v[32:35]
    v_mfma_f32_16x16x32_bf16 v[36:39], a[0:3], a[20:23], v[36:39]
    v_mfma_f32_16x16x32_bf16 v[72:75], a[4:7], a[16:19], v[72:75]
    v_mfma_f32_16x16x32_bf16 v[76:79], a[4:7], a[20:23], v[76:79]
    v_mfma_f32_16x16x32_bf16 v[32:35], a[112:115], a[128:131], v[32:35]
    v_mfma_f32_16x16x32_bf16 v[36:39], a[112:115], a[132:135], v[36:39]
    v_mfma_f32_16x16x32_bf16 v[72:75], a[116:119], a[128:131], v[72:75]
    v_mfma_f32_16x16x32_bf16 v[76:79], a[116:119], a[132:135], v[76:79]
    s_waitcnt lgkmcnt(15)
    v_mfma_f32_16x16x32_bf16 v[40:43], a[0:3], a[24:27], v[40:43]
    v_mfma_f32_16x16x32_bf16 v[44:47], a[0:3], a[28:31], v[44:47]
    v_mfma_f32_16x16x32_bf16 v[80:83], a[4:7], a[24:27], v[80:83]
    v_mfma_f32_16x16x32_bf16 v[84:87], a[4:7], a[28:31], v[84:87]
    v_mfma_f32_16x16x32_bf16 v[40:43], a[112:115], a[136:139], v[40:43]
    v_mfma_f32_16x16x32_bf16 v[44:47], a[112:115], a[140:143], v[44:47]
    v_mfma_f32_16x16x32_bf16 v[80:83], a[116:119], a[136:139], v[80:83]
    v_mfma_f32_16x16x32_bf16 v[84:87], a[116:119], a[140:143], v[84:87]
    s_waitcnt lgkmcnt(15)
    v_mfma_f32_16x16x32_bf16 v[48:51], a[32:35], a[0:3], v[48:51]
    v_cvt_pk_bf16_f32 v192, v32, v33
    v_cvt_pk_bf16_f32 v193, v34, v35
    v_mfma_f32_16x16x32_bf16 v[52:55], a[36:39], a[0:3], v[52:55]
    v_cvt_pk_bf16_f32 v194, v72, v73
    v_cvt_pk_bf16_f32 v195, v74, v75
    v_mfma_f32_16x16x32_bf16 v[88:91], a[32:35], a[4:7], v[88:91]
    v_cvt_pk_bf16_f32 v196, v36, v37
    v_cvt_pk_bf16_f32 v197, v38, v39
    v_mfma_f32_16x16x32_bf16 v[92:95], a[36:39], a[4:7], v[92:95]
    v_cvt_pk_bf16_f32 v198, v76, v77
    v_cvt_pk_bf16_f32 v199, v78, v79
    v_mfma_f32_16x16x32_bf16 v[48:51], a[144:147], a[112:115], v[48:51]
    s_nop 1
    v_permlane16_swap_b32 v192, v194
    v_mfma_f32_16x16x32_bf16 v[52:55], a[148:151], a[112:115], v[52:55]
    v_permlane16_swap_b32 v193, v195
    v_permlane16_swap_b32 v196, v198
    v_mfma_f32_16x16x32_bf16 v[88:91], a[144:147], a[116:119], v[88:91]
    v_permlane16_swap_b32 v197, v199
    buffer_store_dwordx4 v[192:195], v26, s[24:27], s47 offen offset:0
    v_mfma_f32_16x16x32_bf16 v[92:95], a[148:151], a[116:119], v[92:95]
    buffer_store_dwordx4 v[196:199], v26, s[24:27], s47 offen offset:1024
    s_waitcnt lgkmcnt(12)
    v_mfma_f32_16x16x32_bf16 v[56:59], a[40:43], a[0:3], v[56:59]
    v_cvt_pk_bf16_f32 v200, -v40, -v41
    v_cvt_pk_bf16_f32 v201, -v42, -v43
    v_mfma_f32_16x16x32_bf16 v[60:63], a[44:47], a[0:3], v[60:63]
    v_cvt_pk_bf16_f32 v202, -v80, -v81
    v_cvt_pk_bf16_f32 v203, -v82, -v83
    v_mfma_f32_16x16x32_bf16 v[96:99], a[40:43], a[4:7], v[96:99]
    v_cvt_pk_bf16_f32 v204, -v44, -v45
    v_cvt_pk_bf16_f32 v205, -v46, -v47
    v_mfma_f32_16x16x32_bf16 v[100:103], a[44:47], a[4:7], v[100:103]
    v_cvt_pk_bf16_f32 v206, -v84, -v85
    v_cvt_pk_bf16_f32 v207, -v86, -v87
    v_mfma_f32_16x16x32_bf16 v[56:59], a[152:155], a[112:115], v[56:59]
    s_nop 1
    v_permlane16_swap_b32 v200, v202
    v_mfma_f32_16x16x32_bf16 v[60:63], a[156:159], a[112:115], v[60:63]
    v_permlane16_swap_b32 v201, v203
    v_permlane16_swap_b32 v204, v206
    v_mfma_f32_16x16x32_bf16 v[96:99], a[152:155], a[116:119], v[96:99]
    v_permlane16_swap_b32 v205, v207
    buffer_store_dwordx4 v[200:203], v26, s[24:27], s50 offen offset:0
    v_mfma_f32_16x16x32_bf16 v[100:103], a[156:159], a[116:119], v[100:103]
    buffer_store_dwordx4 v[204:207], v26, s[24:27], s50 offen offset:1024
    s_waitcnt lgkmcnt(4)
    v_mfma_f32_16x16x32_bf16 v[64:67], a[0:3], a[48:51], v[64:67]
    v_mul_f32 v48, s52, v48
    v_mul_f32 v49, s52, v49
    v_mul_f32 v50, s52, v50
    v_mul_f32 v51, s52, v51
    v_mfma_f32_16x16x32_bf16 v[68:71], a[0:3], a[52:55], v[68:71]
    v_mul_f32 v52, s52, v52
    v_mul_f32 v53, s52, v53
    v_mul_f32 v54, s52, v54
    v_mul_f32 v55, s52, v55
    v_mfma_f32_16x16x32_bf16 v[104:107], a[4:7], a[48:51], v[104:107]
    v_mul_f32 v88, s52, v88
    v_mul_f32 v89, s52, v89
    v_mul_f32 v90, s52, v90
    v_mul_f32 v91, s52, v91
    v_mfma_f32_16x16x32_bf16 v[108:111], a[4:7], a[52:55], v[108:111]
    v_mul_f32 v92, s52, v92
    v_mul_f32 v93, s52, v93
    v_mul_f32 v94, s52, v94
    v_mul_f32 v95, s52, v95
    v_mfma_f32_16x16x32_bf16 v[64:67], a[112:115], a[160:163], v[64:67]
    v_cvt_pk_bf16_f32 v208, v48, v49
    v_cvt_pk_bf16_f32 v209, v50, v51
    v_cvt_pk_bf16_f32 v210, v52, v53
    v_cvt_pk_bf16_f32 v211, v54, v55
    v_mfma_f32_16x16x32_bf16 v[68:71], a[112:115], a[164:167], v[68:71]
    v_cvt_pk_bf16_f32 v212, v88, v89
    v_cvt_pk_bf16_f32 v213, v90, v91
    v_cvt_pk_bf16_f32 v214, v92, v93
    v_cvt_pk_bf16_f32 v215, v94, v95
    v_mfma_f32_16x16x32_bf16 v[104:107], a[116:119], a[160:163], v[104:107]
    buffer_store_dwordx4 v[208:211], v28, s[24:27], s48 offen offset:0
    buffer_store_dwordx4 v[212:215], v28, s[24:27], s48 offen offset:1024
    v_mfma_f32_16x16x32_bf16 v[108:111], a[116:119], a[164:167], v[108:111]
    s_waitcnt lgkmcnt(0)
    v_mfma_f32_16x16x32_bf16 v[112:115], a[8:11], a[16:19], v[112:115]
    v_cvt_pk_bf16_f32 v216, v56, v57
    v_cvt_pk_bf16_f32 v217, v58, v59
    v_mfma_f32_16x16x32_bf16 v[116:119], a[8:11], a[20:23], v[116:119]
    v_cvt_pk_bf16_f32 v218, v60, v61
    v_cvt_pk_bf16_f32 v219, v62, v63
    v_mfma_f32_16x16x32_bf16 v[152:155], a[12:15], a[16:19], v[152:155]
    v_cvt_pk_bf16_f32 v220, v96, v97
    v_cvt_pk_bf16_f32 v221, v98, v99
    v_mfma_f32_16x16x32_bf16 v[156:159], a[12:15], a[20:23], v[156:159]
    v_cvt_pk_bf16_f32 v222, v100, v101
    v_cvt_pk_bf16_f32 v223, v102, v103
    v_mfma_f32_16x16x32_bf16 v[112:115], a[120:123], a[128:131], v[112:115]
    buffer_store_dwordx4 v[216:219], v28, s[24:27], s49 offen offset:0
    buffer_store_dwordx4 v[220:223], v28, s[24:27], s49 offen offset:1024
    v_mfma_f32_16x16x32_bf16 v[116:119], a[120:123], a[132:135], v[116:119]
    v_mfma_f32_16x16x32_bf16 v[152:155], a[124:127], a[128:131], v[152:155]
    v_mfma_f32_16x16x32_bf16 v[156:159], a[124:127], a[132:135], v[156:159]
    v_mfma_f32_16x16x32_bf16 v[120:123], a[8:11], a[24:27], v[120:123]
    v_cvt_pk_bf16_f32 v224, v64, v65
    v_cvt_pk_bf16_f32 v225, v66, v67
    v_mfma_f32_16x16x32_bf16 v[124:127], a[8:11], a[28:31], v[124:127]
    v_cvt_pk_bf16_f32 v226, v104, v105
    v_cvt_pk_bf16_f32 v227, v106, v107
    v_mfma_f32_16x16x32_bf16 v[160:163], a[12:15], a[24:27], v[160:163]
    v_cvt_pk_bf16_f32 v228, v68, v69
    v_cvt_pk_bf16_f32 v229, v70, v71
    v_mfma_f32_16x16x32_bf16 v[164:167], a[12:15], a[28:31], v[164:167]
    v_cvt_pk_bf16_f32 v230, v108, v109
    v_cvt_pk_bf16_f32 v231, v110, v111
    v_mfma_f32_16x16x32_bf16 v[120:123], a[120:123], a[136:139], v[120:123]
    buffer_store_dwordx4 v[224:227], v28, s[24:27], s49 offen offset:2048
    buffer_store_dwordx4 v[228:231], v28, s[24:27], s49 offen offset:3072
    v_mfma_f32_16x16x32_bf16 v[124:127], a[120:123], a[140:143], v[124:127]
    v_mfma_f32_16x16x32_bf16 v[160:163], a[124:127], a[136:139], v[160:163]
    v_mfma_f32_16x16x32_bf16 v[164:167], a[124:127], a[140:143], v[164:167]
    v_mfma_f32_16x16x32_bf16 v[128:131], a[32:35], a[8:11], v[128:131]
    v_cvt_pk_bf16_f32 v192, v112, v113
    v_cvt_pk_bf16_f32 v193, v114, v115
    v_mfma_f32_16x16x32_bf16 v[132:135], a[36:39], a[8:11], v[132:135]
    v_cvt_pk_bf16_f32 v194, v152, v153
    v_cvt_pk_bf16_f32 v195, v154, v155
    v_mfma_f32_16x16x32_bf16 v[168:171], a[32:35], a[12:15], v[168:171]
    v_cvt_pk_bf16_f32 v196, v116, v117
    v_cvt_pk_bf16_f32 v197, v118, v119
    v_mfma_f32_16x16x32_bf16 v[172:175], a[36:39], a[12:15], v[172:175]
    v_cvt_pk_bf16_f32 v198, v156, v157
    v_cvt_pk_bf16_f32 v199, v158, v159
    v_mfma_f32_16x16x32_bf16 v[128:131], a[144:147], a[120:123], v[128:131]
    s_nop 1
    v_permlane16_swap_b32 v192, v194
    v_mfma_f32_16x16x32_bf16 v[132:135], a[148:151], a[120:123], v[132:135]
    v_permlane16_swap_b32 v193, v195
    v_permlane16_swap_b32 v196, v198
    v_mfma_f32_16x16x32_bf16 v[168:171], a[144:147], a[124:127], v[168:171]
    v_permlane16_swap_b32 v197, v199
    buffer_store_dwordx4 v[192:195], v26, s[24:27], s47 offen offset:2048
    v_mfma_f32_16x16x32_bf16 v[172:175], a[148:151], a[124:127], v[172:175]
    buffer_store_dwordx4 v[196:199], v26, s[24:27], s47 offen offset:3072
    v_mfma_f32_16x16x32_bf16 v[136:139], a[40:43], a[8:11], v[136:139]
    v_cvt_pk_bf16_f32 v200, -v120, -v121
    v_cvt_pk_bf16_f32 v201, -v122, -v123
    v_mfma_f32_16x16x32_bf16 v[140:143], a[44:47], a[8:11], v[140:143]
    v_cvt_pk_bf16_f32 v202, -v160, -v161
    v_cvt_pk_bf16_f32 v203, -v162, -v163
    v_mfma_f32_16x16x32_bf16 v[176:179], a[40:43], a[12:15], v[176:179]
    v_cvt_pk_bf16_f32 v204, -v124, -v125
    v_cvt_pk_bf16_f32 v205, -v126, -v127
    v_mfma_f32_16x16x32_bf16 v[180:183], a[44:47], a[12:15], v[180:183]
    v_cvt_pk_bf16_f32 v206, -v164, -v165
    v_cvt_pk_bf16_f32 v207, -v166, -v167
    v_mfma_f32_16x16x32_bf16 v[136:139], a[152:155], a[120:123], v[136:139]
    s_nop 1
    v_permlane16_swap_b32 v200, v202
    v_mfma_f32_16x16x32_bf16 v[140:143], a[156:159], a[120:123], v[140:143]
    v_permlane16_swap_b32 v201, v203
    v_permlane16_swap_b32 v204, v206
    v_mfma_f32_16x16x32_bf16 v[176:179], a[152:155], a[124:127], v[176:179]
    v_permlane16_swap_b32 v205, v207
    buffer_store_dwordx4 v[200:203], v26, s[24:27], s50 offen offset:2048
    v_mfma_f32_16x16x32_bf16 v[180:183], a[156:159], a[124:127], v[180:183]
    buffer_store_dwordx4 v[204:207], v26, s[24:27], s50 offen offset:3072
    v_mfma_f32_16x16x32_bf16 v[144:147], a[8:11], a[48:51], v[144:147]
    v_mul_f32 v128, s52, v128
    v_mul_f32 v129, s52, v129
    v_mul_f32 v130, s52, v130
    v_mul_f32 v131, s52, v131
    v_mfma_f32_16x16x32_bf16 v[148:151], a[8:11], a[52:55], v[148:151]
    v_mul_f32 v132, s52, v132
    v_mul_f32 v133, s52, v133
    v_mul_f32 v134, s52, v134
    v_mul_f32 v135, s52, v135
    v_mfma_f32_16x16x32_bf16 v[184:187], a[12:15], a[48:51], v[184:187]
    v_mul_f32 v168, s52, v168
    v_mul_f32 v169, s52, v169
    v_mul_f32 v170, s52, v170
    v_mul_f32 v171, s52, v171
    v_mfma_f32_16x16x32_bf16 v[188:191], a[12:15], a[52:55], v[188:191]
    v_mul_f32 v172, s52, v172
    v_mul_f32 v173, s52, v173
    v_mul_f32 v174, s52, v174
    v_mul_f32 v175, s52, v175
    v_mfma_f32_16x16x32_bf16 v[144:147], a[120:123], a[160:163], v[144:147]
    v_cvt_pk_bf16_f32 v208, v128, v129
    v_cvt_pk_bf16_f32 v209, v130, v131
    v_cvt_pk_bf16_f32 v210, v132, v133
    v_cvt_pk_bf16_f32 v211, v134, v135
    v_mfma_f32_16x16x32_bf16 v[148:151], a[120:123], a[164:167], v[148:151]
    v_cvt_pk_bf16_f32 v212, v168, v169
    v_cvt_pk_bf16_f32 v213, v170, v171
    v_cvt_pk_bf16_f32 v214, v172, v173
    v_cvt_pk_bf16_f32 v215, v174, v175
    v_mfma_f32_16x16x32_bf16 v[184:187], a[124:127], a[160:163], v[184:187]
    buffer_store_dwordx4 v[208:211], v28, s[24:27], s48 offen offset:2048
    buffer_store_dwordx4 v[212:215], v28, s[24:27], s48 offen offset:3072
    v_mfma_f32_16x16x32_bf16 v[188:191], a[124:127], a[164:167], v[188:191]
    s_nop 7
    v_cvt_pk_bf16_f32 v216, v136, v137
    v_cvt_pk_bf16_f32 v217, v138, v139
    v_cvt_pk_bf16_f32 v218, v140, v141
    v_cvt_pk_bf16_f32 v219, v142, v143
    v_cvt_pk_bf16_f32 v220, v176, v177
    v_cvt_pk_bf16_f32 v221, v178, v179
    v_cvt_pk_bf16_f32 v222, v180, v181
    v_cvt_pk_bf16_f32 v223, v182, v183
    buffer_store_dwordx4 v[216:219], v28, s[24:27], s51 offen offset:0
    buffer_store_dwordx4 v[220:223], v28, s[24:27], s51 offen offset:1024
    v_cvt_pk_bf16_f32 v224, v144, v145
    v_cvt_pk_bf16_f32 v225, v146, v147
    v_cvt_pk_bf16_f32 v226, v184, v185
    v_cvt_pk_bf16_f32 v227, v186, v187
    v_cvt_pk_bf16_f32 v228, v148, v149
    v_cvt_pk_bf16_f32 v229, v150, v151
    v_cvt_pk_bf16_f32 v230, v188, v189
    v_cvt_pk_bf16_f32 v231, v190, v191
    buffer_store_dwordx4 v[224:227], v28, s[24:27], s51 offen offset:2048
    buffer_store_dwordx4 v[228:231], v28, s[24:27], s51 offen offset:3072
    s_waitcnt vmcnt(0)
K1_END:
    s_endpgm
    .globl k2_attn_seqdft_kernel
    .p2align 8
    .type k2_attn_seqdft_kernel,@function
k2_attn_seqdft_kernel:
    s_cmp_ge_u32 s2, 512
    s_cbranch_scc1 K23_END
    s_cmp_ge_u32 s2, 256
    s_cbranch_scc1 K23_GEMM
    s_setprio 1
    s_load_dwordx2 s[60:61], s[0:1], 88
    s_load_dwordx2 s[56:57], s[0:1], 56
    v_and_b32 v1, 63, v0
    v_lshrrev_b32 v8, 6, v0
    v_lshlrev_b32 v3, 4, v1
    v_readfirstlane_b32 s32, v8
    v_lshlrev_b32 v10, 5, v0
    s_and_b32 s40, s2, 7
    s_lshl_b32 s33, s40, 2
    s_lshr_b32 s41, s2, 6
    s_add_u32 s33, s33, s41
    s_bfe_u32 s41, s2, 0x30003
    s_lshl_b32 s34, s41, 3
    s_lshl_b32 s41, s32, 1
    s_add_u32 s34, s34, s41
    s_lshl_b32 s36, s32, 12
    v_add_u32 v2, s36, v3
    s_lshl_b32 s44, s33, 18
    s_add_u32 s44, s44, 12582912
    s_lshl_b32 s40, s33, 17
    s_lshl_b32 s41, s34, 11
    s_add_u32 s40, s40, s41
    s_add_u32 s40, s40, 8388608
    s_waitcnt lgkmcnt(0)
    s_mov_b32 s8, s60
    s_and_b32 s9, s61, 0xffff
    s_mov_b32 s10, 37748736
    s_mov_b32 s11, 0x00020000
    s_add_u32 m0, s36, 0
    s_add_u32 s35, s44, 0
    buffer_load_dwordx4 v2, s[8:11], s35 offen offset:0 lds
    buffer_load_dwordx4 v2, s[8:11], s35 offen offset:1024 lds
    buffer_load_dwordx4 v2, s[8:11], s35 offen offset:2048 lds
    buffer_load_dwordx4 v2, s[8:11], s35 offen offset:3072 lds
    buffer_load_dwordx4 v[16:19], v3, s[8:11], s40 offen offset:0
    buffer_load_dwordx4 v[20:23], v3, s[8:11], s40 offen offset:1024
    buffer_load_dwordx4 v[24:27], v3, s[8:11], s40 offen offset:2048
    buffer_load_dwordx4 v[28:31], v3, s[8:11], s40 offen offset:3072
    s_mov_b32 s20, s56
    s_and_b32 s21, s57, 0xffff
    s_mov_b32 s22, 2097152
    s_mov_b32 s23, 0x00020000
    v_and_b32 v8, 3, v1
    v_cmp_eq_u32 vcc, 0, v8
    v_mov_b32 v9, 0x3f803f80
    s_nop 0
    v_cndmask_b32 v12, 0, v9, vcc
    v_mov_b32 v13, v12
    v_mov_b32 v14, v12
    v_mov_b32 v15, v12
    v_mov_b32 v88, 0
    v_mov_b32 v89, 0
    v_mov_b32 v90, 0
    v_mov_b32 v91, 0
    v_mov_b32 v92, 0
    v_mov_b32 v93, 0
    v_mov_b32 v94, 0
    v_mov_b32 v95, 0
    v_mov_b32 v96, 0
    v_mov_b32 v97, 0
    v_mov_b32 v98, 0
    v_mov_b32 v99, 0
    v_mov_b32 v100, 0
    v_mov_b32 v101, 0
    v_mov_b32 v102, 0
    v_mov_b32 v103, 0
    v_mov_b32 v104, 0
    v_mov_b32 v105, 0
    v_mov_b32 v106, 0
    v_mov_b32 v107, 0
    v_mov_b32 v108, 0
    v_mov_b32 v109, 0
    v_mov_b32 v110, 0
    v_mov_b32 v111, 0
    v_mov_b32 v112, 0
    v_mov_b32 v113, 0
    v_mov_b32 v114, 0
    v_mov_b32 v115, 0
    v_mov_b32 v116, 0
    v_mov_b32 v117, 0
    v_mov_b32 v118, 0
    v_mov_b32 v119, 0
    v_mov_b32 v152, 0
    v_mov_b32 v153, 0
    v_mov_b32 v154, 0
    v_mov_b32 v155, 0
    v_mov_b32 v156, 0
    v_mov_b32 v157, 0
    v_mov_b32 v158, 0
    v_mov_b32 v159, 0
    v_mov_b32 v160, 0
    v_mov_b32 v161, 0
    v_mov_b32 v162, 0
    v_mov_b32 v163, 0
    v_mov_b32 v164, 0
    v_mov_b32 v165, 0
    v_mov_b32 v166, 0
    v_mov_b32 v167, 0
    v_mov_b32 v84, 0
    v_mov_b32 v85, 0
    v_mov_b32 v86, 0
    v_mov_b32 v87, 0
    v_mov_b32 v144, 0
    v_mov_b32 v145, 0
    v_mov_b32 v146, 0
    v_mov_b32 v147, 0
    v_mov_b32 v148, 0
    v_mov_b32 v149, 0
    v_mov_b32 v150, 0
    v_mov_b32 v151, 0
    s_waitcnt vmcnt(0)
    s_barrier
    ds_read_b128 v[120:123], v3 offset:0
    ds_read_b128 v[124:127], v3 offset:1024
    ds_read_b128 v[136:139], v3 offset:2048
    ds_read_b128 v[140:143], v3 offset:3072
    ds_read_b128 v[128:131], v3 offset:4096
    ds_read_b128 v[132:135], v3 offset:5120
    s_waitcnt lgkmcnt(4)
    v_mfma_f32_16x16x32_bf16 v[48:51], v[120:123], v[16:19], 0
    v_mfma_f32_16x16x32_bf16 v[52:55], v[124:127], v[16:19], 0
    v_mfma_f32_16x16x32_bf16 v[56:59], v[120:123], v[20:23], 0
    v_mfma_f32_16x16x32_bf16 v[60:63], v[124:127], v[20:23], 0
    v_mfma_f32_16x16x32_bf16 v[64:67], v[120:123], v[24:27], 0
    v_mfma_f32_16x16x32_bf16 v[68:71], v[124:127], v[24:27], 0
    v_mfma_f32_16x16x32_bf16 v[72:75], v[120:123], v[28:31], 0
    v_mfma_f32_16x16x32_bf16 v[76:79], v[124:127], v[28:31], 0
    s_add_u32 m0, s36, 16384
    s_add_u32 s35, s44, 16384
    buffer_load_dwordx4 v2, s[8:11], s35 offen offset:0 lds
    buffer_load_dwordx4 v2, s[8:11], s35 offen offset:1024 lds
    buffer_load_dwordx4 v2, s[8:11], s35 offen offset:2048 lds
    buffer_load_dwordx4 v2, s[8:11], s35 offen offset:3072 lds
    s_nop 1
    s_mov_b32 s40, 3254779904
    v_max3_f32 v8, v48, v49, v50
    v_max3_f32 v8, v8, v51, v52
    v_max3_f32 v8, v8, v53, v54
    v_max_f32 v8, v8, v55
    v_mov_b32 v9, v8
    s_nop 1
    v_permlane32_swap_b32 v8, v9
    v_max_f32 v8, v8, v9
    v_mov_b32 v9, v8
    s_nop 1
    v_permlane16_swap_b32 v8, v9
    v_max_f32 v8, v8, v9
    v_sub_f32 v8, s40, v8
    v_mov_b32 v32, v8
    v_mov_b32 v33, v8
    v_mov_b32 v34, v8
    v_mov_b32 v35, v8
    v_add_f32 v48, v48, v8
    v_add_f32 v49, v49, v8
    v_add_f32 v50, v50, v8
    v_add_f32 v51, v51, v8
    v_add_f32 v52, v52, v8
    v_add_f32 v53, v53, v8
    v_add_f32 v54, v54, v8
    v_add_f32 v55, v55, v8
    v_max3_f32 v8, v56, v57, v58
    v_max3_f32 v8, v8, v59, v60
    v_max3_f32 v8, v8, v61, v62
    v_max_f32 v8, v8, v63
    v_mov_b32 v9, v8
    s_nop 1
    v_permlane32_swap_b32 v8, v9
    v_max_f32 v8, v8, v9
    v_mov_b32 v9, v8
    s_nop 1
    v_permlane16_swap_b32 v8, v9
    v_max_f32 v8, v8, v9
    v_sub_f32 v8, s40, v8
    v_mov_b32 v36, v8
    v_mov_b32 v37, v8
    v_mov_b32 v38, v8
    v_mov_b32 v39, v8
    v_add_f32 v56, v56, v8
    v_add_f32 v57, v57, v8
    v_add_f32 v58, v58, v8
    v_add_f32 v59, v59, v8
    v_add_f32 v60, v60, v8
    v_add_f32 v61, v61, v8
    v_add_f32 v62, v62, v8
    v_add_f32 v63, v63, v8
    v_max3_f32 v8, v64, v65, v66
    v_max3_f32 v8, v8, v67, v68
    v_max3_f32 v8, v8, v69, v70
    v_max_f32 v8, v8, v71
    v_mov_b32 v9, v8
    s_nop 1
    v_permlane32_swap_b32 v8, v9
    v_max_f32 v8, v8, v9
    v_mov_b32 v9, v8
    s_nop 1
    v_permlane16_swap_b32 v8, v9
    v_max_f32 v8, v8, v9
    v_sub_f32 v8, s40, v8
    v_mov_b32 v40, v8
    v_mov_b32 v41, v8
    v_mov_b32 v42, v8
    v_mov_b32 v43, v8
    v_max3_f32 v8, v72, v73, v74
    v_max3_f32 v8, v8, v75, v76
    v_max3_f32 v8, v8, v77, v78
    v_max_f32 v8, v8, v79
    v_mov_b32 v9, v8
    s_nop 1
    v_permlane32_swap_b32 v8, v9
    v_max_f32 v8, v8, v9
    v_mov_b32 v9, v8
    s_nop 1
    v_permlane16_swap_b32 v8, v9
    v_max_f32 v8, v8, v9
    v_sub_f32 v8, s40, v8
    v_mov_b32 v44, v8
    v_mov_b32 v45, v8
    v_mov_b32 v46, v8
    v_mov_b32 v47, v8
    s_waitcnt lgkmcnt(0)
    s_nop 0
    v_mfma_f32_16x16x32_bf16 v[112:115], v[144:147], v[84:87], v[112:115]
    v_exp_f32 v48, v48
    v_mfma_f32_16x16x32_bf16 v[116:119], v[148:151], v[84:87], v[116:119]
    ds_read_b128 v[144:147], v3 offset:6144
    ds_read_b128 v[148:151], v3 offset:7168
    v_exp_f32 v49, v49
    v_exp_f32 v50, v50
    v_mfma_f32_16x16x32_bf16 v[164:167], v[12:15], v[84:87], v[164:167]
    v_exp_f32 v51, v51
    v_exp_f32 v52, v52
    v_mfma_f32_16x16x32_bf16 v[64:67], v[120:123], v[24:27], v[40:43]
    v_exp_f32 v53, v53
    v_exp_f32 v54, v54
    v_mfma_f32_16x16x32_bf16 v[68:71], v[124:127], v[24:27], v[40:43]
    v_exp_f32 v55, v55
    v_cvt_pk_bf16_f32 v80, v48, v49
    v_cvt_pk_bf16_f32 v81, v50, v51
    v_mfma_f32_16x16x32_bf16 v[72:75], v[120:123], v[28:31], v[44:47]
    v_cvt_pk_bf16_f32 v82, v52, v53
    v_cvt_pk_bf16_f32 v83, v54, v55
    v_exp_f32 v56, v56
    v_mfma_f32_16x16x32_bf16 v[76:79], v[124:127], v[28:31], v[44:47]
    v_exp_f32 v57, v57
    v_exp_f32 v58, v58
    v_mfma_f32_16x16x32_bf16 v[88:91], v[136:139], v[80:83], v[88:91]
    v_exp_f32 v59, v59
    v_exp_f32 v60, v60
    v_mfma_f32_16x16x32_bf16 v[92:95], v[140:143], v[80:83], v[92:95]
    v_exp_f32 v61, v61
    v_exp_f32 v62, v62
    v_mfma_f32_16x16x32_bf16 v[152:155], v[12:15], v[80:83], v[152:155]
    v_exp_f32 v63, v63
    v_cvt_pk_bf16_f32 v84, v56, v57
    v_cvt_pk_bf16_f32 v85, v58, v59
    v_cvt_pk_bf16_f32 v86, v60, v61
    v_cvt_pk_bf16_f32 v87, v62, v63
    s_waitcnt lgkmcnt(0)
    s_nop 0
    v_mfma_f32_16x16x32_bf16 v[96:99], v[136:139], v[84:87], v[96:99]
    v_exp_f32 v64, v64
    v_mfma_f32_16x16x32_bf16 v[100:103], v[140:143], v[84:87], v[100:103]
    ds_read_b128 v[120:123], v3 offset:8192
    ds_read_b128 v[124:127], v3 offset:9216
    v_exp_f32 v65, v65
    v_exp_f32 v66, v66
    v_mfma_f32_16x16x32_bf16 v[156:159], v[12:15], v[84:87], v[156:159]
    v_exp_f32 v67, v67
    v_exp_f32 v68, v68
    v_mfma_f32_16x16x32_bf16 v[48:51], v[128:131], v[16:19], v[32:35]
    v_exp_f32 v69, v69
    v_exp_f32 v70, v70
    v_mfma_f32_16x16x32_bf16 v[52:55], v[132:135], v[16:19], v[32:35]
    v_exp_f32 v71, v71
    v_cvt_pk_bf16_f32 v80, v64, v65
    v_cvt_pk_bf16_f32 v81, v66, v67
    v_mfma_f32_16x16x32_bf16 v[56:59], v[128:131], v[20:23], v[36:39]
    v_cvt_pk_bf16_f32 v82, v68, v69
    v_cvt_pk_bf16_f32 v83, v70, v71
    v_exp_f32 v72, v72
    v_mfma_f32_16x16x32_bf16 v[60:63], v[132:135], v[20:23], v[36:39]
    v_exp_f32 v73, v73
    v_exp_f32 v74, v74
    v_mfma_f32_16x16x32_bf16 v[104:107], v[136:139], v[80:83], v[104:107]
    v_exp_f32 v75, v75
    v_exp_f32 v76, v76
    v_mfma_f32_16x16x32_bf16 v[108:111], v[140:143], v[80:83], v[108:111]
    v_exp_f32 v77, v77
    v_exp_f32 v78, v78
    v_mfma_f32_16x16x32_bf16 v[160:163], v[12:15], v[80:83], v[160:163]
    v_exp_f32 v79, v79
    v_cvt_pk_bf16_f32 v84, v72, v73
    v_cvt_pk_bf16_f32 v85, v74, v75
    v_cvt_pk_bf16_f32 v86, v76, v77
    v_cvt_pk_bf16_f32 v87, v78, v79
    s_waitcnt lgkmcnt(0)
    s_nop 0
    v_mfma_f32_16x16x32_bf16 v[112:115], v[136:139], v[84:87], v[112:115]
    v_exp_f32 v48, v48
    v_mfma_f32_16x16x32_bf16 v[116:119], v[140:143], v[84:87], v[116:119]
    ds_read_b128 v[136:139], v3 offset:10240
    ds_read_b128 v[140:143], v3 offset:11264
    v_exp_f32 v49, v49
    v_exp_f32 v50, v50
    v_mfma_f32_16x16x32_bf16 v[164:167], v[12:15], v[84:87], v[164:167]
    v_exp_f32 v51, v51
    v_exp_f32 v52, v52
    v_mfma_f32_16x16x32_bf16 v[64:67], v[128:131], v[24:27], v[40:43]
    v_exp_f32 v53, v53
    v_exp_f32 v54, v54
    v_mfma_f32_16x16x32_bf16 v[68:71], v[132:135], v[24:27], v[40:43]
    v_exp_f32 v55, v55
    v_cvt_pk_bf16_f32 v80, v48, v49
    v_cvt_pk_bf16_f32 v81, v50, v51
    v_mfma_f32_16x16x32_bf16 v[72:75], v[128:131], v[28:31], v[44:47]
    s_add_u32 m0, s36, 32768
    s_add_u32 s35, s44, 32768
    buffer_load_dwordx4 v2, s[8:11], s35 offen offset:0 lds
    buffer_load_dwordx4 v2, s[8:11], s35 offen offset:1024 lds
    buffer_load_dwordx4 v2, s[8:11], s35 offen offset:2048 lds
    buffer_load_dwordx4 v2, s[8:11], s35 offen offset:3072 lds
    v_cvt_pk_bf16_f32 v82, v52, v53
    v_cvt_pk_bf16_f32 v83, v54, v55
    v_exp_f32 v56, v56
    v_mfma_f32_16x16x32_bf16 v[76:79], v[132:135], v[28:31], v[44:47]
    v_exp_f32 v57, v57
    v_exp_f32 v58, v58
    v_mfma_f32_16x16x32_bf16 v[88:91], v[144:147], v[80:83], v[88:91]
    v_exp_f32 v59, v59
    v_exp_f32 v60, v60
    v_mfma_f32_16x16x32_bf16 v[92:95], v[148:151], v[80:83], v[92:95]
    v_exp_f32 v61, v61
    v_exp_f32 v62, v62
    v_mfma_f32_16x16x32_bf16 v[152:155], v[12:15], v[80:83], v[152:155]
    v_exp_f32 v63, v63
    v_cvt_pk_bf16_f32 v84, v56, v57
    v_cvt_pk_bf16_f32 v85, v58, v59
    v_cvt_pk_bf16_f32 v86, v60, v61
    v_cvt_pk_bf16_f32 v87, v62, v63
    s_waitcnt lgkmcnt(0)
    s_nop 0
    v_mfma_f32_16x16x32_bf16 v[96:99], v[144:147], v[84:87], v[96:99]
    v_exp_f32 v64, v64
    v_mfma_f32_16x16x32_bf16 v[100:103], v[148:151], v[84:87], v[100:103]
    ds_read_b128 v[128:131], v3 offset:12288
    ds_read_b128 v[132:135], v3 offset:13312
    v_exp_f32 v65, v65
    v_exp_f32 v66, v66
    v_mfma_f32_16x16x32_bf16 v[156:159], v[12:15], v[84:87], v[156:159]
    v_exp_f32 v67, v67
    v_exp_f32 v68, v68
    v_mfma_f32_16x16x32_bf16 v[48:51], v[120:123], v[16:19], v[32:35]
    v_exp_f32 v69, v69
    v_exp_f32 v70, v70
    v_mfma_f32_16x16x32_bf16 v[52:55], v[124:127], v[16:19], v[32:35]
    v_exp_f32 v71, v71
    v_cvt_pk_bf16_f32 v80, v64, v65
    v_cvt_pk_bf16_f32 v81, v66, v67
    v_mfma_f32_16x16x32_bf16 v[56:59], v[120:123], v[20:23], v[36:39]
    v_cvt_pk_bf16_f32 v82, v68, v69
    v_cvt_pk_bf16_f32 v83, v70, v71
    v_exp_f32 v72, v72
    v_mfma_f32_16x16x32_bf16 v[60:63], v[124:127], v[20:23], v[36:39]
    v_exp_f32 v73, v73
    v_exp_f32 v74, v74
    v_mfma_f32_16x16x32_bf16 v[104:107], v[144:147], v[80:83], v[104:107]
    v_exp_f32 v75, v75
    v_exp_f32 v76, v76
    v_mfma_f32_16x16x32_bf16 v[108:111], v[148:151], v[80:83], v[108:111]
    v_exp_f32 v77, v77
    v_exp_f32 v78, v78
    v_mfma_f32_16x16x32_bf16 v[160:163], v[12:15], v[80:83], v[160:163]
    v_exp_f32 v79, v79
    v_cvt_pk_bf16_f32 v84, v72, v73
    v_cvt_pk_bf16_f32 v85, v74, v75
    v_cvt_pk_bf16_f32 v86, v76, v77
    v_cvt_pk_bf16_f32 v87, v78, v79
    s_waitcnt lgkmcnt(0)
    s_nop 0
    v_mfma_f32_16x16x32_bf16 v[112:115], v[144:147], v[84:87], v[112:115]
    v_exp_f32 v48, v48
    v_mfma_f32_16x16x32_bf16 v[116:119], v[148:151], v[84:87], v[116:119]
    ds_read_b128 v[144:147], v3 offset:14336
    ds_read_b128 v[148:151], v3 offset:15360
    v_exp_f32 v49, v49
    v_exp_f32 v50, v50
    v_mfma_f32_16x16x32_bf16 v[164:167], v[12:15], v[84:87], v[164:167]
    v_exp_f32 v51, v51
    v_exp_f32 v52, v52
    v_mfma_f32_16x16x32_bf16 v[64:67], v[120:123], v[24:27], v[40:43]
    v_exp_f32 v53, v53
    v_exp_f32 v54, v54
    v_mfma_f32_16x16x32_bf16 v[68:71], v[124:127], v[24:27], v[40:43]
    v_exp_f32 v55, v55
    v_cvt_pk_bf16_f32 v80, v48, v49
    v_cvt_pk_bf16_f32 v81, v50, v51
    v_mfma_f32_16x16x32_bf16 v[72:75], v[120:123], v[28:31], v[44:47]
    v_and_b32 v8, 15, v1
    v_lshlrev_b32 v8, 2, v8
    s_lshl_b32 s40, s34, 7
    s_add_u32 s40, s40, 20979712
    buffer_load_dword v4, v8, s[8:11], s40 offen offset:0
    buffer_load_dword v5, v8, s[8:11], s40 offen offset:64
    buffer_load_dword v6, v8, s[8:11], s40 offen offset:128
    buffer_load_dword v7, v8, s[8:11], s40 offen offset:192
    v_cvt_pk_bf16_f32 v82, v52, v53
    v_cvt_pk_bf16_f32 v83, v54, v55
    v_exp_f32 v56, v56
    v_mfma_f32_16x16x32_bf16 v[76:79], v[124:127], v[28:31], v[44:47]
    v_exp_f32 v57, v57
    v_exp_f32 v58, v58
    v_mfma_f32_16x16x32_bf16 v[88:91], v[136:139], v[80:83], v[88:91]
    v_exp_f32 v59, v59
    v_exp_f32 v60, v60
    v_mfma_f32_16x16x32_bf16 v[92:95], v[140:143], v[80:83], v[92:95]
    v_exp_f32 v61, v61
    v_exp_f32 v62, v62
    v_mfma_f32_16x16x32_bf16 v[152:155], v[12:15], v[80:83], v[152:155]
    v_exp_f32 v63, v63
    v_cvt_pk_bf16_f32 v84, v56, v57
    v_cvt_pk_bf16_f32 v85, v58, v59
    v_cvt_pk_bf16_f32 v86, v60, v61
    v_cvt_pk_bf16_f32 v87, v62, v63
    s_waitcnt lgkmcnt(0)
    s_nop 0
    v_mfma_f32_16x16x32_bf16 v[96:99], v[136:139], v[84:87], v[96:99]
    v_exp_f32 v64, v64
    v_mfma_f32_16x16x32_bf16 v[100:103], v[140:143], v[84:87], v[100:103]
    v_exp_f32 v65, v65
    v_exp_f32 v66, v66
    v_mfma_f32_16x16x32_bf16 v[156:159], v[12:15], v[84:87], v[156:159]
    v_exp_f32 v67, v67
    v_exp_f32 v68, v68
    v_mfma_f32_16x16x32_bf16 v[48:51], v[128:131], v[16:19], v[32:35]
    v_exp_f32 v69, v69
    v_exp_f32 v70, v70
    v_mfma_f32_16x16x32_bf16 v[52:55], v[132:135], v[16:19], v[32:35]
    v_exp_f32 v71, v71
    v_cvt_pk_bf16_f32 v80, v64, v65
    v_cvt_pk_bf16_f32 v81, v66, v67
    v_mfma_f32_16x16x32_bf16 v[56:59], v[128:131], v[20:23], v[36:39]
    v_cvt_pk_bf16_f32 v82, v68, v69
    v_cvt_pk_bf16_f32 v83, v70, v71
    v_exp_f32 v72, v72
    v_mfma_f32_16x16x32_bf16 v[60:63], v[132:135], v[20:23], v[36:39]
    v_exp_f32 v73, v73
    v_exp_f32 v74, v74
    v_mfma_f32_16x16x32_bf16 v[104:107], v[136:139], v[80:83], v[104:107]
    v_exp_f32 v75, v75
    v_exp_f32 v76, v76
    v_mfma_f32_16x16x32_bf16 v[108:111], v[140:143], v[80:83], v[108:111]
    v_exp_f32 v77, v77
    v_exp_f32 v78, v78
    v_mfma_f32_16x16x32_bf16 v[160:163], v[12:15], v[80:83], v[160:163]
    v_exp_f32 v79, v79
    v_cvt_pk_bf16_f32 v84, v72, v73
    v_cvt_pk_bf16_f32 v85, v74, v75
    v_cvt_pk_bf16_f32 v86, v76, v77
    v_cvt_pk_bf16_f32 v87, v78, v79
    s_waitcnt lgkmcnt(0)
    s_waitcnt vmcnt(8)
    s_barrier
    v_mfma_f32_16x16x32_bf16 v[112:115], v[136:139], v[84:87], v[112:115]
    v_exp_f32 v48, v48
    v_mfma_f32_16x16x32_bf16 v[116:119], v[140:143], v[84:87], v[116:119]
    ds_read_b128 v[120:123], v3 offset:16384
    ds_read_b128 v[124:127], v3 offset:17408
    v_exp_f32 v49, v49
    v_exp_f32 v50, v50
    v_mfma_f32_16x16x32_bf16 v[164:167], v[12:15], v[84:87], v[164:167]
    ds_read_b128 v[136:139], v3 offset:18432
    ds_read_b128 v[140:143], v3 offset:19456
    v_exp_f32 v51, v51
    v_exp_f32 v52, v52
    v_mfma_f32_16x16x32_bf16 v[64:67], v[128:131], v[24:27], v[40:43]
    v_exp_f32 v53, v53
    v_exp_f32 v54, v54
    v_mfma_f32_16x16x32_bf16 v[68:71], v[132:135], v[24:27], v[40:43]
    v_exp_f32 v55, v55
    v_cvt_pk_bf16_f32 v80, v48, v49
    v_cvt_pk_bf16_f32 v81, v50, v51
    v_mfma_f32_16x16x32_bf16 v[72:75], v[128:131], v[28:31], v[44:47]
    s_add_u32 m0, s36, 49152
    s_add_u32 s35, s44, 49152
    buffer_load_dwordx4 v2, s[8:11], s35 offen offset:0 lds
    buffer_load_dwordx4 v2, s[8:11], s35 offen offset:1024 lds
    buffer_load_dwordx4 v2, s[8:11], s35 offen offset:2048 lds
    buffer_load_dwordx4 v2, s[8:11], s35 offen offset:3072 lds
    v_cvt_pk_bf16_f32 v82, v52, v53
    v_cvt_pk_bf16_f32 v83, v54, v55
    v_exp_f32 v56, v56
    v_mfma_f32_16x16x32_bf16 v[76:79], v[132:135], v[28:31], v[44:47]
    v_exp_f32 v57, v57
    v_exp_f32 v58, v58
    v_mfma_f32_16x16x32_bf16 v[88:91], v[144:147], v[80:83], v[88:91]
    v_exp_f32 v59, v59
    v_exp_f32 v60, v60
    v_mfma_f32_16x16x32_bf16 v[92:95], v[148:151], v[80:83], v[92:95]
    v_exp_f32 v61, v61
    v_exp_f32 v62, v62
    v_mfma_f32_16x16x32_bf16 v[152:155], v[12:15], v[80:83], v[152:155]
    v_exp_f32 v63, v63
    v_cvt_pk_bf16_f32 v84, v56, v57
    v_cvt_pk_bf16_f32 v85, v58, v59
    v_cvt_pk_bf16_f32 v86, v60, v61
    v_cvt_pk_bf16_f32 v87, v62, v63
    s_waitcnt lgkmcnt(0)
    s_nop 0
    v_mfma_f32_16x16x32_bf16 v[96:99], v[144:147], v[84:87], v[96:99]
    v_exp_f32 v64, v64
    v_mfma_f32_16x16x32_bf16 v[100:103], v[148:151], v[84:87], v[100:103]
    ds_read_b128 v[128:131], v3 offset:20480
    ds_read_b128 v[132:135], v3 offset:21504
    v_exp_f32 v65, v65
    v_exp_f32 v66, v66
    v_mfma_f32_16x16x32_bf16 v[156:159], v[12:15], v[84:87], v[156:159]
    v_exp_f32 v67, v67
    v_exp_f32 v68, v68
    v_mfma_f32_16x16x32_bf16 v[48:51], v[120:123], v[16:19], v[32:35]
    v_exp_f32 v69, v69
    v_exp_f32 v70, v70
    v_mfma_f32_16x16x32_bf16 v[52:55], v[124:127], v[16:19], v[32:35]
    v_exp_f32 v71, v71
    v_cvt_pk_bf16_f32 v80, v64, v65
    v_cvt_pk_bf16_f32 v81, v66, v67
    v_mfma_f32_16x16x32_bf16 v[56:59], v[120:123], v[20:23], v[36:39]
    v_cvt_pk_bf16_f32 v82, v68, v69
    v_cvt_pk_bf16_f32 v83, v70, v71
    v_exp_f32 v72, v72
    v_mfma_f32_16x16x32_bf16 v[60:63], v[124:127], v[20:23], v[36:39]
    v_exp_f32 v73, v73
    v_exp_f32 v74, v74
    v_mfma_f32_16x16x32_bf16 v[104:107], v[144:147], v[80:83], v[104:107]
    v_exp_f32 v75, v75
    v_exp_f32 v76, v76
    v_mfma_f32_16x16x32_bf16 v[108:111], v[148:151], v[80:83], v[108:111]
    v_exp_f32 v77, v77
    v_exp_f32 v78, v78
    v_mfma_f32_16x16x32_bf16 v[160:163], v[12:15], v[80:83], v[160:163]
    v_exp_f32 v79, v79
    v_cvt_pk_bf16_f32 v84, v72, v73
    v_cvt_pk_bf16_f32 v85, v74, v75
    v_cvt_pk_bf16_f32 v86, v76, v77
    v_cvt_pk_bf16_f32 v87, v78, v79
    s_waitcnt lgkmcnt(0)
    s_nop 0
    v_mfma_f32_16x16x32_bf16 v[112:115], v[144:147], v[84:87], v[112:115]
    v_exp_f32 v48, v48
    v_mfma_f32_16x16x32_bf16 v[116:119], v[148:151], v[84:87], v[116:119]
    ds_read_b128 v[144:147], v3 offset:22528
    ds_read_b128 v[148:151], v3 offset:23552
    v_exp_f32 v49, v49
    v_exp_f32 v50, v50
    v_mfma_f32_16x16x32_bf16 v[164:167], v[12:15], v[84:87], v[164:167]
    v_exp_f32 v51, v51
    v_exp_f32 v52, v52
    v_mfma_f32_16x16x32_bf16 v[64:67], v[120:123], v[24:27], v[40:43]
    v_exp_f32 v53, v53
    v_exp_f32 v54, v54
    v_mfma_f32_16x16x32_bf16 v[68:71], v[124:127], v[24:27], v[40:43]
    v_exp_f32 v55, v55
    v_cvt_pk_bf16_f32 v80, v48, v49
    v_cvt_pk_bf16_f32 v81, v50, v51
    v_mfma_f32_16x16x32_bf16 v[72:75], v[120:123], v[28:31], v[44:47]
    v_cvt_pk_bf16_f32 v82, v52, v53
    v_cvt_pk_bf16_f32 v83, v54, v55
    v_exp_f32 v56, v56
    v_mfma_f32_16x16x32_bf16 v[76:79], v[124:127], v[28:31], v[44:47]
    v_exp_f32 v57, v57
    v_exp_f32 v58, v58
    v_mfma_f32_16x16x32_bf16 v[88:91], v[136:139], v[80:83], v[88:91]
    v_exp_f32 v59, v59
    v_exp_f32 v60, v60
    v_mfma_f32_16x16x32_bf16 v[92:95], v[140:143], v[80:83], v[92:95]
    v_exp_f32 v61, v61
    v_exp_f32 v62, v62
    v_mfma_f32_16x16x32_bf16 v[152:155], v[12:15], v[80:83], v[152:155]
    v_exp_f32 v63, v63
    v_cvt_pk_bf16_f32 v84, v56, v57
    v_cvt_pk_bf16_f32 v85, v58, v59
    v_cvt_pk_bf16_f32 v86, v60, v61
    v_cvt_pk_bf16_f32 v87, v62, v63
    s_waitcnt lgkmcnt(0)
    s_nop 0
    v_mfma_f32_16x16x32_bf16 v[96:99], v[136:139], v[84:87], v[96:99]
    v_exp_f32 v64, v64
    v_mfma_f32_16x16x32_bf16 v[100:103], v[140:143], v[84:87], v[100:103]
    ds_read_b128 v[120:123], v3 offset:24576
    ds_read_b128 v[124:127], v3 offset:25600
    v_exp_f32 v65, v65
    v_exp_f32 v66, v66
    v_mfma_f32_16x16x32_bf16 v[156:159], v[12:15], v[84:87], v[156:159]
    v_exp_f32 v67, v67
    v_exp_f32 v68, v68
    v_mfma_f32_16x16x32_bf16 v[48:51], v[128:131], v[16:19], v[32:35]
    v_exp_f32 v69, v69
    v_exp_f32 v70, v70
    v_mfma_f32_16x16x32_bf16 v[52:55], v[132:135], v[16:19], v[32:35]
    v_exp_f32 v71, v71
    v_cvt_pk_bf16_f32 v80, v64, v65
    v_cvt_pk_bf16_f32 v81, v66, v67
    v_mfma_f32_16x16x32_bf16 v[56:59], v[128:131], v[20:23], v[36:39]
    v_cvt_pk_bf16_f32 v82, v68, v69
    v_cvt_pk_bf16_f32 v83, v70, v71
    v_exp_f32 v72, v72
    v_mfma_f32_16x16x32_bf16 v[60:63], v[132:135], v[20:23], v[36:39]
    v_exp_f32 v73, v73
    v_exp_f32 v74, v74
    v_mfma_f32_16x16x32_bf16 v[104:107], v[136:139], v[80:83], v[104:107]
    v_exp_f32 v75, v75
    v_exp_f32 v76, v76
    v_mfma_f32_16x16x32_bf16 v[108:111], v[140:143], v[80:83], v[108:111]
    v_exp_f32 v77, v77
    v_exp_f32 v78, v78
    v_mfma_f32_16x16x32_bf16 v[160:163], v[12:15], v[80:83], v[160:163]
    v_exp_f32 v79, v79
    v_cvt_pk_bf16_f32 v84, v72, v73
    v_cvt_pk_bf16_f32 v85, v74, v75
    v_cvt_pk_bf16_f32 v86, v76, v77
    v_cvt_pk_bf16_f32 v87, v78, v79
    s_waitcnt lgkmcnt(0)
    s_nop 0
    v_mfma_f32_16x16x32_bf16 v[112:115], v[136:139], v[84:87], v[112:115]
    v_exp_f32 v48, v48
    v_mfma_f32_16x16x32_bf16 v[116:119], v[140:143], v[84:87], v[116:119]
    ds_read_b128 v[136:139], v3 offset:26624
    ds_read_b128 v[140:143], v3 offset:27648
    v_exp_f32 v49, v49
    v_exp_f32 v50, v50
    v_mfma_f32_16x16x32_bf16 v[164:167], v[12:15], v[84:87], v[164:167]
    v_exp_f32 v51, v51
    v_exp_f32 v52, v52
    v_mfma_f32_16x16x32_bf16 v[64:67], v[128:131], v[24:27], v[40:43]
    v_exp_f32 v53, v53
    v_exp_f32 v54, v54
    v_mfma_f32_16x16x32_bf16 v[68:71], v[132:135], v[24:27], v[40:43]
    v_exp_f32 v55, v55
    v_cvt_pk_bf16_f32 v80, v48, v49
    v_cvt_pk_bf16_f32 v81, v50, v51
    v_mfma_f32_16x16x32_bf16 v[72:75], v[128:131], v[28:31], v[44:47]
    v_cvt_pk_bf16_f32 v82, v52, v53
    v_cvt_pk_bf16_f32 v83, v54, v55
    v_exp_f32 v56, v56
    v_mfma_f32_16x16x32_bf16 v[76:79], v[132:135], v[28:31], v[44:47]
    v_exp_f32 v57, v57
    v_exp_f32 v58, v58
    v_mfma_f32_16x16x32_bf16 v[88:91], v[144:147], v[80:83], v[88:91]
    v_exp_f32 v59, v59
    v_exp_f32 v60, v60
    v_mfma_f32_16x16x32_bf16 v[92:95], v[148:151], v[80:83], v[92:95]
    v_exp_f32 v61, v61
    v_exp_f32 v62, v62
    v_mfma_f32_16x16x32_bf16 v[152:155], v[12:15], v[80:83], v[152:155]
    v_exp_f32 v63, v63
    v_cvt_pk_bf16_f32 v84, v56, v57
    v_cvt_pk_bf16_f32 v85, v58, v59
    v_cvt_pk_bf16_f32 v86, v60, v61
    v_cvt_pk_bf16_f32 v87, v62, v63
    s_waitcnt lgkmcnt(0)
    s_nop 0
    v_mfma_f32_16x16x32_bf16 v[96:99], v[144:147], v[84:87], v[96:99]
    v_exp_f32 v64, v64
    v_mfma_f32_16x16x32_bf16 v[100:103], v[148:151], v[84:87], v[100:103]
    ds_read_b128 v[128:131], v3 offset:28672
    ds_read_b128 v[132:135], v3 offset:29696
    v_exp_f32 v65, v65
    v_exp_f32 v66, v66
    v_mfma_f32_16x16x32_bf16 v[156:159], v[12:15], v[84:87], v[156:159]
    v_exp_f32 v67, v67
    v_exp_f32 v68, v68
    v_mfma_f32_16x16x32_bf16 v[48:51], v[120:123], v[16:19], v[32:35]
    v_exp_f32 v69, v69
    v_exp_f32 v70, v70
    v_mfma_f32_16x16x32_bf16 v[52:55], v[124:127], v[16:19], v[32:35]
    v_exp_f32 v71, v71
    v_cvt_pk_bf16_f32 v80, v64, v65
    v_cvt_pk_bf16_f32 v81, v66, v67
    v_mfma_f32_16x16x32_bf16 v[56:59], v[120:123], v[20:23], v[36:39]
    v_cvt_pk_bf16_f32 v82, v68, v69
    v_cvt_pk_bf16_f32 v83, v70, v71
    v_exp_f32 v72, v72
    v_mfma_f32_16x16x32_bf16 v[60:63], v[124:127], v[20:23], v[36:39]
    v_exp_f32 v73, v73
    v_exp_f32 v74, v74
    v_mfma_f32_16x16x32_bf16 v[104:107], v[144:147], v[80:83], v[104:107]
    v_exp_f32 v75, v75
    v_exp_f32 v76, v76
    v_mfma_f32_16x16x32_bf16 v[108:111], v[148:151], v[80:83], v[108:111]
    v_exp_f32 v77, v77
    v_exp_f32 v78, v78
    v_mfma_f32_16x16x32_bf16 v[160:163], v[12:15], v[80:83], v[160:163]
    v_exp_f32 v79, v79
    v_cvt_pk_bf16_f32 v84, v72, v73
    v_cvt_pk_bf16_f32 v85, v74, v75
    v_cvt_pk_bf16_f32 v86, v76, v77
    v_cvt_pk_bf16_f32 v87, v78, v79
    s_waitcnt lgkmcnt(0)
    s_nop 0
    v_mfma_f32_16x16x32_bf16 v[112:115], v[144:147], v[84:87], v[112:115]
    v_exp_f32 v48, v48
    v_mfma_f32_16x16x32_bf16 v[116:119], v[148:151], v[84:87], v[116:119]
    ds_read_b128 v[144:147], v3 offset:30720
    ds_read_b128 v[148:151], v3 offset:31744
    v_exp_f32 v49, v49
    v_exp_f32 v50, v50
    v_mfma_f32_16x16x32_bf16 v[164:167], v[12:15], v[84:87], v[164:167]
    v_exp_f32 v51, v51
    v_exp_f32 v52, v52
    v_mfma_f32_16x16x32_bf16 v[64:67], v[120:123], v[24:27], v[40:43]
    v_exp_f32 v53, v53
    v_exp_f32 v54, v54
    v_mfma_f32_16x16x32_bf16 v[68:71], v[124:127], v[24:27], v[40:43]
    v_exp_f32 v55, v55
    v_cvt_pk_bf16_f32 v80, v48, v49
    v_cvt_pk_bf16_f32 v81, v50, v51
    v_mfma_f32_16x16x32_bf16 v[72:75], v[120:123], v[28:31], v[44:47]
    v_cvt_pk_bf16_f32 v82, v52, v53
    v_cvt_pk_bf16_f32 v83, v54, v55
    v_exp_f32 v56, v56
    v_mfma_f32_16x16x32_bf16 v[76:79], v[124:127], v[28:31], v[44:47]
    v_exp_f32 v57, v57
    v_exp_f32 v58, v58
    v_mfma_f32_16x16x32_bf16 v[88:91], v[136:139], v[80:83], v[88:91]
    v_exp_f32 v59, v59
    v_exp_f32 v60, v60
    v_mfma_f32_16x16x32_bf16 v[92:95], v[140:143], v[80:83], v[92:95]
    v_exp_f32 v61, v61
    v_exp_f32 v62, v62
    v_mfma_f32_16x16x32_bf16 v[152:155], v[12:15], v[80:83], v[152:155]
    v_exp_f32 v63, v63
    v_cvt_pk_bf16_f32 v84, v56, v57
    v_cvt_pk_bf16_f32 v85, v58, v59
    v_cvt_pk_bf16_f32 v86, v60, v61
    v_cvt_pk_bf16_f32 v87, v62, v63
    s_waitcnt lgkmcnt(0)
    s_nop 0
    v_mfma_f32_16x16x32_bf16 v[96:99], v[136:139], v[84:87], v[96:99]
    v_exp_f32 v64, v64
    v_mfma_f32_16x16x32_bf16 v[100:103], v[140:143], v[84:87], v[100:103]
    v_exp_f32 v65, v65
    v_exp_f32 v66, v66
    v_mfma_f32_16x16x32_bf16 v[156:159], v[12:15], v[84:87], v[156:159]
    v_exp_f32 v67, v67
    v_exp_f32 v68, v68
    v_mfma_f32_16x16x32_bf16 v[48:51], v[128:131], v[16:19], v[32:35]
    v_exp_f32 v69, v69
    v_exp_f32 v70, v70
    v_mfma_f32_16x16x32_bf16 v[52:55], v[132:135], v[16:19], v[32:35]
    v_exp_f32 v71, v71
    v_cvt_pk_bf16_f32 v80, v64, v65
    v_cvt_pk_bf16_f32 v81, v66, v67
    v_mfma_f32_16x16x32_bf16 v[56:59], v[128:131], v[20:23], v[36:39]
    v_cvt_pk_bf16_f32 v82, v68, v69
    v_cvt_pk_bf16_f32 v83, v70, v71
    v_exp_f32 v72, v72
    v_mfma_f32_16x16x32_bf16 v[60:63], v[132:135], v[20:23], v[36:39]
    v_exp_f32 v73, v73
    v_exp_f32 v74, v74
    v_mfma_f32_16x16x32_bf16 v[104:107], v[136:139], v[80:83], v[104:107]
    v_exp_f32 v75, v75
    v_exp_f32 v76, v76
    v_mfma_f32_16x16x32_bf16 v[108:111], v[140:143], v[80:83], v[108:111]
    v_exp_f32 v77, v77
    v_exp_f32 v78, v78
    v_mfma_f32_16x16x32_bf16 v[160:163], v[12:15], v[80:83], v[160:163]
    v_exp_f32 v79, v79
    v_cvt_pk_bf16_f32 v84, v72, v73
    v_cvt_pk_bf16_f32 v85, v74, v75
    v_cvt_pk_bf16_f32 v86, v76, v77
    v_cvt_pk_bf16_f32 v87, v78, v79
    s_waitcnt lgkmcnt(0)
    s_waitcnt vmcnt(8)
    s_barrier
    v_mfma_f32_16x16x32_bf16 v[112:115], v[136:139], v[84:87], v[112:115]
    v_exp_f32 v48, v48
    v_mfma_f32_16x16x32_bf16 v[116:119], v[140:143], v[84:87], v[116:119]
    ds_read_b128 v[120:123], v3 offset:32768
    ds_read_b128 v[124:127], v3 offset:33792
    v_exp_f32 v49, v49
    v_exp_f32 v50, v50
    v_mfma_f32_16x16x32_bf16 v[164:167], v[12:15], v[84:87], v[164:167]
    ds_read_b128 v[136:139], v3 offset:34816
    ds_read_b128 v[140:143], v3 offset:35840
    v_exp_f32 v51, v51
    v_exp_f32 v52, v52
    v_mfma_f32_16x16x32_bf16 v[64:67], v[128:131], v[24:27], v[40:43]
    v_exp_f32 v53, v53
    v_exp_f32 v54, v54
    v_mfma_f32_16x16x32_bf16 v[68:71], v[132:135], v[24:27], v[40:43]
    v_exp_f32 v55, v55
    v_cvt_pk_bf16_f32 v80, v48, v49
    v_cvt_pk_bf16_f32 v81, v50, v51
    v_mfma_f32_16x16x32_bf16 v[72:75], v[128:131], v[28:31], v[44:47]
    s_add_u32 m0, s36, 0
    s_add_u32 s35, s44, 65536
    buffer_load_dwordx4 v2, s[8:11], s35 offen offset:0 lds
    buffer_load_dwordx4 v2, s[8:11], s35 offen offset:1024 lds
    buffer_load_dwordx4 v2, s[8:11], s35 offen offset:2048 lds
    buffer_load_dwordx4 v2, s[8:11], s35 offen offset:3072 lds
    v_cvt_pk_bf16_f32 v82, v52, v53
    v_cvt_pk_bf16_f32 v83, v54, v55
    v_exp_f32 v56, v56
    v_mfma_f32_16x16x32_bf16 v[76:79], v[132:135], v[28:31], v[44:47]
    v_exp_f32 v57, v57
    v_exp_f32 v58, v58
    v_mfma_f32_16x16x32_bf16 v[88:91], v[144:147], v[80:83], v[88:91]
    v_exp_f32 v59, v59
    v_exp_f32 v60, v60
    v_mfma_f32_16x16x32_bf16 v[92:95], v[148:151], v[80:83], v[92:95]
    v_exp_f32 v61, v61
    v_exp_f32 v62, v62
    v_mfma_f32_16x16x32_bf16 v[152:155], v[12:15], v[80:83], v[152:155]
    v_exp_f32 v63, v63
    v_cvt_pk_bf16_f32 v84, v56, v57
    v_cvt_pk_bf16_f32 v85, v58, v59
    v_cvt_pk_bf16_f32 v86, v60, v61
    v_cvt_pk_bf16_f32 v87, v62, v63
    s_waitcnt lgkmcnt(0)
    s_nop 0
    v_mfma_f32_16x16x32_bf16 v[96:99], v[144:147], v[84:87], v[96:99]
    v_exp_f32 v64, v64
    v_mfma_f32_16x16x32_bf16 v[100:103], v[148:151], v[84:87], v[100:103]
    ds_read_b128 v[128:131], v3 offset:36864
    ds_read_b128 v[132:135], v3 offset:37888
    v_exp_f32 v65, v65
    v_exp_f32 v66, v66
    v_mfma_f32_16x16x32_bf16 v[156:159], v[12:15], v[84:87], v[156:159]
    v_exp_f32 v67, v67
    v_exp_f32 v68, v68
    v_mfma_f32_16x16x32_bf16 v[48:51], v[120:123], v[16:19], v[32:35]
    v_exp_f32 v69, v69
    v_exp_f32 v70, v70
    v_mfma_f32_16x16x32_bf16 v[52:55], v[124:127], v[16:19], v[32:35]
    v_exp_f32 v71, v71
    v_cvt_pk_bf16_f32 v80, v64, v65
    v_cvt_pk_bf16_f32 v81, v66, v67
    v_mfma_f32_16x16x32_bf16 v[56:59], v[120:123], v[20:23], v[36:39]
    v_cvt_pk_bf16_f32 v82, v68, v69
    v_cvt_pk_bf16_f32 v83, v70, v71
    v_exp_f32 v72, v72
    v_mfma_f32_16x16x32_bf16 v[60:63], v[124:127], v[20:23], v[36:39]
    v_exp_f32 v73, v73
    v_exp_f32 v74, v74
    v_mfma_f32_16x16x32_bf16 v[104:107], v[144:147], v[80:83], v[104:107]
    v_exp_f32 v75, v75
    v_exp_f32 v76, v76
    v_mfma_f32_16x16x32_bf16 v[108:111], v[148:151], v[80:83], v[108:111]
    v_exp_f32 v77, v77
    v_exp_f32 v78, v78
    v_mfma_f32_16x16x32_bf16 v[160:163], v[12:15], v[80:83], v[160:163]
    v_exp_f32 v79, v79
    v_cvt_pk_bf16_f32 v84, v72, v73
    v_cvt_pk_bf16_f32 v85, v74, v75
    v_cvt_pk_bf16_f32 v86, v76, v77
    v_cvt_pk_bf16_f32 v87, v78, v79
    s_waitcnt lgkmcnt(0)
    s_nop 0
    v_mfma_f32_16x16x32_bf16 v[112:115], v[144:147], v[84:87], v[112:115]
    v_exp_f32 v48, v48
    v_mfma_f32_16x16x32_bf16 v[116:119], v[148:151], v[84:87], v[116:119]
    ds_read_b128 v[144:147], v3 offset:38912
    ds_read_b128 v[148:151], v3 offset:39936
    v_exp_f32 v49, v49
    v_exp_f32 v50, v50
    v_mfma_f32_16x16x32_bf16 v[164:167], v[12:15], v[84:87], v[164:167]
    v_exp_f32 v51, v51
    v_exp_f32 v52, v52
    v_mfma_f32_16x16x32_bf16 v[64:67], v[120:123], v[24:27], v[40:43]
    v_exp_f32 v53, v53
    v_exp_f32 v54, v54
    v_mfma_f32_16x16x32_bf16 v[68:71], v[124:127], v[24:27], v[40:43]
    v_exp_f32 v55, v55
    v_cvt_pk_bf16_f32 v80, v48, v49
    v_cvt_pk_bf16_f32 v81, v50, v51
    v_mfma_f32_16x16x32_bf16 v[72:75], v[120:123], v[28:31], v[44:47]
    v_cvt_pk_bf16_f32 v82, v52, v53
    v_cvt_pk_bf16_f32 v83, v54, v55
    v_exp_f32 v56, v56
    v_mfma_f32_16x16x32_bf16 v[76:79], v[124:127], v[28:31], v[44:47]
    v_exp_f32 v57, v57
    v_exp_f32 v58, v58
    v_mfma_f32_16x16x32_bf16 v[88:91], v[136:139], v[80:83], v[88:91]
    v_exp_f32 v59, v59
    v_exp_f32 v60, v60
    v_mfma_f32_16x16x32_bf16 v[92:95], v[140:143], v[80:83], v[92:95]
    v_exp_f32 v61, v61
    v_exp_f32 v62, v62
    v_mfma_f32_16x16x32_bf16 v[152:155], v[12:15], v[80:83], v[152:155]
    v_exp_f32 v63, v63
    v_cvt_pk_bf16_f32 v84, v56, v57
    v_cvt_pk_bf16_f32 v85, v58, v59
    v_cvt_pk_bf16_f32 v86, v60, v61
    v_cvt_pk_bf16_f32 v87, v62, v63
    s_waitcnt lgkmcnt(0)
    s_nop 0
    v_mfma_f32_16x16x32_bf16 v[96:99], v[136:139], v[84:87], v[96:99]
    v_exp_f32 v64, v64
    v_mfma_f32_16x16x32_bf16 v[100:103], v[140:143], v[84:87], v[100:103]
    ds_read_b128 v[120:123], v3 offset:40960
    ds_read_b128 v[124:127], v3 offset:41984
    v_exp_f32 v65, v65
    v_exp_f32 v66, v66
    v_mfma_f32_16x16x32_bf16 v[156:159], v[12:15], v[84:87], v[156:159]
    v_exp_f32 v67, v67
    v_exp_f32 v68, v68
    v_mfma_f32_16x16x32_bf16 v[48:51], v[128:131], v[16:19], v[32:35]
    v_exp_f32 v69, v69
    v_exp_f32 v70, v70
    v_mfma_f32_16x16x32_bf16 v[52:55], v[132:135], v[16:19], v[32:35]
    v_exp_f32 v71, v71
    v_cvt_pk_bf16_f32 v80, v64, v65
    v_cvt_pk_bf16_f32 v81, v66, v67
    v_mfma_f32_16x16x32_bf16 v[56:59], v[128:131], v[20:23], v[36:39]
    v_cvt_pk_bf16_f32 v82, v68, v69
    v_cvt_pk_bf16_f32 v83, v70, v71
    v_exp_f32 v72, v72
    v_mfma_f32_16x16x32_bf16 v[60:63], v[132:135], v[20:23], v[36:39]
    v_exp_f32 v73, v73
    v_exp_f32 v74, v74
    v_mfma_f32_16x16x32_bf16 v[104:107], v[136:139], v[80:83], v[104:107]
    v_exp_f32 v75, v75
    v_exp_f32 v76, v76
    v_mfma_f32_16x16x32_bf16 v[108:111], v[140:143], v[80:83], v[108:111]
    v_exp_f32 v77, v77
    v_exp_f32 v78, v78
    v_mfma_f32_16x16x32_bf16 v[160:163], v[12:15], v[80:83], v[160:163]
    v_exp_f32 v79, v79
    v_cvt_pk_bf16_f32 v84, v72, v73
    v_cvt_pk_bf16_f32 v85, v74, v75
    v_cvt_pk_bf16_f32 v86, v76, v77
    v_cvt_pk_bf16_f32 v87, v78, v79
    s_waitcnt lgkmcnt(0)
    s_nop 0
    v_mfma_f32_16x16x32_bf16 v[112:115], v[136:139], v[84:87], v[112:115]
    v_exp_f32 v48, v48
    v_mfma_f32_16x16x32_bf16 v[116:119], v[140:143], v[84:87], v[116:119]
    ds_read_b128 v[136:139], v3 offset:43008
    ds_read_b128 v[140:143], v3 offset:44032
    v_exp_f32 v49, v49
    v_exp_f32 v50, v50
    v_mfma_f32_16x16x32_bf16 v[164:167], v[12:15], v[84:87], v[164:167]
    v_exp_f32 v51, v51
    v_exp_f32 v52, v52
    v_mfma_f32_16x16x32_bf16 v[64:67], v[128:131], v[24:27], v[40:43]
    v_exp_f32 v53, v53
    v_exp_f32 v54, v54
    v_mfma_f32_16x16x32_bf16 v[68:71], v[132:135], v[24:27], v[40:43]
    v_exp_f32 v55, v55
    v_cvt_pk_bf16_f32 v80, v48, v49
    v_cvt_pk_bf16_f32 v81, v50, v51
    v_mfma_f32_16x16x32_bf16 v[72:75], v[128:131], v[28:31], v[44:47]
    v_cvt_pk_bf16_f32 v82, v52, v53
    v_cvt_pk_bf16_f32 v83, v54, v55
    v_exp_f32 v56, v56
    v_mfma_f32_16x16x32_bf16 v[76:79], v[132:135], v[28:31], v[44:47]
    v_exp_f32 v57, v57
    v_exp_f32 v58, v58
    v_mfma_f32_16x16x32_bf16 v[88:91], v[144:147], v[80:83], v[88:91]
    v_exp_f32 v59, v59
    v_exp_f32 v60, v60
    v_mfma_f32_16x16x32_bf16 v[92:95], v[148:151], v[80:83], v[92:95]
    v_exp_f32 v61, v61
    v_exp_f32 v62, v62
    v_mfma_f32_16x16x32_bf16 v[152:155], v[12:15], v[80:83], v[152:155]
    v_exp_f32 v63, v63
    v_cvt_pk_bf16_f32 v84, v56, v57
    v_cvt_pk_bf16_f32 v85, v58, v59
    v_cvt_pk_bf16_f32 v86, v60, v61
    v_cvt_pk_bf16_f32 v87, v62, v63
    s_waitcnt lgkmcnt(0)
    s_nop 0
    v_mfma_f32_16x16x32_bf16 v[96:99], v[144:147], v[84:87], v[96:99]
    v_exp_f32 v64, v64
    v_mfma_f32_16x16x32_bf16 v[100:103], v[148:151], v[84:87], v[100:103]
    ds_read_b128 v[128:131], v3 offset:45056
    ds_read_b128 v[132:135], v3 offset:46080
    v_exp_f32 v65, v65
    v_exp_f32 v66, v66
    v_mfma_f32_16x16x32_bf16 v[156:159], v[12:15], v[84:87], v[156:159]
    v_exp_f32 v67, v67
    v_exp_f32 v68, v68
    v_mfma_f32_16x16x32_bf16 v[48:51], v[120:123], v[16:19], v[32:35]
    v_exp_f32 v69, v69
    v_exp_f32 v70, v70
    v_mfma_f32_16x16x32_bf16 v[52:55], v[124:127], v[16:19], v[32:35]
    v_exp_f32 v71, v71
    v_cvt_pk_bf16_f32 v80, v64, v65
    v_cvt_pk_bf16_f32 v81, v66, v67
    v_mfma_f32_16x16x32_bf16 v[56:59], v[120:123], v[20:23], v[36:39]
    v_cvt_pk_bf16_f32 v82, v68, v69
    v_cvt_pk_bf16_f32 v83, v70, v71
    v_exp_f32 v72, v72
    v_mfma_f32_16x16x32_bf16 v[60:63], v[124:127], v[20:23], v[36:39]
    v_exp_f32 v73, v73
    v_exp_f32 v74, v74
    v_mfma_f32_16x16x32_bf16 v[104:107], v[144:147], v[80:83], v[104:107]
    v_exp_f32 v75, v75
    v_exp_f32 v76, v76
    v_mfma_f32_16x16x32_bf16 v[108:111], v[148:151], v[80:83], v[108:111]
    v_exp_f32 v77, v77
    v_exp_f32 v78, v78
    v_mfma_f32_16x16x32_bf16 v[160:163], v[12:15], v[80:83], v[160:163]
    v_exp_f32 v79, v79
    v_cvt_pk_bf16_f32 v84, v72, v73
    v_cvt_pk_bf16_f32 v85, v74, v75
    v_cvt_pk_bf16_f32 v86, v76, v77
    v_cvt_pk_bf16_f32 v87, v78, v79
    s_waitcnt lgkmcnt(0)
    s_nop 0
    v_mfma_f32_16x16x32_bf16 v[112:115], v[144:147], v[84:87], v[112:115]
    v_exp_f32 v48, v48
    v_mfma_f32_16x16x32_bf16 v[116:119], v[148:151], v[84:87], v[116:119]
    ds_read_b128 v[144:147], v3 offset:47104
    ds_read_b128 v[148:151], v3 offset:48128
    v_exp_f32 v49, v49
    v_exp_f32 v50, v50
    v_mfma_f32_16x16x32_bf16 v[164:167], v[12:15], v[84:87], v[164:167]
    v_exp_f32 v51, v51
    v_exp_f32 v52, v52
    v_mfma_f32_16x16x32_bf16 v[64:67], v[120:123], v[24:27], v[40:43]
    v_exp_f32 v53, v53
    v_exp_f32 v54, v54
    v_mfma_f32_16x16x32_bf16 v[68:71], v[124:127], v[24:27], v[40:43]
    v_exp_f32 v55, v55
    v_cvt_pk_bf16_f32 v80, v48, v49
    v_cvt_pk_bf16_f32 v81, v50, v51
    v_mfma_f32_16x16x32_bf16 v[72:75], v[120:123], v[28:31], v[44:47]
    v_cvt_pk_bf16_f32 v82, v52, v53
    v_cvt_pk_bf16_f32 v83, v54, v55
    v_exp_f32 v56, v56
    v_mfma_f32_16x16x32_bf16 v[76:79], v[124:127], v[28:31], v[44:47]
    v_exp_f32 v57, v57
    v_exp_f32 v58, v58
    v_mfma_f32_16x16x32_bf16 v[88:91], v[136:139], v[80:83], v[88:91]
    v_exp_f32 v59, v59
    v_exp_f32 v60, v60
    v_mfma_f32_16x16x32_bf16 v[92:95], v[140:143], v[80:83], v[92:95]
    v_exp_f32 v61, v61
    v_exp_f32 v62, v62
    v_mfma_f32_16x16x32_bf16 v[152:155], v[12:15], v[80:83], v[152:155]
    v_exp_f32 v63, v63
    v_cvt_pk_bf16_f32 v84, v56, v57
    v_cvt_pk_bf16_f32 v85, v58, v59
    v_cvt_pk_bf16_f32 v86, v60, v61
    v_cvt_pk_bf16_f32 v87, v62, v63
    s_waitcnt lgkmcnt(0)
    s_nop 0
    v_mfma_f32_16x16x32_bf16 v[96:99], v[136:139], v[84:87], v[96:99]
    v_exp_f32 v64, v64
    v_mfma_f32_16x16x32_bf16 v[100:103], v[140:143], v[84:87], v[100:103]
    v_exp_f32 v65, v65
    v_exp_f32 v66, v66
    v_mfma_f32_16x16x32_bf16 v[156:159], v[12:15], v[84:87], v[156:159]
    v_exp_f32 v67, v67
    v_exp_f32 v68, v68
    v_mfma_f32_16x16x32_bf16 v[48:51], v[128:131], v[16:19], v[32:35]
    v_exp_f32 v69, v69
    v_exp_f32 v70, v70
    v_mfma_f32_16x16x32_bf16 v[52:55], v[132:135], v[16:19], v[32:35]
    v_exp_f32 v71, v71
    v_cvt_pk_bf16_f32 v80, v64, v65
    v_cvt_pk_bf16_f32 v81, v66, v67
    v_mfma_f32_16x16x32_bf16 v[56:59], v[128:131], v[20:23], v[36:39]
    v_cvt_pk_bf16_f32 v82, v68, v69
    v_cvt_pk_bf16_f32 v83, v70, v71
    v_exp_f32 v72, v72
    v_mfma_f32_16x16x32_bf16 v[60:63], v[132:135], v[20:23], v[36:39]
    v_exp_f32 v73, v73
    v_exp_f32 v74, v74
    v_mfma_f32_16x16x32_bf16 v[104:107], v[136:139], v[80:83], v[104:107]
    v_exp_f32 v75, v75
    v_exp_f32 v76, v76
    v_mfma_f32_16x16x32_bf16 v[108:111], v[140:143], v[80:83], v[108:111]
    v_exp_f32 v77, v77
    v_exp_f32 v78, v78
    v_mfma_f32_16x16x32_bf16 v[160:163], v[12:15], v[80:83], v[160:163]
    v_exp_f32 v79, v79
    v_cvt_pk_bf16_f32 v84, v72, v73
    v_cvt_pk_bf16_f32 v85, v74, v75
    v_cvt_pk_bf16_f32 v86, v76, v77
    v_cvt_pk_bf16_f32 v87, v78, v79
    s_waitcnt lgkmcnt(0)
    s_waitcnt vmcnt(4)
    s_barrier
    v_mfma_f32_16x16x32_bf16 v[112:115], v[136:139], v[84:87], v[112:115]
    v_exp_f32 v48, v48
    v_mfma_f32_16x16x32_bf16 v[116:119], v[140:143], v[84:87], v[116:119]
    ds_read_b128 v[120:123], v3 offset:49152
    ds_read_b128 v[124:127], v3 offset:50176
    v_exp_f32 v49, v49
    v_exp_f32 v50, v50
    v_mfma_f32_16x16x32_bf16 v[164:167], v[12:15], v[84:87], v[164:167]
    ds_read_b128 v[136:139], v3 offset:51200
    ds_read_b128 v[140:143], v3 offset:52224
    v_exp_f32 v51, v51
    v_exp_f32 v52, v52
    v_mfma_f32_16x16x32_bf16 v[64:67], v[128:131], v[24:27], v[40:43]
    v_exp_f32 v53, v53
    v_exp_f32 v54, v54
    v_mfma_f32_16x16x32_bf16 v[68:71], v[132:135], v[24:27], v[40:43]
    v_exp_f32 v55, v55
    v_cvt_pk_bf16_f32 v80, v48, v49
    v_cvt_pk_bf16_f32 v81, v50, v51
    v_mfma_f32_16x16x32_bf16 v[72:75], v[128:131], v[28:31], v[44:47]
    s_add_u32 m0, s36, 16384
    s_add_u32 s35, s44, 81920
    buffer_load_dwordx4 v2, s[8:11], s35 offen offset:0 lds
    buffer_load_dwordx4 v2, s[8:11], s35 offen offset:1024 lds
    buffer_load_dwordx4 v2, s[8:11], s35 offen offset:2048 lds
    buffer_load_dwordx4 v2, s[8:11], s35 offen offset:3072 lds
    v_cvt_pk_bf16_f32 v82, v52, v53
    v_cvt_pk_bf16_f32 v83, v54, v55
    v_exp_f32 v56, v56
    v_mfma_f32_16x16x32_bf16 v[76:79], v[132:135], v[28:31], v[44:47]
    v_exp_f32 v57, v57
    v_exp_f32 v58, v58
    v_mfma_f32_16x16x32_bf16 v[88:91], v[144:147], v[80:83], v[88:91]
    v_exp_f32 v59, v59
    v_exp_f32 v60, v60
    v_mfma_f32_16x16x32_bf16 v[92:95], v[148:151], v[80:83], v[92:95]
    v_exp_f32 v61, v61
    v_exp_f32 v62, v62
    v_mfma_f32_16x16x32_bf16 v[152:155], v[12:15], v[80:83], v[152:155]
    v_exp_f32 v63, v63
    v_cvt_pk_bf16_f32 v84, v56, v57
    v_cvt_pk_bf16_f32 v85, v58, v59
    v_cvt_pk_bf16_f32 v86, v60, v61
    v_cvt_pk_bf16_f32 v87, v62, v63
    s_waitcnt lgkmcnt(0)
    s_nop 0
    v_mfma_f32_16x16x32_bf16 v[96:99], v[144:147], v[84:87], v[96:99]
    v_exp_f32 v64, v64
    v_mfma_f32_16x16x32_bf16 v[100:103], v[148:151], v[84:87], v[100:103]
    ds_read_b128 v[128:131], v3 offset:53248
    ds_read_b128 v[132:135], v3 offset:54272
    v_exp_f32 v65, v65
    v_exp_f32 v66, v66
    v_mfma_f32_16x16x32_bf16 v[156:159], v[12:15], v[84:87], v[156:159]
    v_exp_f32 v67, v67
    v_exp_f32 v68, v68
    v_mfma_f32_16x16x32_bf16 v[48:51], v[120:123], v[16:19], v[32:35]
    v_exp_f32 v69, v69
    v_exp_f32 v70, v70
    v_mfma_f32_16x16x32_bf16 v[52:55], v[124:127], v[16:19], v[32:35]
    v_exp_f32 v71, v71
    v_cvt_pk_bf16_f32 v80, v64, v65
    v_cvt_pk_bf16_f32 v81, v66, v67
    v_mfma_f32_16x16x32_bf16 v[56:59], v[120:123], v[20:23], v[36:39]
    v_cvt_pk_bf16_f32 v82, v68, v69
    v_cvt_pk_bf16_f32 v83, v70, v71
    v_exp_f32 v72, v72
    v_mfma_f32_16x16x32_bf16 v[60:63], v[124:127], v[20:23], v[36:39]
    v_exp_f32 v73, v73
    v_exp_f32 v74, v74
    v_mfma_f32_16x16x32_bf16 v[104:107], v[144:147], v[80:83], v[104:107]
    v_exp_f32 v75, v75
    v_exp_f32 v76, v76
    v_mfma_f32_16x16x32_bf16 v[108:111], v[148:151], v[80:83], v[108:111]
    v_exp_f32 v77, v77
    v_exp_f32 v78, v78
    v_mfma_f32_16x16x32_bf16 v[160:163], v[12:15], v[80:83], v[160:163]
    v_exp_f32 v79, v79
    v_cvt_pk_bf16_f32 v84, v72, v73
    v_cvt_pk_bf16_f32 v85, v74, v75
    v_cvt_pk_bf16_f32 v86, v76, v77
    v_cvt_pk_bf16_f32 v87, v78, v79
    s_waitcnt lgkmcnt(0)
    s_nop 0
    v_mfma_f32_16x16x32_bf16 v[112:115], v[144:147], v[84:87], v[112:115]
    v_exp_f32 v48, v48
    v_mfma_f32_16x16x32_bf16 v[116:119], v[148:151], v[84:87], v[116:119]
    ds_read_b128 v[144:147], v3 offset:55296
    ds_read_b128 v[148:151], v3 offset:56320
    v_exp_f32 v49, v49
    v_exp_f32 v50, v50
    v_mfma_f32_16x16x32_bf16 v[164:167], v[12:15], v[84:87], v[164:167]
    v_exp_f32 v51, v51
    v_exp_f32 v52, v52
    v_mfma_f32_16x16x32_bf16 v[64:67], v[120:123], v[24:27], v[40:43]
    v_exp_f32 v53, v53
    v_exp_f32 v54, v54
    v_mfma_f32_16x16x32_bf16 v[68:71], v[124:127], v[24:27], v[40:43]
    v_exp_f32 v55, v55
    v_cvt_pk_bf16_f32 v80, v48, v49
    v_cvt_pk_bf16_f32 v81, v50, v51
    v_mfma_f32_16x16x32_bf16 v[72:75], v[120:123], v[28:31], v[44:47]
    v_cvt_pk_bf16_f32 v82, v52, v53
    v_cvt_pk_bf16_f32 v83, v54, v55
    v_exp_f32 v56, v56
    v_mfma_f32_16x16x32_bf16 v[76:79], v[124:127], v[28:31], v[44:47]
    v_exp_f32 v57, v57
    v_exp_f32 v58, v58
    v_mfma_f32_16x16x32_bf16 v[88:91], v[136:139], v[80:83], v[88:91]
    v_exp_f32 v59, v59
    v_exp_f32 v60, v60
    v_mfma_f32_16x16x32_bf16 v[92:95], v[140:143], v[80:83], v[92:95]
    v_exp_f32 v61, v61
    v_exp_f32 v62, v62
    v_mfma_f32_16x16x32_bf16 v[152:155], v[12:15], v[80:83], v[152:155]
    v_exp_f32 v63, v63
    v_cvt_pk_bf16_f32 v84, v56, v57
    v_cvt_pk_bf16_f32 v85, v58, v59
    v_cvt_pk_bf16_f32 v86, v60, v61
    v_cvt_pk_bf16_f32 v87, v62, v63
    s_waitcnt lgkmcnt(0)
    s_nop 0
    v_mfma_f32_16x16x32_bf16 v[96:99], v[136:139], v[84:87], v[96:99]
    v_exp_f32 v64, v64
    v_mfma_f32_16x16x32_bf16 v[100:103], v[140:143], v[84:87], v[100:103]
    ds_read_b128 v[120:123], v3 offset:57344
    ds_read_b128 v[124:127], v3 offset:58368
    v_exp_f32 v65, v65
    v_exp_f32 v66, v66
    v_mfma_f32_16x16x32_bf16 v[156:159], v[12:15], v[84:87], v[156:159]
    v_exp_f32 v67, v67
    v_exp_f32 v68, v68
    v_mfma_f32_16x16x32_bf16 v[48:51], v[128:131], v[16:19], v[32:35]
    v_exp_f32 v69, v69
    v_exp_f32 v70, v70
    v_mfma_f32_16x16x32_bf16 v[52:55], v[132:135], v[16:19], v[32:35]
    v_exp_f32 v71, v71
    v_cvt_pk_bf16_f32 v80, v64, v65
    v_cvt_pk_bf16_f32 v81, v66, v67
    v_mfma_f32_16x16x32_bf16 v[56:59], v[128:131], v[20:23], v[36:39]
    v_cvt_pk_bf16_f32 v82, v68, v69
    v_cvt_pk_bf16_f32 v83, v70, v71
    v_exp_f32 v72, v72
    v_mfma_f32_16x16x32_bf16 v[60:63], v[132:135], v[20:23], v[36:39]
    v_exp_f32 v73, v73
    v_exp_f32 v74, v74
    v_mfma_f32_16x16x32_bf16 v[104:107], v[136:139], v[80:83], v[104:107]
    v_exp_f32 v75, v75
    v_exp_f32 v76, v76
    v_mfma_f32_16x16x32_bf16 v[108:111], v[140:143], v[80:83], v[108:111]
    v_exp_f32 v77, v77
    v_exp_f32 v78, v78
    v_mfma_f32_16x16x32_bf16 v[160:163], v[12:15], v[80:83], v[160:163]
    v_exp_f32 v79, v79
    v_cvt_pk_bf16_f32 v84, v72, v73
    v_cvt_pk_bf16_f32 v85, v74, v75
    v_cvt_pk_bf16_f32 v86, v76, v77
    v_cvt_pk_bf16_f32 v87, v78, v79
    s_waitcnt lgkmcnt(0)
    s_nop 0
    v_mfma_f32_16x16x32_bf16 v[112:115], v[136:139], v[84:87], v[112:115]
    v_exp_f32 v48, v48
    v_mfma_f32_16x16x32_bf16 v[116:119], v[140:143], v[84:87], v[116:119]
    ds_read_b128 v[136:139], v3 offset:59392
    ds_read_b128 v[140:143], v3 offset:60416
    v_exp_f32 v49, v49
    v_exp_f32 v50, v50
    v_mfma_f32_16x16x32_bf16 v[164:167], v[12:15], v[84:87], v[164:167]
    v_exp_f32 v51, v51
    v_exp_f32 v52, v52
    v_mfma_f32_16x16x32_bf16 v[64:67], v[128:131], v[24:27], v[40:43]
    v_exp_f32 v53, v53
    v_exp_f32 v54, v54
    v_mfma_f32_16x16x32_bf16 v[68:71], v[132:135], v[24:27], v[40:43]
    v_exp_f32 v55, v55
    v_cvt_pk_bf16_f32 v80, v48, v49
    v_cvt_pk_bf16_f32 v81, v50, v51
    v_mfma_f32_16x16x32_bf16 v[72:75], v[128:131], v[28:31], v[44:47]
    v_cvt_pk_bf16_f32 v82, v52, v53
    v_cvt_pk_bf16_f32 v83, v54, v55
    v_exp_f32 v56, v56
    v_mfma_f32_16x16x32_bf16 v[76:79], v[132:135], v[28:31], v[44:47]
    v_exp_f32 v57, v57
    v_exp_f32 v58, v58
    v_mfma_f32_16x16x32_bf16 v[88:91], v[144:147], v[80:83], v[88:91]
    v_exp_f32 v59, v59
    v_exp_f32 v60, v60
    v_mfma_f32_16x16x32_bf16 v[92:95], v[148:151], v[80:83], v[92:95]
    v_exp_f32 v61, v61
    v_exp_f32 v62, v62
    v_mfma_f32_16x16x32_bf16 v[152:155], v[12:15], v[80:83], v[152:155]
    v_exp_f32 v63, v63
    v_cvt_pk_bf16_f32 v84, v56, v57
    v_cvt_pk_bf16_f32 v85, v58, v59
    v_cvt_pk_bf16_f32 v86, v60, v61
    v_cvt_pk_bf16_f32 v87, v62, v63
    s_waitcnt lgkmcnt(0)
    s_nop 0
    v_mfma_f32_16x16x32_bf16 v[96:99], v[144:147], v[84:87], v[96:99]
    v_exp_f32 v64, v64
    v_mfma_f32_16x16x32_bf16 v[100:103], v[148:151], v[84:87], v[100:103]
    ds_read_b128 v[128:131], v3 offset:61440
    ds_read_b128 v[132:135], v3 offset:62464
    v_exp_f32 v65, v65
    v_exp_f32 v66, v66
    v_mfma_f32_16x16x32_bf16 v[156:159], v[12:15], v[84:87], v[156:159]
    v_exp_f32 v67, v67
    v_exp_f32 v68, v68
    v_mfma_f32_16x16x32_bf16 v[48:51], v[120:123], v[16:19], v[32:35]
    v_exp_f32 v69, v69
    v_exp_f32 v70, v70
    v_mfma_f32_16x16x32_bf16 v[52:55], v[124:127], v[16:19], v[32:35]
    v_exp_f32 v71, v71
    v_cvt_pk_bf16_f32 v80, v64, v65
    v_cvt_pk_bf16_f32 v81, v66, v67
    v_mfma_f32_16x16x32_bf16 v[56:59], v[120:123], v[20:23], v[36:39]
    v_cvt_pk_bf16_f32 v82, v68, v69
    v_cvt_pk_bf16_f32 v83, v70, v71
    v_exp_f32 v72, v72
    v_mfma_f32_16x16x32_bf16 v[60:63], v[124:127], v[20:23], v[36:39]
    v_exp_f32 v73, v73
    v_exp_f32 v74, v74
    v_mfma_f32_16x16x32_bf16 v[104:107], v[144:147], v[80:83], v[104:107]
    v_exp_f32 v75, v75
    v_exp_f32 v76, v76
    v_mfma_f32_16x16x32_bf16 v[108:111], v[148:151], v[80:83], v[108:111]
    v_exp_f32 v77, v77
    v_exp_f32 v78, v78
    v_mfma_f32_16x16x32_bf16 v[160:163], v[12:15], v[80:83], v[160:163]
    v_exp_f32 v79, v79
    v_cvt_pk_bf16_f32 v84, v72, v73
    v_cvt_pk_bf16_f32 v85, v74, v75
    v_cvt_pk_bf16_f32 v86, v76, v77
    v_cvt_pk_bf16_f32 v87, v78, v79
    s_waitcnt lgkmcnt(0)
    s_nop 0
    v_mfma_f32_16x16x32_bf16 v[112:115], v[144:147], v[84:87], v[112:115]
    v_exp_f32 v48, v48
    v_mfma_f32_16x16x32_bf16 v[116:119], v[148:151], v[84:87], v[116:119]
    ds_read_b128 v[144:147], v3 offset:63488
    ds_read_b128 v[148:151], v3 offset:64512
    v_exp_f32 v49, v49
    v_exp_f32 v50, v50
    v_mfma_f32_16x16x32_bf16 v[164:167], v[12:15], v[84:87], v[164:167]
    v_exp_f32 v51, v51
    v_exp_f32 v52, v52
    v_mfma_f32_16x16x32_bf16 v[64:67], v[120:123], v[24:27], v[40:43]
    v_exp_f32 v53, v53
    v_exp_f32 v54, v54
    v_mfma_f32_16x16x32_bf16 v[68:71], v[124:127], v[24:27], v[40:43]
    v_exp_f32 v55, v55
    v_cvt_pk_bf16_f32 v80, v48, v49
    v_cvt_pk_bf16_f32 v81, v50, v51
    v_mfma_f32_16x16x32_bf16 v[72:75], v[120:123], v[28:31], v[44:47]
    v_cvt_pk_bf16_f32 v82, v52, v53
    v_cvt_pk_bf16_f32 v83, v54, v55
    v_exp_f32 v56, v56
    v_mfma_f32_16x16x32_bf16 v[76:79], v[124:127], v[28:31], v[44:47]
    v_exp_f32 v57, v57
    v_exp_f32 v58, v58
    v_mfma_f32_16x16x32_bf16 v[88:91], v[136:139], v[80:83], v[88:91]
    v_exp_f32 v59, v59
    v_exp_f32 v60, v60
    v_mfma_f32_16x16x32_bf16 v[92:95], v[140:143], v[80:83], v[92:95]
    v_exp_f32 v61, v61
    v_exp_f32 v62, v62
    v_mfma_f32_16x16x32_bf16 v[152:155], v[12:15], v[80:83], v[152:155]
    v_exp_f32 v63, v63
    v_cvt_pk_bf16_f32 v84, v56, v57
    v_cvt_pk_bf16_f32 v85, v58, v59
    v_cvt_pk_bf16_f32 v86, v60, v61
    v_cvt_pk_bf16_f32 v87, v62, v63
    s_waitcnt lgkmcnt(0)
    s_nop 0
    v_mfma_f32_16x16x32_bf16 v[96:99], v[136:139], v[84:87], v[96:99]
    v_exp_f32 v64, v64
    v_mfma_f32_16x16x32_bf16 v[100:103], v[140:143], v[84:87], v[100:103]
    v_exp_f32 v65, v65
    v_exp_f32 v66, v66
    v_mfma_f32_16x16x32_bf16 v[156:159], v[12:15], v[84:87], v[156:159]
    v_exp_f32 v67, v67
    v_exp_f32 v68, v68
    v_mfma_f32_16x16x32_bf16 v[48:51], v[128:131], v[16:19], v[32:35]
    v_exp_f32 v69, v69
    v_exp_f32 v70, v70
    v_mfma_f32_16x16x32_bf16 v[52:55], v[132:135], v[16:19], v[32:35]
    v_exp_f32 v71, v71
    v_cvt_pk_bf16_f32 v80, v64, v65
    v_cvt_pk_bf16_f32 v81, v66, v67
    v_mfma_f32_16x16x32_bf16 v[56:59], v[128:131], v[20:23], v[36:39]
    v_cvt_pk_bf16_f32 v82, v68, v69
    v_cvt_pk_bf16_f32 v83, v70, v71
    v_exp_f32 v72, v72
    v_mfma_f32_16x16x32_bf16 v[60:63], v[132:135], v[20:23], v[36:39]
    v_exp_f32 v73, v73
    v_exp_f32 v74, v74
    v_mfma_f32_16x16x32_bf16 v[104:107], v[136:139], v[80:83], v[104:107]
    v_exp_f32 v75, v75
    v_exp_f32 v76, v76
    v_mfma_f32_16x16x32_bf16 v[108:111], v[140:143], v[80:83], v[108:111]
    v_exp_f32 v77, v77
    v_exp_f32 v78, v78
    v_mfma_f32_16x16x32_bf16 v[160:163], v[12:15], v[80:83], v[160:163]
    v_exp_f32 v79, v79
    v_cvt_pk_bf16_f32 v84, v72, v73
    v_cvt_pk_bf16_f32 v85, v74, v75
    v_cvt_pk_bf16_f32 v86, v76, v77
    v_cvt_pk_bf16_f32 v87, v78, v79
    s_waitcnt lgkmcnt(0)
    s_waitcnt vmcnt(4)
    s_barrier
    v_mfma_f32_16x16x32_bf16 v[112:115], v[136:139], v[84:87], v[112:115]
    v_exp_f32 v48, v48
    v_mfma_f32_16x16x32_bf16 v[116:119], v[140:143], v[84:87], v[116:119]
    ds_read_b128 v[120:123], v3 offset:0
    ds_read_b128 v[124:127], v3 offset:1024
    v_exp_f32 v49, v49
    v_exp_f32 v50, v50
    v_mfma_f32_16x16x32_bf16 v[164:167], v[12:15], v[84:87], v[164:167]
    ds_read_b128 v[136:139], v3 offset:2048
    ds_read_b128 v[140:143], v3 offset:3072
    v_exp_f32 v51, v51
    v_exp_f32 v52, v52
    v_mfma_f32_16x16x32_bf16 v[64:67], v[128:131], v[24:27], v[40:43]
    v_exp_f32 v53, v53
    v_exp_f32 v54, v54
    v_mfma_f32_16x16x32_bf16 v[68:71], v[132:135], v[24:27], v[40:43]
    v_exp_f32 v55, v55
    v_cvt_pk_bf16_f32 v80, v48, v49
    v_cvt_pk_bf16_f32 v81, v50, v51
    v_mfma_f32_16x16x32_bf16 v[72:75], v[128:131], v[28:31], v[44:47]
    s_add_u32 m0, s36, 32768
    s_add_u32 s35, s44, 98304
    buffer_load_dwordx4 v2, s[8:11], s35 offen offset:0 lds
    buffer_load_dwordx4 v2, s[8:11], s35 offen offset:1024 lds
    buffer_load_dwordx4 v2, s[8:11], s35 offen offset:2048 lds
    buffer_load_dwordx4 v2, s[8:11], s35 offen offset:3072 lds
    v_cvt_pk_bf16_f32 v82, v52, v53
    v_cvt_pk_bf16_f32 v83, v54, v55
    v_exp_f32 v56, v56
    v_mfma_f32_16x16x32_bf16 v[76:79], v[132:135], v[28:31], v[44:47]
    v_exp_f32 v57, v57
    v_exp_f32 v58, v58
    v_mfma_f32_16x16x32_bf16 v[88:91], v[144:147], v[80:83], v[88:91]
    v_exp_f32 v59, v59
    v_exp_f32 v60, v60
    v_mfma_f32_16x16x32_bf16 v[92:95], v[148:151], v[80:83], v[92:95]
    v_exp_f32 v61, v61
    v_exp_f32 v62, v62
    v_mfma_f32_16x16x32_bf16 v[152:155], v[12:15], v[80:83], v[152:155]
    v_exp_f32 v63, v63
    v_cvt_pk_bf16_f32 v84, v56, v57
    v_cvt_pk_bf16_f32 v85, v58, v59
    v_cvt_pk_bf16_f32 v86, v60, v61
    v_cvt_pk_bf16_f32 v87, v62, v63
    s_waitcnt lgkmcnt(0)
    s_nop 0
    v_mfma_f32_16x16x32_bf16 v[96:99], v[144:147], v[84:87], v[96:99]
    v_exp_f32 v64, v64
    v_mfma_f32_16x16x32_bf16 v[100:103], v[148:151], v[84:87], v[100:103]
    ds_read_b128 v[128:131], v3 offset:4096
    ds_read_b128 v[132:135], v3 offset:5120
    v_exp_f32 v65, v65
    v_exp_f32 v66, v66
    v_mfma_f32_16x16x32_bf16 v[156:159], v[12:15], v[84:87], v[156:159]
    v_exp_f32 v67, v67
    v_exp_f32 v68, v68
    v_mfma_f32_16x16x32_bf16 v[48:51], v[120:123], v[16:19], v[32:35]
    v_exp_f32 v69, v69
    v_exp_f32 v70, v70
    v_mfma_f32_16x16x32_bf16 v[52:55], v[124:127], v[16:19], v[32:35]
    v_exp_f32 v71, v71
    v_cvt_pk_bf16_f32 v80, v64, v65
    v_cvt_pk_bf16_f32 v81, v66, v67
    v_mfma_f32_16x16x32_bf16 v[56:59], v[120:123], v[20:23], v[36:39]
    v_cvt_pk_bf16_f32 v82, v68, v69
    v_cvt_pk_bf16_f32 v83, v70, v71
    v_exp_f32 v72, v72
    v_mfma_f32_16x16x32_bf16 v[60:63], v[124:127], v[20:23], v[36:39]
    v_exp_f32 v73, v73
    v_exp_f32 v74, v74
    v_mfma_f32_16x16x32_bf16 v[104:107], v[144:147], v[80:83], v[104:107]
    v_exp_f32 v75, v75
    v_exp_f32 v76, v76
    v_mfma_f32_16x16x32_bf16 v[108:111], v[148:151], v[80:83], v[108:111]
    v_exp_f32 v77, v77
    v_exp_f32 v78, v78
    v_mfma_f32_16x16x32_bf16 v[160:163], v[12:15], v[80:83], v[160:163]
    v_exp_f32 v79, v79
    v_cvt_pk_bf16_f32 v84, v72, v73
    v_cvt_pk_bf16_f32 v85, v74, v75
    v_cvt_pk_bf16_f32 v86, v76, v77
    v_cvt_pk_bf16_f32 v87, v78, v79
    s_waitcnt lgkmcnt(0)
    s_nop 0
    v_mfma_f32_16x16x32_bf16 v[112:115], v[144:147], v[84:87], v[112:115]
    v_exp_f32 v48, v48
    v_mfma_f32_16x16x32_bf16 v[116:119], v[148:151], v[84:87], v[116:119]
    ds_read_b128 v[144:147], v3 offset:6144
    ds_read_b128 v[148:151], v3 offset:7168
    v_exp_f32 v49, v49
    v_exp_f32 v50, v50
    v_mfma_f32_16x16x32_bf16 v[164:167], v[12:15], v[84:87], v[164:167]
    v_exp_f32 v51, v51
    v_exp_f32 v52, v52
    v_mfma_f32_16x16x32_bf16 v[64:67], v[120:123], v[24:27], v[40:43]
    v_exp_f32 v53, v53
    v_exp_f32 v54, v54
    v_mfma_f32_16x16x32_bf16 v[68:71], v[124:127], v[24:27], v[40:43]
    v_exp_f32 v55, v55
    v_cvt_pk_bf16_f32 v80, v48, v49
    v_cvt_pk_bf16_f32 v81, v50, v51
    v_mfma_f32_16x16x32_bf16 v[72:75], v[120:123], v[28:31], v[44:47]
    v_cvt_pk_bf16_f32 v82, v52, v53
    v_cvt_pk_bf16_f32 v83, v54, v55
    v_exp_f32 v56, v56
    v_mfma_f32_16x16x32_bf16 v[76:79], v[124:127], v[28:31], v[44:47]
    v_exp_f32 v57, v57
    v_exp_f32 v58, v58
    v_mfma_f32_16x16x32_bf16 v[88:91], v[136:139], v[80:83], v[88:91]
    v_exp_f32 v59, v59
    v_exp_f32 v60, v60
    v_mfma_f32_16x16x32_bf16 v[92:95], v[140:143], v[80:83], v[92:95]
    v_exp_f32 v61, v61
    v_exp_f32 v62, v62
    v_mfma_f32_16x16x32_bf16 v[152:155], v[12:15], v[80:83], v[152:155]
    v_exp_f32 v63, v63
    v_cvt_pk_bf16_f32 v84, v56, v57
    v_cvt_pk_bf16_f32 v85, v58, v59
    v_cvt_pk_bf16_f32 v86, v60, v61
    v_cvt_pk_bf16_f32 v87, v62, v63
    s_waitcnt lgkmcnt(0)
    s_nop 0
    v_mfma_f32_16x16x32_bf16 v[96:99], v[136:139], v[84:87], v[96:99]
    v_exp_f32 v64, v64
    v_mfma_f32_16x16x32_bf16 v[100:103], v[140:143], v[84:87], v[100:103]
    ds_read_b128 v[120:123], v3 offset:8192
    ds_read_b128 v[124:127], v3 offset:9216
    v_exp_f32 v65, v65
    v_exp_f32 v66, v66
    v_mfma_f32_16x16x32_bf16 v[156:159], v[12:15], v[84:87], v[156:159]
    v_exp_f32 v67, v67
    v_exp_f32 v68, v68
    v_mfma_f32_16x16x32_bf16 v[48:51], v[128:131], v[16:19], v[32:35]
    v_exp_f32 v69, v69
    v_exp_f32 v70, v70
    v_mfma_f32_16x16x32_bf16 v[52:55], v[132:135], v[16:19], v[32:35]
    v_exp_f32 v71, v71
    v_cvt_pk_bf16_f32 v80, v64, v65
    v_cvt_pk_bf16_f32 v81, v66, v67
    v_mfma_f32_16x16x32_bf16 v[56:59], v[128:131], v[20:23], v[36:39]
    v_cvt_pk_bf16_f32 v82, v68, v69
    v_cvt_pk_bf16_f32 v83, v70, v71
    v_exp_f32 v72, v72
    v_mfma_f32_16x16x32_bf16 v[60:63], v[132:135], v[20:23], v[36:39]
    v_exp_f32 v73, v73
    v_exp_f32 v74, v74
    v_mfma_f32_16x16x32_bf16 v[104:107], v[136:139], v[80:83], v[104:107]
    v_exp_f32 v75, v75
    v_exp_f32 v76, v76
    v_mfma_f32_16x16x32_bf16 v[108:111], v[140:143], v[80:83], v[108:111]
    v_exp_f32 v77, v77
    v_exp_f32 v78, v78
    v_mfma_f32_16x16x32_bf16 v[160:163], v[12:15], v[80:83], v[160:163]
    v_exp_f32 v79, v79
    v_cvt_pk_bf16_f32 v84, v72, v73
    v_cvt_pk_bf16_f32 v85, v74, v75
    v_cvt_pk_bf16_f32 v86, v76, v77
    v_cvt_pk_bf16_f32 v87, v78, v79
    s_waitcnt lgkmcnt(0)
    s_nop 0
    v_mfma_f32_16x16x32_bf16 v[112:115], v[136:139], v[84:87], v[112:115]
    v_exp_f32 v48, v48
    v_mfma_f32_16x16x32_bf16 v[116:119], v[140:143], v[84:87], v[116:119]
    ds_read_b128 v[136:139], v3 offset:10240
    ds_read_b128 v[140:143], v3 offset:11264
    v_exp_f32 v49, v49
    v_exp_f32 v50, v50
    v_mfma_f32_16x16x32_bf16 v[164:167], v[12:15], v[84:87], v[164:167]
    v_exp_f32 v51, v51
    v_exp_f32 v52, v52
    v_mfma_f32_16x16x32_bf16 v[64:67], v[128:131], v[24:27], v[40:43]
    v_exp_f32 v53, v53
    v_exp_f32 v54, v54
    v_mfma_f32_16x16x32_bf16 v[68:71], v[132:135], v[24:27], v[40:43]
    v_exp_f32 v55, v55
    v_cvt_pk_bf16_f32 v80, v48, v49
    v_cvt_pk_bf16_f32 v81, v50, v51
    v_mfma_f32_16x16x32_bf16 v[72:75], v[128:131], v[28:31], v[44:47]
    v_cvt_pk_bf16_f32 v82, v52, v53
    v_cvt_pk_bf16_f32 v83, v54, v55
    v_exp_f32 v56, v56
    v_mfma_f32_16x16x32_bf16 v[76:79], v[132:135], v[28:31], v[44:47]
    v_exp_f32 v57, v57
    v_exp_f32 v58, v58
    v_mfma_f32_16x16x32_bf16 v[88:91], v[144:147], v[80:83], v[88:91]
    v_exp_f32 v59, v59
    v_exp_f32 v60, v60
    v_mfma_f32_16x16x32_bf16 v[92:95], v[148:151], v[80:83], v[92:95]
    v_exp_f32 v61, v61
    v_exp_f32 v62, v62
    v_mfma_f32_16x16x32_bf16 v[152:155], v[12:15], v[80:83], v[152:155]
    v_exp_f32 v63, v63
    v_cvt_pk_bf16_f32 v84, v56, v57
    v_cvt_pk_bf16_f32 v85, v58, v59
    v_cvt_pk_bf16_f32 v86, v60, v61
    v_cvt_pk_bf16_f32 v87, v62, v63
    s_waitcnt lgkmcnt(0)
    s_nop 0
    v_mfma_f32_16x16x32_bf16 v[96:99], v[144:147], v[84:87], v[96:99]
    v_exp_f32 v64, v64
    v_mfma_f32_16x16x32_bf16 v[100:103], v[148:151], v[84:87], v[100:103]
    ds_read_b128 v[128:131], v3 offset:12288
    ds_read_b128 v[132:135], v3 offset:13312
    v_exp_f32 v65, v65
    v_exp_f32 v66, v66
    v_mfma_f32_16x16x32_bf16 v[156:159], v[12:15], v[84:87], v[156:159]
    v_exp_f32 v67, v67
    v_exp_f32 v68, v68
    v_mfma_f32_16x16x32_bf16 v[48:51], v[120:123], v[16:19], v[32:35]
    v_exp_f32 v69, v69
    v_exp_f32 v70, v70
    v_mfma_f32_16x16x32_bf16 v[52:55], v[124:127], v[16:19], v[32:35]
    v_exp_f32 v71, v71
    v_cvt_pk_bf16_f32 v80, v64, v65
    v_cvt_pk_bf16_f32 v81, v66, v67
    v_mfma_f32_16x16x32_bf16 v[56:59], v[120:123], v[20:23], v[36:39]
    v_cvt_pk_bf16_f32 v82, v68, v69
    v_cvt_pk_bf16_f32 v83, v70, v71
    v_exp_f32 v72, v72
    v_mfma_f32_16x16x32_bf16 v[60:63], v[124:127], v[20:23], v[36:39]
    v_exp_f32 v73, v73
    v_exp_f32 v74, v74
    v_mfma_f32_16x16x32_bf16 v[104:107], v[144:147], v[80:83], v[104:107]
    v_exp_f32 v75, v75
    v_exp_f32 v76, v76
    v_mfma_f32_16x16x32_bf16 v[108:111], v[148:151], v[80:83], v[108:111]
    v_exp_f32 v77, v77
    v_exp_f32 v78, v78
    v_mfma_f32_16x16x32_bf16 v[160:163], v[12:15], v[80:83], v[160:163]
    v_exp_f32 v79, v79
    v_cvt_pk_bf16_f32 v84, v72, v73
    v_cvt_pk_bf16_f32 v85, v74, v75
    v_cvt_pk_bf16_f32 v86, v76, v77
    v_cvt_pk_bf16_f32 v87, v78, v79
    s_waitcnt lgkmcnt(0)
    s_nop 0
    v_mfma_f32_16x16x32_bf16 v[112:115], v[144:147], v[84:87], v[112:115]
    v_exp_f32 v48, v48
    v_mfma_f32_16x16x32_bf16 v[116:119], v[148:151], v[84:87], v[116:119]
    ds_read_b128 v[144:147], v3 offset:14336
    ds_read_b128 v[148:151], v3 offset:15360
    v_exp_f32 v49, v49
    v_exp_f32 v50, v50
    v_mfma_f32_16x16x32_bf16 v[164:167], v[12:15], v[84:87], v[164:167]
    v_exp_f32 v51, v51
    v_exp_f32 v52, v52
    v_mfma_f32_16x16x32_bf16 v[64:67], v[120:123], v[24:27], v[40:43]
    v_exp_f32 v53, v53
    v_exp_f32 v54, v54
    v_mfma_f32_16x16x32_bf16 v[68:71], v[124:127], v[24:27], v[40:43]
    v_exp_f32 v55, v55
    v_cvt_pk_bf16_f32 v80, v48, v49
    v_cvt_pk_bf16_f32 v81, v50, v51
    v_mfma_f32_16x16x32_bf16 v[72:75], v[120:123], v[28:31], v[44:47]
    v_cvt_pk_bf16_f32 v82, v52, v53
    v_cvt_pk_bf16_f32 v83, v54, v55
    v_exp_f32 v56, v56
    v_mfma_f32_16x16x32_bf16 v[76:79], v[124:127], v[28:31], v[44:47]
    v_exp_f32 v57, v57
    v_exp_f32 v58, v58
    v_mfma_f32_16x16x32_bf16 v[88:91], v[136:139], v[80:83], v[88:91]
    v_exp_f32 v59, v59
    v_exp_f32 v60, v60
    v_mfma_f32_16x16x32_bf16 v[92:95], v[140:143], v[80:83], v[92:95]
    v_exp_f32 v61, v61
    v_exp_f32 v62, v62
    v_mfma_f32_16x16x32_bf16 v[152:155], v[12:15], v[80:83], v[152:155]
    v_exp_f32 v63, v63
    v_cvt_pk_bf16_f32 v84, v56, v57
    v_cvt_pk_bf16_f32 v85, v58, v59
    v_cvt_pk_bf16_f32 v86, v60, v61
    v_cvt_pk_bf16_f32 v87, v62, v63
    s_waitcnt lgkmcnt(0)
    s_nop 0
    v_mfma_f32_16x16x32_bf16 v[96:99], v[136:139], v[84:87], v[96:99]
    v_exp_f32 v64, v64
    v_mfma_f32_16x16x32_bf16 v[100:103], v[140:143], v[84:87], v[100:103]
    v_exp_f32 v65, v65
    v_exp_f32 v66, v66
    v_mfma_f32_16x16x32_bf16 v[156:159], v[12:15], v[84:87], v[156:159]
    v_exp_f32 v67, v67
    v_exp_f32 v68, v68
    v_mfma_f32_16x16x32_bf16 v[48:51], v[128:131], v[16:19], v[32:35]
    v_exp_f32 v69, v69
    v_exp_f32 v70, v70
    v_mfma_f32_16x16x32_bf16 v[52:55], v[132:135], v[16:19], v[32:35]
    v_exp_f32 v71, v71
    v_cvt_pk_bf16_f32 v80, v64, v65
    v_cvt_pk_bf16_f32 v81, v66, v67
    v_mfma_f32_16x16x32_bf16 v[56:59], v[128:131], v[20:23], v[36:39]
    v_cvt_pk_bf16_f32 v82, v68, v69
    v_cvt_pk_bf16_f32 v83, v70, v71
    v_exp_f32 v72, v72
    v_mfma_f32_16x16x32_bf16 v[60:63], v[132:135], v[20:23], v[36:39]
    v_exp_f32 v73, v73
    v_exp_f32 v74, v74
    v_mfma_f32_16x16x32_bf16 v[104:107], v[136:139], v[80:83], v[104:107]
    v_exp_f32 v75, v75
    v_exp_f32 v76, v76
    v_mfma_f32_16x16x32_bf16 v[108:111], v[140:143], v[80:83], v[108:111]
    v_exp_f32 v77, v77
    v_exp_f32 v78, v78
    v_mfma_f32_16x16x32_bf16 v[160:163], v[12:15], v[80:83], v[160:163]
    v_exp_f32 v79, v79
    v_cvt_pk_bf16_f32 v84, v72, v73
    v_cvt_pk_bf16_f32 v85, v74, v75
    v_cvt_pk_bf16_f32 v86, v76, v77
    v_cvt_pk_bf16_f32 v87, v78, v79
    s_waitcnt lgkmcnt(0)
    s_waitcnt vmcnt(4)
    s_barrier
    v_mfma_f32_16x16x32_bf16 v[112:115], v[136:139], v[84:87], v[112:115]
    v_exp_f32 v48, v48
    v_mfma_f32_16x16x32_bf16 v[116:119], v[140:143], v[84:87], v[116:119]
    ds_read_b128 v[120:123], v3 offset:16384
    ds_read_b128 v[124:127], v3 offset:17408
    v_exp_f32 v49, v49
    v_exp_f32 v50, v50
    v_mfma_f32_16x16x32_bf16 v[164:167], v[12:15], v[84:87], v[164:167]
    ds_read_b128 v[136:139], v3 offset:18432
    ds_read_b128 v[140:143], v3 offset:19456
    v_exp_f32 v51, v51
    v_exp_f32 v52, v52
    v_mfma_f32_16x16x32_bf16 v[64:67], v[128:131], v[24:27], v[40:43]
    v_exp_f32 v53, v53
    v_exp_f32 v54, v54
    v_mfma_f32_16x16x32_bf16 v[68:71], v[132:135], v[24:27], v[40:43]
    v_exp_f32 v55, v55
    v_cvt_pk_bf16_f32 v80, v48, v49
    v_cvt_pk_bf16_f32 v81, v50, v51
    v_mfma_f32_16x16x32_bf16 v[72:75], v[128:131], v[28:31], v[44:47]
    s_add_u32 m0, s36, 49152
    s_add_u32 s35, s44, 114688
    buffer_load_dwordx4 v2, s[8:11], s35 offen offset:0 lds
    buffer_load_dwordx4 v2, s[8:11], s35 offen offset:1024 lds
    buffer_load_dwordx4 v2, s[8:11], s35 offen offset:2048 lds
    buffer_load_dwordx4 v2, s[8:11], s35 offen offset:3072 lds
    v_cvt_pk_bf16_f32 v82, v52, v53
    v_cvt_pk_bf16_f32 v83, v54, v55
    v_exp_f32 v56, v56
    v_mfma_f32_16x16x32_bf16 v[76:79], v[132:135], v[28:31], v[44:47]
    v_exp_f32 v57, v57
    v_exp_f32 v58, v58
    v_mfma_f32_16x16x32_bf16 v[88:91], v[144:147], v[80:83], v[88:91]
    v_exp_f32 v59, v59
    v_exp_f32 v60, v60
    v_mfma_f32_16x16x32_bf16 v[92:95], v[148:151], v[80:83], v[92:95]
    v_exp_f32 v61, v61
    v_exp_f32 v62, v62
    v_mfma_f32_16x16x32_bf16 v[152:155], v[12:15], v[80:83], v[152:155]
    v_exp_f32 v63, v63
    v_cvt_pk_bf16_f32 v84, v56, v57
    v_cvt_pk_bf16_f32 v85, v58, v59
    v_cvt_pk_bf16_f32 v86, v60, v61
    v_cvt_pk_bf16_f32 v87, v62, v63
    s_waitcnt lgkmcnt(0)
    s_nop 0
    v_mfma_f32_16x16x32_bf16 v[96:99], v[144:147], v[84:87], v[96:99]
    v_exp_f32 v64, v64
    v_mfma_f32_16x16x32_bf16 v[100:103], v[148:151], v[84:87], v[100:103]
    ds_read_b128 v[128:131], v3 offset:20480
    ds_read_b128 v[132:135], v3 offset:21504
    v_exp_f32 v65, v65
    v_exp_f32 v66, v66
    v_mfma_f32_16x16x32_bf16 v[156:159], v[12:15], v[84:87], v[156:159]
    v_exp_f32 v67, v67
    v_exp_f32 v68, v68
    v_mfma_f32_16x16x32_bf16 v[48:51], v[120:123], v[16:19], v[32:35]
    v_exp_f32 v69, v69
    v_exp_f32 v70, v70
    v_mfma_f32_16x16x32_bf16 v[52:55], v[124:127], v[16:19], v[32:35]
    v_exp_f32 v71, v71
    v_cvt_pk_bf16_f32 v80, v64, v65
    v_cvt_pk_bf16_f32 v81, v66, v67
    v_mfma_f32_16x16x32_bf16 v[56:59], v[120:123], v[20:23], v[36:39]
    v_cvt_pk_bf16_f32 v82, v68, v69
    v_cvt_pk_bf16_f32 v83, v70, v71
    v_exp_f32 v72, v72
    v_mfma_f32_16x16x32_bf16 v[60:63], v[124:127], v[20:23], v[36:39]
    v_exp_f32 v73, v73
    v_exp_f32 v74, v74
    v_mfma_f32_16x16x32_bf16 v[104:107], v[144:147], v[80:83], v[104:107]
    v_exp_f32 v75, v75
    v_exp_f32 v76, v76
    v_mfma_f32_16x16x32_bf16 v[108:111], v[148:151], v[80:83], v[108:111]
    v_exp_f32 v77, v77
    v_exp_f32 v78, v78
    v_mfma_f32_16x16x32_bf16 v[160:163], v[12:15], v[80:83], v[160:163]
    v_exp_f32 v79, v79
    v_cvt_pk_bf16_f32 v84, v72, v73
    v_cvt_pk_bf16_f32 v85, v74, v75
    v_cvt_pk_bf16_f32 v86, v76, v77
    v_cvt_pk_bf16_f32 v87, v78, v79
    s_waitcnt lgkmcnt(0)
    s_nop 0
    v_mfma_f32_16x16x32_bf16 v[112:115], v[144:147], v[84:87], v[112:115]
    v_exp_f32 v48, v48
    v_mfma_f32_16x16x32_bf16 v[116:119], v[148:151], v[84:87], v[116:119]
    ds_read_b128 v[144:147], v3 offset:22528
    ds_read_b128 v[148:151], v3 offset:23552
    v_exp_f32 v49, v49
    v_exp_f32 v50, v50
    v_mfma_f32_16x16x32_bf16 v[164:167], v[12:15], v[84:87], v[164:167]
    v_exp_f32 v51, v51
    v_exp_f32 v52, v52
    v_mfma_f32_16x16x32_bf16 v[64:67], v[120:123], v[24:27], v[40:43]
    v_exp_f32 v53, v53
    v_exp_f32 v54, v54
    v_mfma_f32_16x16x32_bf16 v[68:71], v[124:127], v[24:27], v[40:43]
    v_exp_f32 v55, v55
    v_cvt_pk_bf16_f32 v80, v48, v49
    v_cvt_pk_bf16_f32 v81, v50, v51
    v_mfma_f32_16x16x32_bf16 v[72:75], v[120:123], v[28:31], v[44:47]
    v_cvt_pk_bf16_f32 v82, v52, v53
    v_cvt_pk_bf16_f32 v83, v54, v55
    v_exp_f32 v56, v56
    v_mfma_f32_16x16x32_bf16 v[76:79], v[124:127], v[28:31], v[44:47]
    v_exp_f32 v57, v57
    v_exp_f32 v58, v58
    v_mfma_f32_16x16x32_bf16 v[88:91], v[136:139], v[80:83], v[88:91]
    v_exp_f32 v59, v59
    v_exp_f32 v60, v60
    v_mfma_f32_16x16x32_bf16 v[92:95], v[140:143], v[80:83], v[92:95]
    v_exp_f32 v61, v61
    v_exp_f32 v62, v62
    v_mfma_f32_16x16x32_bf16 v[152:155], v[12:15], v[80:83], v[152:155]
    v_exp_f32 v63, v63
    v_cvt_pk_bf16_f32 v84, v56, v57
    v_cvt_pk_bf16_f32 v85, v58, v59
    v_cvt_pk_bf16_f32 v86, v60, v61
    v_cvt_pk_bf16_f32 v87, v62, v63
    s_waitcnt lgkmcnt(0)
    s_nop 0
    v_mfma_f32_16x16x32_bf16 v[96:99], v[136:139], v[84:87], v[96:99]
    v_exp_f32 v64, v64
    v_mfma_f32_16x16x32_bf16 v[100:103], v[140:143], v[84:87], v[100:103]
    ds_read_b128 v[120:123], v3 offset:24576
    ds_read_b128 v[124:127], v3 offset:25600
    v_exp_f32 v65, v65
    v_exp_f32 v66, v66
    v_mfma_f32_16x16x32_bf16 v[156:159], v[12:15], v[84:87], v[156:159]
    v_exp_f32 v67, v67
    v_exp_f32 v68, v68
    v_mfma_f32_16x16x32_bf16 v[48:51], v[128:131], v[16:19], v[32:35]
    v_exp_f32 v69, v69
    v_exp_f32 v70, v70
    v_mfma_f32_16x16x32_bf16 v[52:55], v[132:135], v[16:19], v[32:35]
    v_exp_f32 v71, v71
    v_cvt_pk_bf16_f32 v80, v64, v65
    v_cvt_pk_bf16_f32 v81, v66, v67
    v_mfma_f32_16x16x32_bf16 v[56:59], v[128:131], v[20:23], v[36:39]
    v_cvt_pk_bf16_f32 v82, v68, v69
    v_cvt_pk_bf16_f32 v83, v70, v71
    v_exp_f32 v72, v72
    v_mfma_f32_16x16x32_bf16 v[60:63], v[132:135], v[20:23], v[36:39]
    v_exp_f32 v73, v73
    v_exp_f32 v74, v74
    v_mfma_f32_16x16x32_bf16 v[104:107], v[136:139], v[80:83], v[104:107]
    v_exp_f32 v75, v75
    v_exp_f32 v76, v76
    v_mfma_f32_16x16x32_bf16 v[108:111], v[140:143], v[80:83], v[108:111]
    v_exp_f32 v77, v77
    v_exp_f32 v78, v78
    v_mfma_f32_16x16x32_bf16 v[160:163], v[12:15], v[80:83], v[160:163]
    v_exp_f32 v79, v79
    v_cvt_pk_bf16_f32 v84, v72, v73
    v_cvt_pk_bf16_f32 v85, v74, v75
    v_cvt_pk_bf16_f32 v86, v76, v77
    v_cvt_pk_bf16_f32 v87, v78, v79
    s_waitcnt lgkmcnt(0)
    s_nop 0
    v_mfma_f32_16x16x32_bf16 v[112:115], v[136:139], v[84:87], v[112:115]
    v_exp_f32 v48, v48
    v_mfma_f32_16x16x32_bf16 v[116:119], v[140:143], v[84:87], v[116:119]
    ds_read_b128 v[136:139], v3 offset:26624
    ds_read_b128 v[140:143], v3 offset:27648
    v_exp_f32 v49, v49
    v_exp_f32 v50, v50
    v_mfma_f32_16x16x32_bf16 v[164:167], v[12:15], v[84:87], v[164:167]
    v_exp_f32 v51, v51
    v_exp_f32 v52, v52
    v_mfma_f32_16x16x32_bf16 v[64:67], v[128:131], v[24:27], v[40:43]
    v_exp_f32 v53, v53
    v_exp_f32 v54, v54
    v_mfma_f32_16x16x32_bf16 v[68:71], v[132:135], v[24:27], v[40:43]
    v_exp_f32 v55, v55
    v_cvt_pk_bf16_f32 v80, v48, v49
    v_cvt_pk_bf16_f32 v81, v50, v51
    v_mfma_f32_16x16x32_bf16 v[72:75], v[128:131], v[28:31], v[44:47]
    v_cvt_pk_bf16_f32 v82, v52, v53
    v_cvt_pk_bf16_f32 v83, v54, v55
    v_exp_f32 v56, v56
    v_mfma_f32_16x16x32_bf16 v[76:79], v[132:135], v[28:31], v[44:47]
    v_exp_f32 v57, v57
    v_exp_f32 v58, v58
    v_mfma_f32_16x16x32_bf16 v[88:91], v[144:147], v[80:83], v[88:91]
    v_exp_f32 v59, v59
    v_exp_f32 v60, v60
    v_mfma_f32_16x16x32_bf16 v[92:95], v[148:151], v[80:83], v[92:95]
    v_exp_f32 v61, v61
    v_exp_f32 v62, v62
    v_mfma_f32_16x16x32_bf16 v[152:155], v[12:15], v[80:83], v[152:155]
    v_exp_f32 v63, v63
    v_cvt_pk_bf16_f32 v84, v56, v57
    v_cvt_pk_bf16_f32 v85, v58, v59
    v_cvt_pk_bf16_f32 v86, v60, v61
    v_cvt_pk_bf16_f32 v87, v62, v63
    s_waitcnt lgkmcnt(0)
    s_nop 0
    v_mfma_f32_16x16x32_bf16 v[96:99], v[144:147], v[84:87], v[96:99]
    v_exp_f32 v64, v64
    v_mfma_f32_16x16x32_bf16 v[100:103], v[148:151], v[84:87], v[100:103]
    ds_read_b128 v[128:131], v3 offset:28672
    ds_read_b128 v[132:135], v3 offset:29696
    v_exp_f32 v65, v65
    v_exp_f32 v66, v66
    v_mfma_f32_16x16x32_bf16 v[156:159], v[12:15], v[84:87], v[156:159]
    v_exp_f32 v67, v67
    v_exp_f32 v68, v68
    v_mfma_f32_16x16x32_bf16 v[48:51], v[120:123], v[16:19], v[32:35]
    v_exp_f32 v69, v69
    v_exp_f32 v70, v70
    v_mfma_f32_16x16x32_bf16 v[52:55], v[124:127], v[16:19], v[32:35]
    v_exp_f32 v71, v71
    v_cvt_pk_bf16_f32 v80, v64, v65
    v_cvt_pk_bf16_f32 v81, v66, v67
    v_mfma_f32_16x16x32_bf16 v[56:59], v[120:123], v[20:23], v[36:39]
    v_cvt_pk_bf16_f32 v82, v68, v69
    v_cvt_pk_bf16_f32 v83, v70, v71
    v_exp_f32 v72, v72
    v_mfma_f32_16x16x32_bf16 v[60:63], v[124:127], v[20:23], v[36:39]
    v_exp_f32 v73, v73
    v_exp_f32 v74, v74
    v_mfma_f32_16x16x32_bf16 v[104:107], v[144:147], v[80:83], v[104:107]
    v_exp_f32 v75, v75
    v_exp_f32 v76, v76
    v_mfma_f32_16x16x32_bf16 v[108:111], v[148:151], v[80:83], v[108:111]
    v_exp_f32 v77, v77
    v_exp_f32 v78, v78
    v_mfma_f32_16x16x32_bf16 v[160:163], v[12:15], v[80:83], v[160:163]
    v_exp_f32 v79, v79
    v_cvt_pk_bf16_f32 v84, v72, v73
    v_cvt_pk_bf16_f32 v85, v74, v75
    v_cvt_pk_bf16_f32 v86, v76, v77
    v_cvt_pk_bf16_f32 v87, v78, v79
    s_waitcnt lgkmcnt(0)
    s_nop 0
    v_mfma_f32_16x16x32_bf16 v[112:115], v[144:147], v[84:87], v[112:115]
    v_exp_f32 v48, v48
    v_mfma_f32_16x16x32_bf16 v[116:119], v[148:151], v[84:87], v[116:119]
    ds_read_b128 v[144:147], v3 offset:30720
    ds_read_b128 v[148:151], v3 offset:31744
    v_exp_f32 v49, v49
    v_exp_f32 v50, v50
    v_mfma_f32_16x16x32_bf16 v[164:167], v[12:15], v[84:87], v[164:167]
    v_exp_f32 v51, v51
    v_exp_f32 v52, v52
    v_mfma_f32_16x16x32_bf16 v[64:67], v[120:123], v[24:27], v[40:43]
    v_exp_f32 v53, v53
    v_exp_f32 v54, v54
    v_mfma_f32_16x16x32_bf16 v[68:71], v[124:127], v[24:27], v[40:43]
    v_exp_f32 v55, v55
    v_cvt_pk_bf16_f32 v80, v48, v49
    v_cvt_pk_bf16_f32 v81, v50, v51
    v_mfma_f32_16x16x32_bf16 v[72:75], v[120:123], v[28:31], v[44:47]
    v_cvt_pk_bf16_f32 v82, v52, v53
    v_cvt_pk_bf16_f32 v83, v54, v55
    v_exp_f32 v56, v56
    v_mfma_f32_16x16x32_bf16 v[76:79], v[124:127], v[28:31], v[44:47]
    v_exp_f32 v57, v57
    v_exp_f32 v58, v58
    v_mfma_f32_16x16x32_bf16 v[88:91], v[136:139], v[80:83], v[88:91]
    v_exp_f32 v59, v59
    v_exp_f32 v60, v60
    v_mfma_f32_16x16x32_bf16 v[92:95], v[140:143], v[80:83], v[92:95]
    v_exp_f32 v61, v61
    v_exp_f32 v62, v62
    v_mfma_f32_16x16x32_bf16 v[152:155], v[12:15], v[80:83], v[152:155]
    v_exp_f32 v63, v63
    v_cvt_pk_bf16_f32 v84, v56, v57
    v_cvt_pk_bf16_f32 v85, v58, v59
    v_cvt_pk_bf16_f32 v86, v60, v61
    v_cvt_pk_bf16_f32 v87, v62, v63
    s_waitcnt lgkmcnt(0)
    s_nop 0
    v_mfma_f32_16x16x32_bf16 v[96:99], v[136:139], v[84:87], v[96:99]
    v_exp_f32 v64, v64
    v_mfma_f32_16x16x32_bf16 v[100:103], v[140:143], v[84:87], v[100:103]
    v_exp_f32 v65, v65
    v_exp_f32 v66, v66
    v_mfma_f32_16x16x32_bf16 v[156:159], v[12:15], v[84:87], v[156:159]
    v_exp_f32 v67, v67
    v_exp_f32 v68, v68
    v_mfma_f32_16x16x32_bf16 v[48:51], v[128:131], v[16:19], v[32:35]
    v_exp_f32 v69, v69
    v_exp_f32 v70, v70
    v_mfma_f32_16x16x32_bf16 v[52:55], v[132:135], v[16:19], v[32:35]
    v_exp_f32 v71, v71
    v_cvt_pk_bf16_f32 v80, v64, v65
    v_cvt_pk_bf16_f32 v81, v66, v67
    v_mfma_f32_16x16x32_bf16 v[56:59], v[128:131], v[20:23], v[36:39]
    v_cvt_pk_bf16_f32 v82, v68, v69
    v_cvt_pk_bf16_f32 v83, v70, v71
    v_exp_f32 v72, v72
    v_mfma_f32_16x16x32_bf16 v[60:63], v[132:135], v[20:23], v[36:39]
    v_exp_f32 v73, v73
    v_exp_f32 v74, v74
    v_mfma_f32_16x16x32_bf16 v[104:107], v[136:139], v[80:83], v[104:107]
    v_exp_f32 v75, v75
    v_exp_f32 v76, v76
    v_mfma_f32_16x16x32_bf16 v[108:111], v[140:143], v[80:83], v[108:111]
    v_exp_f32 v77, v77
    v_exp_f32 v78, v78
    v_mfma_f32_16x16x32_bf16 v[160:163], v[12:15], v[80:83], v[160:163]
    v_exp_f32 v79, v79
    v_cvt_pk_bf16_f32 v84, v72, v73
    v_cvt_pk_bf16_f32 v85, v74, v75
    v_cvt_pk_bf16_f32 v86, v76, v77
    v_cvt_pk_bf16_f32 v87, v78, v79
    s_waitcnt lgkmcnt(0)
    s_waitcnt vmcnt(4)
    s_barrier
    v_mfma_f32_16x16x32_bf16 v[112:115], v[136:139], v[84:87], v[112:115]
    v_exp_f32 v48, v48
    v_mfma_f32_16x16x32_bf16 v[116:119], v[140:143], v[84:87], v[116:119]
    ds_read_b128 v[120:123], v3 offset:32768
    ds_read_b128 v[124:127], v3 offset:33792
    v_exp_f32 v49, v49
    v_exp_f32 v50, v50
    v_mfma_f32_16x16x32_bf16 v[164:167], v[12:15], v[84:87], v[164:167]
    ds_read_b128 v[136:139], v3 offset:34816
    ds_read_b128 v[140:143], v3 offset:35840
    v_exp_f32 v51, v51
    v_exp_f32 v52, v52
    v_mfma_f32_16x16x32_bf16 v[64:67], v[128:131], v[24:27], v[40:43]
    v_exp_f32 v53, v53
    v_exp_f32 v54, v54
    v_mfma_f32_16x16x32_bf16 v[68:71], v[132:135], v[24:27], v[40:43]
    v_exp_f32 v55, v55
    v_cvt_pk_bf16_f32 v80, v48, v49
    v_cvt_pk_bf16_f32 v81, v50, v51
    v_mfma_f32_16x16x32_bf16 v[72:75], v[128:131], v[28:31], v[44:47]
    s_add_u32 m0, s36, 0
    s_add_u32 s35, s44, 131072
    buffer_load_dwordx4 v2, s[8:11], s35 offen offset:0 lds
    buffer_load_dwordx4 v2, s[8:11], s35 offen offset:1024 lds
    buffer_load_dwordx4 v2, s[8:11], s35 offen offset:2048 lds
    buffer_load_dwordx4 v2, s[8:11], s35 offen offset:3072 lds
    v_cvt_pk_bf16_f32 v82, v52, v53
    v_cvt_pk_bf16_f32 v83, v54, v55
    v_exp_f32 v56, v56
    v_mfma_f32_16x16x32_bf16 v[76:79], v[132:135], v[28:31], v[44:47]
    v_exp_f32 v57, v57
    v_exp_f32 v58, v58
    v_mfma_f32_16x16x32_bf16 v[88:91], v[144:147], v[80:83], v[88:91]
    v_exp_f32 v59, v59
    v_exp_f32 v60, v60
    v_mfma_f32_16x16x32_bf16 v[92:95], v[148:151], v[80:83], v[92:95]
    v_exp_f32 v61, v61
    v_exp_f32 v62, v62
    v_mfma_f32_16x16x32_bf16 v[152:155], v[12:15], v[80:83], v[152:155]
    v_exp_f32 v63, v63
    v_cvt_pk_bf16_f32 v84, v56, v57
    v_cvt_pk_bf16_f32 v85, v58, v59
    v_cvt_pk_bf16_f32 v86, v60, v61
    v_cvt_pk_bf16_f32 v87, v62, v63
    s_waitcnt lgkmcnt(0)
    s_nop 0
    v_mfma_f32_16x16x32_bf16 v[96:99], v[144:147], v[84:87], v[96:99]
    v_exp_f32 v64, v64
    v_mfma_f32_16x16x32_bf16 v[100:103], v[148:151], v[84:87], v[100:103]
    ds_read_b128 v[128:131], v3 offset:36864
    ds_read_b128 v[132:135], v3 offset:37888
    v_exp_f32 v65, v65
    v_exp_f32 v66, v66
    v_mfma_f32_16x16x32_bf16 v[156:159], v[12:15], v[84:87], v[156:159]
    v_exp_f32 v67, v67
    v_exp_f32 v68, v68
    v_mfma_f32_16x16x32_bf16 v[48:51], v[120:123], v[16:19], v[32:35]
    v_exp_f32 v69, v69
    v_exp_f32 v70, v70
    v_mfma_f32_16x16x32_bf16 v[52:55], v[124:127], v[16:19], v[32:35]
    v_exp_f32 v71, v71
    v_cvt_pk_bf16_f32 v80, v64, v65
    v_cvt_pk_bf16_f32 v81, v66, v67
    v_mfma_f32_16x16x32_bf16 v[56:59], v[120:123], v[20:23], v[36:39]
    v_cvt_pk_bf16_f32 v82, v68, v69
    v_cvt_pk_bf16_f32 v83, v70, v71
    v_exp_f32 v72, v72
    v_mfma_f32_16x16x32_bf16 v[60:63], v[124:127], v[20:23], v[36:39]
    v_exp_f32 v73, v73
    v_exp_f32 v74, v74
    v_mfma_f32_16x16x32_bf16 v[104:107], v[144:147], v[80:83], v[104:107]
    v_exp_f32 v75, v75
    v_exp_f32 v76, v76
    v_mfma_f32_16x16x32_bf16 v[108:111], v[148:151], v[80:83], v[108:111]
    v_exp_f32 v77, v77
    v_exp_f32 v78, v78
    v_mfma_f32_16x16x32_bf16 v[160:163], v[12:15], v[80:83], v[160:163]
    v_exp_f32 v79, v79
    v_cvt_pk_bf16_f32 v84, v72, v73
    v_cvt_pk_bf16_f32 v85, v74, v75
    v_cvt_pk_bf16_f32 v86, v76, v77
    v_cvt_pk_bf16_f32 v87, v78, v79
    s_waitcnt lgkmcnt(0)
    s_nop 0
    v_mfma_f32_16x16x32_bf16 v[112:115], v[144:147], v[84:87], v[112:115]
    v_exp_f32 v48, v48
    v_mfma_f32_16x16x32_bf16 v[116:119], v[148:151], v[84:87], v[116:119]
    ds_read_b128 v[144:147], v3 offset:38912
    ds_read_b128 v[148:151], v3 offset:39936
    v_exp_f32 v49, v49
    v_exp_f32 v50, v50
    v_mfma_f32_16x16x32_bf16 v[164:167], v[12:15], v[84:87], v[164:167]
    v_exp_f32 v51, v51
    v_exp_f32 v52, v52
    v_mfma_f32_16x16x32_bf16 v[64:67], v[120:123], v[24:27], v[40:43]
    v_exp_f32 v53, v53
    v_exp_f32 v54, v54
    v_mfma_f32_16x16x32_bf16 v[68:71], v[124:127], v[24:27], v[40:43]
    v_exp_f32 v55, v55
    v_cvt_pk_bf16_f32 v80, v48, v49
    v_cvt_pk_bf16_f32 v81, v50, v51
    v_mfma_f32_16x16x32_bf16 v[72:75], v[120:123], v[28:31], v[44:47]
    v_cvt_pk_bf16_f32 v82, v52, v53
    v_cvt_pk_bf16_f32 v83, v54, v55
    v_exp_f32 v56, v56
    v_mfma_f32_16x16x32_bf16 v[76:79], v[124:127], v[28:31], v[44:47]
    v_exp_f32 v57, v57
    v_exp_f32 v58, v58
    v_mfma_f32_16x16x32_bf16 v[88:91], v[136:139], v[80:83], v[88:91]
    v_exp_f32 v59, v59
    v_exp_f32 v60, v60
    v_mfma_f32_16x16x32_bf16 v[92:95], v[140:143], v[80:83], v[92:95]
    v_exp_f32 v61, v61
    v_exp_f32 v62, v62
    v_mfma_f32_16x16x32_bf16 v[152:155], v[12:15], v[80:83], v[152:155]
    v_exp_f32 v63, v63
    v_cvt_pk_bf16_f32 v84, v56, v57
    v_cvt_pk_bf16_f32 v85, v58, v59
    v_cvt_pk_bf16_f32 v86, v60, v61
    v_cvt_pk_bf16_f32 v87, v62, v63
    s_waitcnt lgkmcnt(0)
    s_nop 0
    v_mfma_f32_16x16x32_bf16 v[96:99], v[136:139], v[84:87], v[96:99]
    v_exp_f32 v64, v64
    v_mfma_f32_16x16x32_bf16 v[100:103], v[140:143], v[84:87], v[100:103]
    ds_read_b128 v[120:123], v3 offset:40960
    ds_read_b128 v[124:127], v3 offset:41984
    v_exp_f32 v65, v65
    v_exp_f32 v66, v66
    v_mfma_f32_16x16x32_bf16 v[156:159], v[12:15], v[84:87], v[156:159]
    v_exp_f32 v67, v67
    v_exp_f32 v68, v68
    v_mfma_f32_16x16x32_bf16 v[48:51], v[128:131], v[16:19], v[32:35]
    v_exp_f32 v69, v69
    v_exp_f32 v70, v70
    v_mfma_f32_16x16x32_bf16 v[52:55], v[132:135], v[16:19], v[32:35]
    v_exp_f32 v71, v71
    v_cvt_pk_bf16_f32 v80, v64, v65
    v_cvt_pk_bf16_f32 v81, v66, v67
    v_mfma_f32_16x16x32_bf16 v[56:59], v[128:131], v[20:23], v[36:39]
    v_cvt_pk_bf16_f32 v82, v68, v69
    v_cvt_pk_bf16_f32 v83, v70, v71
    v_exp_f32 v72, v72
    v_mfma_f32_16x16x32_bf16 v[60:63], v[132:135], v[20:23], v[36:39]
    v_exp_f32 v73, v73
    v_exp_f32 v74, v74
    v_mfma_f32_16x16x32_bf16 v[104:107], v[136:139], v[80:83], v[104:107]
    v_exp_f32 v75, v75
    v_exp_f32 v76, v76
    v_mfma_f32_16x16x32_bf16 v[108:111], v[140:143], v[80:83], v[108:111]
    v_exp_f32 v77, v77
    v_exp_f32 v78, v78
    v_mfma_f32_16x16x32_bf16 v[160:163], v[12:15], v[80:83], v[160:163]
    v_exp_f32 v79, v79
    v_cvt_pk_bf16_f32 v84, v72, v73
    v_cvt_pk_bf16_f32 v85, v74, v75
    v_cvt_pk_bf16_f32 v86, v76, v77
    v_cvt_pk_bf16_f32 v87, v78, v79
    s_waitcnt lgkmcnt(0)
    s_nop 0
    v_mfma_f32_16x16x32_bf16 v[112:115], v[136:139], v[84:87], v[112:115]
    v_exp_f32 v48, v48
    v_mfma_f32_16x16x32_bf16 v[116:119], v[140:143], v[84:87], v[116:119]
    ds_read_b128 v[136:139], v3 offset:43008
    ds_read_b128 v[140:143], v3 offset:44032
    v_exp_f32 v49, v49
    v_exp_f32 v50, v50
    v_mfma_f32_16x16x32_bf16 v[164:167], v[12:15], v[84:87], v[164:167]
    v_exp_f32 v51, v51
    v_exp_f32 v52, v52
    v_mfma_f32_16x16x32_bf16 v[64:67], v[128:131], v[24:27], v[40:43]
    v_exp_f32 v53, v53
    v_exp_f32 v54, v54
    v_mfma_f32_16x16x32_bf16 v[68:71], v[132:135], v[24:27], v[40:43]
    v_exp_f32 v55, v55
    v_cvt_pk_bf16_f32 v80, v48, v49
    v_cvt_pk_bf16_f32 v81, v50, v51
    v_mfma_f32_16x16x32_bf16 v[72:75], v[128:131], v[28:31], v[44:47]
    v_cvt_pk_bf16_f32 v82, v52, v53
    v_cvt_pk_bf16_f32 v83, v54, v55
    v_exp_f32 v56, v56
    v_mfma_f32_16x16x32_bf16 v[76:79], v[132:135], v[28:31], v[44:47]
    v_exp_f32 v57, v57
    v_exp_f32 v58, v58
    v_mfma_f32_16x16x32_bf16 v[88:91], v[144:147], v[80:83], v[88:91]
    v_exp_f32 v59, v59
    v_exp_f32 v60, v60
    v_mfma_f32_16x16x32_bf16 v[92:95], v[148:151], v[80:83], v[92:95]
    v_exp_f32 v61, v61
    v_exp_f32 v62, v62
    v_mfma_f32_16x16x32_bf16 v[152:155], v[12:15], v[80:83], v[152:155]
    v_exp_f32 v63, v63
    v_cvt_pk_bf16_f32 v84, v56, v57
    v_cvt_pk_bf16_f32 v85, v58, v59
    v_cvt_pk_bf16_f32 v86, v60, v61
    v_cvt_pk_bf16_f32 v87, v62, v63
    s_waitcnt lgkmcnt(0)
    s_nop 0
    v_mfma_f32_16x16x32_bf16 v[96:99], v[144:147], v[84:87], v[96:99]
    v_exp_f32 v64, v64
    v_mfma_f32_16x16x32_bf16 v[100:103], v[148:151], v[84:87], v[100:103]
    ds_read_b128 v[128:131], v3 offset:45056
    ds_read_b128 v[132:135], v3 offset:46080
    v_exp_f32 v65, v65
    v_exp_f32 v66, v66
    v_mfma_f32_16x16x32_bf16 v[156:159], v[12:15], v[84:87], v[156:159]
    v_exp_f32 v67, v67
    v_exp_f32 v68, v68
    v_mfma_f32_16x16x32_bf16 v[48:51], v[120:123], v[16:19], v[32:35]
    v_exp_f32 v69, v69
    v_exp_f32 v70, v70
    v_mfma_f32_16x16x32_bf16 v[52:55], v[124:127], v[16:19], v[32:35]
    v_exp_f32 v71, v71
    v_cvt_pk_bf16_f32 v80, v64, v65
    v_cvt_pk_bf16_f32 v81, v66, v67
    v_mfma_f32_16x16x32_bf16 v[56:59], v[120:123], v[20:23], v[36:39]
    v_cvt_pk_bf16_f32 v82, v68, v69
    v_cvt_pk_bf16_f32 v83, v70, v71
    v_exp_f32 v72, v72
    v_mfma_f32_16x16x32_bf16 v[60:63], v[124:127], v[20:23], v[36:39]
    v_exp_f32 v73, v73
    v_exp_f32 v74, v74
    v_mfma_f32_16x16x32_bf16 v[104:107], v[144:147], v[80:83], v[104:107]
    v_exp_f32 v75, v75
    v_exp_f32 v76, v76
    v_mfma_f32_16x16x32_bf16 v[108:111], v[148:151], v[80:83], v[108:111]
    v_exp_f32 v77, v77
    v_exp_f32 v78, v78
    v_mfma_f32_16x16x32_bf16 v[160:163], v[12:15], v[80:83], v[160:163]
    v_exp_f32 v79, v79
    v_cvt_pk_bf16_f32 v84, v72, v73
    v_cvt_pk_bf16_f32 v85, v74, v75
    v_cvt_pk_bf16_f32 v86, v76, v77
    v_cvt_pk_bf16_f32 v87, v78, v79
    s_waitcnt lgkmcnt(0)
    s_nop 0
    v_mfma_f32_16x16x32_bf16 v[112:115], v[144:147], v[84:87], v[112:115]
    v_exp_f32 v48, v48
    v_mfma_f32_16x16x32_bf16 v[116:119], v[148:151], v[84:87], v[116:119]
    ds_read_b128 v[144:147], v3 offset:47104
    ds_read_b128 v[148:151], v3 offset:48128
    v_exp_f32 v49, v49
    v_exp_f32 v50, v50
    v_mfma_f32_16x16x32_bf16 v[164:167], v[12:15], v[84:87], v[164:167]
    v_exp_f32 v51, v51
    v_exp_f32 v52, v52
    v_mfma_f32_16x16x32_bf16 v[64:67], v[120:123], v[24:27], v[40:43]
    v_exp_f32 v53, v53
    v_exp_f32 v54, v54
    v_mfma_f32_16x16x32_bf16 v[68:71], v[124:127], v[24:27], v[40:43]
    v_exp_f32 v55, v55
    v_cvt_pk_bf16_f32 v80, v48, v49
    v_cvt_pk_bf16_f32 v81, v50, v51
    v_mfma_f32_16x16x32_bf16 v[72:75], v[120:123], v[28:31], v[44:47]
    v_cvt_pk_bf16_f32 v82, v52, v53
    v_cvt_pk_bf16_f32 v83, v54, v55
    v_exp_f32 v56, v56
    v_mfma_f32_16x16x32_bf16 v[76:79], v[124:127], v[28:31], v[44:47]
    v_exp_f32 v57, v57
    v_exp_f32 v58, v58
    v_mfma_f32_16x16x32_bf16 v[88:91], v[136:139], v[80:83], v[88:91]
    v_exp_f32 v59, v59
    v_exp_f32 v60, v60
    v_mfma_f32_16x16x32_bf16 v[92:95], v[140:143], v[80:83], v[92:95]
    v_exp_f32 v61, v61
    v_exp_f32 v62, v62
    v_mfma_f32_16x16x32_bf16 v[152:155], v[12:15], v[80:83], v[152:155]
    v_exp_f32 v63, v63
    v_cvt_pk_bf16_f32 v84, v56, v57
    v_cvt_pk_bf16_f32 v85, v58, v59
    v_cvt_pk_bf16_f32 v86, v60, v61
    v_cvt_pk_bf16_f32 v87, v62, v63
    s_waitcnt lgkmcnt(0)
    s_nop 0
    v_mfma_f32_16x16x32_bf16 v[96:99], v[136:139], v[84:87], v[96:99]
    v_exp_f32 v64, v64
    v_mfma_f32_16x16x32_bf16 v[100:103], v[140:143], v[84:87], v[100:103]
    v_exp_f32 v65, v65
    v_exp_f32 v66, v66
    v_mfma_f32_16x16x32_bf16 v[156:159], v[12:15], v[84:87], v[156:159]
    v_exp_f32 v67, v67
    v_exp_f32 v68, v68
    v_mfma_f32_16x16x32_bf16 v[48:51], v[128:131], v[16:19], v[32:35]
    v_exp_f32 v69, v69
    v_exp_f32 v70, v70
    v_mfma_f32_16x16x32_bf16 v[52:55], v[132:135], v[16:19], v[32:35]
    v_exp_f32 v71, v71
    v_cvt_pk_bf16_f32 v80, v64, v65
    v_cvt_pk_bf16_f32 v81, v66, v67
    v_mfma_f32_16x16x32_bf16 v[56:59], v[128:131], v[20:23], v[36:39]
    v_cvt_pk_bf16_f32 v82, v68, v69
    v_cvt_pk_bf16_f32 v83, v70, v71
    v_exp_f32 v72, v72
    v_mfma_f32_16x16x32_bf16 v[60:63], v[132:135], v[20:23], v[36:39]
    v_exp_f32 v73, v73
    v_exp_f32 v74, v74
    v_mfma_f32_16x16x32_bf16 v[104:107], v[136:139], v[80:83], v[104:107]
    v_exp_f32 v75, v75
    v_exp_f32 v76, v76
    v_mfma_f32_16x16x32_bf16 v[108:111], v[140:143], v[80:83], v[108:111]
    v_exp_f32 v77, v77
    v_exp_f32 v78, v78
    v_mfma_f32_16x16x32_bf16 v[160:163], v[12:15], v[80:83], v[160:163]
    v_exp_f32 v79, v79
    v_cvt_pk_bf16_f32 v84, v72, v73
    v_cvt_pk_bf16_f32 v85, v74, v75
    v_cvt_pk_bf16_f32 v86, v76, v77
    v_cvt_pk_bf16_f32 v87, v78, v79
    s_waitcnt lgkmcnt(0)
    s_waitcnt vmcnt(4)
    s_barrier
    v_mfma_f32_16x16x32_bf16 v[112:115], v[136:139], v[84:87], v[112:115]
    v_exp_f32 v48, v48
    v_mfma_f32_16x16x32_bf16 v[116:119], v[140:143], v[84:87], v[116:119]
    ds_read_b128 v[120:123], v3 offset:49152
    ds_read_b128 v[124:127], v3 offset:50176
    v_exp_f32 v49, v49
    v_exp_f32 v50, v50
    v_mfma_f32_16x16x32_bf16 v[164:167], v[12:15], v[84:87], v[164:167]
    ds_read_b128 v[136:139], v3 offset:51200
    ds_read_b128 v[140:143], v3 offset:52224
    v_exp_f32 v51, v51
    v_exp_f32 v52, v52
    v_mfma_f32_16x16x32_bf16 v[64:67], v[128:131], v[24:27], v[40:43]
    v_exp_f32 v53, v53
    v_exp_f32 v54, v54
    v_mfma_f32_16x16x32_bf16 v[68:71], v[132:135], v[24:27], v[40:43]
    v_exp_f32 v55, v55
    v_cvt_pk_bf16_f32 v80, v48, v49
    v_cvt_pk_bf16_f32 v81, v50, v51
    v_mfma_f32_16x16x32_bf16 v[72:75], v[128:131], v[28:31], v[44:47]
    s_add_u32 m0, s36, 16384
    s_add_u32 s35, s44, 147456
    buffer_load_dwordx4 v2, s[8:11], s35 offen offset:0 lds
    buffer_load_dwordx4 v2, s[8:11], s35 offen offset:1024 lds
    buffer_load_dwordx4 v2, s[8:11], s35 offen offset:2048 lds
    buffer_load_dwordx4 v2, s[8:11], s35 offen offset:3072 lds
    s_lshl_b32 s40, s2, 13
    buffer_load_dword v11, v10, s[20:23], s40 offen
    v_cvt_pk_bf16_f32 v82, v52, v53
    v_cvt_pk_bf16_f32 v83, v54, v55
    v_exp_f32 v56, v56
    v_mfma_f32_16x16x32_bf16 v[76:79], v[132:135], v[28:31], v[44:47]
    v_exp_f32 v57, v57
    v_exp_f32 v58, v58
    v_mfma_f32_16x16x32_bf16 v[88:91], v[144:147], v[80:83], v[88:91]
    v_exp_f32 v59, v59
    v_exp_f32 v60, v60
    v_mfma_f32_16x16x32_bf16 v[92:95], v[148:151], v[80:83], v[92:95]
    v_exp_f32 v61, v61
    v_exp_f32 v62, v62
    v_mfma_f32_16x16x32_bf16 v[152:155], v[12:15], v[80:83], v[152:155]
    v_exp_f32 v63, v63
    v_cvt_pk_bf16_f32 v84, v56, v57
    v_cvt_pk_bf16_f32 v85, v58, v59
    v_cvt_pk_bf16_f32 v86, v60, v61
    v_cvt_pk_bf16_f32 v87, v62, v63
    s_waitcnt lgkmcnt(0)
    s_nop 0
    v_mfma_f32_16x16x32_bf16 v[96:99], v[144:147], v[84:87], v[96:99]
    v_exp_f32 v64, v64
    v_mfma_f32_16x16x32_bf16 v[100:103], v[148:151], v[84:87], v[100:103]
    ds_read_b128 v[128:131], v3 offset:53248
    ds_read_b128 v[132:135], v3 offset:54272
    v_exp_f32 v65, v65
    v_exp_f32 v66, v66
    v_mfma_f32_16x16x32_bf16 v[156:159], v[12:15], v[84:87], v[156:159]
    v_exp_f32 v67, v67
    v_exp_f32 v68, v68
    v_mfma_f32_16x16x32_bf16 v[48:51], v[120:123], v[16:19], v[32:35]
    v_exp_f32 v69, v69
    v_exp_f32 v70, v70
    v_mfma_f32_16x16x32_bf16 v[52:55], v[124:127], v[16:19], v[32:35]
    v_exp_f32 v71, v71
    v_cvt_pk_bf16_f32 v80, v64, v65
    v_cvt_pk_bf16_f32 v81, v66, v67
    v_mfma_f32_16x16x32_bf16 v[56:59], v[120:123], v[20:23], v[36:39]
    v_cvt_pk_bf16_f32 v82, v68, v69
    v_cvt_pk_bf16_f32 v83, v70, v71
    v_exp_f32 v72, v72
    v_mfma_f32_16x16x32_bf16 v[60:63], v[124:127], v[20:23], v[36:39]
    v_exp_f32 v73, v73
    v_exp_f32 v74, v74
    v_mfma_f32_16x16x32_bf16 v[104:107], v[144:147], v[80:83], v[104:107]
    v_exp_f32 v75, v75
    v_exp_f32 v76, v76
    v_mfma_f32_16x16x32_bf16 v[108:111], v[148:151], v[80:83], v[108:111]
    v_exp_f32 v77, v77
    v_exp_f32 v78, v78
    v_mfma_f32_16x16x32_bf16 v[160:163], v[12:15], v[80:83], v[160:163]
    v_exp_f32 v79, v79
    v_cvt_pk_bf16_f32 v84, v72, v73
    v_cvt_pk_bf16_f32 v85, v74, v75
    v_cvt_pk_bf16_f32 v86, v76, v77
    v_cvt_pk_bf16_f32 v87, v78, v79
    s_waitcnt lgkmcnt(0)
    s_nop 0
    v_mfma_f32_16x16x32_bf16 v[112:115], v[144:147], v[84:87], v[112:115]
    v_exp_f32 v48, v48
    v_mfma_f32_16x16x32_bf16 v[116:119], v[148:151], v[84:87], v[116:119]
    ds_read_b128 v[144:147], v3 offset:55296
    ds_read_b128 v[148:151], v3 offset:56320
    v_exp_f32 v49, v49
    v_exp_f32 v50, v50
    v_mfma_f32_16x16x32_bf16 v[164:167], v[12:15], v[84:87], v[164:167]
    v_exp_f32 v51, v51
    v_exp_f32 v52, v52
    v_mfma_f32_16x16x32_bf16 v[64:67], v[120:123], v[24:27], v[40:43]
    v_exp_f32 v53, v53
    v_exp_f32 v54, v54
    v_mfma_f32_16x16x32_bf16 v[68:71], v[124:127], v[24:27], v[40:43]
    v_exp_f32 v55, v55
    v_cvt_pk_bf16_f32 v80, v48, v49
    v_cvt_pk_bf16_f32 v81, v50, v51
    v_mfma_f32_16x16x32_bf16 v[72:75], v[120:123], v[28:31], v[44:47]
    v_cvt_pk_bf16_f32 v82, v52, v53
    v_cvt_pk_bf16_f32 v83, v54, v55
    v_exp_f32 v56, v56
    v_mfma_f32_16x16x32_bf16 v[76:79], v[124:127], v[28:31], v[44:47]
    v_exp_f32 v57, v57
    v_exp_f32 v58, v58
    v_mfma_f32_16x16x32_bf16 v[88:91], v[136:139], v[80:83], v[88:91]
    v_exp_f32 v59, v59
    v_exp_f32 v60, v60
    v_mfma_f32_16x16x32_bf16 v[92:95], v[140:143], v[80:83], v[92:95]
    v_exp_f32 v61, v61
    v_exp_f32 v62, v62
    v_mfma_f32_16x16x32_bf16 v[152:155], v[12:15], v[80:83], v[152:155]
    v_exp_f32 v63, v63
    v_cvt_pk_bf16_f32 v84, v56, v57
    v_cvt_pk_bf16_f32 v85, v58, v59
    v_cvt_pk_bf16_f32 v86, v60, v61
    v_cvt_pk_bf16_f32 v87, v62, v63
    s_waitcnt lgkmcnt(0)
    s_nop 0
    v_mfma_f32_16x16x32_bf16 v[96:99], v[136:139], v[84:87], v[96:99]
    v_exp_f32 v64, v64
    v_mfma_f32_16x16x32_bf16 v[100:103], v[140:143], v[84:87], v[100:103]
    ds_read_b128 v[120:123], v3 offset:57344
    ds_read_b128 v[124:127], v3 offset:58368
    v_exp_f32 v65, v65
    v_exp_f32 v66, v66
    v_mfma_f32_16x16x32_bf16 v[156:159], v[12:15], v[84:87], v[156:159]
    v_exp_f32 v67, v67
    v_exp_f32 v68, v68
    v_mfma_f32_16x16x32_bf16 v[48:51], v[128:131], v[16:19], v[32:35]
    v_exp_f32 v69, v69
    v_exp_f32 v70, v70
    v_mfma_f32_16x16x32_bf16 v[52:55], v[132:135], v[16:19], v[32:35]
    v_exp_f32 v71, v71
    v_cvt_pk_bf16_f32 v80, v64, v65
    v_cvt_pk_bf16_f32 v81, v66, v67
    v_mfma_f32_16x16x32_bf16 v[56:59], v[128:131], v[20:23], v[36:39]
    v_cvt_pk_bf16_f32 v82, v68, v69
    v_cvt_pk_bf16_f32 v83, v70, v71
    v_exp_f32 v72, v72
    v_mfma_f32_16x16x32_bf16 v[60:63], v[132:135], v[20:23], v[36:39]
    v_exp_f32 v73, v73
    v_exp_f32 v74, v74
    v_mfma_f32_16x16x32_bf16 v[104:107], v[136:139], v[80:83], v[104:107]
    v_exp_f32 v75, v75
    v_exp_f32 v76, v76
    v_mfma_f32_16x16x32_bf16 v[108:111], v[140:143], v[80:83], v[108:111]
    v_exp_f32 v77, v77
    v_exp_f32 v78, v78
    v_mfma_f32_16x16x32_bf16 v[160:163], v[12:15], v[80:83], v[160:163]
    v_exp_f32 v79, v79
    v_cvt_pk_bf16_f32 v84, v72, v73
    v_cvt_pk_bf16_f32 v85, v74, v75
    v_cvt_pk_bf16_f32 v86, v76, v77
    v_cvt_pk_bf16_f32 v87, v78, v79
    s_waitcnt lgkmcnt(0)
    s_nop 0
    v_mfma_f32_16x16x32_bf16 v[112:115], v[136:139], v[84:87], v[112:115]
    v_exp_f32 v48, v48
    v_mfma_f32_16x16x32_bf16 v[116:119], v[140:143], v[84:87], v[116:119]
    ds_read_b128 v[136:139], v3 offset:59392
    ds_read_b128 v[140:143], v3 offset:60416
    v_exp_f32 v49, v49
    v_exp_f32 v50, v50
    v_mfma_f32_16x16x32_bf16 v[164:167], v[12:15], v[84:87], v[164:167]
    v_exp_f32 v51, v51
    v_exp_f32 v52, v52
    v_mfma_f32_16x16x32_bf16 v[64:67], v[128:131], v[24:27], v[40:43]
    v_exp_f32 v53, v53
    v_exp_f32 v54, v54
    v_mfma_f32_16x16x32_bf16 v[68:71], v[132:135], v[24:27], v[40:43]
    v_exp_f32 v55, v55
    v_cvt_pk_bf16_f32 v80, v48, v49
    v_cvt_pk_bf16_f32 v81, v50, v51
    v_mfma_f32_16x16x32_bf16 v[72:75], v[128:131], v[28:31], v[44:47]
    v_cvt_pk_bf16_f32 v82, v52, v53
    v_cvt_pk_bf16_f32 v83, v54, v55
    v_exp_f32 v56, v56
    v_mfma_f32_16x16x32_bf16 v[76:79], v[132:135], v[28:31], v[44:47]
    v_exp_f32 v57, v57
    v_exp_f32 v58, v58
    v_mfma_f32_16x16x32_bf16 v[88:91], v[144:147], v[80:83], v[88:91]
    v_exp_f32 v59, v59
    v_exp_f32 v60, v60
    v_mfma_f32_16x16x32_bf16 v[92:95], v[148:151], v[80:83], v[92:95]
    v_exp_f32 v61, v61
    v_exp_f32 v62, v62
    v_mfma_f32_16x16x32_bf16 v[152:155], v[12:15], v[80:83], v[152:155]
    v_exp_f32 v63, v63
    v_cvt_pk_bf16_f32 v84, v56, v57
    v_cvt_pk_bf16_f32 v85, v58, v59
    v_cvt_pk_bf16_f32 v86, v60, v61
    v_cvt_pk_bf16_f32 v87, v62, v63
    s_waitcnt lgkmcnt(0)
    s_nop 0
    v_mfma_f32_16x16x32_bf16 v[96:99], v[144:147], v[84:87], v[96:99]
    v_exp_f32 v64, v64
    v_mfma_f32_16x16x32_bf16 v[100:103], v[148:151], v[84:87], v[100:103]
    ds_read_b128 v[128:131], v3 offset:61440
    ds_read_b128 v[132:135], v3 offset:62464
    v_exp_f32 v65, v65
    v_exp_f32 v66, v66
    v_mfma_f32_16x16x32_bf16 v[156:159], v[12:15], v[84:87], v[156:159]
    v_exp_f32 v67, v67
    v_exp_f32 v68, v68
    v_mfma_f32_16x16x32_bf16 v[48:51], v[120:123], v[16:19], v[32:35]
    v_exp_f32 v69, v69
    v_exp_f32 v70, v70
    v_mfma_f32_16x16x32_bf16 v[52:55], v[124:127], v[16:19], v[32:35]
    v_exp_f32 v71, v71
    v_cvt_pk_bf16_f32 v80, v64, v65
    v_cvt_pk_bf16_f32 v81, v66, v67
    v_mfma_f32_16x16x32_bf16 v[56:59], v[120:123], v[20:23], v[36:39]
    v_cvt_pk_bf16_f32 v82, v68, v69
    v_cvt_pk_bf16_f32 v83, v70, v71
    v_exp_f32 v72, v72
    v_mfma_f32_16x16x32_bf16 v[60:63], v[124:127], v[20:23], v[36:39]
    v_exp_f32 v73, v73
    v_exp_f32 v74, v74
    v_mfma_f32_16x16x32_bf16 v[104:107], v[144:147], v[80:83], v[104:107]
    v_exp_f32 v75, v75
    v_exp_f32 v76, v76
    v_mfma_f32_16x16x32_bf16 v[108:111], v[148:151], v[80:83], v[108:111]
    v_exp_f32 v77, v77
    v_exp_f32 v78, v78
    v_mfma_f32_16x16x32_bf16 v[160:163], v[12:15], v[80:83], v[160:163]
    v_exp_f32 v79, v79
    v_cvt_pk_bf16_f32 v84, v72, v73
    v_cvt_pk_bf16_f32 v85, v74, v75
    v_cvt_pk_bf16_f32 v86, v76, v77
    v_cvt_pk_bf16_f32 v87, v78, v79
    s_waitcnt lgkmcnt(0)
    s_nop 0
    v_mfma_f32_16x16x32_bf16 v[112:115], v[144:147], v[84:87], v[112:115]
    v_exp_f32 v48, v48
    v_mfma_f32_16x16x32_bf16 v[116:119], v[148:151], v[84:87], v[116:119]
    ds_read_b128 v[144:147], v3 offset:63488
    ds_read_b128 v[148:151], v3 offset:64512
    v_exp_f32 v49, v49
    v_exp_f32 v50, v50
    v_mfma_f32_16x16x32_bf16 v[164:167], v[12:15], v[84:87], v[164:167]
    v_exp_f32 v51, v51
    v_exp_f32 v52, v52
    v_mfma_f32_16x16x32_bf16 v[64:67], v[120:123], v[24:27], v[40:43]
    v_exp_f32 v53, v53
    v_exp_f32 v54, v54
    v_mfma_f32_16x16x32_bf16 v[68:71], v[124:127], v[24:27], v[40:43]
    v_exp_f32 v55, v55
    v_cvt_pk_bf16_f32 v80, v48, v49
    v_cvt_pk_bf16_f32 v81, v50, v51
    v_mfma_f32_16x16x32_bf16 v[72:75], v[120:123], v[28:31], v[44:47]
    v_cvt_pk_bf16_f32 v82, v52, v53
    v_cvt_pk_bf16_f32 v83, v54, v55
    v_exp_f32 v56, v56
    v_mfma_f32_16x16x32_bf16 v[76:79], v[124:127], v[28:31], v[44:47]
    v_exp_f32 v57, v57
    v_exp_f32 v58, v58
    v_mfma_f32_16x16x32_bf16 v[88:91], v[136:139], v[80:83], v[88:91]
    v_exp_f32 v59, v59
    v_exp_f32 v60, v60
    v_mfma_f32_16x16x32_bf16 v[92:95], v[140:143], v[80:83], v[92:95]
    v_exp_f32 v61, v61
    v_exp_f32 v62, v62
    v_mfma_f32_16x16x32_bf16 v[152:155], v[12:15], v[80:83], v[152:155]
    v_exp_f32 v63, v63
    v_cvt_pk_bf16_f32 v84, v56, v57
    v_cvt_pk_bf16_f32 v85, v58, v59
    v_cvt_pk_bf16_f32 v86, v60, v61
    v_cvt_pk_bf16_f32 v87, v62, v63
    s_waitcnt lgkmcnt(0)
    s_nop 0
    v_mfma_f32_16x16x32_bf16 v[96:99], v[136:139], v[84:87], v[96:99]
    v_exp_f32 v64, v64
    v_mfma_f32_16x16x32_bf16 v[100:103], v[140:143], v[84:87], v[100:103]
    v_exp_f32 v65, v65
    v_exp_f32 v66, v66
    v_mfma_f32_16x16x32_bf16 v[156:159], v[12:15], v[84:87], v[156:159]
    v_exp_f32 v67, v67
    v_exp_f32 v68, v68
    v_mfma_f32_16x16x32_bf16 v[48:51], v[128:131], v[16:19], v[32:35]
    v_exp_f32 v69, v69
    v_exp_f32 v70, v70
    v_mfma_f32_16x16x32_bf16 v[52:55], v[132:135], v[16:19], v[32:35]
    v_exp_f32 v71, v71
    v_cvt_pk_bf16_f32 v80, v64, v65
    v_cvt_pk_bf16_f32 v81, v66, v67
    v_mfma_f32_16x16x32_bf16 v[56:59], v[128:131], v[20:23], v[36:39]
    v_cvt_pk_bf16_f32 v82, v68, v69
    v_cvt_pk_bf16_f32 v83, v70, v71
    v_exp_f32 v72, v72
    v_mfma_f32_16x16x32_bf16 v[60:63], v[132:135], v[20:23], v[36:39]
    v_exp_f32 v73, v73
    v_exp_f32 v74, v74
    v_mfma_f32_16x16x32_bf16 v[104:107], v[136:139], v[80:83], v[104:107]
    v_exp_f32 v75, v75
    v_exp_f32 v76, v76
    v_mfma_f32_16x16x32_bf16 v[108:111], v[140:143], v[80:83], v[108:111]
    v_exp_f32 v77, v77
    v_exp_f32 v78, v78
    v_mfma_f32_16x16x32_bf16 v[160:163], v[12:15], v[80:83], v[160:163]
    v_exp_f32 v79, v79
    v_cvt_pk_bf16_f32 v84, v72, v73
    v_cvt_pk_bf16_f32 v85, v74, v75
    v_cvt_pk_bf16_f32 v86, v76, v77
    v_cvt_pk_bf16_f32 v87, v78, v79
    s_waitcnt lgkmcnt(0)
    s_waitcnt vmcnt(5)
    s_barrier
    v_mfma_f32_16x16x32_bf16 v[112:115], v[136:139], v[84:87], v[112:115]
    v_exp_f32 v48, v48
    v_mfma_f32_16x16x32_bf16 v[116:119], v[140:143], v[84:87], v[116:119]
    ds_read_b128 v[120:123], v3 offset:0
    ds_read_b128 v[124:127], v3 offset:1024
    v_exp_f32 v49, v49
    v_exp_f32 v50, v50
    v_mfma_f32_16x16x32_bf16 v[164:167], v[12:15], v[84:87], v[164:167]
    ds_read_b128 v[136:139], v3 offset:2048
    ds_read_b128 v[140:143], v3 offset:3072
    v_exp_f32 v51, v51
    v_exp_f32 v52, v52
    v_mfma_f32_16x16x32_bf16 v[64:67], v[128:131], v[24:27], v[40:43]
    v_exp_f32 v53, v53
    v_exp_f32 v54, v54
    v_mfma_f32_16x16x32_bf16 v[68:71], v[132:135], v[24:27], v[40:43]
    v_exp_f32 v55, v55
    v_cvt_pk_bf16_f32 v80, v48, v49
    v_cvt_pk_bf16_f32 v81, v50, v51
    v_mfma_f32_16x16x32_bf16 v[72:75], v[128:131], v[28:31], v[44:47]
    s_add_u32 m0, s36, 32768
    s_add_u32 s35, s44, 163840
    buffer_load_dwordx4 v2, s[8:11], s35 offen offset:0 lds
    buffer_load_dwordx4 v2, s[8:11], s35 offen offset:1024 lds
    buffer_load_dwordx4 v2, s[8:11], s35 offen offset:2048 lds
    buffer_load_dwordx4 v2, s[8:11], s35 offen offset:3072 lds
    v_cvt_pk_bf16_f32 v82, v52, v53
    v_cvt_pk_bf16_f32 v83, v54, v55
    v_exp_f32 v56, v56
    v_mfma_f32_16x16x32_bf16 v[76:79], v[132:135], v[28:31], v[44:47]
    v_exp_f32 v57, v57
    v_exp_f32 v58, v58
    v_mfma_f32_16x16x32_bf16 v[88:91], v[144:147], v[80:83], v[88:91]
    v_exp_f32 v59, v59
    v_exp_f32 v60, v60
    v_mfma_f32_16x16x32_bf16 v[92:95], v[148:151], v[80:83], v[92:95]
    v_exp_f32 v61, v61
    v_exp_f32 v62, v62
    v_mfma_f32_16x16x32_bf16 v[152:155], v[12:15], v[80:83], v[152:155]
    v_exp_f32 v63, v63
    v_cvt_pk_bf16_f32 v84, v56, v57
    v_cvt_pk_bf16_f32 v85, v58, v59
    v_cvt_pk_bf16_f32 v86, v60, v61
    v_cvt_pk_bf16_f32 v87, v62, v63
    s_waitcnt lgkmcnt(0)
    s_nop 0
    v_mfma_f32_16x16x32_bf16 v[96:99], v[144:147], v[84:87], v[96:99]
    v_exp_f32 v64, v64
    v_mfma_f32_16x16x32_bf16 v[100:103], v[148:151], v[84:87], v[100:103]
    ds_read_b128 v[128:131], v3 offset:4096
    ds_read_b128 v[132:135], v3 offset:5120
    v_exp_f32 v65, v65
    v_exp_f32 v66, v66
    v_mfma_f32_16x16x32_bf16 v[156:159], v[12:15], v[84:87], v[156:159]
    v_exp_f32 v67, v67
    v_exp_f32 v68, v68
    v_mfma_f32_16x16x32_bf16 v[48:51], v[120:123], v[16:19], v[32:35]
    v_exp_f32 v69, v69
    v_exp_f32 v70, v70
    v_mfma_f32_16x16x32_bf16 v[52:55], v[124:127], v[16:19], v[32:35]
    v_exp_f32 v71, v71
    v_cvt_pk_bf16_f32 v80, v64, v65
    v_cvt_pk_bf16_f32 v81, v66, v67
    v_mfma_f32_16x16x32_bf16 v[56:59], v[120:123], v[20:23], v[36:39]
    v_cvt_pk_bf16_f32 v82, v68, v69
    v_cvt_pk_bf16_f32 v83, v70, v71
    v_exp_f32 v72, v72
    v_mfma_f32_16x16x32_bf16 v[60:63], v[124:127], v[20:23], v[36:39]
    v_exp_f32 v73, v73
    v_exp_f32 v74, v74
    v_mfma_f32_16x16x32_bf16 v[104:107], v[144:147], v[80:83], v[104:107]
    v_exp_f32 v75, v75
    v_exp_f32 v76, v76
    v_mfma_f32_16x16x32_bf16 v[108:111], v[148:151], v[80:83], v[108:111]
    v_exp_f32 v77, v77
    v_exp_f32 v78, v78
    v_mfma_f32_16x16x32_bf16 v[160:163], v[12:15], v[80:83], v[160:163]
    v_exp_f32 v79, v79
    v_cvt_pk_bf16_f32 v84, v72, v73
    v_cvt_pk_bf16_f32 v85, v74, v75
    v_cvt_pk_bf16_f32 v86, v76, v77
    v_cvt_pk_bf16_f32 v87, v78, v79
    s_waitcnt lgkmcnt(0)
    s_nop 0
    v_mfma_f32_16x16x32_bf16 v[112:115], v[144:147], v[84:87], v[112:115]
    v_exp_f32 v48, v48
    v_mfma_f32_16x16x32_bf16 v[116:119], v[148:151], v[84:87], v[116:119]
    ds_read_b128 v[144:147], v3 offset:6144
    ds_read_b128 v[148:151], v3 offset:7168
    v_exp_f32 v49, v49
    v_exp_f32 v50, v50
    v_mfma_f32_16x16x32_bf16 v[164:167], v[12:15], v[84:87], v[164:167]
    v_exp_f32 v51, v51
    v_exp_f32 v52, v52
    v_mfma_f32_16x16x32_bf16 v[64:67], v[120:123], v[24:27], v[40:43]
    v_exp_f32 v53, v53
    v_exp_f32 v54, v54
    v_mfma_f32_16x16x32_bf16 v[68:71], v[124:127], v[24:27], v[40:43]
    v_exp_f32 v55, v55
    v_cvt_pk_bf16_f32 v80, v48, v49
    v_cvt_pk_bf16_f32 v81, v50, v51
    v_mfma_f32_16x16x32_bf16 v[72:75], v[120:123], v[28:31], v[44:47]
    v_cvt_pk_bf16_f32 v82, v52, v53
    v_cvt_pk_bf16_f32 v83, v54, v55
    v_exp_f32 v56, v56
    v_mfma_f32_16x16x32_bf16 v[76:79], v[124:127], v[28:31], v[44:47]
    v_exp_f32 v57, v57
    v_exp_f32 v58, v58
    v_mfma_f32_16x16x32_bf16 v[88:91], v[136:139], v[80:83], v[88:91]
    v_exp_f32 v59, v59
    v_exp_f32 v60, v60
    v_mfma_f32_16x16x32_bf16 v[92:95], v[140:143], v[80:83], v[92:95]
    v_exp_f32 v61, v61
    v_exp_f32 v62, v62
    v_mfma_f32_16x16x32_bf16 v[152:155], v[12:15], v[80:83], v[152:155]
    v_exp_f32 v63, v63
    v_cvt_pk_bf16_f32 v84, v56, v57
    v_cvt_pk_bf16_f32 v85, v58, v59
    v_cvt_pk_bf16_f32 v86, v60, v61
    v_cvt_pk_bf16_f32 v87, v62, v63
    s_waitcnt lgkmcnt(0)
    s_nop 0
    v_mfma_f32_16x16x32_bf16 v[96:99], v[136:139], v[84:87], v[96:99]
    v_exp_f32 v64, v64
    v_mfma_f32_16x16x32_bf16 v[100:103], v[140:143], v[84:87], v[100:103]
    ds_read_b128 v[120:123], v3 offset:8192
    ds_read_b128 v[124:127], v3 offset:9216
    v_exp_f32 v65, v65
    v_exp_f32 v66, v66
    v_mfma_f32_16x16x32_bf16 v[156:159], v[12:15], v[84:87], v[156:159]
    v_exp_f32 v67, v67
    v_exp_f32 v68, v68
    v_mfma_f32_16x16x32_bf16 v[48:51], v[128:131], v[16:19], v[32:35]
    v_exp_f32 v69, v69
    v_exp_f32 v70, v70
    v_mfma_f32_16x16x32_bf16 v[52:55], v[132:135], v[16:19], v[32:35]
    v_exp_f32 v71, v71
    v_cvt_pk_bf16_f32 v80, v64, v65
    v_cvt_pk_bf16_f32 v81, v66, v67
    v_mfma_f32_16x16x32_bf16 v[56:59], v[128:131], v[20:23], v[36:39]
    v_cvt_pk_bf16_f32 v82, v68, v69
    v_cvt_pk_bf16_f32 v83, v70, v71
    v_exp_f32 v72, v72
    v_mfma_f32_16x16x32_bf16 v[60:63], v[132:135], v[20:23], v[36:39]
    v_exp_f32 v73, v73
    v_exp_f32 v74, v74
    v_mfma_f32_16x16x32_bf16 v[104:107], v[136:139], v[80:83], v[104:107]
    v_exp_f32 v75, v75
    v_exp_f32 v76, v76
    v_mfma_f32_16x16x32_bf16 v[108:111], v[140:143], v[80:83], v[108:111]
    v_exp_f32 v77, v77
    v_exp_f32 v78, v78
    v_mfma_f32_16x16x32_bf16 v[160:163], v[12:15], v[80:83], v[160:163]
    v_exp_f32 v79, v79
    v_cvt_pk_bf16_f32 v84, v72, v73
    v_cvt_pk_bf16_f32 v85, v74, v75
    v_cvt_pk_bf16_f32 v86, v76, v77
    v_cvt_pk_bf16_f32 v87, v78, v79
    s_waitcnt lgkmcnt(0)
    s_nop 0
    v_mfma_f32_16x16x32_bf16 v[112:115], v[136:139], v[84:87], v[112:115]
    v_exp_f32 v48, v48
    v_mfma_f32_16x16x32_bf16 v[116:119], v[140:143], v[84:87], v[116:119]
    ds_read_b128 v[136:139], v3 offset:10240
    ds_read_b128 v[140:143], v3 offset:11264
    v_exp_f32 v49, v49
    v_exp_f32 v50, v50
    v_mfma_f32_16x16x32_bf16 v[164:167], v[12:15], v[84:87], v[164:167]
    v_exp_f32 v51, v51
    v_exp_f32 v52, v52
    v_mfma_f32_16x16x32_bf16 v[64:67], v[128:131], v[24:27], v[40:43]
    v_exp_f32 v53, v53
    v_exp_f32 v54, v54
    v_mfma_f32_16x16x32_bf16 v[68:71], v[132:135], v[24:27], v[40:43]
    v_exp_f32 v55, v55
    v_cvt_pk_bf16_f32 v80, v48, v49
    v_cvt_pk_bf16_f32 v81, v50, v51
    v_mfma_f32_16x16x32_bf16 v[72:75], v[128:131], v[28:31], v[44:47]
    v_cvt_pk_bf16_f32 v82, v52, v53
    v_cvt_pk_bf16_f32 v83, v54, v55
    v_exp_f32 v56, v56
    v_mfma_f32_16x16x32_bf16 v[76:79], v[132:135], v[28:31], v[44:47]
    v_exp_f32 v57, v57
    v_exp_f32 v58, v58
    v_mfma_f32_16x16x32_bf16 v[88:91], v[144:147], v[80:83], v[88:91]
    v_exp_f32 v59, v59
    v_exp_f32 v60, v60
    v_mfma_f32_16x16x32_bf16 v[92:95], v[148:151], v[80:83], v[92:95]
    v_exp_f32 v61, v61
    v_exp_f32 v62, v62
    v_mfma_f32_16x16x32_bf16 v[152:155], v[12:15], v[80:83], v[152:155]
    v_exp_f32 v63, v63
    v_cvt_pk_bf16_f32 v84, v56, v57
    v_cvt_pk_bf16_f32 v85, v58, v59
    v_cvt_pk_bf16_f32 v86, v60, v61
    v_cvt_pk_bf16_f32 v87, v62, v63
    s_waitcnt lgkmcnt(0)
    s_nop 0
    v_mfma_f32_16x16x32_bf16 v[96:99], v[144:147], v[84:87], v[96:99]
    v_exp_f32 v64, v64
    v_mfma_f32_16x16x32_bf16 v[100:103], v[148:151], v[84:87], v[100:103]
    ds_read_b128 v[128:131], v3 offset:12288
    ds_read_b128 v[132:135], v3 offset:13312
    v_exp_f32 v65, v65
    v_exp_f32 v66, v66
    v_mfma_f32_16x16x32_bf16 v[156:159], v[12:15], v[84:87], v[156:159]
    v_exp_f32 v67, v67
    v_exp_f32 v68, v68
    v_mfma_f32_16x16x32_bf16 v[48:51], v[120:123], v[16:19], v[32:35]
    v_exp_f32 v69, v69
    v_exp_f32 v70, v70
    v_mfma_f32_16x16x32_bf16 v[52:55], v[124:127], v[16:19], v[32:35]
    v_exp_f32 v71, v71
    v_cvt_pk_bf16_f32 v80, v64, v65
    v_cvt_pk_bf16_f32 v81, v66, v67
    v_mfma_f32_16x16x32_bf16 v[56:59], v[120:123], v[20:23], v[36:39]
    v_cvt_pk_bf16_f32 v82, v68, v69
    v_cvt_pk_bf16_f32 v83, v70, v71
    v_exp_f32 v72, v72
    v_mfma_f32_16x16x32_bf16 v[60:63], v[124:127], v[20:23], v[36:39]
    v_exp_f32 v73, v73
    v_exp_f32 v74, v74
    v_mfma_f32_16x16x32_bf16 v[104:107], v[144:147], v[80:83], v[104:107]
    v_exp_f32 v75, v75
    v_exp_f32 v76, v76
    v_mfma_f32_16x16x32_bf16 v[108:111], v[148:151], v[80:83], v[108:111]
    v_exp_f32 v77, v77
    v_exp_f32 v78, v78
    v_mfma_f32_16x16x32_bf16 v[160:163], v[12:15], v[80:83], v[160:163]
    v_exp_f32 v79, v79
    v_cvt_pk_bf16_f32 v84, v72, v73
    v_cvt_pk_bf16_f32 v85, v74, v75
    v_cvt_pk_bf16_f32 v86, v76, v77
    v_cvt_pk_bf16_f32 v87, v78, v79
    s_waitcnt lgkmcnt(0)
    s_nop 0
    v_mfma_f32_16x16x32_bf16 v[112:115], v[144:147], v[84:87], v[112:115]
    v_exp_f32 v48, v48
    v_mfma_f32_16x16x32_bf16 v[116:119], v[148:151], v[84:87], v[116:119]
    ds_read_b128 v[144:147], v3 offset:14336
    ds_read_b128 v[148:151], v3 offset:15360
    v_exp_f32 v49, v49
    v_exp_f32 v50, v50
    v_mfma_f32_16x16x32_bf16 v[164:167], v[12:15], v[84:87], v[164:167]
    v_exp_f32 v51, v51
    v_exp_f32 v52, v52
    v_mfma_f32_16x16x32_bf16 v[64:67], v[120:123], v[24:27], v[40:43]
    v_exp_f32 v53, v53
    v_exp_f32 v54, v54
    v_mfma_f32_16x16x32_bf16 v[68:71], v[124:127], v[24:27], v[40:43]
    v_exp_f32 v55, v55
    v_cvt_pk_bf16_f32 v80, v48, v49
    v_cvt_pk_bf16_f32 v81, v50, v51
    v_mfma_f32_16x16x32_bf16 v[72:75], v[120:123], v[28:31], v[44:47]
    v_cvt_pk_bf16_f32 v82, v52, v53
    v_cvt_pk_bf16_f32 v83, v54, v55
    v_exp_f32 v56, v56
    v_mfma_f32_16x16x32_bf16 v[76:79], v[124:127], v[28:31], v[44:47]
    v_exp_f32 v57, v57
    v_exp_f32 v58, v58
    v_mfma_f32_16x16x32_bf16 v[88:91], v[136:139], v[80:83], v[88:91]
    v_exp_f32 v59, v59
    v_exp_f32 v60, v60
    v_mfma_f32_16x16x32_bf16 v[92:95], v[140:143], v[80:83], v[92:95]
    v_exp_f32 v61, v61
    v_exp_f32 v62, v62
    v_mfma_f32_16x16x32_bf16 v[152:155], v[12:15], v[80:83], v[152:155]
    v_exp_f32 v63, v63
    v_cvt_pk_bf16_f32 v84, v56, v57
    v_cvt_pk_bf16_f32 v85, v58, v59
    v_cvt_pk_bf16_f32 v86, v60, v61
    v_cvt_pk_bf16_f32 v87, v62, v63
    s_waitcnt lgkmcnt(0)
    s_nop 0
    v_mfma_f32_16x16x32_bf16 v[96:99], v[136:139], v[84:87], v[96:99]
    v_exp_f32 v64, v64
    v_mfma_f32_16x16x32_bf16 v[100:103], v[140:143], v[84:87], v[100:103]
    v_exp_f32 v65, v65
    v_exp_f32 v66, v66
    v_mfma_f32_16x16x32_bf16 v[156:159], v[12:15], v[84:87], v[156:159]
    v_exp_f32 v67, v67
    v_exp_f32 v68, v68
    v_mfma_f32_16x16x32_bf16 v[48:51], v[128:131], v[16:19], v[32:35]
    v_exp_f32 v69, v69
    v_exp_f32 v70, v70
    v_mfma_f32_16x16x32_bf16 v[52:55], v[132:135], v[16:19], v[32:35]
    v_exp_f32 v71, v71
    v_cvt_pk_bf16_f32 v80, v64, v65
    v_cvt_pk_bf16_f32 v81, v66, v67
    v_mfma_f32_16x16x32_bf16 v[56:59], v[128:131], v[20:23], v[36:39]
    v_cvt_pk_bf16_f32 v82, v68, v69
    v_cvt_pk_bf16_f32 v83, v70, v71
    v_exp_f32 v72, v72
    v_mfma_f32_16x16x32_bf16 v[60:63], v[132:135], v[20:23], v[36:39]
    v_exp_f32 v73, v73
    v_exp_f32 v74, v74
    v_mfma_f32_16x16x32_bf16 v[104:107], v[136:139], v[80:83], v[104:107]
    v_exp_f32 v75, v75
    v_exp_f32 v76, v76
    v_mfma_f32_16x16x32_bf16 v[108:111], v[140:143], v[80:83], v[108:111]
    v_exp_f32 v77, v77
    v_exp_f32 v78, v78
    v_mfma_f32_16x16x32_bf16 v[160:163], v[12:15], v[80:83], v[160:163]
    v_exp_f32 v79, v79
    v_cvt_pk_bf16_f32 v84, v72, v73
    v_cvt_pk_bf16_f32 v85, v74, v75
    v_cvt_pk_bf16_f32 v86, v76, v77
    v_cvt_pk_bf16_f32 v87, v78, v79
    s_waitcnt lgkmcnt(0)
    s_waitcnt vmcnt(5)
    s_barrier
    v_mfma_f32_16x16x32_bf16 v[112:115], v[136:139], v[84:87], v[112:115]
    v_exp_f32 v48, v48
    v_mfma_f32_16x16x32_bf16 v[116:119], v[140:143], v[84:87], v[116:119]
    ds_read_b128 v[120:123], v3 offset:16384
    ds_read_b128 v[124:127], v3 offset:17408
    v_exp_f32 v49, v49
    v_exp_f32 v50, v50
    v_mfma_f32_16x16x32_bf16 v[164:167], v[12:15], v[84:87], v[164:167]
    ds_read_b128 v[136:139], v3 offset:18432
    ds_read_b128 v[140:143], v3 offset:19456
    v_exp_f32 v51, v51
    v_exp_f32 v52, v52
    v_mfma_f32_16x16x32_bf16 v[64:67], v[128:131], v[24:27], v[40:43]
    v_exp_f32 v53, v53
    v_exp_f32 v54, v54
    v_mfma_f32_16x16x32_bf16 v[68:71], v[132:135], v[24:27], v[40:43]
    v_exp_f32 v55, v55
    v_cvt_pk_bf16_f32 v80, v48, v49
    v_cvt_pk_bf16_f32 v81, v50, v51
    v_mfma_f32_16x16x32_bf16 v[72:75], v[128:131], v[28:31], v[44:47]
    s_add_u32 m0, s36, 49152
    s_add_u32 s35, s44, 180224
    buffer_load_dwordx4 v2, s[8:11], s35 offen offset:0 lds
    buffer_load_dwordx4 v2, s[8:11], s35 offen offset:1024 lds
    buffer_load_dwordx4 v2, s[8:11], s35 offen offset:2048 lds
    buffer_load_dwordx4 v2, s[8:11], s35 offen offset:3072 lds
    v_cvt_pk_bf16_f32 v82, v52, v53
    v_cvt_pk_bf16_f32 v83, v54, v55
    v_exp_f32 v56, v56
    v_mfma_f32_16x16x32_bf16 v[76:79], v[132:135], v[28:31], v[44:47]
    v_exp_f32 v57, v57
    v_exp_f32 v58, v58
    v_mfma_f32_16x16x32_bf16 v[88:91], v[144:147], v[80:83], v[88:91]
    v_exp_f32 v59, v59
    v_exp_f32 v60, v60
    v_mfma_f32_16x16x32_bf16 v[92:95], v[148:151], v[80:83], v[92:95]
    v_exp_f32 v61, v61
    v_exp_f32 v62, v62
    v_mfma_f32_16x16x32_bf16 v[152:155], v[12:15], v[80:83], v[152:155]
    v_exp_f32 v63, v63
    v_cvt_pk_bf16_f32 v84, v56, v57
    v_cvt_pk_bf16_f32 v85, v58, v59
    v_cvt_pk_bf16_f32 v86, v60, v61
    v_cvt_pk_bf16_f32 v87, v62, v63
    s_waitcnt lgkmcnt(0)
    s_nop 0
    v_mfma_f32_16x16x32_bf16 v[96:99], v[144:147], v[84:87], v[96:99]
    v_exp_f32 v64, v64
    v_mfma_f32_16x16x32_bf16 v[100:103], v[148:151], v[84:87], v[100:103]
    ds_read_b128 v[128:131], v3 offset:20480
    ds_read_b128 v[132:135], v3 offset:21504
    v_exp_f32 v65, v65
    v_exp_f32 v66, v66
    v_mfma_f32_16x16x32_bf16 v[156:159], v[12:15], v[84:87], v[156:159]
    v_exp_f32 v67, v67
    v_exp_f32 v68, v68
    v_mfma_f32_16x16x32_bf16 v[48:51], v[120:123], v[16:19], v[32:35]
    v_exp_f32 v69, v69
    v_exp_f32 v70, v70
    v_mfma_f32_16x16x32_bf16 v[52:55], v[124:127], v[16:19], v[32:35]
    v_exp_f32 v71, v71
    v_cvt_pk_bf16_f32 v80, v64, v65
    v_cvt_pk_bf16_f32 v81, v66, v67
    v_mfma_f32_16x16x32_bf16 v[56:59], v[120:123], v[20:23], v[36:39]
    v_cvt_pk_bf16_f32 v82, v68, v69
    v_cvt_pk_bf16_f32 v83, v70, v71
    v_exp_f32 v72, v72
    v_mfma_f32_16x16x32_bf16 v[60:63], v[124:127], v[20:23], v[36:39]
    v_exp_f32 v73, v73
    v_exp_f32 v74, v74
    v_mfma_f32_16x16x32_bf16 v[104:107], v[144:147], v[80:83], v[104:107]
    v_exp_f32 v75, v75
    v_exp_f32 v76, v76
    v_mfma_f32_16x16x32_bf16 v[108:111], v[148:151], v[80:83], v[108:111]
    v_exp_f32 v77, v77
    v_exp_f32 v78, v78
    v_mfma_f32_16x16x32_bf16 v[160:163], v[12:15], v[80:83], v[160:163]
    v_exp_f32 v79, v79
    v_cvt_pk_bf16_f32 v84, v72, v73
    v_cvt_pk_bf16_f32 v85, v74, v75
    v_cvt_pk_bf16_f32 v86, v76, v77
    v_cvt_pk_bf16_f32 v87, v78, v79
    s_waitcnt lgkmcnt(0)
    s_nop 0
    v_mfma_f32_16x16x32_bf16 v[112:115], v[144:147], v[84:87], v[112:115]
    v_exp_f32 v48, v48
    v_mfma_f32_16x16x32_bf16 v[116:119], v[148:151], v[84:87], v[116:119]
    ds_read_b128 v[144:147], v3 offset:22528
    ds_read_b128 v[148:151], v3 offset:23552
    v_exp_f32 v49, v49
    v_exp_f32 v50, v50
    v_mfma_f32_16x16x32_bf16 v[164:167], v[12:15], v[84:87], v[164:167]
    v_exp_f32 v51, v51
    v_exp_f32 v52, v52
    v_mfma_f32_16x16x32_bf16 v[64:67], v[120:123], v[24:27], v[40:43]
    v_exp_f32 v53, v53
    v_exp_f32 v54, v54
    v_mfma_f32_16x16x32_bf16 v[68:71], v[124:127], v[24:27], v[40:43]
    v_exp_f32 v55, v55
    v_cvt_pk_bf16_f32 v80, v48, v49
    v_cvt_pk_bf16_f32 v81, v50, v51
    v_mfma_f32_16x16x32_bf16 v[72:75], v[120:123], v[28:31], v[44:47]
    v_cvt_pk_bf16_f32 v82, v52, v53
    v_cvt_pk_bf16_f32 v83, v54, v55
    v_exp_f32 v56, v56
    v_mfma_f32_16x16x32_bf16 v[76:79], v[124:127], v[28:31], v[44:47]
    v_exp_f32 v57, v57
    v_exp_f32 v58, v58
    v_mfma_f32_16x16x32_bf16 v[88:91], v[136:139], v[80:83], v[88:91]
    v_exp_f32 v59, v59
    v_exp_f32 v60, v60
    v_mfma_f32_16x16x32_bf16 v[92:95], v[140:143], v[80:83], v[92:95]
    v_exp_f32 v61, v61
    v_exp_f32 v62, v62
    v_mfma_f32_16x16x32_bf16 v[152:155], v[12:15], v[80:83], v[152:155]
    v_exp_f32 v63, v63
    v_cvt_pk_bf16_f32 v84, v56, v57
    v_cvt_pk_bf16_f32 v85, v58, v59
    v_cvt_pk_bf16_f32 v86, v60, v61
    v_cvt_pk_bf16_f32 v87, v62, v63
    s_waitcnt lgkmcnt(0)
    s_nop 0
    v_mfma_f32_16x16x32_bf16 v[96:99], v[136:139], v[84:87], v[96:99]
    v_exp_f32 v64, v64
    v_mfma_f32_16x16x32_bf16 v[100:103], v[140:143], v[84:87], v[100:103]
    ds_read_b128 v[120:123], v3 offset:24576
    ds_read_b128 v[124:127], v3 offset:25600
    v_exp_f32 v65, v65
    v_exp_f32 v66, v66
    v_mfma_f32_16x16x32_bf16 v[156:159], v[12:15], v[84:87], v[156:159]
    v_exp_f32 v67, v67
    v_exp_f32 v68, v68
    v_mfma_f32_16x16x32_bf16 v[48:51], v[128:131], v[16:19], v[32:35]
    v_exp_f32 v69, v69
    v_exp_f32 v70, v70
    v_mfma_f32_16x16x32_bf16 v[52:55], v[132:135], v[16:19], v[32:35]
    v_exp_f32 v71, v71
    v_cvt_pk_bf16_f32 v80, v64, v65
    v_cvt_pk_bf16_f32 v81, v66, v67
    v_mfma_f32_16x16x32_bf16 v[56:59], v[128:131], v[20:23], v[36:39]
    v_cvt_pk_bf16_f32 v82, v68, v69
    v_cvt_pk_bf16_f32 v83, v70, v71
    v_exp_f32 v72, v72
    v_mfma_f32_16x16x32_bf16 v[60:63], v[132:135], v[20:23], v[36:39]
    v_exp_f32 v73, v73
    v_exp_f32 v74, v74
    v_mfma_f32_16x16x32_bf16 v[104:107], v[136:139], v[80:83], v[104:107]
    v_exp_f32 v75, v75
    v_exp_f32 v76, v76
    v_mfma_f32_16x16x32_bf16 v[108:111], v[140:143], v[80:83], v[108:111]
    v_exp_f32 v77, v77
    v_exp_f32 v78, v78
    v_mfma_f32_16x16x32_bf16 v[160:163], v[12:15], v[80:83], v[160:163]
    v_exp_f32 v79, v79
    v_cvt_pk_bf16_f32 v84, v72, v73
    v_cvt_pk_bf16_f32 v85, v74, v75
    v_cvt_pk_bf16_f32 v86, v76, v77
    v_cvt_pk_bf16_f32 v87, v78, v79
    s_waitcnt lgkmcnt(0)
    s_nop 0
    v_mfma_f32_16x16x32_bf16 v[112:115], v[136:139], v[84:87], v[112:115]
    v_exp_f32 v48, v48
    v_mfma_f32_16x16x32_bf16 v[116:119], v[140:143], v[84:87], v[116:119]
    ds_read_b128 v[136:139], v3 offset:26624
    ds_read_b128 v[140:143], v3 offset:27648
    v_exp_f32 v49, v49
    v_exp_f32 v50, v50
    v_mfma_f32_16x16x32_bf16 v[164:167], v[12:15], v[84:87], v[164:167]
    v_exp_f32 v51, v51
    v_exp_f32 v52, v52
    v_mfma_f32_16x16x32_bf16 v[64:67], v[128:131], v[24:27], v[40:43]
    v_exp_f32 v53, v53
    v_exp_f32 v54, v54
    v_mfma_f32_16x16x32_bf16 v[68:71], v[132:135], v[24:27], v[40:43]
    v_exp_f32 v55, v55
    v_cvt_pk_bf16_f32 v80, v48, v49
    v_cvt_pk_bf16_f32 v81, v50, v51
    v_mfma_f32_16x16x32_bf16 v[72:75], v[128:131], v[28:31], v[44:47]
    v_cvt_pk_bf16_f32 v82, v52, v53
    v_cvt_pk_bf16_f32 v83, v54, v55
    v_exp_f32 v56, v56
    v_mfma_f32_16x16x32_bf16 v[76:79], v[132:135], v[28:31], v[44:47]
    v_exp_f32 v57, v57
    v_exp_f32 v58, v58
    v_mfma_f32_16x16x32_bf16 v[88:91], v[144:147], v[80:83], v[88:91]
    v_exp_f32 v59, v59
    v_exp_f32 v60, v60
    v_mfma_f32_16x16x32_bf16 v[92:95], v[148:151], v[80:83], v[92:95]
    v_exp_f32 v61, v61
    v_exp_f32 v62, v62
    v_mfma_f32_16x16x32_bf16 v[152:155], v[12:15], v[80:83], v[152:155]
    v_exp_f32 v63, v63
    v_cvt_pk_bf16_f32 v84, v56, v57
    v_cvt_pk_bf16_f32 v85, v58, v59
    v_cvt_pk_bf16_f32 v86, v60, v61
    v_cvt_pk_bf16_f32 v87, v62, v63
    s_waitcnt lgkmcnt(0)
    s_nop 0
    v_mfma_f32_16x16x32_bf16 v[96:99], v[144:147], v[84:87], v[96:99]
    v_exp_f32 v64, v64
    v_mfma_f32_16x16x32_bf16 v[100:103], v[148:151], v[84:87], v[100:103]
    ds_read_b128 v[128:131], v3 offset:28672
    ds_read_b128 v[132:135], v3 offset:29696
    v_exp_f32 v65, v65
    v_exp_f32 v66, v66
    v_mfma_f32_16x16x32_bf16 v[156:159], v[12:15], v[84:87], v[156:159]
    v_exp_f32 v67, v67
    v_exp_f32 v68, v68
    v_mfma_f32_16x16x32_bf16 v[48:51], v[120:123], v[16:19], v[32:35]
    v_exp_f32 v69, v69
    v_exp_f32 v70, v70
    v_mfma_f32_16x16x32_bf16 v[52:55], v[124:127], v[16:19], v[32:35]
    v_exp_f32 v71, v71
    v_cvt_pk_bf16_f32 v80, v64, v65
    v_cvt_pk_bf16_f32 v81, v66, v67
    v_mfma_f32_16x16x32_bf16 v[56:59], v[120:123], v[20:23], v[36:39]
    v_cvt_pk_bf16_f32 v82, v68, v69
    v_cvt_pk_bf16_f32 v83, v70, v71
    v_exp_f32 v72, v72
    v_mfma_f32_16x16x32_bf16 v[60:63], v[124:127], v[20:23], v[36:39]
    v_exp_f32 v73, v73
    v_exp_f32 v74, v74
    v_mfma_f32_16x16x32_bf16 v[104:107], v[144:147], v[80:83], v[104:107]
    v_exp_f32 v75, v75
    v_exp_f32 v76, v76
    v_mfma_f32_16x16x32_bf16 v[108:111], v[148:151], v[80:83], v[108:111]
    v_exp_f32 v77, v77
    v_exp_f32 v78, v78
    v_mfma_f32_16x16x32_bf16 v[160:163], v[12:15], v[80:83], v[160:163]
    v_exp_f32 v79, v79
    v_cvt_pk_bf16_f32 v84, v72, v73
    v_cvt_pk_bf16_f32 v85, v74, v75
    v_cvt_pk_bf16_f32 v86, v76, v77
    v_cvt_pk_bf16_f32 v87, v78, v79
    s_waitcnt lgkmcnt(0)
    s_nop 0
    v_mfma_f32_16x16x32_bf16 v[112:115], v[144:147], v[84:87], v[112:115]
    v_exp_f32 v48, v48
    v_mfma_f32_16x16x32_bf16 v[116:119], v[148:151], v[84:87], v[116:119]
    ds_read_b128 v[144:147], v3 offset:30720
    ds_read_b128 v[148:151], v3 offset:31744
    v_exp_f32 v49, v49
    v_exp_f32 v50, v50
    v_mfma_f32_16x16x32_bf16 v[164:167], v[12:15], v[84:87], v[164:167]
    v_exp_f32 v51, v51
    v_exp_f32 v52, v52
    v_mfma_f32_16x16x32_bf16 v[64:67], v[120:123], v[24:27], v[40:43]
    v_exp_f32 v53, v53
    v_exp_f32 v54, v54
    v_mfma_f32_16x16x32_bf16 v[68:71], v[124:127], v[24:27], v[40:43]
    v_exp_f32 v55, v55
    v_cvt_pk_bf16_f32 v80, v48, v49
    v_cvt_pk_bf16_f32 v81, v50, v51
    v_mfma_f32_16x16x32_bf16 v[72:75], v[120:123], v[28:31], v[44:47]
    v_cvt_pk_bf16_f32 v82, v52, v53
    v_cvt_pk_bf16_f32 v83, v54, v55
    v_exp_f32 v56, v56
    v_mfma_f32_16x16x32_bf16 v[76:79], v[124:127], v[28:31], v[44:47]
    v_exp_f32 v57, v57
    v_exp_f32 v58, v58
    v_mfma_f32_16x16x32_bf16 v[88:91], v[136:139], v[80:83], v[88:91]
    v_exp_f32 v59, v59
    v_exp_f32 v60, v60
    v_mfma_f32_16x16x32_bf16 v[92:95], v[140:143], v[80:83], v[92:95]
    v_exp_f32 v61, v61
    v_exp_f32 v62, v62
    v_mfma_f32_16x16x32_bf16 v[152:155], v[12:15], v[80:83], v[152:155]
    v_exp_f32 v63, v63
    v_cvt_pk_bf16_f32 v84, v56, v57
    v_cvt_pk_bf16_f32 v85, v58, v59
    v_cvt_pk_bf16_f32 v86, v60, v61
    v_cvt_pk_bf16_f32 v87, v62, v63
    s_waitcnt lgkmcnt(0)
    s_nop 0
    v_mfma_f32_16x16x32_bf16 v[96:99], v[136:139], v[84:87], v[96:99]
    v_exp_f32 v64, v64
    v_mfma_f32_16x16x32_bf16 v[100:103], v[140:143], v[84:87], v[100:103]
    v_exp_f32 v65, v65
    v_exp_f32 v66, v66
    v_mfma_f32_16x16x32_bf16 v[156:159], v[12:15], v[84:87], v[156:159]
    v_exp_f32 v67, v67
    v_exp_f32 v68, v68
    v_mfma_f32_16x16x32_bf16 v[48:51], v[128:131], v[16:19], v[32:35]
    v_exp_f32 v69, v69
    v_exp_f32 v70, v70
    v_mfma_f32_16x16x32_bf16 v[52:55], v[132:135], v[16:19], v[32:35]
    v_exp_f32 v71, v71
    v_cvt_pk_bf16_f32 v80, v64, v65
    v_cvt_pk_bf16_f32 v81, v66, v67
    v_mfma_f32_16x16x32_bf16 v[56:59], v[128:131], v[20:23], v[36:39]
    v_cvt_pk_bf16_f32 v82, v68, v69
    v_cvt_pk_bf16_f32 v83, v70, v71
    v_exp_f32 v72, v72
    v_mfma_f32_16x16x32_bf16 v[60:63], v[132:135], v[20:23], v[36:39]
    v_exp_f32 v73, v73
    v_exp_f32 v74, v74
    v_mfma_f32_16x16x32_bf16 v[104:107], v[136:139], v[80:83], v[104:107]
    v_exp_f32 v75, v75
    v_exp_f32 v76, v76
    v_mfma_f32_16x16x32_bf16 v[108:111], v[140:143], v[80:83], v[108:111]
    v_exp_f32 v77, v77
    v_exp_f32 v78, v78
    v_mfma_f32_16x16x32_bf16 v[160:163], v[12:15], v[80:83], v[160:163]
    v_exp_f32 v79, v79
    v_cvt_pk_bf16_f32 v84, v72, v73
    v_cvt_pk_bf16_f32 v85, v74, v75
    v_cvt_pk_bf16_f32 v86, v76, v77
    v_cvt_pk_bf16_f32 v87, v78, v79
    s_waitcnt lgkmcnt(0)
    s_waitcnt vmcnt(4)
    s_barrier
    v_mfma_f32_16x16x32_bf16 v[112:115], v[136:139], v[84:87], v[112:115]
    v_exp_f32 v48, v48
    v_mfma_f32_16x16x32_bf16 v[116:119], v[140:143], v[84:87], v[116:119]
    ds_read_b128 v[120:123], v3 offset:32768
    ds_read_b128 v[124:127], v3 offset:33792
    v_exp_f32 v49, v49
    v_exp_f32 v50, v50
    v_mfma_f32_16x16x32_bf16 v[164:167], v[12:15], v[84:87], v[164:167]
    ds_read_b128 v[136:139], v3 offset:34816
    ds_read_b128 v[140:143], v3 offset:35840
    v_exp_f32 v51, v51
    v_exp_f32 v52, v52
    v_mfma_f32_16x16x32_bf16 v[64:67], v[128:131], v[24:27], v[40:43]
    v_exp_f32 v53, v53
    v_exp_f32 v54, v54
    v_mfma_f32_16x16x32_bf16 v[68:71], v[132:135], v[24:27], v[40:43]
    v_exp_f32 v55, v55
    v_cvt_pk_bf16_f32 v80, v48, v49
    v_cvt_pk_bf16_f32 v81, v50, v51
    v_mfma_f32_16x16x32_bf16 v[72:75], v[128:131], v[28:31], v[44:47]
    s_add_u32 m0, s36, 0
    s_add_u32 s35, s44, 196608
    buffer_load_dwordx4 v2, s[8:11], s35 offen offset:0 lds
    buffer_load_dwordx4 v2, s[8:11], s35 offen offset:1024 lds
    buffer_load_dwordx4 v2, s[8:11], s35 offen offset:2048 lds
    buffer_load_dwordx4 v2, s[8:11], s35 offen offset:3072 lds
    v_cvt_pk_bf16_f32 v82, v52, v53
    v_cvt_pk_bf16_f32 v83, v54, v55
    v_exp_f32 v56, v56
    v_mfma_f32_16x16x32_bf16 v[76:79], v[132:135], v[28:31], v[44:47]
    v_exp_f32 v57, v57
    v_exp_f32 v58, v58
    v_mfma_f32_16x16x32_bf16 v[88:91], v[144:147], v[80:83], v[88:91]
    v_exp_f32 v59, v59
    v_exp_f32 v60, v60
    v_mfma_f32_16x16x32_bf16 v[92:95], v[148:151], v[80:83], v[92:95]
    v_exp_f32 v61, v61
    v_exp_f32 v62, v62
    v_mfma_f32_16x16x32_bf16 v[152:155], v[12:15], v[80:83], v[152:155]
    v_exp_f32 v63, v63
    v_cvt_pk_bf16_f32 v84, v56, v57
    v_cvt_pk_bf16_f32 v85, v58, v59
    v_cvt_pk_bf16_f32 v86, v60, v61
    v_cvt_pk_bf16_f32 v87, v62, v63
    s_waitcnt lgkmcnt(0)
    s_nop 0
    v_mfma_f32_16x16x32_bf16 v[96:99], v[144:147], v[84:87], v[96:99]
    v_exp_f32 v64, v64
    v_mfma_f32_16x16x32_bf16 v[100:103], v[148:151], v[84:87], v[100:103]
    ds_read_b128 v[128:131], v3 offset:36864
    ds_read_b128 v[132:135], v3 offset:37888
    v_exp_f32 v65, v65
    v_exp_f32 v66, v66
    v_mfma_f32_16x16x32_bf16 v[156:159], v[12:15], v[84:87], v[156:159]
    v_exp_f32 v67, v67
    v_exp_f32 v68, v68
    v_mfma_f32_16x16x32_bf16 v[48:51], v[120:123], v[16:19], v[32:35]
    v_exp_f32 v69, v69
    v_exp_f32 v70, v70
    v_mfma_f32_16x16x32_bf16 v[52:55], v[124:127], v[16:19], v[32:35]
    v_exp_f32 v71, v71
    v_cvt_pk_bf16_f32 v80, v64, v65
    v_cvt_pk_bf16_f32 v81, v66, v67
    v_mfma_f32_16x16x32_bf16 v[56:59], v[120:123], v[20:23], v[36:39]
    v_cvt_pk_bf16_f32 v82, v68, v69
    v_cvt_pk_bf16_f32 v83, v70, v71
    v_exp_f32 v72, v72
    v_mfma_f32_16x16x32_bf16 v[60:63], v[124:127], v[20:23], v[36:39]
    v_exp_f32 v73, v73
    v_exp_f32 v74, v74
    v_mfma_f32_16x16x32_bf16 v[104:107], v[144:147], v[80:83], v[104:107]
    v_exp_f32 v75, v75
    v_exp_f32 v76, v76
    v_mfma_f32_16x16x32_bf16 v[108:111], v[148:151], v[80:83], v[108:111]
    v_exp_f32 v77, v77
    v_exp_f32 v78, v78
    v_mfma_f32_16x16x32_bf16 v[160:163], v[12:15], v[80:83], v[160:163]
    v_exp_f32 v79, v79
    v_cvt_pk_bf16_f32 v84, v72, v73
    v_cvt_pk_bf16_f32 v85, v74, v75
    v_cvt_pk_bf16_f32 v86, v76, v77
    v_cvt_pk_bf16_f32 v87, v78, v79
    s_waitcnt lgkmcnt(0)
    s_nop 0
    v_mfma_f32_16x16x32_bf16 v[112:115], v[144:147], v[84:87], v[112:115]
    v_exp_f32 v48, v48
    v_mfma_f32_16x16x32_bf16 v[116:119], v[148:151], v[84:87], v[116:119]
    ds_read_b128 v[144:147], v3 offset:38912
    ds_read_b128 v[148:151], v3 offset:39936
    v_exp_f32 v49, v49
    v_exp_f32 v50, v50
    v_mfma_f32_16x16x32_bf16 v[164:167], v[12:15], v[84:87], v[164:167]
    v_exp_f32 v51, v51
    v_exp_f32 v52, v52
    v_mfma_f32_16x16x32_bf16 v[64:67], v[120:123], v[24:27], v[40:43]
    v_exp_f32 v53, v53
    v_exp_f32 v54, v54
    v_mfma_f32_16x16x32_bf16 v[68:71], v[124:127], v[24:27], v[40:43]
    v_exp_f32 v55, v55
    v_cvt_pk_bf16_f32 v80, v48, v49
    v_cvt_pk_bf16_f32 v81, v50, v51
    v_mfma_f32_16x16x32_bf16 v[72:75], v[120:123], v[28:31], v[44:47]
    v_cvt_pk_bf16_f32 v82, v52, v53
    v_cvt_pk_bf16_f32 v83, v54, v55
    v_exp_f32 v56, v56
    v_mfma_f32_16x16x32_bf16 v[76:79], v[124:127], v[28:31], v[44:47]
    v_exp_f32 v57, v57
    v_exp_f32 v58, v58
    v_mfma_f32_16x16x32_bf16 v[88:91], v[136:139], v[80:83], v[88:91]
    v_exp_f32 v59, v59
    v_exp_f32 v60, v60
    v_mfma_f32_16x16x32_bf16 v[92:95], v[140:143], v[80:83], v[92:95]
    v_exp_f32 v61, v61
    v_exp_f32 v62, v62
    v_mfma_f32_16x16x32_bf16 v[152:155], v[12:15], v[80:83], v[152:155]
    v_exp_f32 v63, v63
    v_cvt_pk_bf16_f32 v84, v56, v57
    v_cvt_pk_bf16_f32 v85, v58, v59
    v_cvt_pk_bf16_f32 v86, v60, v61
    v_cvt_pk_bf16_f32 v87, v62, v63
    s_waitcnt lgkmcnt(0)
    s_nop 0
    v_mfma_f32_16x16x32_bf16 v[96:99], v[136:139], v[84:87], v[96:99]
    v_exp_f32 v64, v64
    v_mfma_f32_16x16x32_bf16 v[100:103], v[140:143], v[84:87], v[100:103]
    ds_read_b128 v[120:123], v3 offset:40960
    ds_read_b128 v[124:127], v3 offset:41984
    v_exp_f32 v65, v65
    v_exp_f32 v66, v66
    v_mfma_f32_16x16x32_bf16 v[156:159], v[12:15], v[84:87], v[156:159]
    v_exp_f32 v67, v67
    v_exp_f32 v68, v68
    v_mfma_f32_16x16x32_bf16 v[48:51], v[128:131], v[16:19], v[32:35]
    v_exp_f32 v69, v69
    v_exp_f32 v70, v70
    v_mfma_f32_16x16x32_bf16 v[52:55], v[132:135], v[16:19], v[32:35]
    v_exp_f32 v71, v71
    v_cvt_pk_bf16_f32 v80, v64, v65
    v_cvt_pk_bf16_f32 v81, v66, v67
    v_mfma_f32_16x16x32_bf16 v[56:59], v[128:131], v[20:23], v[36:39]
    v_cvt_pk_bf16_f32 v82, v68, v69
    v_cvt_pk_bf16_f32 v83, v70, v71
    v_exp_f32 v72, v72
    v_mfma_f32_16x16x32_bf16 v[60:63], v[132:135], v[20:23], v[36:39]
    v_exp_f32 v73, v73
    v_exp_f32 v74, v74
    v_mfma_f32_16x16x32_bf16 v[104:107], v[136:139], v[80:83], v[104:107]
    v_exp_f32 v75, v75
    v_exp_f32 v76, v76
    v_mfma_f32_16x16x32_bf16 v[108:111], v[140:143], v[80:83], v[108:111]
    v_exp_f32 v77, v77
    v_exp_f32 v78, v78
    v_mfma_f32_16x16x32_bf16 v[160:163], v[12:15], v[80:83], v[160:163]
    v_exp_f32 v79, v79
    v_cvt_pk_bf16_f32 v84, v72, v73
    v_cvt_pk_bf16_f32 v85, v74, v75
    v_cvt_pk_bf16_f32 v86, v76, v77
    v_cvt_pk_bf16_f32 v87, v78, v79
    s_waitcnt lgkmcnt(0)
    s_nop 0
    v_mfma_f32_16x16x32_bf16 v[112:115], v[136:139], v[84:87], v[112:115]
    v_exp_f32 v48, v48
    v_mfma_f32_16x16x32_bf16 v[116:119], v[140:143], v[84:87], v[116:119]
    ds_read_b128 v[136:139], v3 offset:43008
    ds_read_b128 v[140:143], v3 offset:44032
    v_exp_f32 v49, v49
    v_exp_f32 v50, v50
    v_mfma_f32_16x16x32_bf16 v[164:167], v[12:15], v[84:87], v[164:167]
    v_exp_f32 v51, v51
    v_exp_f32 v52, v52
    v_mfma_f32_16x16x32_bf16 v[64:67], v[128:131], v[24:27], v[40:43]
    v_exp_f32 v53, v53
    v_exp_f32 v54, v54
    v_mfma_f32_16x16x32_bf16 v[68:71], v[132:135], v[24:27], v[40:43]
    v_exp_f32 v55, v55
    v_cvt_pk_bf16_f32 v80, v48, v49
    v_cvt_pk_bf16_f32 v81, v50, v51
    v_mfma_f32_16x16x32_bf16 v[72:75], v[128:131], v[28:31], v[44:47]
    v_cvt_pk_bf16_f32 v82, v52, v53
    v_cvt_pk_bf16_f32 v83, v54, v55
    v_exp_f32 v56, v56
    v_mfma_f32_16x16x32_bf16 v[76:79], v[132:135], v[28:31], v[44:47]
    v_exp_f32 v57, v57
    v_exp_f32 v58, v58
    v_mfma_f32_16x16x32_bf16 v[88:91], v[144:147], v[80:83], v[88:91]
    v_exp_f32 v59, v59
    v_exp_f32 v60, v60
    v_mfma_f32_16x16x32_bf16 v[92:95], v[148:151], v[80:83], v[92:95]
    v_exp_f32 v61, v61
    v_exp_f32 v62, v62
    v_mfma_f32_16x16x32_bf16 v[152:155], v[12:15], v[80:83], v[152:155]
    v_exp_f32 v63, v63
    v_cvt_pk_bf16_f32 v84, v56, v57
    v_cvt_pk_bf16_f32 v85, v58, v59
    v_cvt_pk_bf16_f32 v86, v60, v61
    v_cvt_pk_bf16_f32 v87, v62, v63
    s_waitcnt lgkmcnt(0)
    s_nop 0
    v_mfma_f32_16x16x32_bf16 v[96:99], v[144:147], v[84:87], v[96:99]
    v_exp_f32 v64, v64
    v_mfma_f32_16x16x32_bf16 v[100:103], v[148:151], v[84:87], v[100:103]
    ds_read_b128 v[128:131], v3 offset:45056
    ds_read_b128 v[132:135], v3 offset:46080
    v_exp_f32 v65, v65
    v_exp_f32 v66, v66
    v_mfma_f32_16x16x32_bf16 v[156:159], v[12:15], v[84:87], v[156:159]
    v_exp_f32 v67, v67
    v_exp_f32 v68, v68
    v_mfma_f32_16x16x32_bf16 v[48:51], v[120:123], v[16:19], v[32:35]
    v_exp_f32 v69, v69
    v_exp_f32 v70, v70
    v_mfma_f32_16x16x32_bf16 v[52:55], v[124:127], v[16:19], v[32:35]
    v_exp_f32 v71, v71
    v_cvt_pk_bf16_f32 v80, v64, v65
    v_cvt_pk_bf16_f32 v81, v66, v67
    v_mfma_f32_16x16x32_bf16 v[56:59], v[120:123], v[20:23], v[36:39]
    v_cvt_pk_bf16_f32 v82, v68, v69
    v_cvt_pk_bf16_f32 v83, v70, v71
    v_exp_f32 v72, v72
    v_mfma_f32_16x16x32_bf16 v[60:63], v[124:127], v[20:23], v[36:39]
    v_exp_f32 v73, v73
    v_exp_f32 v74, v74
    v_mfma_f32_16x16x32_bf16 v[104:107], v[144:147], v[80:83], v[104:107]
    v_exp_f32 v75, v75
    v_exp_f32 v76, v76
    v_mfma_f32_16x16x32_bf16 v[108:111], v[148:151], v[80:83], v[108:111]
    v_exp_f32 v77, v77
    v_exp_f32 v78, v78
    v_mfma_f32_16x16x32_bf16 v[160:163], v[12:15], v[80:83], v[160:163]
    v_exp_f32 v79, v79
    v_cvt_pk_bf16_f32 v84, v72, v73
    v_cvt_pk_bf16_f32 v85, v74, v75
    v_cvt_pk_bf16_f32 v86, v76, v77
    v_cvt_pk_bf16_f32 v87, v78, v79
    s_waitcnt lgkmcnt(0)
    s_nop 0
    v_mfma_f32_16x16x32_bf16 v[112:115], v[144:147], v[84:87], v[112:115]
    v_exp_f32 v48, v48
    v_mfma_f32_16x16x32_bf16 v[116:119], v[148:151], v[84:87], v[116:119]
    ds_read_b128 v[144:147], v3 offset:47104
    ds_read_b128 v[148:151], v3 offset:48128
    v_exp_f32 v49, v49
    v_exp_f32 v50, v50
    v_mfma_f32_16x16x32_bf16 v[164:167], v[12:15], v[84:87], v[164:167]
    v_exp_f32 v51, v51
    v_exp_f32 v52, v52
    v_mfma_f32_16x16x32_bf16 v[64:67], v[120:123], v[24:27], v[40:43]
    v_exp_f32 v53, v53
    v_exp_f32 v54, v54
    v_mfma_f32_16x16x32_bf16 v[68:71], v[124:127], v[24:27], v[40:43]
    v_exp_f32 v55, v55
    v_cvt_pk_bf16_f32 v80, v48, v49
    v_cvt_pk_bf16_f32 v81, v50, v51
    v_mfma_f32_16x16x32_bf16 v[72:75], v[120:123], v[28:31], v[44:47]
    v_cvt_pk_bf16_f32 v82, v52, v53
    v_cvt_pk_bf16_f32 v83, v54, v55
    v_exp_f32 v56, v56
    v_mfma_f32_16x16x32_bf16 v[76:79], v[124:127], v[28:31], v[44:47]
    v_exp_f32 v57, v57
    v_exp_f32 v58, v58
    v_mfma_f32_16x16x32_bf16 v[88:91], v[136:139], v[80:83], v[88:91]
    v_exp_f32 v59, v59
    v_exp_f32 v60, v60
    v_mfma_f32_16x16x32_bf16 v[92:95], v[140:143], v[80:83], v[92:95]
    v_exp_f32 v61, v61
    v_exp_f32 v62, v62
    v_mfma_f32_16x16x32_bf16 v[152:155], v[12:15], v[80:83], v[152:155]
    v_exp_f32 v63, v63
    v_cvt_pk_bf16_f32 v84, v56, v57
    v_cvt_pk_bf16_f32 v85, v58, v59
    v_cvt_pk_bf16_f32 v86, v60, v61
    v_cvt_pk_bf16_f32 v87, v62, v63
    s_waitcnt lgkmcnt(0)
    s_nop 0
    v_mfma_f32_16x16x32_bf16 v[96:99], v[136:139], v[84:87], v[96:99]
    v_exp_f32 v64, v64
    v_mfma_f32_16x16x32_bf16 v[100:103], v[140:143], v[84:87], v[100:103]
    v_exp_f32 v65, v65
    v_exp_f32 v66, v66
    v_mfma_f32_16x16x32_bf16 v[156:159], v[12:15], v[84:87], v[156:159]
    v_exp_f32 v67, v67
    v_exp_f32 v68, v68
    v_mfma_f32_16x16x32_bf16 v[48:51], v[128:131], v[16:19], v[32:35]
    v_exp_f32 v69, v69
    v_exp_f32 v70, v70
    v_mfma_f32_16x16x32_bf16 v[52:55], v[132:135], v[16:19], v[32:35]
    v_exp_f32 v71, v71
    v_cvt_pk_bf16_f32 v80, v64, v65
    v_cvt_pk_bf16_f32 v81, v66, v67
    v_mfma_f32_16x16x32_bf16 v[56:59], v[128:131], v[20:23], v[36:39]
    v_cvt_pk_bf16_f32 v82, v68, v69
    v_cvt_pk_bf16_f32 v83, v70, v71
    v_exp_f32 v72, v72
    v_mfma_f32_16x16x32_bf16 v[60:63], v[132:135], v[20:23], v[36:39]
    v_exp_f32 v73, v73
    v_exp_f32 v74, v74
    v_mfma_f32_16x16x32_bf16 v[104:107], v[136:139], v[80:83], v[104:107]
    v_exp_f32 v75, v75
    v_exp_f32 v76, v76
    v_mfma_f32_16x16x32_bf16 v[108:111], v[140:143], v[80:83], v[108:111]
    v_exp_f32 v77, v77
    v_exp_f32 v78, v78
    v_mfma_f32_16x16x32_bf16 v[160:163], v[12:15], v[80:83], v[160:163]
    v_exp_f32 v79, v79
    v_cvt_pk_bf16_f32 v84, v72, v73
    v_cvt_pk_bf16_f32 v85, v74, v75
    v_cvt_pk_bf16_f32 v86, v76, v77
    v_cvt_pk_bf16_f32 v87, v78, v79
    s_waitcnt lgkmcnt(0)
    s_waitcnt vmcnt(4)
    s_barrier
    v_mfma_f32_16x16x32_bf16 v[112:115], v[136:139], v[84:87], v[112:115]
    v_exp_f32 v48, v48
    v_mfma_f32_16x16x32_bf16 v[116:119], v[140:143], v[84:87], v[116:119]
    ds_read_b128 v[120:123], v3 offset:49152
    ds_read_b128 v[124:127], v3 offset:50176
    v_exp_f32 v49, v49
    v_exp_f32 v50, v50
    v_mfma_f32_16x16x32_bf16 v[164:167], v[12:15], v[84:87], v[164:167]
    ds_read_b128 v[136:139], v3 offset:51200
    ds_read_b128 v[140:143], v3 offset:52224
    v_exp_f32 v51, v51
    v_exp_f32 v52, v52
    v_mfma_f32_16x16x32_bf16 v[64:67], v[128:131], v[24:27], v[40:43]
    v_exp_f32 v53, v53
    v_exp_f32 v54, v54
    v_mfma_f32_16x16x32_bf16 v[68:71], v[132:135], v[24:27], v[40:43]
    v_exp_f32 v55, v55
    v_cvt_pk_bf16_f32 v80, v48, v49
    v_cvt_pk_bf16_f32 v81, v50, v51
    v_mfma_f32_16x16x32_bf16 v[72:75], v[128:131], v[28:31], v[44:47]
    s_add_u32 m0, s36, 16384
    s_add_u32 s35, s44, 212992
    buffer_load_dwordx4 v2, s[8:11], s35 offen offset:0 lds
    buffer_load_dwordx4 v2, s[8:11], s35 offen offset:1024 lds
    buffer_load_dwordx4 v2, s[8:11], s35 offen offset:2048 lds
    buffer_load_dwordx4 v2, s[8:11], s35 offen offset:3072 lds
    v_cvt_pk_bf16_f32 v82, v52, v53
    v_cvt_pk_bf16_f32 v83, v54, v55
    v_exp_f32 v56, v56
    v_mfma_f32_16x16x32_bf16 v[76:79], v[132:135], v[28:31], v[44:47]
    v_exp_f32 v57, v57
    v_exp_f32 v58, v58
    v_mfma_f32_16x16x32_bf16 v[88:91], v[144:147], v[80:83], v[88:91]
    v_exp_f32 v59, v59
    v_exp_f32 v60, v60
    v_mfma_f32_16x16x32_bf16 v[92:95], v[148:151], v[80:83], v[92:95]
    v_exp_f32 v61, v61
    v_exp_f32 v62, v62
    v_mfma_f32_16x16x32_bf16 v[152:155], v[12:15], v[80:83], v[152:155]
    v_exp_f32 v63, v63
    v_cvt_pk_bf16_f32 v84, v56, v57
    v_cvt_pk_bf16_f32 v85, v58, v59
    v_cvt_pk_bf16_f32 v86, v60, v61
    v_cvt_pk_bf16_f32 v87, v62, v63
    s_waitcnt lgkmcnt(0)
    s_nop 0
    v_mfma_f32_16x16x32_bf16 v[96:99], v[144:147], v[84:87], v[96:99]
    v_exp_f32 v64, v64
    v_mfma_f32_16x16x32_bf16 v[100:103], v[148:151], v[84:87], v[100:103]
    ds_read_b128 v[128:131], v3 offset:53248
    ds_read_b128 v[132:135], v3 offset:54272
    v_exp_f32 v65, v65
    v_exp_f32 v66, v66
    v_mfma_f32_16x16x32_bf16 v[156:159], v[12:15], v[84:87], v[156:159]
    v_exp_f32 v67, v67
    v_exp_f32 v68, v68
    v_mfma_f32_16x16x32_bf16 v[48:51], v[120:123], v[16:19], v[32:35]
    v_exp_f32 v69, v69
    v_exp_f32 v70, v70
    v_mfma_f32_16x16x32_bf16 v[52:55], v[124:127], v[16:19], v[32:35]
    v_exp_f32 v71, v71
    v_cvt_pk_bf16_f32 v80, v64, v65
    v_cvt_pk_bf16_f32 v81, v66, v67
    v_mfma_f32_16x16x32_bf16 v[56:59], v[120:123], v[20:23], v[36:39]
    v_cvt_pk_bf16_f32 v82, v68, v69
    v_cvt_pk_bf16_f32 v83, v70, v71
    v_exp_f32 v72, v72
    v_mfma_f32_16x16x32_bf16 v[60:63], v[124:127], v[20:23], v[36:39]
    v_exp_f32 v73, v73
    v_exp_f32 v74, v74
    v_mfma_f32_16x16x32_bf16 v[104:107], v[144:147], v[80:83], v[104:107]
    v_exp_f32 v75, v75
    v_exp_f32 v76, v76
    v_mfma_f32_16x16x32_bf16 v[108:111], v[148:151], v[80:83], v[108:111]
    v_exp_f32 v77, v77
    v_exp_f32 v78, v78
    v_mfma_f32_16x16x32_bf16 v[160:163], v[12:15], v[80:83], v[160:163]
    v_exp_f32 v79, v79
    v_cvt_pk_bf16_f32 v84, v72, v73
    v_cvt_pk_bf16_f32 v85, v74, v75
    v_cvt_pk_bf16_f32 v86, v76, v77
    v_cvt_pk_bf16_f32 v87, v78, v79
    s_waitcnt lgkmcnt(0)
    s_nop 0
    v_mfma_f32_16x16x32_bf16 v[112:115], v[144:147], v[84:87], v[112:115]
    v_exp_f32 v48, v48
    v_mfma_f32_16x16x32_bf16 v[116:119], v[148:151], v[84:87], v[116:119]
    ds_read_b128 v[144:147], v3 offset:55296
    ds_read_b128 v[148:151], v3 offset:56320
    v_exp_f32 v49, v49
    v_exp_f32 v50, v50
    v_mfma_f32_16x16x32_bf16 v[164:167], v[12:15], v[84:87], v[164:167]
    v_exp_f32 v51, v51
    v_exp_f32 v52, v52
    v_mfma_f32_16x16x32_bf16 v[64:67], v[120:123], v[24:27], v[40:43]
    v_exp_f32 v53, v53
    v_exp_f32 v54, v54
    v_mfma_f32_16x16x32_bf16 v[68:71], v[124:127], v[24:27], v[40:43]
    v_exp_f32 v55, v55
    v_cvt_pk_bf16_f32 v80, v48, v49
    v_cvt_pk_bf16_f32 v81, v50, v51
    v_mfma_f32_16x16x32_bf16 v[72:75], v[120:123], v[28:31], v[44:47]
    v_cvt_pk_bf16_f32 v82, v52, v53
    v_cvt_pk_bf16_f32 v83, v54, v55
    v_exp_f32 v56, v56
    v_mfma_f32_16x16x32_bf16 v[76:79], v[124:127], v[28:31], v[44:47]
    v_exp_f32 v57, v57
    v_exp_f32 v58, v58
    v_mfma_f32_16x16x32_bf16 v[88:91], v[136:139], v[80:83], v[88:91]
    v_exp_f32 v59, v59
    v_exp_f32 v60, v60
    v_mfma_f32_16x16x32_bf16 v[92:95], v[140:143], v[80:83], v[92:95]
    v_exp_f32 v61, v61
    v_exp_f32 v62, v62
    v_mfma_f32_16x16x32_bf16 v[152:155], v[12:15], v[80:83], v[152:155]
    v_exp_f32 v63, v63
    v_cvt_pk_bf16_f32 v84, v56, v57
    v_cvt_pk_bf16_f32 v85, v58, v59
    v_cvt_pk_bf16_f32 v86, v60, v61
    v_cvt_pk_bf16_f32 v87, v62, v63
    s_waitcnt lgkmcnt(0)
    s_nop 0
    v_mfma_f32_16x16x32_bf16 v[96:99], v[136:139], v[84:87], v[96:99]
    v_exp_f32 v64, v64
    v_mfma_f32_16x16x32_bf16 v[100:103], v[140:143], v[84:87], v[100:103]
    ds_read_b128 v[120:123], v3 offset:57344
    ds_read_b128 v[124:127], v3 offset:58368
    v_exp_f32 v65, v65
    v_exp_f32 v66, v66
    v_mfma_f32_16x16x32_bf16 v[156:159], v[12:15], v[84:87], v[156:159]
    v_exp_f32 v67, v67
    v_exp_f32 v68, v68
    v_mfma_f32_16x16x32_bf16 v[48:51], v[128:131], v[16:19], v[32:35]
    v_exp_f32 v69, v69
    v_exp_f32 v70, v70
    v_mfma_f32_16x16x32_bf16 v[52:55], v[132:135], v[16:19], v[32:35]
    v_exp_f32 v71, v71
    v_cvt_pk_bf16_f32 v80, v64, v65
    v_cvt_pk_bf16_f32 v81, v66, v67
    v_mfma_f32_16x16x32_bf16 v[56:59], v[128:131], v[20:23], v[36:39]
    v_cvt_pk_bf16_f32 v82, v68, v69
    v_cvt_pk_bf16_f32 v83, v70, v71
    v_exp_f32 v72, v72
    v_mfma_f32_16x16x32_bf16 v[60:63], v[132:135], v[20:23], v[36:39]
    v_exp_f32 v73, v73
    v_exp_f32 v74, v74
    v_mfma_f32_16x16x32_bf16 v[104:107], v[136:139], v[80:83], v[104:107]
    v_exp_f32 v75, v75
    v_exp_f32 v76, v76
    v_mfma_f32_16x16x32_bf16 v[108:111], v[140:143], v[80:83], v[108:111]
    v_exp_f32 v77, v77
    v_exp_f32 v78, v78
    v_mfma_f32_16x16x32_bf16 v[160:163], v[12:15], v[80:83], v[160:163]
    v_exp_f32 v79, v79
    v_cvt_pk_bf16_f32 v84, v72, v73
    v_cvt_pk_bf16_f32 v85, v74, v75
    v_cvt_pk_bf16_f32 v86, v76, v77
    v_cvt_pk_bf16_f32 v87, v78, v79
    s_waitcnt lgkmcnt(0)
    s_nop 0
    v_mfma_f32_16x16x32_bf16 v[112:115], v[136:139], v[84:87], v[112:115]
    v_exp_f32 v48, v48
    v_mfma_f32_16x16x32_bf16 v[116:119], v[140:143], v[84:87], v[116:119]
    ds_read_b128 v[136:139], v3 offset:59392
    ds_read_b128 v[140:143], v3 offset:60416
    v_exp_f32 v49, v49
    v_exp_f32 v50, v50
    v_mfma_f32_16x16x32_bf16 v[164:167], v[12:15], v[84:87], v[164:167]
    v_exp_f32 v51, v51
    v_exp_f32 v52, v52
    v_mfma_f32_16x16x32_bf16 v[64:67], v[128:131], v[24:27], v[40:43]
    v_exp_f32 v53, v53
    v_exp_f32 v54, v54
    v_mfma_f32_16x16x32_bf16 v[68:71], v[132:135], v[24:27], v[40:43]
    v_exp_f32 v55, v55
    v_cvt_pk_bf16_f32 v80, v48, v49
    v_cvt_pk_bf16_f32 v81, v50, v51
    v_mfma_f32_16x16x32_bf16 v[72:75], v[128:131], v[28:31], v[44:47]
    v_cvt_pk_bf16_f32 v82, v52, v53
    v_cvt_pk_bf16_f32 v83, v54, v55
    v_exp_f32 v56, v56
    v_mfma_f32_16x16x32_bf16 v[76:79], v[132:135], v[28:31], v[44:47]
    v_exp_f32 v57, v57
    v_exp_f32 v58, v58
    v_mfma_f32_16x16x32_bf16 v[88:91], v[144:147], v[80:83], v[88:91]
    v_exp_f32 v59, v59
    v_exp_f32 v60, v60
    v_mfma_f32_16x16x32_bf16 v[92:95], v[148:151], v[80:83], v[92:95]
    v_exp_f32 v61, v61
    v_exp_f32 v62, v62
    v_mfma_f32_16x16x32_bf16 v[152:155], v[12:15], v[80:83], v[152:155]
    v_exp_f32 v63, v63
    v_cvt_pk_bf16_f32 v84, v56, v57
    v_cvt_pk_bf16_f32 v85, v58, v59
    v_cvt_pk_bf16_f32 v86, v60, v61
    v_cvt_pk_bf16_f32 v87, v62, v63
    s_waitcnt lgkmcnt(0)
    s_nop 0
    v_mfma_f32_16x16x32_bf16 v[96:99], v[144:147], v[84:87], v[96:99]
    v_exp_f32 v64, v64
    v_mfma_f32_16x16x32_bf16 v[100:103], v[148:151], v[84:87], v[100:103]
    ds_read_b128 v[128:131], v3 offset:61440
    ds_read_b128 v[132:135], v3 offset:62464
    v_exp_f32 v65, v65
    v_exp_f32 v66, v66
    v_mfma_f32_16x16x32_bf16 v[156:159], v[12:15], v[84:87], v[156:159]
    v_exp_f32 v67, v67
    v_exp_f32 v68, v68
    v_mfma_f32_16x16x32_bf16 v[48:51], v[120:123], v[16:19], v[32:35]
    v_exp_f32 v69, v69
    v_exp_f32 v70, v70
    v_mfma_f32_16x16x32_bf16 v[52:55], v[124:127], v[16:19], v[32:35]
    v_exp_f32 v71, v71
    v_cvt_pk_bf16_f32 v80, v64, v65
    v_cvt_pk_bf16_f32 v81, v66, v67
    v_mfma_f32_16x16x32_bf16 v[56:59], v[120:123], v[20:23], v[36:39]
    v_cvt_pk_bf16_f32 v82, v68, v69
    v_cvt_pk_bf16_f32 v83, v70, v71
    v_exp_f32 v72, v72
    v_mfma_f32_16x16x32_bf16 v[60:63], v[124:127], v[20:23], v[36:39]
    v_exp_f32 v73, v73
    v_exp_f32 v74, v74
    v_mfma_f32_16x16x32_bf16 v[104:107], v[144:147], v[80:83], v[104:107]
    v_exp_f32 v75, v75
    v_exp_f32 v76, v76
    v_mfma_f32_16x16x32_bf16 v[108:111], v[148:151], v[80:83], v[108:111]
    v_exp_f32 v77, v77
    v_exp_f32 v78, v78
    v_mfma_f32_16x16x32_bf16 v[160:163], v[12:15], v[80:83], v[160:163]
    v_exp_f32 v79, v79
    v_cvt_pk_bf16_f32 v84, v72, v73
    v_cvt_pk_bf16_f32 v85, v74, v75
    v_cvt_pk_bf16_f32 v86, v76, v77
    v_cvt_pk_bf16_f32 v87, v78, v79
    s_waitcnt lgkmcnt(0)
    s_nop 0
    v_mfma_f32_16x16x32_bf16 v[112:115], v[144:147], v[84:87], v[112:115]
    v_exp_f32 v48, v48
    v_mfma_f32_16x16x32_bf16 v[116:119], v[148:151], v[84:87], v[116:119]
    ds_read_b128 v[144:147], v3 offset:63488
    ds_read_b128 v[148:151], v3 offset:64512
    v_exp_f32 v49, v49
    v_exp_f32 v50, v50
    v_mfma_f32_16x16x32_bf16 v[164:167], v[12:15], v[84:87], v[164:167]
    v_exp_f32 v51, v51
    v_exp_f32 v52, v52
    v_mfma_f32_16x16x32_bf16 v[64:67], v[120:123], v[24:27], v[40:43]
    v_exp_f32 v53, v53
    v_exp_f32 v54, v54
    v_mfma_f32_16x16x32_bf16 v[68:71], v[124:127], v[24:27], v[40:43]
    v_exp_f32 v55, v55
    v_cvt_pk_bf16_f32 v80, v48, v49
    v_cvt_pk_bf16_f32 v81, v50, v51
    v_mfma_f32_16x16x32_bf16 v[72:75], v[120:123], v[28:31], v[44:47]
    v_cvt_pk_bf16_f32 v82, v52, v53
    v_cvt_pk_bf16_f32 v83, v54, v55
    v_exp_f32 v56, v56
    v_mfma_f32_16x16x32_bf16 v[76:79], v[124:127], v[28:31], v[44:47]
    v_exp_f32 v57, v57
    v_exp_f32 v58, v58
    v_mfma_f32_16x16x32_bf16 v[88:91], v[136:139], v[80:83], v[88:91]
    v_exp_f32 v59, v59
    v_exp_f32 v60, v60
    v_mfma_f32_16x16x32_bf16 v[92:95], v[140:143], v[80:83], v[92:95]
    v_exp_f32 v61, v61
    v_exp_f32 v62, v62
    v_mfma_f32_16x16x32_bf16 v[152:155], v[12:15], v[80:83], v[152:155]
    v_exp_f32 v63, v63
    v_cvt_pk_bf16_f32 v84, v56, v57
    v_cvt_pk_bf16_f32 v85, v58, v59
    v_cvt_pk_bf16_f32 v86, v60, v61
    v_cvt_pk_bf16_f32 v87, v62, v63
    s_waitcnt lgkmcnt(0)
    s_nop 0
    v_mfma_f32_16x16x32_bf16 v[96:99], v[136:139], v[84:87], v[96:99]
    v_exp_f32 v64, v64
    v_mfma_f32_16x16x32_bf16 v[100:103], v[140:143], v[84:87], v[100:103]
    v_exp_f32 v65, v65
    v_exp_f32 v66, v66
    v_mfma_f32_16x16x32_bf16 v[156:159], v[12:15], v[84:87], v[156:159]
    v_exp_f32 v67, v67
    v_exp_f32 v68, v68
    v_mfma_f32_16x16x32_bf16 v[48:51], v[128:131], v[16:19], v[32:35]
    v_exp_f32 v69, v69
    v_exp_f32 v70, v70
    v_mfma_f32_16x16x32_bf16 v[52:55], v[132:135], v[16:19], v[32:35]
    v_exp_f32 v71, v71
    v_cvt_pk_bf16_f32 v80, v64, v65
    v_cvt_pk_bf16_f32 v81, v66, v67
    v_mfma_f32_16x16x32_bf16 v[56:59], v[128:131], v[20:23], v[36:39]
    v_cvt_pk_bf16_f32 v82, v68, v69
    v_cvt_pk_bf16_f32 v83, v70, v71
    v_exp_f32 v72, v72
    v_mfma_f32_16x16x32_bf16 v[60:63], v[132:135], v[20:23], v[36:39]
    v_exp_f32 v73, v73
    v_exp_f32 v74, v74
    v_mfma_f32_16x16x32_bf16 v[104:107], v[136:139], v[80:83], v[104:107]
    v_exp_f32 v75, v75
    v_exp_f32 v76, v76
    v_mfma_f32_16x16x32_bf16 v[108:111], v[140:143], v[80:83], v[108:111]
    v_exp_f32 v77, v77
    v_exp_f32 v78, v78
    v_mfma_f32_16x16x32_bf16 v[160:163], v[12:15], v[80:83], v[160:163]
    v_exp_f32 v79, v79
    v_cvt_pk_bf16_f32 v84, v72, v73
    v_cvt_pk_bf16_f32 v85, v74, v75
    v_cvt_pk_bf16_f32 v86, v76, v77
    v_cvt_pk_bf16_f32 v87, v78, v79
    s_waitcnt lgkmcnt(0)
    s_waitcnt vmcnt(4)
    s_barrier
    v_mfma_f32_16x16x32_bf16 v[112:115], v[136:139], v[84:87], v[112:115]
    v_exp_f32 v48, v48
    v_mfma_f32_16x16x32_bf16 v[116:119], v[140:143], v[84:87], v[116:119]
    ds_read_b128 v[120:123], v3 offset:0
    ds_read_b128 v[124:127], v3 offset:1024
    v_exp_f32 v49, v49
    v_exp_f32 v50, v50
    v_mfma_f32_16x16x32_bf16 v[164:167], v[12:15], v[84:87], v[164:167]
    ds_read_b128 v[136:139], v3 offset:2048
    ds_read_b128 v[140:143], v3 offset:3072
    v_exp_f32 v51, v51
    v_exp_f32 v52, v52
    v_mfma_f32_16x16x32_bf16 v[64:67], v[128:131], v[24:27], v[40:43]
    v_exp_f32 v53, v53
    v_exp_f32 v54, v54
    v_mfma_f32_16x16x32_bf16 v[68:71], v[132:135], v[24:27], v[40:43]
    v_exp_f32 v55, v55
    v_cvt_pk_bf16_f32 v80, v48, v49
    v_cvt_pk_bf16_f32 v81, v50, v51
    v_mfma_f32_16x16x32_bf16 v[72:75], v[128:131], v[28:31], v[44:47]
    s_add_u32 m0, s36, 32768
    s_add_u32 s35, s44, 229376
    buffer_load_dwordx4 v2, s[8:11], s35 offen offset:0 lds
    buffer_load_dwordx4 v2, s[8:11], s35 offen offset:1024 lds
    buffer_load_dwordx4 v2, s[8:11], s35 offen offset:2048 lds
    buffer_load_dwordx4 v2, s[8:11], s35 offen offset:3072 lds
    v_cvt_pk_bf16_f32 v82, v52, v53
    v_cvt_pk_bf16_f32 v83, v54, v55
    v_exp_f32 v56, v56
    v_mfma_f32_16x16x32_bf16 v[76:79], v[132:135], v[28:31], v[44:47]
    v_exp_f32 v57, v57
    v_exp_f32 v58, v58
    v_mfma_f32_16x16x32_bf16 v[88:91], v[144:147], v[80:83], v[88:91]
    v_exp_f32 v59, v59
    v_exp_f32 v60, v60
    v_mfma_f32_16x16x32_bf16 v[92:95], v[148:151], v[80:83], v[92:95]
    v_exp_f32 v61, v61
    v_exp_f32 v62, v62
    v_mfma_f32_16x16x32_bf16 v[152:155], v[12:15], v[80:83], v[152:155]
    v_exp_f32 v63, v63
    v_cvt_pk_bf16_f32 v84, v56, v57
    v_cvt_pk_bf16_f32 v85, v58, v59
    v_cvt_pk_bf16_f32 v86, v60, v61
    v_cvt_pk_bf16_f32 v87, v62, v63
    s_waitcnt lgkmcnt(0)
    s_nop 0
    v_mfma_f32_16x16x32_bf16 v[96:99], v[144:147], v[84:87], v[96:99]
    v_exp_f32 v64, v64
    v_mfma_f32_16x16x32_bf16 v[100:103], v[148:151], v[84:87], v[100:103]
    ds_read_b128 v[128:131], v3 offset:4096
    ds_read_b128 v[132:135], v3 offset:5120
    v_exp_f32 v65, v65
    v_exp_f32 v66, v66
    v_mfma_f32_16x16x32_bf16 v[156:159], v[12:15], v[84:87], v[156:159]
    v_exp_f32 v67, v67
    v_exp_f32 v68, v68
    v_mfma_f32_16x16x32_bf16 v[48:51], v[120:123], v[16:19], v[32:35]
    v_exp_f32 v69, v69
    v_exp_f32 v70, v70
    v_mfma_f32_16x16x32_bf16 v[52:55], v[124:127], v[16:19], v[32:35]
    v_exp_f32 v71, v71
    v_cvt_pk_bf16_f32 v80, v64, v65
    v_cvt_pk_bf16_f32 v81, v66, v67
    v_mfma_f32_16x16x32_bf16 v[56:59], v[120:123], v[20:23], v[36:39]
    v_cvt_pk_bf16_f32 v82, v68, v69
    v_cvt_pk_bf16_f32 v83, v70, v71
    v_exp_f32 v72, v72
    v_mfma_f32_16x16x32_bf16 v[60:63], v[124:127], v[20:23], v[36:39]
    v_exp_f32 v73, v73
    v_exp_f32 v74, v74
    v_mfma_f32_16x16x32_bf16 v[104:107], v[144:147], v[80:83], v[104:107]
    v_exp_f32 v75, v75
    v_exp_f32 v76, v76
    v_mfma_f32_16x16x32_bf16 v[108:111], v[148:151], v[80:83], v[108:111]
    v_exp_f32 v77, v77
    v_exp_f32 v78, v78
    v_mfma_f32_16x16x32_bf16 v[160:163], v[12:15], v[80:83], v[160:163]
    v_exp_f32 v79, v79
    v_cvt_pk_bf16_f32 v84, v72, v73
    v_cvt_pk_bf16_f32 v85, v74, v75
    v_cvt_pk_bf16_f32 v86, v76, v77
    v_cvt_pk_bf16_f32 v87, v78, v79
    s_waitcnt lgkmcnt(0)
    s_nop 0
    v_mfma_f32_16x16x32_bf16 v[112:115], v[144:147], v[84:87], v[112:115]
    v_exp_f32 v48, v48
    v_mfma_f32_16x16x32_bf16 v[116:119], v[148:151], v[84:87], v[116:119]
    ds_read_b128 v[144:147], v3 offset:6144
    ds_read_b128 v[148:151], v3 offset:7168
    v_exp_f32 v49, v49
    v_exp_f32 v50, v50
    v_mfma_f32_16x16x32_bf16 v[164:167], v[12:15], v[84:87], v[164:167]
    v_exp_f32 v51, v51
    v_exp_f32 v52, v52
    v_mfma_f32_16x16x32_bf16 v[64:67], v[120:123], v[24:27], v[40:43]
    v_exp_f32 v53, v53
    v_exp_f32 v54, v54
    v_mfma_f32_16x16x32_bf16 v[68:71], v[124:127], v[24:27], v[40:43]
    v_exp_f32 v55, v55
    v_cvt_pk_bf16_f32 v80, v48, v49
    v_cvt_pk_bf16_f32 v81, v50, v51
    v_mfma_f32_16x16x32_bf16 v[72:75], v[120:123], v[28:31], v[44:47]
    v_cvt_pk_bf16_f32 v82, v52, v53
    v_cvt_pk_bf16_f32 v83, v54, v55
    v_exp_f32 v56, v56
    v_mfma_f32_16x16x32_bf16 v[76:79], v[124:127], v[28:31], v[44:47]
    v_exp_f32 v57, v57
    v_exp_f32 v58, v58
    v_mfma_f32_16x16x32_bf16 v[88:91], v[136:139], v[80:83], v[88:91]
    v_exp_f32 v59, v59
    v_exp_f32 v60, v60
    v_mfma_f32_16x16x32_bf16 v[92:95], v[140:143], v[80:83], v[92:95]
    v_exp_f32 v61, v61
    v_exp_f32 v62, v62
    v_mfma_f32_16x16x32_bf16 v[152:155], v[12:15], v[80:83], v[152:155]
    v_exp_f32 v63, v63
    v_cvt_pk_bf16_f32 v84, v56, v57
    v_cvt_pk_bf16_f32 v85, v58, v59
    v_cvt_pk_bf16_f32 v86, v60, v61
    v_cvt_pk_bf16_f32 v87, v62, v63
    s_waitcnt lgkmcnt(0)
    s_nop 0
    v_mfma_f32_16x16x32_bf16 v[96:99], v[136:139], v[84:87], v[96:99]
    v_exp_f32 v64, v64
    v_mfma_f32_16x16x32_bf16 v[100:103], v[140:143], v[84:87], v[100:103]
    ds_read_b128 v[120:123], v3 offset:8192
    ds_read_b128 v[124:127], v3 offset:9216
    v_exp_f32 v65, v65
    v_exp_f32 v66, v66
    v_mfma_f32_16x16x32_bf16 v[156:159], v[12:15], v[84:87], v[156:159]
    v_exp_f32 v67, v67
    v_exp_f32 v68, v68
    v_mfma_f32_16x16x32_bf16 v[48:51], v[128:131], v[16:19], v[32:35]
    v_exp_f32 v69, v69
    v_exp_f32 v70, v70
    v_mfma_f32_16x16x32_bf16 v[52:55], v[132:135], v[16:19], v[32:35]
    v_exp_f32 v71, v71
    v_cvt_pk_bf16_f32 v80, v64, v65
    v_cvt_pk_bf16_f32 v81, v66, v67
    v_mfma_f32_16x16x32_bf16 v[56:59], v[128:131], v[20:23], v[36:39]
    v_cvt_pk_bf16_f32 v82, v68, v69
    v_cvt_pk_bf16_f32 v83, v70, v71
    v_exp_f32 v72, v72
    v_mfma_f32_16x16x32_bf16 v[60:63], v[132:135], v[20:23], v[36:39]
    v_exp_f32 v73, v73
    v_exp_f32 v74, v74
    v_mfma_f32_16x16x32_bf16 v[104:107], v[136:139], v[80:83], v[104:107]
    v_exp_f32 v75, v75
    v_exp_f32 v76, v76
    v_mfma_f32_16x16x32_bf16 v[108:111], v[140:143], v[80:83], v[108:111]
    v_exp_f32 v77, v77
    v_exp_f32 v78, v78
    v_mfma_f32_16x16x32_bf16 v[160:163], v[12:15], v[80:83], v[160:163]
    v_exp_f32 v79, v79
    v_cvt_pk_bf16_f32 v84, v72, v73
    v_cvt_pk_bf16_f32 v85, v74, v75
    v_cvt_pk_bf16_f32 v86, v76, v77
    v_cvt_pk_bf16_f32 v87, v78, v79
    s_waitcnt lgkmcnt(0)
    s_nop 0
    v_mfma_f32_16x16x32_bf16 v[112:115], v[136:139], v[84:87], v[112:115]
    v_exp_f32 v48, v48
    v_mfma_f32_16x16x32_bf16 v[116:119], v[140:143], v[84:87], v[116:119]
    ds_read_b128 v[136:139], v3 offset:10240
    ds_read_b128 v[140:143], v3 offset:11264
    v_exp_f32 v49, v49
    v_exp_f32 v50, v50
    v_mfma_f32_16x16x32_bf16 v[164:167], v[12:15], v[84:87], v[164:167]
    v_exp_f32 v51, v51
    v_exp_f32 v52, v52
    v_mfma_f32_16x16x32_bf16 v[64:67], v[128:131], v[24:27], v[40:43]
    v_exp_f32 v53, v53
    v_exp_f32 v54, v54
    v_mfma_f32_16x16x32_bf16 v[68:71], v[132:135], v[24:27], v[40:43]
    v_exp_f32 v55, v55
    v_cvt_pk_bf16_f32 v80, v48, v49
    v_cvt_pk_bf16_f32 v81, v50, v51
    v_mfma_f32_16x16x32_bf16 v[72:75], v[128:131], v[28:31], v[44:47]
    v_cvt_pk_bf16_f32 v82, v52, v53
    v_cvt_pk_bf16_f32 v83, v54, v55
    v_exp_f32 v56, v56
    v_mfma_f32_16x16x32_bf16 v[76:79], v[132:135], v[28:31], v[44:47]
    v_exp_f32 v57, v57
    v_exp_f32 v58, v58
    v_mfma_f32_16x16x32_bf16 v[88:91], v[144:147], v[80:83], v[88:91]
    v_exp_f32 v59, v59
    v_exp_f32 v60, v60
    v_mfma_f32_16x16x32_bf16 v[92:95], v[148:151], v[80:83], v[92:95]
    v_exp_f32 v61, v61
    v_exp_f32 v62, v62
    v_mfma_f32_16x16x32_bf16 v[152:155], v[12:15], v[80:83], v[152:155]
    v_exp_f32 v63, v63
    v_cvt_pk_bf16_f32 v84, v56, v57
    v_cvt_pk_bf16_f32 v85, v58, v59
    v_cvt_pk_bf16_f32 v86, v60, v61
    v_cvt_pk_bf16_f32 v87, v62, v63
    s_waitcnt lgkmcnt(0)
    s_nop 0
    v_mfma_f32_16x16x32_bf16 v[96:99], v[144:147], v[84:87], v[96:99]
    v_exp_f32 v64, v64
    v_mfma_f32_16x16x32_bf16 v[100:103], v[148:151], v[84:87], v[100:103]
    ds_read_b128 v[128:131], v3 offset:12288
    ds_read_b128 v[132:135], v3 offset:13312
    v_exp_f32 v65, v65
    v_exp_f32 v66, v66
    v_mfma_f32_16x16x32_bf16 v[156:159], v[12:15], v[84:87], v[156:159]
    v_exp_f32 v67, v67
    v_exp_f32 v68, v68
    v_mfma_f32_16x16x32_bf16 v[48:51], v[120:123], v[16:19], v[32:35]
    v_exp_f32 v69, v69
    v_exp_f32 v70, v70
    v_mfma_f32_16x16x32_bf16 v[52:55], v[124:127], v[16:19], v[32:35]
    v_exp_f32 v71, v71
    v_cvt_pk_bf16_f32 v80, v64, v65
    v_cvt_pk_bf16_f32 v81, v66, v67
    v_mfma_f32_16x16x32_bf16 v[56:59], v[120:123], v[20:23], v[36:39]
    v_cvt_pk_bf16_f32 v82, v68, v69
    v_cvt_pk_bf16_f32 v83, v70, v71
    v_exp_f32 v72, v72
    v_mfma_f32_16x16x32_bf16 v[60:63], v[124:127], v[20:23], v[36:39]
    v_exp_f32 v73, v73
    v_exp_f32 v74, v74
    v_mfma_f32_16x16x32_bf16 v[104:107], v[144:147], v[80:83], v[104:107]
    v_exp_f32 v75, v75
    v_exp_f32 v76, v76
    v_mfma_f32_16x16x32_bf16 v[108:111], v[148:151], v[80:83], v[108:111]
    v_exp_f32 v77, v77
    v_exp_f32 v78, v78
    v_mfma_f32_16x16x32_bf16 v[160:163], v[12:15], v[80:83], v[160:163]
    v_exp_f32 v79, v79
    v_cvt_pk_bf16_f32 v84, v72, v73
    v_cvt_pk_bf16_f32 v85, v74, v75
    v_cvt_pk_bf16_f32 v86, v76, v77
    v_cvt_pk_bf16_f32 v87, v78, v79
    s_waitcnt lgkmcnt(0)
    s_nop 0
    v_mfma_f32_16x16x32_bf16 v[112:115], v[144:147], v[84:87], v[112:115]
    v_exp_f32 v48, v48
    v_mfma_f32_16x16x32_bf16 v[116:119], v[148:151], v[84:87], v[116:119]
    ds_read_b128 v[144:147], v3 offset:14336
    ds_read_b128 v[148:151], v3 offset:15360
    v_exp_f32 v49, v49
    v_exp_f32 v50, v50
    v_mfma_f32_16x16x32_bf16 v[164:167], v[12:15], v[84:87], v[164:167]
    v_exp_f32 v51, v51
    v_exp_f32 v52, v52
    v_mfma_f32_16x16x32_bf16 v[64:67], v[120:123], v[24:27], v[40:43]
    v_exp_f32 v53, v53
    v_exp_f32 v54, v54
    v_mfma_f32_16x16x32_bf16 v[68:71], v[124:127], v[24:27], v[40:43]
    v_exp_f32 v55, v55
    v_cvt_pk_bf16_f32 v80, v48, v49
    v_cvt_pk_bf16_f32 v81, v50, v51
    v_mfma_f32_16x16x32_bf16 v[72:75], v[120:123], v[28:31], v[44:47]
    v_cvt_pk_bf16_f32 v82, v52, v53
    v_cvt_pk_bf16_f32 v83, v54, v55
    v_exp_f32 v56, v56
    v_mfma_f32_16x16x32_bf16 v[76:79], v[124:127], v[28:31], v[44:47]
    v_exp_f32 v57, v57
    v_exp_f32 v58, v58
    v_mfma_f32_16x16x32_bf16 v[88:91], v[136:139], v[80:83], v[88:91]
    v_exp_f32 v59, v59
    v_exp_f32 v60, v60
    v_mfma_f32_16x16x32_bf16 v[92:95], v[140:143], v[80:83], v[92:95]
    v_exp_f32 v61, v61
    v_exp_f32 v62, v62
    v_mfma_f32_16x16x32_bf16 v[152:155], v[12:15], v[80:83], v[152:155]
    v_exp_f32 v63, v63
    v_cvt_pk_bf16_f32 v84, v56, v57
    v_cvt_pk_bf16_f32 v85, v58, v59
    v_cvt_pk_bf16_f32 v86, v60, v61
    v_cvt_pk_bf16_f32 v87, v62, v63
    s_waitcnt lgkmcnt(0)
    s_nop 0
    v_mfma_f32_16x16x32_bf16 v[96:99], v[136:139], v[84:87], v[96:99]
    v_exp_f32 v64, v64
    v_mfma_f32_16x16x32_bf16 v[100:103], v[140:143], v[84:87], v[100:103]
    v_exp_f32 v65, v65
    v_exp_f32 v66, v66
    v_mfma_f32_16x16x32_bf16 v[156:159], v[12:15], v[84:87], v[156:159]
    v_exp_f32 v67, v67
    v_exp_f32 v68, v68
    v_mfma_f32_16x16x32_bf16 v[48:51], v[128:131], v[16:19], v[32:35]
    v_exp_f32 v69, v69
    v_exp_f32 v70, v70
    v_mfma_f32_16x16x32_bf16 v[52:55], v[132:135], v[16:19], v[32:35]
    v_exp_f32 v71, v71
    v_cvt_pk_bf16_f32 v80, v64, v65
    v_cvt_pk_bf16_f32 v81, v66, v67
    v_mfma_f32_16x16x32_bf16 v[56:59], v[128:131], v[20:23], v[36:39]
    v_cvt_pk_bf16_f32 v82, v68, v69
    v_cvt_pk_bf16_f32 v83, v70, v71
    v_exp_f32 v72, v72
    v_mfma_f32_16x16x32_bf16 v[60:63], v[132:135], v[20:23], v[36:39]
    v_exp_f32 v73, v73
    v_exp_f32 v74, v74
    v_mfma_f32_16x16x32_bf16 v[104:107], v[136:139], v[80:83], v[104:107]
    v_exp_f32 v75, v75
    v_exp_f32 v76, v76
    v_mfma_f32_16x16x32_bf16 v[108:111], v[140:143], v[80:83], v[108:111]
    v_exp_f32 v77, v77
    v_exp_f32 v78, v78
    v_mfma_f32_16x16x32_bf16 v[160:163], v[12:15], v[80:83], v[160:163]
    v_exp_f32 v79, v79
    v_cvt_pk_bf16_f32 v84, v72, v73
    v_cvt_pk_bf16_f32 v85, v74, v75
    v_cvt_pk_bf16_f32 v86, v76, v77
    v_cvt_pk_bf16_f32 v87, v78, v79
    s_waitcnt lgkmcnt(0)
    s_waitcnt vmcnt(4)
    s_barrier
    v_mfma_f32_16x16x32_bf16 v[112:115], v[136:139], v[84:87], v[112:115]
    v_exp_f32 v48, v48
    v_mfma_f32_16x16x32_bf16 v[116:119], v[140:143], v[84:87], v[116:119]
    ds_read_b128 v[120:123], v3 offset:16384
    ds_read_b128 v[124:127], v3 offset:17408
    v_exp_f32 v49, v49
    v_exp_f32 v50, v50
    v_mfma_f32_16x16x32_bf16 v[164:167], v[12:15], v[84:87], v[164:167]
    ds_read_b128 v[136:139], v3 offset:18432
    ds_read_b128 v[140:143], v3 offset:19456
    v_exp_f32 v51, v51
    v_exp_f32 v52, v52
    v_mfma_f32_16x16x32_bf16 v[64:67], v[128:131], v[24:27], v[40:43]
    v_exp_f32 v53, v53
    v_exp_f32 v54, v54
    v_mfma_f32_16x16x32_bf16 v[68:71], v[132:135], v[24:27], v[40:43]
    v_exp_f32 v55, v55
    v_cvt_pk_bf16_f32 v80, v48, v49
    v_cvt_pk_bf16_f32 v81, v50, v51
    v_mfma_f32_16x16x32_bf16 v[72:75], v[128:131], v[28:31], v[44:47]
    s_add_u32 m0, s36, 49152
    s_add_u32 s35, s44, 245760
    buffer_load_dwordx4 v2, s[8:11], s35 offen offset:0 lds
    buffer_load_dwordx4 v2, s[8:11], s35 offen offset:1024 lds
    buffer_load_dwordx4 v2, s[8:11], s35 offen offset:2048 lds
    buffer_load_dwordx4 v2, s[8:11], s35 offen offset:3072 lds
    v_cvt_pk_bf16_f32 v82, v52, v53
    v_cvt_pk_bf16_f32 v83, v54, v55
    v_exp_f32 v56, v56
    v_mfma_f32_16x16x32_bf16 v[76:79], v[132:135], v[28:31], v[44:47]
    v_exp_f32 v57, v57
    v_exp_f32 v58, v58
    v_mfma_f32_16x16x32_bf16 v[88:91], v[144:147], v[80:83], v[88:91]
    v_exp_f32 v59, v59
    v_exp_f32 v60, v60
    v_mfma_f32_16x16x32_bf16 v[92:95], v[148:151], v[80:83], v[92:95]
    v_exp_f32 v61, v61
    v_exp_f32 v62, v62
    v_mfma_f32_16x16x32_bf16 v[152:155], v[12:15], v[80:83], v[152:155]
    v_exp_f32 v63, v63
    v_cvt_pk_bf16_f32 v84, v56, v57
    v_cvt_pk_bf16_f32 v85, v58, v59
    v_cvt_pk_bf16_f32 v86, v60, v61
    v_cvt_pk_bf16_f32 v87, v62, v63
    s_waitcnt lgkmcnt(0)
    s_nop 0
    v_mfma_f32_16x16x32_bf16 v[96:99], v[144:147], v[84:87], v[96:99]
    v_exp_f32 v64, v64
    v_mfma_f32_16x16x32_bf16 v[100:103], v[148:151], v[84:87], v[100:103]
    ds_read_b128 v[128:131], v3 offset:20480
    ds_read_b128 v[132:135], v3 offset:21504
    v_exp_f32 v65, v65
    v_exp_f32 v66, v66
    v_mfma_f32_16x16x32_bf16 v[156:159], v[12:15], v[84:87], v[156:159]
    v_exp_f32 v67, v67
    v_exp_f32 v68, v68
    v_mfma_f32_16x16x32_bf16 v[48:51], v[120:123], v[16:19], v[32:35]
    v_exp_f32 v69, v69
    v_exp_f32 v70, v70
    v_mfma_f32_16x16x32_bf16 v[52:55], v[124:127], v[16:19], v[32:35]
    v_exp_f32 v71, v71
    v_cvt_pk_bf16_f32 v80, v64, v65
    v_cvt_pk_bf16_f32 v81, v66, v67
    v_mfma_f32_16x16x32_bf16 v[56:59], v[120:123], v[20:23], v[36:39]
    v_cvt_pk_bf16_f32 v82, v68, v69
    v_cvt_pk_bf16_f32 v83, v70, v71
    v_exp_f32 v72, v72
    v_mfma_f32_16x16x32_bf16 v[60:63], v[124:127], v[20:23], v[36:39]
    v_exp_f32 v73, v73
    v_exp_f32 v74, v74
    v_mfma_f32_16x16x32_bf16 v[104:107], v[144:147], v[80:83], v[104:107]
    v_exp_f32 v75, v75
    v_exp_f32 v76, v76
    v_mfma_f32_16x16x32_bf16 v[108:111], v[148:151], v[80:83], v[108:111]
    v_exp_f32 v77, v77
    v_exp_f32 v78, v78
    v_mfma_f32_16x16x32_bf16 v[160:163], v[12:15], v[80:83], v[160:163]
    v_exp_f32 v79, v79
    v_cvt_pk_bf16_f32 v84, v72, v73
    v_cvt_pk_bf16_f32 v85, v74, v75
    v_cvt_pk_bf16_f32 v86, v76, v77
    v_cvt_pk_bf16_f32 v87, v78, v79
    s_waitcnt lgkmcnt(0)
    s_nop 0
    v_mfma_f32_16x16x32_bf16 v[112:115], v[144:147], v[84:87], v[112:115]
    v_exp_f32 v48, v48
    v_mfma_f32_16x16x32_bf16 v[116:119], v[148:151], v[84:87], v[116:119]
    ds_read_b128 v[144:147], v3 offset:22528
    ds_read_b128 v[148:151], v3 offset:23552
    v_exp_f32 v49, v49
    v_exp_f32 v50, v50
    v_mfma_f32_16x16x32_bf16 v[164:167], v[12:15], v[84:87], v[164:167]
    v_exp_f32 v51, v51
    v_exp_f32 v52, v52
    v_mfma_f32_16x16x32_bf16 v[64:67], v[120:123], v[24:27], v[40:43]
    v_exp_f32 v53, v53
    v_exp_f32 v54, v54
    v_mfma_f32_16x16x32_bf16 v[68:71], v[124:127], v[24:27], v[40:43]
    v_exp_f32 v55, v55
    v_cvt_pk_bf16_f32 v80, v48, v49
    v_cvt_pk_bf16_f32 v81, v50, v51
    v_mfma_f32_16x16x32_bf16 v[72:75], v[120:123], v[28:31], v[44:47]
    v_cvt_pk_bf16_f32 v82, v52, v53
    v_cvt_pk_bf16_f32 v83, v54, v55
    v_exp_f32 v56, v56
    v_mfma_f32_16x16x32_bf16 v[76:79], v[124:127], v[28:31], v[44:47]
    v_exp_f32 v57, v57
    v_exp_f32 v58, v58
    v_mfma_f32_16x16x32_bf16 v[88:91], v[136:139], v[80:83], v[88:91]
    v_exp_f32 v59, v59
    v_exp_f32 v60, v60
    v_mfma_f32_16x16x32_bf16 v[92:95], v[140:143], v[80:83], v[92:95]
    v_exp_f32 v61, v61
    v_exp_f32 v62, v62
    v_mfma_f32_16x16x32_bf16 v[152:155], v[12:15], v[80:83], v[152:155]
    v_exp_f32 v63, v63
    v_cvt_pk_bf16_f32 v84, v56, v57
    v_cvt_pk_bf16_f32 v85, v58, v59
    v_cvt_pk_bf16_f32 v86, v60, v61
    v_cvt_pk_bf16_f32 v87, v62, v63
    s_waitcnt lgkmcnt(0)
    s_nop 0
    v_mfma_f32_16x16x32_bf16 v[96:99], v[136:139], v[84:87], v[96:99]
    v_exp_f32 v64, v64
    v_mfma_f32_16x16x32_bf16 v[100:103], v[140:143], v[84:87], v[100:103]
    ds_read_b128 v[120:123], v3 offset:24576
    ds_read_b128 v[124:127], v3 offset:25600
    v_exp_f32 v65, v65
    v_exp_f32 v66, v66
    v_mfma_f32_16x16x32_bf16 v[156:159], v[12:15], v[84:87], v[156:159]
    v_exp_f32 v67, v67
    v_exp_f32 v68, v68
    v_mfma_f32_16x16x32_bf16 v[48:51], v[128:131], v[16:19], v[32:35]
    v_exp_f32 v69, v69
    v_exp_f32 v70, v70
    v_mfma_f32_16x16x32_bf16 v[52:55], v[132:135], v[16:19], v[32:35]
    v_exp_f32 v71, v71
    v_cvt_pk_bf16_f32 v80, v64, v65
    v_cvt_pk_bf16_f32 v81, v66, v67
    v_mfma_f32_16x16x32_bf16 v[56:59], v[128:131], v[20:23], v[36:39]
    v_cvt_pk_bf16_f32 v82, v68, v69
    v_cvt_pk_bf16_f32 v83, v70, v71
    v_exp_f32 v72, v72
    v_mfma_f32_16x16x32_bf16 v[60:63], v[132:135], v[20:23], v[36:39]
    v_exp_f32 v73, v73
    v_exp_f32 v74, v74
    v_mfma_f32_16x16x32_bf16 v[104:107], v[136:139], v[80:83], v[104:107]
    v_exp_f32 v75, v75
    v_exp_f32 v76, v76
    v_mfma_f32_16x16x32_bf16 v[108:111], v[140:143], v[80:83], v[108:111]
    v_exp_f32 v77, v77
    v_exp_f32 v78, v78
    v_mfma_f32_16x16x32_bf16 v[160:163], v[12:15], v[80:83], v[160:163]
    v_exp_f32 v79, v79
    v_cvt_pk_bf16_f32 v84, v72, v73
    v_cvt_pk_bf16_f32 v85, v74, v75
    v_cvt_pk_bf16_f32 v86, v76, v77
    v_cvt_pk_bf16_f32 v87, v78, v79
    s_waitcnt lgkmcnt(0)
    s_nop 0
    v_mfma_f32_16x16x32_bf16 v[112:115], v[136:139], v[84:87], v[112:115]
    v_exp_f32 v48, v48
    v_mfma_f32_16x16x32_bf16 v[116:119], v[140:143], v[84:87], v[116:119]
    ds_read_b128 v[136:139], v3 offset:26624
    ds_read_b128 v[140:143], v3 offset:27648
    v_exp_f32 v49, v49
    v_exp_f32 v50, v50
    v_mfma_f32_16x16x32_bf16 v[164:167], v[12:15], v[84:87], v[164:167]
    v_exp_f32 v51, v51
    v_exp_f32 v52, v52
    v_mfma_f32_16x16x32_bf16 v[64:67], v[128:131], v[24:27], v[40:43]
    v_exp_f32 v53, v53
    v_exp_f32 v54, v54
    v_mfma_f32_16x16x32_bf16 v[68:71], v[132:135], v[24:27], v[40:43]
    v_exp_f32 v55, v55
    v_cvt_pk_bf16_f32 v80, v48, v49
    v_cvt_pk_bf16_f32 v81, v50, v51
    v_mfma_f32_16x16x32_bf16 v[72:75], v[128:131], v[28:31], v[44:47]
    v_cvt_pk_bf16_f32 v82, v52, v53
    v_cvt_pk_bf16_f32 v83, v54, v55
    v_exp_f32 v56, v56
    v_mfma_f32_16x16x32_bf16 v[76:79], v[132:135], v[28:31], v[44:47]
    v_exp_f32 v57, v57
    v_exp_f32 v58, v58
    v_mfma_f32_16x16x32_bf16 v[88:91], v[144:147], v[80:83], v[88:91]
    v_exp_f32 v59, v59
    v_exp_f32 v60, v60
    v_mfma_f32_16x16x32_bf16 v[92:95], v[148:151], v[80:83], v[92:95]
    v_exp_f32 v61, v61
    v_exp_f32 v62, v62
    v_mfma_f32_16x16x32_bf16 v[152:155], v[12:15], v[80:83], v[152:155]
    v_exp_f32 v63, v63
    v_cvt_pk_bf16_f32 v84, v56, v57
    v_cvt_pk_bf16_f32 v85, v58, v59
    v_cvt_pk_bf16_f32 v86, v60, v61
    v_cvt_pk_bf16_f32 v87, v62, v63
    s_waitcnt lgkmcnt(0)
    s_nop 0
    v_mfma_f32_16x16x32_bf16 v[96:99], v[144:147], v[84:87], v[96:99]
    v_exp_f32 v64, v64
    v_mfma_f32_16x16x32_bf16 v[100:103], v[148:151], v[84:87], v[100:103]
    ds_read_b128 v[128:131], v3 offset:28672
    ds_read_b128 v[132:135], v3 offset:29696
    v_exp_f32 v65, v65
    v_exp_f32 v66, v66
    v_mfma_f32_16x16x32_bf16 v[156:159], v[12:15], v[84:87], v[156:159]
    v_exp_f32 v67, v67
    v_exp_f32 v68, v68
    v_mfma_f32_16x16x32_bf16 v[48:51], v[120:123], v[16:19], v[32:35]
    v_exp_f32 v69, v69
    v_exp_f32 v70, v70
    v_mfma_f32_16x16x32_bf16 v[52:55], v[124:127], v[16:19], v[32:35]
    v_exp_f32 v71, v71
    v_cvt_pk_bf16_f32 v80, v64, v65
    v_cvt_pk_bf16_f32 v81, v66, v67
    v_mfma_f32_16x16x32_bf16 v[56:59], v[120:123], v[20:23], v[36:39]
    v_cvt_pk_bf16_f32 v82, v68, v69
    v_cvt_pk_bf16_f32 v83, v70, v71
    v_exp_f32 v72, v72
    v_mfma_f32_16x16x32_bf16 v[60:63], v[124:127], v[20:23], v[36:39]
    v_exp_f32 v73, v73
    v_exp_f32 v74, v74
    v_mfma_f32_16x16x32_bf16 v[104:107], v[144:147], v[80:83], v[104:107]
    v_exp_f32 v75, v75
    v_exp_f32 v76, v76
    v_mfma_f32_16x16x32_bf16 v[108:111], v[148:151], v[80:83], v[108:111]
    v_exp_f32 v77, v77
    v_exp_f32 v78, v78
    v_mfma_f32_16x16x32_bf16 v[160:163], v[12:15], v[80:83], v[160:163]
    v_exp_f32 v79, v79
    v_cvt_pk_bf16_f32 v84, v72, v73
    v_cvt_pk_bf16_f32 v85, v74, v75
    v_cvt_pk_bf16_f32 v86, v76, v77
    v_cvt_pk_bf16_f32 v87, v78, v79
    s_waitcnt lgkmcnt(0)
    s_nop 0
    v_mfma_f32_16x16x32_bf16 v[112:115], v[144:147], v[84:87], v[112:115]
    v_exp_f32 v48, v48
    v_mfma_f32_16x16x32_bf16 v[116:119], v[148:151], v[84:87], v[116:119]
    ds_read_b128 v[144:147], v3 offset:30720
    ds_read_b128 v[148:151], v3 offset:31744
    v_exp_f32 v49, v49
    v_exp_f32 v50, v50
    v_mfma_f32_16x16x32_bf16 v[164:167], v[12:15], v[84:87], v[164:167]
    v_exp_f32 v51, v51
    v_exp_f32 v52, v52
    v_mfma_f32_16x16x32_bf16 v[64:67], v[120:123], v[24:27], v[40:43]
    v_exp_f32 v53, v53
    v_exp_f32 v54, v54
    v_mfma_f32_16x16x32_bf16 v[68:71], v[124:127], v[24:27], v[40:43]
    v_exp_f32 v55, v55
    v_cvt_pk_bf16_f32 v80, v48, v49
    v_cvt_pk_bf16_f32 v81, v50, v51
    v_mfma_f32_16x16x32_bf16 v[72:75], v[120:123], v[28:31], v[44:47]
    v_cvt_pk_bf16_f32 v82, v52, v53
    v_cvt_pk_bf16_f32 v83, v54, v55
    v_exp_f32 v56, v56
    v_mfma_f32_16x16x32_bf16 v[76:79], v[124:127], v[28:31], v[44:47]
    v_exp_f32 v57, v57
    v_exp_f32 v58, v58
    v_mfma_f32_16x16x32_bf16 v[88:91], v[136:139], v[80:83], v[88:91]
    v_exp_f32 v59, v59
    v_exp_f32 v60, v60
    v_mfma_f32_16x16x32_bf16 v[92:95], v[140:143], v[80:83], v[92:95]
    v_exp_f32 v61, v61
    v_exp_f32 v62, v62
    v_mfma_f32_16x16x32_bf16 v[152:155], v[12:15], v[80:83], v[152:155]
    v_exp_f32 v63, v63
    v_cvt_pk_bf16_f32 v84, v56, v57
    v_cvt_pk_bf16_f32 v85, v58, v59
    v_cvt_pk_bf16_f32 v86, v60, v61
    v_cvt_pk_bf16_f32 v87, v62, v63
    s_waitcnt lgkmcnt(0)
    s_nop 0
    v_mfma_f32_16x16x32_bf16 v[96:99], v[136:139], v[84:87], v[96:99]
    v_exp_f32 v64, v64
    v_mfma_f32_16x16x32_bf16 v[100:103], v[140:143], v[84:87], v[100:103]
    v_exp_f32 v65, v65
    v_exp_f32 v66, v66
    v_mfma_f32_16x16x32_bf16 v[156:159], v[12:15], v[84:87], v[156:159]
    v_exp_f32 v67, v67
    v_exp_f32 v68, v68
    v_mfma_f32_16x16x32_bf16 v[48:51], v[128:131], v[16:19], v[32:35]
    v_exp_f32 v69, v69
    v_exp_f32 v70, v70
    v_mfma_f32_16x16x32_bf16 v[52:55], v[132:135], v[16:19], v[32:35]
    v_exp_f32 v71, v71
    v_cvt_pk_bf16_f32 v80, v64, v65
    v_cvt_pk_bf16_f32 v81, v66, v67
    v_mfma_f32_16x16x32_bf16 v[56:59], v[128:131], v[20:23], v[36:39]
    v_cvt_pk_bf16_f32 v82, v68, v69
    v_cvt_pk_bf16_f32 v83, v70, v71
    v_exp_f32 v72, v72
    v_mfma_f32_16x16x32_bf16 v[60:63], v[132:135], v[20:23], v[36:39]
    v_exp_f32 v73, v73
    v_exp_f32 v74, v74
    v_mfma_f32_16x16x32_bf16 v[104:107], v[136:139], v[80:83], v[104:107]
    v_exp_f32 v75, v75
    v_exp_f32 v76, v76
    v_mfma_f32_16x16x32_bf16 v[108:111], v[140:143], v[80:83], v[108:111]
    v_exp_f32 v77, v77
    v_exp_f32 v78, v78
    v_mfma_f32_16x16x32_bf16 v[160:163], v[12:15], v[80:83], v[160:163]
    v_exp_f32 v79, v79
    v_cvt_pk_bf16_f32 v84, v72, v73
    v_cvt_pk_bf16_f32 v85, v74, v75
    v_cvt_pk_bf16_f32 v86, v76, v77
    v_cvt_pk_bf16_f32 v87, v78, v79
    s_waitcnt lgkmcnt(0)
    s_waitcnt vmcnt(4)
    s_barrier
    v_mfma_f32_16x16x32_bf16 v[112:115], v[136:139], v[84:87], v[112:115]
    v_exp_f32 v48, v48
    v_mfma_f32_16x16x32_bf16 v[116:119], v[140:143], v[84:87], v[116:119]
    ds_read_b128 v[120:123], v3 offset:32768
    ds_read_b128 v[124:127], v3 offset:33792
    v_exp_f32 v49, v49
    v_exp_f32 v50, v50
    v_mfma_f32_16x16x32_bf16 v[164:167], v[12:15], v[84:87], v[164:167]
    ds_read_b128 v[136:139], v3 offset:34816
    ds_read_b128 v[140:143], v3 offset:35840
    v_exp_f32 v51, v51
    v_exp_f32 v52, v52
    v_mfma_f32_16x16x32_bf16 v[64:67], v[128:131], v[24:27], v[40:43]
    v_exp_f32 v53, v53
    v_exp_f32 v54, v54
    v_mfma_f32_16x16x32_bf16 v[68:71], v[132:135], v[24:27], v[40:43]
    v_exp_f32 v55, v55
    v_cvt_pk_bf16_f32 v80, v48, v49
    v_cvt_pk_bf16_f32 v81, v50, v51
    v_mfma_f32_16x16x32_bf16 v[72:75], v[128:131], v[28:31], v[44:47]
    v_cvt_pk_bf16_f32 v82, v52, v53
    v_cvt_pk_bf16_f32 v83, v54, v55
    v_exp_f32 v56, v56
    v_mfma_f32_16x16x32_bf16 v[76:79], v[132:135], v[28:31], v[44:47]
    v_exp_f32 v57, v57
    v_exp_f32 v58, v58
    v_mfma_f32_16x16x32_bf16 v[88:91], v[144:147], v[80:83], v[88:91]
    v_exp_f32 v59, v59
    v_exp_f32 v60, v60
    v_mfma_f32_16x16x32_bf16 v[92:95], v[148:151], v[80:83], v[92:95]
    v_exp_f32 v61, v61
    v_exp_f32 v62, v62
    v_mfma_f32_16x16x32_bf16 v[152:155], v[12:15], v[80:83], v[152:155]
    v_exp_f32 v63, v63
    v_cvt_pk_bf16_f32 v84, v56, v57
    v_cvt_pk_bf16_f32 v85, v58, v59
    v_cvt_pk_bf16_f32 v86, v60, v61
    v_cvt_pk_bf16_f32 v87, v62, v63
    s_waitcnt lgkmcnt(0)
    s_nop 0
    v_mfma_f32_16x16x32_bf16 v[96:99], v[144:147], v[84:87], v[96:99]
    v_exp_f32 v64, v64
    v_mfma_f32_16x16x32_bf16 v[100:103], v[148:151], v[84:87], v[100:103]
    ds_read_b128 v[128:131], v3 offset:36864
    ds_read_b128 v[132:135], v3 offset:37888
    v_exp_f32 v65, v65
    v_exp_f32 v66, v66
    v_mfma_f32_16x16x32_bf16 v[156:159], v[12:15], v[84:87], v[156:159]
    v_exp_f32 v67, v67
    v_exp_f32 v68, v68
    v_mfma_f32_16x16x32_bf16 v[48:51], v[120:123], v[16:19], v[32:35]
    v_exp_f32 v69, v69
    v_exp_f32 v70, v70
    v_mfma_f32_16x16x32_bf16 v[52:55], v[124:127], v[16:19], v[32:35]
    v_exp_f32 v71, v71
    v_cvt_pk_bf16_f32 v80, v64, v65
    v_cvt_pk_bf16_f32 v81, v66, v67
    v_mfma_f32_16x16x32_bf16 v[56:59], v[120:123], v[20:23], v[36:39]
    v_cvt_pk_bf16_f32 v82, v68, v69
    v_cvt_pk_bf16_f32 v83, v70, v71
    v_exp_f32 v72, v72
    v_mfma_f32_16x16x32_bf16 v[60:63], v[124:127], v[20:23], v[36:39]
    v_exp_f32 v73, v73
    v_exp_f32 v74, v74
    v_mfma_f32_16x16x32_bf16 v[104:107], v[144:147], v[80:83], v[104:107]
    v_exp_f32 v75, v75
    v_exp_f32 v76, v76
    v_mfma_f32_16x16x32_bf16 v[108:111], v[148:151], v[80:83], v[108:111]
    v_exp_f32 v77, v77
    v_exp_f32 v78, v78
    v_mfma_f32_16x16x32_bf16 v[160:163], v[12:15], v[80:83], v[160:163]
    v_exp_f32 v79, v79
    v_cvt_pk_bf16_f32 v84, v72, v73
    v_cvt_pk_bf16_f32 v85, v74, v75
    v_cvt_pk_bf16_f32 v86, v76, v77
    v_cvt_pk_bf16_f32 v87, v78, v79
    s_waitcnt lgkmcnt(0)
    s_nop 0
    v_mfma_f32_16x16x32_bf16 v[112:115], v[144:147], v[84:87], v[112:115]
    v_exp_f32 v48, v48
    v_mfma_f32_16x16x32_bf16 v[116:119], v[148:151], v[84:87], v[116:119]
    ds_read_b128 v[144:147], v3 offset:38912
    ds_read_b128 v[148:151], v3 offset:39936
    v_exp_f32 v49, v49
    v_exp_f32 v50, v50
    v_mfma_f32_16x16x32_bf16 v[164:167], v[12:15], v[84:87], v[164:167]
    v_exp_f32 v51, v51
    v_exp_f32 v52, v52
    v_mfma_f32_16x16x32_bf16 v[64:67], v[120:123], v[24:27], v[40:43]
    v_exp_f32 v53, v53
    v_exp_f32 v54, v54
    v_mfma_f32_16x16x32_bf16 v[68:71], v[124:127], v[24:27], v[40:43]
    v_exp_f32 v55, v55
    v_cvt_pk_bf16_f32 v80, v48, v49
    v_cvt_pk_bf16_f32 v81, v50, v51
    v_mfma_f32_16x16x32_bf16 v[72:75], v[120:123], v[28:31], v[44:47]
    v_cvt_pk_bf16_f32 v82, v52, v53
    v_cvt_pk_bf16_f32 v83, v54, v55
    v_exp_f32 v56, v56
    v_mfma_f32_16x16x32_bf16 v[76:79], v[124:127], v[28:31], v[44:47]
    v_exp_f32 v57, v57
    v_exp_f32 v58, v58
    v_mfma_f32_16x16x32_bf16 v[88:91], v[136:139], v[80:83], v[88:91]
    v_exp_f32 v59, v59
    v_exp_f32 v60, v60
    v_mfma_f32_16x16x32_bf16 v[92:95], v[140:143], v[80:83], v[92:95]
    v_exp_f32 v61, v61
    v_exp_f32 v62, v62
    v_mfma_f32_16x16x32_bf16 v[152:155], v[12:15], v[80:83], v[152:155]
    v_exp_f32 v63, v63
    v_cvt_pk_bf16_f32 v84, v56, v57
    v_cvt_pk_bf16_f32 v85, v58, v59
    v_cvt_pk_bf16_f32 v86, v60, v61
    v_cvt_pk_bf16_f32 v87, v62, v63
    s_waitcnt lgkmcnt(0)
    s_nop 0
    v_mfma_f32_16x16x32_bf16 v[96:99], v[136:139], v[84:87], v[96:99]
    v_exp_f32 v64, v64
    v_mfma_f32_16x16x32_bf16 v[100:103], v[140:143], v[84:87], v[100:103]
    ds_read_b128 v[120:123], v3 offset:40960
    ds_read_b128 v[124:127], v3 offset:41984
    v_exp_f32 v65, v65
    v_exp_f32 v66, v66
    v_mfma_f32_16x16x32_bf16 v[156:159], v[12:15], v[84:87], v[156:159]
    v_exp_f32 v67, v67
    v_exp_f32 v68, v68
    v_mfma_f32_16x16x32_bf16 v[48:51], v[128:131], v[16:19], v[32:35]
    v_exp_f32 v69, v69
    v_exp_f32 v70, v70
    v_mfma_f32_16x16x32_bf16 v[52:55], v[132:135], v[16:19], v[32:35]
    v_exp_f32 v71, v71
    v_cvt_pk_bf16_f32 v80, v64, v65
    v_cvt_pk_bf16_f32 v81, v66, v67
    v_mfma_f32_16x16x32_bf16 v[56:59], v[128:131], v[20:23], v[36:39]
    v_cvt_pk_bf16_f32 v82, v68, v69
    v_cvt_pk_bf16_f32 v83, v70, v71
    v_exp_f32 v72, v72
    v_mfma_f32_16x16x32_bf16 v[60:63], v[132:135], v[20:23], v[36:39]
    v_exp_f32 v73, v73
    v_exp_f32 v74, v74
    v_mfma_f32_16x16x32_bf16 v[104:107], v[136:139], v[80:83], v[104:107]
    v_exp_f32 v75, v75
    v_exp_f32 v76, v76
    v_mfma_f32_16x16x32_bf16 v[108:111], v[140:143], v[80:83], v[108:111]
    v_exp_f32 v77, v77
    v_exp_f32 v78, v78
    v_mfma_f32_16x16x32_bf16 v[160:163], v[12:15], v[80:83], v[160:163]
    v_exp_f32 v79, v79
    v_cvt_pk_bf16_f32 v84, v72, v73
    v_cvt_pk_bf16_f32 v85, v74, v75
    v_cvt_pk_bf16_f32 v86, v76, v77
    v_cvt_pk_bf16_f32 v87, v78, v79
    s_waitcnt lgkmcnt(0)
    s_nop 0
    v_mfma_f32_16x16x32_bf16 v[112:115], v[136:139], v[84:87], v[112:115]
    v_exp_f32 v48, v48
    v_mfma_f32_16x16x32_bf16 v[116:119], v[140:143], v[84:87], v[116:119]
    ds_read_b128 v[136:139], v3 offset:43008
    ds_read_b128 v[140:143], v3 offset:44032
    v_exp_f32 v49, v49
    v_exp_f32 v50, v50
    v_mfma_f32_16x16x32_bf16 v[164:167], v[12:15], v[84:87], v[164:167]
    v_exp_f32 v51, v51
    v_exp_f32 v52, v52
    v_mfma_f32_16x16x32_bf16 v[64:67], v[128:131], v[24:27], v[40:43]
    v_exp_f32 v53, v53
    v_exp_f32 v54, v54
    v_mfma_f32_16x16x32_bf16 v[68:71], v[132:135], v[24:27], v[40:43]
    v_exp_f32 v55, v55
    v_cvt_pk_bf16_f32 v80, v48, v49
    v_cvt_pk_bf16_f32 v81, v50, v51
    v_mfma_f32_16x16x32_bf16 v[72:75], v[128:131], v[28:31], v[44:47]
    v_cvt_pk_bf16_f32 v82, v52, v53
    v_cvt_pk_bf16_f32 v83, v54, v55
    v_exp_f32 v56, v56
    v_mfma_f32_16x16x32_bf16 v[76:79], v[132:135], v[28:31], v[44:47]
    v_exp_f32 v57, v57
    v_exp_f32 v58, v58
    v_mfma_f32_16x16x32_bf16 v[88:91], v[144:147], v[80:83], v[88:91]
    v_exp_f32 v59, v59
    v_exp_f32 v60, v60
    v_mfma_f32_16x16x32_bf16 v[92:95], v[148:151], v[80:83], v[92:95]
    v_exp_f32 v61, v61
    v_exp_f32 v62, v62
    v_mfma_f32_16x16x32_bf16 v[152:155], v[12:15], v[80:83], v[152:155]
    v_exp_f32 v63, v63
    v_cvt_pk_bf16_f32 v84, v56, v57
    v_cvt_pk_bf16_f32 v85, v58, v59
    v_cvt_pk_bf16_f32 v86, v60, v61
    v_cvt_pk_bf16_f32 v87, v62, v63
    s_waitcnt lgkmcnt(0)
    s_nop 0
    v_mfma_f32_16x16x32_bf16 v[96:99], v[144:147], v[84:87], v[96:99]
    v_exp_f32 v64, v64
    v_mfma_f32_16x16x32_bf16 v[100:103], v[148:151], v[84:87], v[100:103]
    ds_read_b128 v[128:131], v3 offset:45056
    ds_read_b128 v[132:135], v3 offset:46080
    v_exp_f32 v65, v65
    v_exp_f32 v66, v66
    v_mfma_f32_16x16x32_bf16 v[156:159], v[12:15], v[84:87], v[156:159]
    v_exp_f32 v67, v67
    v_exp_f32 v68, v68
    v_mfma_f32_16x16x32_bf16 v[48:51], v[120:123], v[16:19], v[32:35]
    v_exp_f32 v69, v69
    v_exp_f32 v70, v70
    v_mfma_f32_16x16x32_bf16 v[52:55], v[124:127], v[16:19], v[32:35]
    v_exp_f32 v71, v71
    v_cvt_pk_bf16_f32 v80, v64, v65
    v_cvt_pk_bf16_f32 v81, v66, v67
    v_mfma_f32_16x16x32_bf16 v[56:59], v[120:123], v[20:23], v[36:39]
    v_cvt_pk_bf16_f32 v82, v68, v69
    v_cvt_pk_bf16_f32 v83, v70, v71
    v_exp_f32 v72, v72
    v_mfma_f32_16x16x32_bf16 v[60:63], v[124:127], v[20:23], v[36:39]
    v_exp_f32 v73, v73
    v_exp_f32 v74, v74
    v_mfma_f32_16x16x32_bf16 v[104:107], v[144:147], v[80:83], v[104:107]
    v_exp_f32 v75, v75
    v_exp_f32 v76, v76
    v_mfma_f32_16x16x32_bf16 v[108:111], v[148:151], v[80:83], v[108:111]
    v_exp_f32 v77, v77
    v_exp_f32 v78, v78
    v_mfma_f32_16x16x32_bf16 v[160:163], v[12:15], v[80:83], v[160:163]
    v_exp_f32 v79, v79
    v_cvt_pk_bf16_f32 v84, v72, v73
    v_cvt_pk_bf16_f32 v85, v74, v75
    v_cvt_pk_bf16_f32 v86, v76, v77
    v_cvt_pk_bf16_f32 v87, v78, v79
    s_waitcnt lgkmcnt(0)
    s_nop 0
    v_mfma_f32_16x16x32_bf16 v[112:115], v[144:147], v[84:87], v[112:115]
    v_exp_f32 v48, v48
    v_mfma_f32_16x16x32_bf16 v[116:119], v[148:151], v[84:87], v[116:119]
    ds_read_b128 v[144:147], v3 offset:47104
    ds_read_b128 v[148:151], v3 offset:48128
    v_exp_f32 v49, v49
    v_exp_f32 v50, v50
    v_mfma_f32_16x16x32_bf16 v[164:167], v[12:15], v[84:87], v[164:167]
    v_exp_f32 v51, v51
    v_exp_f32 v52, v52
    v_mfma_f32_16x16x32_bf16 v[64:67], v[120:123], v[24:27], v[40:43]
    v_exp_f32 v53, v53
    v_exp_f32 v54, v54
    v_mfma_f32_16x16x32_bf16 v[68:71], v[124:127], v[24:27], v[40:43]
    v_exp_f32 v55, v55
    v_cvt_pk_bf16_f32 v80, v48, v49
    v_cvt_pk_bf16_f32 v81, v50, v51
    v_mfma_f32_16x16x32_bf16 v[72:75], v[120:123], v[28:31], v[44:47]
    v_cvt_pk_bf16_f32 v82, v52, v53
    v_cvt_pk_bf16_f32 v83, v54, v55
    v_exp_f32 v56, v56
    v_mfma_f32_16x16x32_bf16 v[76:79], v[124:127], v[28:31], v[44:47]
    v_exp_f32 v57, v57
    v_exp_f32 v58, v58
    v_mfma_f32_16x16x32_bf16 v[88:91], v[136:139], v[80:83], v[88:91]
    v_exp_f32 v59, v59
    v_exp_f32 v60, v60
    v_mfma_f32_16x16x32_bf16 v[92:95], v[140:143], v[80:83], v[92:95]
    v_exp_f32 v61, v61
    v_exp_f32 v62, v62
    v_mfma_f32_16x16x32_bf16 v[152:155], v[12:15], v[80:83], v[152:155]
    v_exp_f32 v63, v63
    v_cvt_pk_bf16_f32 v84, v56, v57
    v_cvt_pk_bf16_f32 v85, v58, v59
    v_cvt_pk_bf16_f32 v86, v60, v61
    v_cvt_pk_bf16_f32 v87, v62, v63
    s_waitcnt lgkmcnt(0)
    s_nop 0
    v_mfma_f32_16x16x32_bf16 v[96:99], v[136:139], v[84:87], v[96:99]
    v_exp_f32 v64, v64
    v_mfma_f32_16x16x32_bf16 v[100:103], v[140:143], v[84:87], v[100:103]
    v_exp_f32 v65, v65
    v_exp_f32 v66, v66
    v_mfma_f32_16x16x32_bf16 v[156:159], v[12:15], v[84:87], v[156:159]
    v_exp_f32 v67, v67
    v_exp_f32 v68, v68
    v_mfma_f32_16x16x32_bf16 v[48:51], v[128:131], v[16:19], v[32:35]
    v_exp_f32 v69, v69
    v_exp_f32 v70, v70
    v_mfma_f32_16x16x32_bf16 v[52:55], v[132:135], v[16:19], v[32:35]
    v_exp_f32 v71, v71
    v_cvt_pk_bf16_f32 v80, v64, v65
    v_cvt_pk_bf16_f32 v81, v66, v67
    v_mfma_f32_16x16x32_bf16 v[56:59], v[128:131], v[20:23], v[36:39]
    v_cvt_pk_bf16_f32 v82, v68, v69
    v_cvt_pk_bf16_f32 v83, v70, v71
    v_exp_f32 v72, v72
    v_mfma_f32_16x16x32_bf16 v[60:63], v[132:135], v[20:23], v[36:39]
    v_exp_f32 v73, v73
    v_exp_f32 v74, v74
    v_mfma_f32_16x16x32_bf16 v[104:107], v[136:139], v[80:83], v[104:107]
    v_exp_f32 v75, v75
    v_exp_f32 v76, v76
    v_mfma_f32_16x16x32_bf16 v[108:111], v[140:143], v[80:83], v[108:111]
    v_exp_f32 v77, v77
    v_exp_f32 v78, v78
    v_mfma_f32_16x16x32_bf16 v[160:163], v[12:15], v[80:83], v[160:163]
    v_exp_f32 v79, v79
    v_cvt_pk_bf16_f32 v84, v72, v73
    v_cvt_pk_bf16_f32 v85, v74, v75
    v_cvt_pk_bf16_f32 v86, v76, v77
    v_cvt_pk_bf16_f32 v87, v78, v79
    s_waitcnt lgkmcnt(0)
    s_waitcnt vmcnt(0)
    s_barrier
    v_mfma_f32_16x16x32_bf16 v[112:115], v[136:139], v[84:87], v[112:115]
    v_exp_f32 v48, v48
    v_mfma_f32_16x16x32_bf16 v[116:119], v[140:143], v[84:87], v[116:119]
    ds_read_b128 v[120:123], v3 offset:49152
    ds_read_b128 v[124:127], v3 offset:50176
    v_exp_f32 v49, v49
    v_exp_f32 v50, v50
    v_mfma_f32_16x16x32_bf16 v[164:167], v[12:15], v[84:87], v[164:167]
    ds_read_b128 v[136:139], v3 offset:51200
    ds_read_b128 v[140:143], v3 offset:52224
    v_exp_f32 v51, v51
    v_exp_f32 v52, v52
    v_mfma_f32_16x16x32_bf16 v[64:67], v[128:131], v[24:27], v[40:43]
    v_exp_f32 v53, v53
    v_exp_f32 v54, v54
    v_mfma_f32_16x16x32_bf16 v[68:71], v[132:135], v[24:27], v[40:43]
    v_exp_f32 v55, v55
    v_cvt_pk_bf16_f32 v80, v48, v49
    v_cvt_pk_bf16_f32 v81, v50, v51
    v_mfma_f32_16x16x32_bf16 v[72:75], v[128:131], v[28:31], v[44:47]
    v_cvt_pk_bf16_f32 v82, v52, v53
    v_cvt_pk_bf16_f32 v83, v54, v55
    v_exp_f32 v56, v56
    v_mfma_f32_16x16x32_bf16 v[76:79], v[132:135], v[28:31], v[44:47]
    v_exp_f32 v57, v57
    v_exp_f32 v58, v58
    v_mfma_f32_16x16x32_bf16 v[88:91], v[144:147], v[80:83], v[88:91]
    v_exp_f32 v59, v59
    v_exp_f32 v60, v60
    v_mfma_f32_16x16x32_bf16 v[92:95], v[148:151], v[80:83], v[92:95]
    v_exp_f32 v61, v61
    v_exp_f32 v62, v62
    v_mfma_f32_16x16x32_bf16 v[152:155], v[12:15], v[80:83], v[152:155]
    v_exp_f32 v63, v63
    v_cvt_pk_bf16_f32 v84, v56, v57
    v_cvt_pk_bf16_f32 v85, v58, v59
    v_cvt_pk_bf16_f32 v86, v60, v61
    v_cvt_pk_bf16_f32 v87, v62, v63
    s_waitcnt lgkmcnt(0)
    s_nop 0
    v_mfma_f32_16x16x32_bf16 v[96:99], v[144:147], v[84:87], v[96:99]
    v_exp_f32 v64, v64
    v_mfma_f32_16x16x32_bf16 v[100:103], v[148:151], v[84:87], v[100:103]
    ds_read_b128 v[128:131], v3 offset:53248
    ds_read_b128 v[132:135], v3 offset:54272
    v_exp_f32 v65, v65
    v_exp_f32 v66, v66
    v_mfma_f32_16x16x32_bf16 v[156:159], v[12:15], v[84:87], v[156:159]
    v_exp_f32 v67, v67
    v_exp_f32 v68, v68
    v_mfma_f32_16x16x32_bf16 v[48:51], v[120:123], v[16:19], v[32:35]
    v_exp_f32 v69, v69
    v_exp_f32 v70, v70
    v_mfma_f32_16x16x32_bf16 v[52:55], v[124:127], v[16:19], v[32:35]
    v_exp_f32 v71, v71
    v_cvt_pk_bf16_f32 v80, v64, v65
    v_cvt_pk_bf16_f32 v81, v66, v67
    v_mfma_f32_16x16x32_bf16 v[56:59], v[120:123], v[20:23], v[36:39]
    v_cvt_pk_bf16_f32 v82, v68, v69
    v_cvt_pk_bf16_f32 v83, v70, v71
    v_exp_f32 v72, v72
    v_mfma_f32_16x16x32_bf16 v[60:63], v[124:127], v[20:23], v[36:39]
    v_exp_f32 v73, v73
    v_exp_f32 v74, v74
    v_mfma_f32_16x16x32_bf16 v[104:107], v[144:147], v[80:83], v[104:107]
    v_exp_f32 v75, v75
    v_exp_f32 v76, v76
    v_mfma_f32_16x16x32_bf16 v[108:111], v[148:151], v[80:83], v[108:111]
    v_exp_f32 v77, v77
    v_exp_f32 v78, v78
    v_mfma_f32_16x16x32_bf16 v[160:163], v[12:15], v[80:83], v[160:163]
    v_exp_f32 v79, v79
    v_cvt_pk_bf16_f32 v84, v72, v73
    v_cvt_pk_bf16_f32 v85, v74, v75
    v_cvt_pk_bf16_f32 v86, v76, v77
    v_cvt_pk_bf16_f32 v87, v78, v79
    s_waitcnt lgkmcnt(0)
    s_nop 0
    v_mfma_f32_16x16x32_bf16 v[112:115], v[144:147], v[84:87], v[112:115]
    v_exp_f32 v48, v48
    v_mfma_f32_16x16x32_bf16 v[116:119], v[148:151], v[84:87], v[116:119]
    ds_read_b128 v[144:147], v3 offset:55296
    ds_read_b128 v[148:151], v3 offset:56320
    v_exp_f32 v49, v49
    v_exp_f32 v50, v50
    v_mfma_f32_16x16x32_bf16 v[164:167], v[12:15], v[84:87], v[164:167]
    v_exp_f32 v51, v51
    v_exp_f32 v52, v52
    v_mfma_f32_16x16x32_bf16 v[64:67], v[120:123], v[24:27], v[40:43]
    v_exp_f32 v53, v53
    v_exp_f32 v54, v54
    v_mfma_f32_16x16x32_bf16 v[68:71], v[124:127], v[24:27], v[40:43]
    v_exp_f32 v55, v55
    v_cvt_pk_bf16_f32 v80, v48, v49
    v_cvt_pk_bf16_f32 v81, v50, v51
    v_mfma_f32_16x16x32_bf16 v[72:75], v[120:123], v[28:31], v[44:47]
    v_cvt_pk_bf16_f32 v82, v52, v53
    v_cvt_pk_bf16_f32 v83, v54, v55
    v_exp_f32 v56, v56
    v_mfma_f32_16x16x32_bf16 v[76:79], v[124:127], v[28:31], v[44:47]
    v_exp_f32 v57, v57
    v_exp_f32 v58, v58
    v_mfma_f32_16x16x32_bf16 v[88:91], v[136:139], v[80:83], v[88:91]
    v_exp_f32 v59, v59
    v_exp_f32 v60, v60
    v_mfma_f32_16x16x32_bf16 v[92:95], v[140:143], v[80:83], v[92:95]
    v_exp_f32 v61, v61
    v_exp_f32 v62, v62
    v_mfma_f32_16x16x32_bf16 v[152:155], v[12:15], v[80:83], v[152:155]
    v_exp_f32 v63, v63
    v_cvt_pk_bf16_f32 v84, v56, v57
    v_cvt_pk_bf16_f32 v85, v58, v59
    v_cvt_pk_bf16_f32 v86, v60, v61
    v_cvt_pk_bf16_f32 v87, v62, v63
    s_waitcnt lgkmcnt(0)
    s_nop 0
    v_mfma_f32_16x16x32_bf16 v[96:99], v[136:139], v[84:87], v[96:99]
    v_exp_f32 v64, v64
    v_mfma_f32_16x16x32_bf16 v[100:103], v[140:143], v[84:87], v[100:103]
    ds_read_b128 v[120:123], v3 offset:57344
    ds_read_b128 v[124:127], v3 offset:58368
    v_exp_f32 v65, v65
    v_exp_f32 v66, v66
    v_mfma_f32_16x16x32_bf16 v[156:159], v[12:15], v[84:87], v[156:159]
    v_exp_f32 v67, v67
    v_exp_f32 v68, v68
    v_mfma_f32_16x16x32_bf16 v[48:51], v[128:131], v[16:19], v[32:35]
    v_exp_f32 v69, v69
    v_exp_f32 v70, v70
    v_mfma_f32_16x16x32_bf16 v[52:55], v[132:135], v[16:19], v[32:35]
    v_exp_f32 v71, v71
    v_cvt_pk_bf16_f32 v80, v64, v65
    v_cvt_pk_bf16_f32 v81, v66, v67
    v_mfma_f32_16x16x32_bf16 v[56:59], v[128:131], v[20:23], v[36:39]
    v_cvt_pk_bf16_f32 v82, v68, v69
    v_cvt_pk_bf16_f32 v83, v70, v71
    v_exp_f32 v72, v72
    v_mfma_f32_16x16x32_bf16 v[60:63], v[132:135], v[20:23], v[36:39]
    v_exp_f32 v73, v73
    v_exp_f32 v74, v74
    v_mfma_f32_16x16x32_bf16 v[104:107], v[136:139], v[80:83], v[104:107]
    v_exp_f32 v75, v75
    v_exp_f32 v76, v76
    v_mfma_f32_16x16x32_bf16 v[108:111], v[140:143], v[80:83], v[108:111]
    v_exp_f32 v77, v77
    v_exp_f32 v78, v78
    v_mfma_f32_16x16x32_bf16 v[160:163], v[12:15], v[80:83], v[160:163]
    v_exp_f32 v79, v79
    v_cvt_pk_bf16_f32 v84, v72, v73
    v_cvt_pk_bf16_f32 v85, v74, v75
    v_cvt_pk_bf16_f32 v86, v76, v77
    v_cvt_pk_bf16_f32 v87, v78, v79
    s_waitcnt lgkmcnt(0)
    s_nop 0
    v_mfma_f32_16x16x32_bf16 v[112:115], v[136:139], v[84:87], v[112:115]
    v_exp_f32 v48, v48
    v_mfma_f32_16x16x32_bf16 v[116:119], v[140:143], v[84:87], v[116:119]
    ds_read_b128 v[136:139], v3 offset:59392
    ds_read_b128 v[140:143], v3 offset:60416
    v_exp_f32 v49, v49
    v_exp_f32 v50, v50
    v_mfma_f32_16x16x32_bf16 v[164:167], v[12:15], v[84:87], v[164:167]
    v_exp_f32 v51, v51
    v_exp_f32 v52, v52
    v_mfma_f32_16x16x32_bf16 v[64:67], v[128:131], v[24:27], v[40:43]
    v_exp_f32 v53, v53
    v_exp_f32 v54, v54
    v_mfma_f32_16x16x32_bf16 v[68:71], v[132:135], v[24:27], v[40:43]
    v_exp_f32 v55, v55
    v_cvt_pk_bf16_f32 v80, v48, v49
    v_cvt_pk_bf16_f32 v81, v50, v51
    v_mfma_f32_16x16x32_bf16 v[72:75], v[128:131], v[28:31], v[44:47]
    v_cvt_pk_bf16_f32 v82, v52, v53
    v_cvt_pk_bf16_f32 v83, v54, v55
    v_exp_f32 v56, v56
    v_mfma_f32_16x16x32_bf16 v[76:79], v[132:135], v[28:31], v[44:47]
    v_exp_f32 v57, v57
    v_exp_f32 v58, v58
    v_mfma_f32_16x16x32_bf16 v[88:91], v[144:147], v[80:83], v[88:91]
    v_exp_f32 v59, v59
    v_exp_f32 v60, v60
    v_mfma_f32_16x16x32_bf16 v[92:95], v[148:151], v[80:83], v[92:95]
    v_exp_f32 v61, v61
    v_exp_f32 v62, v62
    v_mfma_f32_16x16x32_bf16 v[152:155], v[12:15], v[80:83], v[152:155]
    v_exp_f32 v63, v63
    v_cvt_pk_bf16_f32 v84, v56, v57
    v_cvt_pk_bf16_f32 v85, v58, v59
    v_cvt_pk_bf16_f32 v86, v60, v61
    v_cvt_pk_bf16_f32 v87, v62, v63
    s_waitcnt lgkmcnt(0)
    s_nop 0
    v_mfma_f32_16x16x32_bf16 v[96:99], v[144:147], v[84:87], v[96:99]
    v_exp_f32 v64, v64
    v_mfma_f32_16x16x32_bf16 v[100:103], v[148:151], v[84:87], v[100:103]
    ds_read_b128 v[128:131], v3 offset:61440
    ds_read_b128 v[132:135], v3 offset:62464
    v_exp_f32 v65, v65
    v_exp_f32 v66, v66
    v_mfma_f32_16x16x32_bf16 v[156:159], v[12:15], v[84:87], v[156:159]
    v_exp_f32 v67, v67
    v_exp_f32 v68, v68
    v_mfma_f32_16x16x32_bf16 v[48:51], v[120:123], v[16:19], v[32:35]
    v_exp_f32 v69, v69
    v_exp_f32 v70, v70
    v_mfma_f32_16x16x32_bf16 v[52:55], v[124:127], v[16:19], v[32:35]
    v_exp_f32 v71, v71
    v_cvt_pk_bf16_f32 v80, v64, v65
    v_cvt_pk_bf16_f32 v81, v66, v67
    v_mfma_f32_16x16x32_bf16 v[56:59], v[120:123], v[20:23], v[36:39]
    v_cvt_pk_bf16_f32 v82, v68, v69
    v_cvt_pk_bf16_f32 v83, v70, v71
    v_exp_f32 v72, v72
    v_mfma_f32_16x16x32_bf16 v[60:63], v[124:127], v[20:23], v[36:39]
    v_exp_f32 v73, v73
    v_exp_f32 v74, v74
    v_mfma_f32_16x16x32_bf16 v[104:107], v[144:147], v[80:83], v[104:107]
    v_exp_f32 v75, v75
    v_exp_f32 v76, v76
    v_mfma_f32_16x16x32_bf16 v[108:111], v[148:151], v[80:83], v[108:111]
    v_exp_f32 v77, v77
    v_exp_f32 v78, v78
    v_mfma_f32_16x16x32_bf16 v[160:163], v[12:15], v[80:83], v[160:163]
    v_exp_f32 v79, v79
    v_cvt_pk_bf16_f32 v84, v72, v73
    v_cvt_pk_bf16_f32 v85, v74, v75
    v_cvt_pk_bf16_f32 v86, v76, v77
    v_cvt_pk_bf16_f32 v87, v78, v79
    s_waitcnt lgkmcnt(0)
    s_nop 0
    v_mfma_f32_16x16x32_bf16 v[112:115], v[144:147], v[84:87], v[112:115]
    v_exp_f32 v48, v48
    v_mfma_f32_16x16x32_bf16 v[116:119], v[148:151], v[84:87], v[116:119]
    ds_read_b128 v[144:147], v3 offset:63488
    ds_read_b128 v[148:151], v3 offset:64512
    v_exp_f32 v49, v49
    v_exp_f32 v50, v50
    v_mfma_f32_16x16x32_bf16 v[164:167], v[12:15], v[84:87], v[164:167]
    v_exp_f32 v51, v51
    v_exp_f32 v52, v52
    v_mfma_f32_16x16x32_bf16 v[64:67], v[120:123], v[24:27], v[40:43]
    v_exp_f32 v53, v53
    v_exp_f32 v54, v54
    v_mfma_f32_16x16x32_bf16 v[68:71], v[124:127], v[24:27], v[40:43]
    v_exp_f32 v55, v55
    v_cvt_pk_bf16_f32 v80, v48, v49
    v_cvt_pk_bf16_f32 v81, v50, v51
    v_mfma_f32_16x16x32_bf16 v[72:75], v[120:123], v[28:31], v[44:47]
    v_cvt_pk_bf16_f32 v82, v52, v53
    v_cvt_pk_bf16_f32 v83, v54, v55
    v_exp_f32 v56, v56
    v_mfma_f32_16x16x32_bf16 v[76:79], v[124:127], v[28:31], v[44:47]
    v_exp_f32 v57, v57
    v_exp_f32 v58, v58
    v_mfma_f32_16x16x32_bf16 v[88:91], v[136:139], v[80:83], v[88:91]
    v_exp_f32 v59, v59
    v_exp_f32 v60, v60
    v_mfma_f32_16x16x32_bf16 v[92:95], v[140:143], v[80:83], v[92:95]
    v_exp_f32 v61, v61
    v_exp_f32 v62, v62
    v_mfma_f32_16x16x32_bf16 v[152:155], v[12:15], v[80:83], v[152:155]
    v_exp_f32 v63, v63
    v_cvt_pk_bf16_f32 v84, v56, v57
    v_cvt_pk_bf16_f32 v85, v58, v59
    v_cvt_pk_bf16_f32 v86, v60, v61
    v_cvt_pk_bf16_f32 v87, v62, v63
    s_waitcnt lgkmcnt(0)
    s_nop 0
    v_mfma_f32_16x16x32_bf16 v[96:99], v[136:139], v[84:87], v[96:99]
    v_exp_f32 v64, v64
    v_mfma_f32_16x16x32_bf16 v[100:103], v[140:143], v[84:87], v[100:103]
    v_exp_f32 v65, v65
    v_exp_f32 v66, v66
    v_mfma_f32_16x16x32_bf16 v[156:159], v[12:15], v[84:87], v[156:159]
    v_exp_f32 v67, v67
    v_exp_f32 v68, v68
    v_mfma_f32_16x16x32_bf16 v[48:51], v[128:131], v[16:19], v[32:35]
    v_exp_f32 v69, v69
    v_exp_f32 v70, v70
    v_mfma_f32_16x16x32_bf16 v[52:55], v[132:135], v[16:19], v[32:35]
    v_exp_f32 v71, v71
    v_cvt_pk_bf16_f32 v80, v64, v65
    v_cvt_pk_bf16_f32 v81, v66, v67
    v_mfma_f32_16x16x32_bf16 v[56:59], v[128:131], v[20:23], v[36:39]
    v_cvt_pk_bf16_f32 v82, v68, v69
    v_cvt_pk_bf16_f32 v83, v70, v71
    v_exp_f32 v72, v72
    v_mfma_f32_16x16x32_bf16 v[60:63], v[132:135], v[20:23], v[36:39]
    v_exp_f32 v73, v73
    v_exp_f32 v74, v74
    v_mfma_f32_16x16x32_bf16 v[104:107], v[136:139], v[80:83], v[104:107]
    v_exp_f32 v75, v75
    v_exp_f32 v76, v76
    v_mfma_f32_16x16x32_bf16 v[108:111], v[140:143], v[80:83], v[108:111]
    v_exp_f32 v77, v77
    v_exp_f32 v78, v78
    v_mfma_f32_16x16x32_bf16 v[160:163], v[12:15], v[80:83], v[160:163]
    v_exp_f32 v79, v79
    v_cvt_pk_bf16_f32 v84, v72, v73
    v_cvt_pk_bf16_f32 v85, v74, v75
    v_cvt_pk_bf16_f32 v86, v76, v77
    v_cvt_pk_bf16_f32 v87, v78, v79
    s_waitcnt lgkmcnt(0)
    s_nop 0
    v_mfma_f32_16x16x32_bf16 v[112:115], v[136:139], v[84:87], v[112:115]
    v_exp_f32 v48, v48
    v_mfma_f32_16x16x32_bf16 v[116:119], v[140:143], v[84:87], v[116:119]
    v_exp_f32 v49, v49
    v_exp_f32 v50, v50
    v_mfma_f32_16x16x32_bf16 v[164:167], v[12:15], v[84:87], v[164:167]
    v_exp_f32 v51, v51
    v_exp_f32 v52, v52
    v_mfma_f32_16x16x32_bf16 v[64:67], v[128:131], v[24:27], v[40:43]
    v_exp_f32 v53, v53
    v_exp_f32 v54, v54
    v_mfma_f32_16x16x32_bf16 v[68:71], v[132:135], v[24:27], v[40:43]
    v_exp_f32 v55, v55
    v_cvt_pk_bf16_f32 v80, v48, v49
    v_cvt_pk_bf16_f32 v81, v50, v51
    v_mfma_f32_16x16x32_bf16 v[72:75], v[128:131], v[28:31], v[44:47]
    v_cvt_pk_bf16_f32 v82, v52, v53
    v_cvt_pk_bf16_f32 v83, v54, v55
    v_exp_f32 v56, v56
    v_mfma_f32_16x16x32_bf16 v[76:79], v[132:135], v[28:31], v[44:47]
    v_exp_f32 v57, v57
    v_exp_f32 v58, v58
    v_mfma_f32_16x16x32_bf16 v[88:91], v[144:147], v[80:83], v[88:91]
    v_exp_f32 v59, v59
    v_exp_f32 v60, v60
    v_mfma_f32_16x16x32_bf16 v[92:95], v[148:151], v[80:83], v[92:95]
    v_exp_f32 v61, v61
    v_exp_f32 v62, v62
    v_mfma_f32_16x16x32_bf16 v[152:155], v[12:15], v[80:83], v[152:155]
    v_exp_f32 v63, v63
    v_cvt_pk_bf16_f32 v84, v56, v57
    v_cvt_pk_bf16_f32 v85, v58, v59
    v_cvt_pk_bf16_f32 v86, v60, v61
    v_cvt_pk_bf16_f32 v87, v62, v63
    s_waitcnt lgkmcnt(0)
    s_nop 0
    v_mfma_f32_16x16x32_bf16 v[96:99], v[144:147], v[84:87], v[96:99]
    v_exp_f32 v64, v64
    v_mfma_f32_16x16x32_bf16 v[100:103], v[148:151], v[84:87], v[100:103]
    v_exp_f32 v65, v65
    v_exp_f32 v66, v66
    v_mfma_f32_16x16x32_bf16 v[156:159], v[12:15], v[84:87], v[156:159]
    v_exp_f32 v67, v67
    v_exp_f32 v68, v68
    v_exp_f32 v69, v69
    v_exp_f32 v70, v70
    v_exp_f32 v71, v71
    v_cvt_pk_bf16_f32 v80, v64, v65
    v_cvt_pk_bf16_f32 v81, v66, v67
    v_cvt_pk_bf16_f32 v82, v68, v69
    v_cvt_pk_bf16_f32 v83, v70, v71
    v_exp_f32 v72, v72
    v_exp_f32 v73, v73
    v_exp_f32 v74, v74
    v_mfma_f32_16x16x32_bf16 v[104:107], v[144:147], v[80:83], v[104:107]
    v_exp_f32 v75, v75
    v_exp_f32 v76, v76
    v_mfma_f32_16x16x32_bf16 v[108:111], v[148:151], v[80:83], v[108:111]
    v_exp_f32 v77, v77
    v_exp_f32 v78, v78
    v_mfma_f32_16x16x32_bf16 v[160:163], v[12:15], v[80:83], v[160:163]
    v_exp_f32 v79, v79
    v_cvt_pk_bf16_f32 v84, v72, v73
    v_cvt_pk_bf16_f32 v85, v74, v75
    v_cvt_pk_bf16_f32 v86, v76, v77
    v_cvt_pk_bf16_f32 v87, v78, v79
    s_nop 1
    v_mfma_f32_16x16x32_bf16 v[112:115], v[144:147], v[84:87], v[112:115]
    v_mfma_f32_16x16x32_bf16 v[116:119], v[148:151], v[84:87], v[116:119]
    v_mfma_f32_16x16x32_bf16 v[164:167], v[12:15], v[84:87], v[164:167]
    s_lshl_b32 s42, s34, 16
    s_lshl_b32 s41, s33, 10
    s_add_u32 s42, s42, s41
    s_add_u32 s42, s42, 25165824
    s_nop 7
    v_mul_f32 v9, 0, v88
    v_fma_f32 v9, 0, v89, v9
    v_fma_f32 v9, 0, v90, v9
    v_fma_f32 v9, 0, v91, v9
    v_fma_f32 v9, 0, v92, v9
    v_fma_f32 v9, 0, v93, v9
    v_fma_f32 v9, 0, v94, v9
    v_fma_f32 v9, 0, v95, v9
    v_fma_f32 v9, 0, v96, v9
    v_fma_f32 v9, 0, v97, v9
    v_fma_f32 v9, 0, v98, v9
    v_fma_f32 v9, 0, v99, v9
    v_fma_f32 v9, 0, v100, v9
    v_fma_f32 v9, 0, v101, v9
    v_fma_f32 v9, 0, v102, v9
    v_fma_f32 v9, 0, v103, v9
    v_max_f32 v8, v152, v156
    v_add_f32 v9, v9, v152
    v_add_f32 v9, v9, v156
    s_mov_b32 s40, 1904214016
    v_cmp_nlt_f32 vcc, v9, s40
    s_nop 1
    s_cmp_lg_u64 vcc, 0
    s_cbranch_scc1 K2_FALLBACK0
K2_STORE0:
    v_rcp_f32 v8, v152
    s_nop 0
    v_mul_f32 v8, v8, v4
    v_mul_f32 v88, v88, v8
    v_mul_f32 v89, v89, v8
    v_mul_f32 v90, v90, v8
    v_mul_f32 v91, v91, v8
    v_mul_f32 v92, v92, v8
    v_mul_f32 v93, v93, v8
    v_mul_f32 v94, v94, v8
    v_mul_f32 v95, v95, v8
    v_cvt_pk_bf16_f32 v32, v88, v89
    v_cvt_pk_bf16_f32 v33, v90, v91
    v_cvt_pk_bf16_f32 v34, v92, v93
    v_cvt_pk_bf16_f32 v35, v94, v95
    buffer_store_dwordx4 v[32:35], v3, s[8:11], s42 offen
    s_add_u32 s42, s42, 32768
    v_rcp_f32 v8, v156
    s_nop 0
    v_mul_f32 v8, v8, v5
    v_mul_f32 v96, v96, v8
    v_mul_f32 v97, v97, v8
    v_mul_f32 v98, v98, v8
    v_mul_f32 v99, v99, v8
    v_mul_f32 v100, v100, v8
    v_mul_f32 v101, v101, v8
    v_mul_f32 v102, v102, v8
    v_mul_f32 v103, v103, v8
    v_cvt_pk_bf16_f32 v36, v96, v97
    v_cvt_pk_bf16_f32 v37, v98, v99
    v_cvt_pk_bf16_f32 v38, v100, v101
    v_cvt_pk_bf16_f32 v39, v102, v103
    buffer_store_dwordx4 v[36:39], v3, s[8:11], s42 offen
    s_add_u32 s42, s42, 32768
    v_mul_f32 v9, 0, v104
    v_fma_f32 v9, 0, v105, v9
    v_fma_f32 v9, 0, v106, v9
    v_fma_f32 v9, 0, v107, v9
    v_fma_f32 v9, 0, v108, v9
    v_fma_f32 v9, 0, v109, v9
    v_fma_f32 v9, 0, v110, v9
    v_fma_f32 v9, 0, v111, v9
    v_fma_f32 v9, 0, v112, v9
    v_fma_f32 v9, 0, v113, v9
    v_fma_f32 v9, 0, v114, v9
    v_fma_f32 v9, 0, v115, v9
    v_fma_f32 v9, 0, v116, v9
    v_fma_f32 v9, 0, v117, v9
    v_fma_f32 v9, 0, v118, v9
    v_fma_f32 v9, 0, v119, v9
    v_max_f32 v8, v160, v164
    v_add_f32 v9, v9, v160
    v_add_f32 v9, v9, v164
    s_mov_b32 s40, 1904214016
    v_cmp_nlt_f32 vcc, v9, s40
    s_nop 1
    s_cmp_lg_u64 vcc, 0
    s_cbranch_scc1 K2_FALLBACK1
K2_STORE1:
    v_rcp_f32 v8, v160
    s_nop 0
    v_mul_f32 v8, v8, v6
    v_mul_f32 v104, v104, v8
    v_mul_f32 v105, v105, v8
    v_mul_f32 v106, v106, v8
    v_mul_f32 v107, v107, v8
    v_mul_f32 v108, v108, v8
    v_mul_f32 v109, v109, v8
    v_mul_f32 v110, v110, v8
    v_mul_f32 v111, v111, v8
    v_cvt_pk_bf16_f32 v40, v104, v105
    v_cvt_pk_bf16_f32 v41, v106, v107
    v_cvt_pk_bf16_f32 v42, v108, v109
    v_cvt_pk_bf16_f32 v43, v110, v111
    buffer_store_dwordx4 v[40:43], v3, s[8:11], s42 offen
    s_add_u32 s42, s42, 32768
    v_rcp_f32 v8, v164
    s_nop 0
    v_mul_f32 v8, v8, v7
    v_mul_f32 v112, v112, v8
    v_mul_f32 v113, v113, v8
    v_mul_f32 v114, v114, v8
    v_mul_f32 v115, v115, v8
    v_mul_f32 v116, v116, v8
    v_mul_f32 v117, v117, v8
    v_mul_f32 v118, v118, v8
    v_mul_f32 v119, v119, v8
    v_cvt_pk_bf16_f32 v44, v112, v113
    v_cvt_pk_bf16_f32 v45, v114, v115
    v_cvt_pk_bf16_f32 v46, v116, v117
    v_cvt_pk_bf16_f32 v47, v118, v119
    buffer_store_dwordx4 v[44:47], v3, s[8:11], s42 offen
    s_add_u32 s42, s42, 32768
    s_waitcnt vmcnt(0)
    s_endpgm
K2_FALLBACK0:
    v_mov_b32 v80, 0xff800000
    v_mov_b32 v81, 0xff800000
    s_mov_b32 s35, s44
    s_mov_b32 s37, 64
K2_FB1_0:
    buffer_load_dwordx4 v[120:123], v3, s[8:11], s35 offen
    buffer_load_dwordx4 v[124:127], v3, s[8:11], s35 offen offset:1024
    s_waitcnt vmcnt(0)
    v_mfma_f32_16x16x32_bf16 v[48:51], v[120:123], v[16:19], 0
    v_mfma_f32_16x16x32_bf16 v[52:55], v[124:127], v[16:19], 0
    v_mfma_f32_16x16x32_bf16 v[56:59], v[120:123], v[20:23], 0
    v_mfma_f32_16x16x32_bf16 v[60:63], v[124:127], v[20:23], 0
    s_nop 7
    s_nop 3
    v_max3_f32 v80, v80, v48, v49
    v_max3_f32 v80, v80, v50, v51
    v_max3_f32 v80, v80, v52, v53
    v_max3_f32 v80, v80, v54, v55
    v_max3_f32 v81, v81, v56, v57
    v_max3_f32 v81, v81, v58, v59
    v_max3_f32 v81, v81, v60, v61
    v_max3_f32 v81, v81, v62, v63
    s_add_u32 s35, s35, 4096
    s_sub_u32 s37, s37, 1
    s_cmp_lg_u32 s37, 0
    s_cbranch_scc1 K2_FB1_0
    v_mov_b32 v8, v80
    v_mov_b32 v9, v8
    s_nop 1
    v_permlane32_swap_b32 v8, v9
    v_max_f32 v8, v8, v9
    v_mov_b32 v9, v8
    s_nop 1
    v_permlane16_swap_b32 v8, v9
    v_max_f32 v8, v8, v9
    v_sub_f32 v8, 0, v8
    v_mov_b32 v32, v8
    v_mov_b32 v33, v8
    v_mov_b32 v34, v8
    v_mov_b32 v35, v8
    v_mov_b32 v8, v81
    v_mov_b32 v9, v8
    s_nop 1
    v_permlane32_swap_b32 v8, v9
    v_max_f32 v8, v8, v9
    v_mov_b32 v9, v8
    s_nop 1
    v_permlane16_swap_b32 v8, v9
    v_max_f32 v8, v8, v9
    v_sub_f32 v8, 0, v8
    v_mov_b32 v36, v8
    v_mov_b32 v37, v8
    v_mov_b32 v38, v8
    v_mov_b32 v39, v8
    v_mov_b32 v88, 0
    v_mov_b32 v89, 0
    v_mov_b32 v90, 0
    v_mov_b32 v91, 0
    v_mov_b32 v92, 0
    v_mov_b32 v93, 0
    v_mov_b32 v94, 0
    v_mov_b32 v95, 0
    v_mov_b32 v96, 0
    v_mov_b32 v97, 0
    v_mov_b32 v98, 0
    v_mov_b32 v99, 0
    v_mov_b32 v100, 0
    v_mov_b32 v101, 0
    v_mov_b32 v102, 0
    v_mov_b32 v103, 0
    v_mov_b32 v152, 0
    v_mov_b32 v153, 0
    v_mov_b32 v154, 0
    v_mov_b32 v155, 0
    v_mov_b32 v156, 0
    v_mov_b32 v157, 0
    v_mov_b32 v158, 0
    v_mov_b32 v159, 0
    s_mov_b32 s35, s44
    s_mov_b32 s37, 64
K2_FB2_0:
    buffer_load_dwordx4 v[120:123], v3, s[8:11], s35 offen
    buffer_load_dwordx4 v[124:127], v3, s[8:11], s35 offen offset:1024
    buffer_load_dwordx4 v[136:139], v3, s[8:11], s35 offen offset:2048
    buffer_load_dwordx4 v[140:143], v3, s[8:11], s35 offen offset:3072
    s_waitcnt vmcnt(0)
    v_mfma_f32_16x16x32_bf16 v[48:51], v[120:123], v[16:19], v[32:35]
    v_mfma_f32_16x16x32_bf16 v[52:55], v[124:127], v[16:19], v[32:35]
    v_mfma_f32_16x16x32_bf16 v[56:59], v[120:123], v[20:23], v[36:39]
    v_mfma_f32_16x16x32_bf16 v[60:63], v[124:127], v[20:23], v[36:39]
    s_nop 7
    s_nop 3
    v_exp_f32 v48, v48
    v_exp_f32 v49, v49
    v_exp_f32 v50, v50
    v_exp_f32 v51, v51
    v_exp_f32 v52, v52
    v_exp_f32 v53, v53
    v_exp_f32 v54, v54
    v_exp_f32 v55, v55
    v_exp_f32 v56, v56
    v_exp_f32 v57, v57
    v_exp_f32 v58, v58
    v_exp_f32 v59, v59
    v_exp_f32 v60, v60
    v_exp_f32 v61, v61
    v_exp_f32 v62, v62
    v_exp_f32 v63, v63
    s_nop 0
    v_cvt_pk_bf16_f32 v80, v48, v49
    v_cvt_pk_bf16_f32 v81, v50, v51
    v_cvt_pk_bf16_f32 v82, v52, v53
    v_cvt_pk_bf16_f32 v83, v54, v55
    v_cvt_pk_bf16_f32 v84, v56, v57
    v_cvt_pk_bf16_f32 v85, v58, v59
    v_cvt_pk_bf16_f32 v86, v60, v61
    v_cvt_pk_bf16_f32 v87, v62, v63
    s_nop 1
    v_mfma_f32_16x16x32_bf16 v[88:91], v[136:139], v[80:83], v[88:91]
    v_mfma_f32_16x16x32_bf16 v[92:95], v[140:143], v[80:83], v[92:95]
    v_mfma_f32_16x16x32_bf16 v[152:155], v[12:15], v[80:83], v[152:155]
    v_mfma_f32_16x16x32_bf16 v[96:99], v[136:139], v[84:87], v[96:99]
    v_mfma_f32_16x16x32_bf16 v[100:103], v[140:143], v[84:87], v[100:103]
    v_mfma_f32_16x16x32_bf16 v[156:159], v[12:15], v[84:87], v[156:159]
    s_add_u32 s35, s35, 4096
    s_sub_u32 s37, s37, 1
    s_cmp_lg_u32 s37, 0
    s_cbranch_scc1 K2_FB2_0
    s_nop 7
    s_nop 3
    s_branch K2_STORE0
K2_FALLBACK1:
    v_mov_b32 v80, 0xff800000
    v_mov_b32 v81, 0xff800000
    s_mov_b32 s35, s44
    s_mov_b32 s37, 64
K2_FB1_1:
    buffer_load_dwordx4 v[120:123], v3, s[8:11], s35 offen
    buffer_load_dwordx4 v[124:127], v3, s[8:11], s35 offen offset:1024
    s_waitcnt vmcnt(0)
    v_mfma_f32_16x16x32_bf16 v[64:67], v[120:123], v[24:27], 0
    v_mfma_f32_16x16x32_bf16 v[68:71], v[124:127], v[24:27], 0
    v_mfma_f32_16x16x32_bf16 v[72:75], v[120:123], v[28:31], 0
    v_mfma_f32_16x16x32_bf16 v[76:79], v[124:127], v[28:31], 0
    s_nop 7
    s_nop 3
    v_max3_f32 v80, v80, v64, v65
    v_max3_f32 v80, v80, v66, v67
    v_max3_f32 v80, v80, v68, v69
    v_max3_f32 v80, v80, v70, v71
    v_max3_f32 v81, v81, v72, v73
    v_max3_f32 v81, v81, v74, v75
    v_max3_f32 v81, v81, v76, v77
    v_max3_f32 v81, v81, v78, v79
    s_add_u32 s35, s35, 4096
    s_sub_u32 s37, s37, 1
    s_cmp_lg_u32 s37, 0
    s_cbranch_scc1 K2_FB1_1
    v_mov_b32 v8, v80
    v_mov_b32 v9, v8
    s_nop 1
    v_permlane32_swap_b32 v8, v9
    v_max_f32 v8, v8, v9
    v_mov_b32 v9, v8
    s_nop 1
    v_permlane16_swap_b32 v8, v9
    v_max_f32 v8, v8, v9
    v_sub_f32 v8, 0, v8
    v_mov_b32 v40, v8
    v_mov_b32 v41, v8
    v_mov_b32 v42, v8
    v_mov_b32 v43, v8
    v_mov_b32 v8, v81
    v_mov_b32 v9, v8
    s_nop 1
    v_permlane32_swap_b32 v8, v9
    v_max_f32 v8, v8, v9
    v_mov_b32 v9, v8
    s_nop 1
    v_permlane16_swap_b32 v8, v9
    v_max_f32 v8, v8, v9
    v_sub_f32 v8, 0, v8
    v_mov_b32 v44, v8
    v_mov_b32 v45, v8
    v_mov_b32 v46, v8
    v_mov_b32 v47, v8
    v_mov_b32 v104, 0
    v_mov_b32 v105, 0
    v_mov_b32 v106, 0
    v_mov_b32 v107, 0
    v_mov_b32 v108, 0
    v_mov_b32 v109, 0
    v_mov_b32 v110, 0
    v_mov_b32 v111, 0
    v_mov_b32 v112, 0
    v_mov_b32 v113, 0
    v_mov_b32 v114, 0
    v_mov_b32 v115, 0
    v_mov_b32 v116, 0
    v_mov_b32 v117, 0
    v_mov_b32 v118, 0
    v_mov_b32 v119, 0
    v_mov_b32 v160, 0
    v_mov_b32 v161, 0
    v_mov_b32 v162, 0
    v_mov_b32 v163, 0
    v_mov_b32 v164, 0
    v_mov_b32 v165, 0
    v_mov_b32 v166, 0
    v_mov_b32 v167, 0
    s_mov_b32 s35, s44
    s_mov_b32 s37, 64
K2_FB2_1:
    buffer_load_dwordx4 v[120:123], v3, s[8:11], s35 offen
    buffer_load_dwordx4 v[124:127], v3, s[8:11], s35 offen offset:1024
    buffer_load_dwordx4 v[136:139], v3, s[8:11], s35 offen offset:2048
    buffer_load_dwordx4 v[140:143], v3, s[8:11], s35 offen offset:3072
    s_waitcnt vmcnt(0)
    v_mfma_f32_16x16x32_bf16 v[64:67], v[120:123], v[24:27], v[40:43]
    v_mfma_f32_16x16x32_bf16 v[68:71], v[124:127], v[24:27], v[40:43]
    v_mfma_f32_16x16x32_bf16 v[72:75], v[120:123], v[28:31], v[44:47]
    v_mfma_f32_16x16x32_bf16 v[76:79], v[124:127], v[28:31], v[44:47]
    s_nop 7
    s_nop 3
    v_exp_f32 v64, v64
    v_exp_f32 v65, v65
    v_exp_f32 v66, v66
    v_exp_f32 v67, v67
    v_exp_f32 v68, v68
    v_exp_f32 v69, v69
    v_exp_f32 v70, v70
    v_exp_f32 v71, v71
    v_exp_f32 v72, v72
    v_exp_f32 v73, v73
    v_exp_f32 v74, v74
    v_exp_f32 v75, v75
    v_exp_f32 v76, v76
    v_exp_f32 v77, v77
    v_exp_f32 v78, v78
    v_exp_f32 v79, v79
    s_nop 0
    v_cvt_pk_bf16_f32 v80, v64, v65
    v_cvt_pk_bf16_f32 v81, v66, v67
    v_cvt_pk_bf16_f32 v82, v68, v69
    v_cvt_pk_bf16_f32 v83, v70, v71
    v_cvt_pk_bf16_f32 v84, v72, v73
    v_cvt_pk_bf16_f32 v85, v74, v75
    v_cvt_pk_bf16_f32 v86, v76, v77
    v_cvt_pk_bf16_f32 v87, v78, v79
    s_nop 1
    v_mfma_f32_16x16x32_bf16 v[104:107], v[136:139], v[80:83], v[104:107]
    v_mfma_f32_16x16x32_bf16 v[108:111], v[140:143], v[80:83], v[108:111]
    v_mfma_f32_16x16x32_bf16 v[160:163], v[12:15], v[80:83], v[160:163]
    v_mfma_f32_16x16x32_bf16 v[112:115], v[136:139], v[84:87], v[112:115]
    v_mfma_f32_16x16x32_bf16 v[116:119], v[140:143], v[84:87], v[116:119]
    v_mfma_f32_16x16x32_bf16 v[164:167], v[12:15], v[84:87], v[164:167]
    s_add_u32 s35, s35, 4096
    s_sub_u32 s37, s37, 1
    s_cmp_lg_u32 s37, 0
    s_cbranch_scc1 K2_FB2_1
    s_nop 7
    s_nop 3
    s_branch K2_STORE1
K23_GEMM:
    s_sub_u32 s3, s2, 256
    s_load_dwordx4 s[48:51], s[0:1], 8
    s_load_dwordx2 s[60:61], s[0:1], 88
    v_and_b32 v1, 63, v0
    v_lshrrev_b32 v2, 6, v0
    v_lshlrev_b32 v12, 4, v1
    v_readfirstlane_b32 s32, v2
    s_and_b32 s33, s3, 1
    s_bfe_u32 s44, s3, 0x20001
    s_lshl_b32 s34, s44, 2
    s_bfe_u32 s44, s3, 0x20003
    s_add_u32 s34, s34, s44
    s_lshr_b32 s35, s3, 5
    s_lshl_b32 s40, s35, 2
    v_lshrrev_b32 v2, 3, v1
    v_and_b32 v3, 7, v1
    v_lshrrev_b32 v4, 4, v1
    v_xor_b32 v3, v3, v4
    v_xor_b32 v4, 4, v3
    v_lshlrev_b32 v3, 4, v3
    v_lshlrev_b32 v4, 4, v4
    v_lshl_add_u32 v3, v2, 12, v3
    v_lshl_add_u32 v4, v2, 12, v4
    s_lshl_b32 s44, s34, 7
    s_lshl_b32 s45, s32, 5
    s_add_u32 s44, s44, s45
    s_lshl_b32 s44, s44, 12
    s_add_u32 s45, s44, 0
    v_add_u32 v8, s45, v3
    s_add_u32 s45, s44, 31744
    v_add_u32 v9, s45, v4
    s_add_u32 s45, s44, 65536
    v_add_u32 v10, s45, v3
    s_add_u32 s45, s44, 97280
    v_add_u32 v11, s45, v4
    s_lshl_b32 s44, s33, 5
    s_lshl_b32 s45, s35, 2
    s_add_u32 s44, s44, s45
    s_add_u32 s44, s44, s32
    s_lshl_b32 s41, s44, 17
    s_lshl_b32 s38, s32, 12
    s_lshl_b32 s39, s32, 11
    s_waitcnt lgkmcnt(0)
    s_cmp_eq_u32 s33, 0
    s_cselect_b32 s52, s48, s50
    s_cselect_b32 s53, s49, s51
    s_mov_b32 s8, s52
    s_and_b32 s9, s53, 0xffff
    s_mov_b32 s10, 8388608
    s_mov_b32 s11, 0x00020000
    s_mov_b32 s12, s60
    s_and_b32 s13, s61, 0xffff
    s_mov_b32 s14, 37748736
    s_mov_b32 s15, 0x00020000
    s_add_u32 s36, s40, 0
    s_and_b32 s36, s36, 31
    s_add_u32 m0, s38, 0
    s_lshl_b32 s36, s36, 7
    buffer_load_dwordx4 v8, s[8:11], s36 offen lds
    buffer_load_dwordx4 v9, s[8:11], s36 offen offset:1024 lds
    s_add_u32 s36, s40, 0
    s_and_b32 s36, s36, 31
    s_add_u32 m0, s38, 2048
    s_lshl_b32 s36, s36, 7
    buffer_load_dwordx4 v10, s[8:11], s36 offen lds
    buffer_load_dwordx4 v11, s[8:11], s36 offen offset:1024 lds
    s_add_u32 s37, s40, 0
    s_and_b32 s37, s37, 31
    s_lshl_b32 s37, s37, 12
    s_add_u32 m0, s39, 49152
    s_add_u32 s37, s37, s41
    buffer_load_dwordx4 v12, s[12:15], s37 offen offset:0 lds
    buffer_load_dwordx4 v12, s[12:15], s37 offen offset:1024 lds
    v_and_b32 v2, 15, v1
    v_lshrrev_b32 v3, 4, v1
    v_bfe_u32 v4, v1, 1, 3
    s_and_b32 s44, s32, 1
    s_lshl_b32 s44, s44, 13
    v_add_u32 v5, 0, v3
    v_xor_b32 v5, v5, v4
    v_lshlrev_b32 v5, 4, v5
    v_lshl_add_u32 v5, v2, 7, v5
    v_add_u32 v13, s44, v5
    v_add_u32 v5, 4, v3
    v_xor_b32 v5, v5, v4
    v_lshlrev_b32 v5, 4, v5
    v_lshl_add_u32 v5, v2, 7, v5
    v_add_u32 v14, s44, v5
    s_lshr_b32 s44, s32, 1
    s_lshl_b32 s44, s44, 12
    s_add_u32 s44, s44, 49152
    v_add_u32 v15, s44, v12
    v_lshlrev_b32 v5, 4, v2
    v_lshl_add_u32 v16, v3, 9, v5
    s_waitcnt vmcnt(2)
    s_waitcnt vmcnt(0)
    s_barrier
    ds_read_b128 v[112:115], v15 offset:0
    ds_read_b128 v[116:119], v15 offset:1024
    ds_read_b128 v[120:123], v15 offset:2048
    ds_read_b128 v[124:127], v15 offset:3072
    ds_read_b128 v[96:99], v13 offset:0
    ds_read_b128 v[100:103], v13 offset:2048
    ds_read_b128 v[104:107], v13 offset:4096
    ds_read_b128 v[108:111], v13 offset:6144
    s_add_u32 s37, s40, 0
    s_and_b32 s37, s37, 31
    s_lshl_b32 s37, s37, 12
    s_add_u32 m0, s39, 55296
    s_add_u32 s37, s37, s41
    buffer_load_dwordx4 v12, s[12:15], s37 offen offset:2048 lds
    buffer_load_dwordx4 v12, s[12:15], s37 offen offset:3072 lds
    s_add_u32 s36, s40, 1
    s_and_b32 s36, s36, 31
    s_add_u32 m0, s38, 16384
    s_lshl_b32 s36, s36, 7
    buffer_load_dwordx4 v8, s[8:11], s36 offen lds
    buffer_load_dwordx4 v9, s[8:11], s36 offen offset:1024 lds
    s_add_u32 s36, s40, 1
    s_and_b32 s36, s36, 31
    s_add_u32 m0, s38, 18432
    s_lshl_b32 s36, s36, 7
    buffer_load_dwordx4 v10, s[8:11], s36 offen lds
    buffer_load_dwordx4 v11, s[8:11], s36 offen offset:1024 lds
    s_add_u32 s37, s40, 1
    s_and_b32 s37, s37, 31
    s_lshl_b32 s37, s37, 12
    s_add_u32 m0, s39, 65536
    s_add_u32 s37, s37, s41
    buffer_load_dwordx4 v12, s[12:15], s37 offen offset:0 lds
    buffer_load_dwordx4 v12, s[12:15], s37 offen offset:1024 lds
    s_add_u32 s36, s40, 2
    s_and_b32 s36, s36, 31
    s_add_u32 m0, s38, 32768
    s_lshl_b32 s36, s36, 7
    buffer_load_dwordx4 v8, s[8:11], s36 offen lds
    buffer_load_dwordx4 v9, s[8:11], s36 offen offset:1024 lds
    s_add_u32 s37, s40, 1
    s_and_b32 s37, s37, 31
    s_lshl_b32 s37, s37, 12
    s_add_u32 m0, s39, 71680
    s_add_u32 s37, s37, s41
    buffer_load_dwordx4 v12, s[12:15], s37 offen offset:2048 lds
    buffer_load_dwordx4 v12, s[12:15], s37 offen offset:3072 lds
    s_waitcnt lgkmcnt(0)
    s_waitcnt vmcnt(10)
    s_barrier
    v_mfma_f32_16x16x32_bf16 v[32:35], v[112:115], v[96:99], 0
    ds_read_b128 v[144:147], v15 offset:8192
    ds_read_b128 v[148:151], v15 offset:9216
    v_mfma_f32_16x16x32_bf16 v[36:39], v[116:119], v[96:99], 0
    ds_read_b128 v[152:155], v15 offset:10240
    ds_read_b128 v[156:159], v15 offset:11264
    v_mfma_f32_16x16x32_bf16 v[40:43], v[120:123], v[96:99], 0
    ds_read_b128 v[128:131], v14 offset:0
    ds_read_b128 v[132:135], v14 offset:2048
    v_mfma_f32_16x16x32_bf16 v[44:47], v[124:127], v[96:99], 0
    ds_read_b128 v[136:139], v14 offset:4096
    ds_read_b128 v[140:143], v14 offset:6144
    v_mfma_f32_16x16x32_bf16 v[48:51], v[112:115], v[100:103], 0
    s_add_u32 s36, s40, 2
    s_and_b32 s36, s36, 31
    v_mfma_f32_16x16x32_bf16 v[52:55], v[116:119], v[100:103], 0
    s_add_u32 m0, s38, 34816
    s_lshl_b32 s36, s36, 7
    v_mfma_f32_16x16x32_bf16 v[56:59], v[120:123], v[100:103], 0
    buffer_load_dwordx4 v10, s[8:11], s36 offen lds
    buffer_load_dwordx4 v11, s[8:11], s36 offen offset:1024 lds
    v_mfma_f32_16x16x32_bf16 v[60:63], v[124:127], v[100:103], 0
    s_add_u32 s37, s40, 2
    s_and_b32 s37, s37, 31
    v_mfma_f32_16x16x32_bf16 v[64:67], v[112:115], v[104:107], 0
    s_lshl_b32 s37, s37, 12
    s_add_u32 m0, s39, 49152
    v_mfma_f32_16x16x32_bf16 v[68:71], v[116:119], v[104:107], 0
    s_add_u32 s37, s37, s41
    buffer_load_dwordx4 v12, s[12:15], s37 offen offset:0 lds
    v_mfma_f32_16x16x32_bf16 v[72:75], v[120:123], v[104:107], 0
    buffer_load_dwordx4 v12, s[12:15], s37 offen offset:1024 lds
    v_mfma_f32_16x16x32_bf16 v[76:79], v[124:127], v[104:107], 0
    v_mfma_f32_16x16x32_bf16 v[80:83], v[112:115], v[108:111], 0
    v_mfma_f32_16x16x32_bf16 v[84:87], v[116:119], v[108:111], 0
    v_mfma_f32_16x16x32_bf16 v[88:91], v[120:123], v[108:111], 0
    v_mfma_f32_16x16x32_bf16 v[92:95], v[124:127], v[108:111], 0
    s_waitcnt lgkmcnt(0)
    s_waitcnt vmcnt(10)
    s_waitcnt vmcnt(8)
    s_barrier
    v_mfma_f32_16x16x32_bf16 v[32:35], v[144:147], v[128:131], v[32:35]
    ds_read_b128 v[112:115], v15 offset:16384
    ds_read_b128 v[116:119], v15 offset:17408
    v_mfma_f32_16x16x32_bf16 v[36:39], v[148:151], v[128:131], v[36:39]
    ds_read_b128 v[120:123], v15 offset:18432
    ds_read_b128 v[124:127], v15 offset:19456
    v_mfma_f32_16x16x32_bf16 v[40:43], v[152:155], v[128:131], v[40:43]
    ds_read_b128 v[96:99], v13 offset:16384
    ds_read_b128 v[100:103], v13 offset:18432
    v_mfma_f32_16x16x32_bf16 v[44:47], v[156:159], v[128:131], v[44:47]
    ds_read_b128 v[104:107], v13 offset:20480
    ds_read_b128 v[108:111], v13 offset:22528
    v_mfma_f32_16x16x32_bf16 v[48:51], v[144:147], v[132:135], v[48:51]
    s_add_u32 s36, s40, 3
    s_and_b32 s36, s36, 31
    v_mfma_f32_16x16x32_bf16 v[52:55], v[148:151], v[132:135], v[52:55]
    s_add_u32 m0, s38, 0
    s_lshl_b32 s36, s36, 7
    v_mfma_f32_16x16x32_bf16 v[56:59], v[152:155], v[132:135], v[56:59]
    buffer_load_dwordx4 v8, s[8:11], s36 offen lds
    buffer_load_dwordx4 v9, s[8:11], s36 offen offset:1024 lds
    v_mfma_f32_16x16x32_bf16 v[60:63], v[156:159], v[132:135], v[60:63]
    s_add_u32 s37, s40, 2
    s_and_b32 s37, s37, 31
    v_mfma_f32_16x16x32_bf16 v[64:67], v[144:147], v[136:139], v[64:67]
    s_lshl_b32 s37, s37, 12
    s_add_u32 m0, s39, 55296
    v_mfma_f32_16x16x32_bf16 v[68:71], v[148:151], v[136:139], v[68:71]
    s_add_u32 s37, s37, s41
    buffer_load_dwordx4 v12, s[12:15], s37 offen offset:2048 lds
    v_mfma_f32_16x16x32_bf16 v[72:75], v[152:155], v[136:139], v[72:75]
    buffer_load_dwordx4 v12, s[12:15], s37 offen offset:3072 lds
    v_mfma_f32_16x16x32_bf16 v[76:79], v[156:159], v[136:139], v[76:79]
    v_mfma_f32_16x16x32_bf16 v[80:83], v[144:147], v[140:143], v[80:83]
    v_mfma_f32_16x16x32_bf16 v[84:87], v[148:151], v[140:143], v[84:87]
    v_mfma_f32_16x16x32_bf16 v[88:91], v[152:155], v[140:143], v[88:91]
    v_mfma_f32_16x16x32_bf16 v[92:95], v[156:159], v[140:143], v[92:95]
    s_waitcnt lgkmcnt(0)
    s_waitcnt vmcnt(8)
    s_barrier
    v_mfma_f32_16x16x32_bf16 v[32:35], v[112:115], v[96:99], v[32:35]
    ds_read_b128 v[144:147], v15 offset:24576
    ds_read_b128 v[148:151], v15 offset:25600
    v_mfma_f32_16x16x32_bf16 v[36:39], v[116:119], v[96:99], v[36:39]
    ds_read_b128 v[152:155], v15 offset:26624
    ds_read_b128 v[156:159], v15 offset:27648
    v_mfma_f32_16x16x32_bf16 v[40:43], v[120:123], v[96:99], v[40:43]
    ds_read_b128 v[128:131], v14 offset:16384
    ds_read_b128 v[132:135], v14 offset:18432
    v_mfma_f32_16x16x32_bf16 v[44:47], v[124:127], v[96:99], v[44:47]
    ds_read_b128 v[136:139], v14 offset:20480
    ds_read_b128 v[140:143], v14 offset:22528
    v_mfma_f32_16x16x32_bf16 v[48:51], v[112:115], v[100:103], v[48:51]
    s_add_u32 s36, s40, 3
    s_and_b32 s36, s36, 31
    v_mfma_f32_16x16x32_bf16 v[52:55], v[116:119], v[100:103], v[52:55]
    s_add_u32 m0, s38, 2048
    s_lshl_b32 s36, s36, 7
    v_mfma_f32_16x16x32_bf16 v[56:59], v[120:123], v[100:103], v[56:59]
    buffer_load_dwordx4 v10, s[8:11], s36 offen lds
    buffer_load_dwordx4 v11, s[8:11], s36 offen offset:1024 lds
    v_mfma_f32_16x16x32_bf16 v[60:63], v[124:127], v[100:103], v[60:63]
    s_add_u32 s37, s40, 3
    s_and_b32 s37, s37, 31
    v_mfma_f32_16x16x32_bf16 v[64:67], v[112:115], v[104:107], v[64:67]
    s_lshl_b32 s37, s37, 12
    s_add_u32 m0, s39, 65536
    v_mfma_f32_16x16x32_bf16 v[68:71], v[116:119], v[104:107], v[68:71]
    s_add_u32 s37, s37, s41
    buffer_load_dwordx4 v12, s[12:15], s37 offen offset:0 lds
    v_mfma_f32_16x16x32_bf16 v[72:75], v[120:123], v[104:107], v[72:75]
    buffer_load_dwordx4 v12, s[12:15], s37 offen offset:1024 lds
    v_mfma_f32_16x16x32_bf16 v[76:79], v[124:127], v[104:107], v[76:79]
    v_mfma_f32_16x16x32_bf16 v[80:83], v[112:115], v[108:111], v[80:83]
    v_mfma_f32_16x16x32_bf16 v[84:87], v[116:119], v[108:111], v[84:87]
    v_mfma_f32_16x16x32_bf16 v[88:91], v[120:123], v[108:111], v[88:91]
    v_mfma_f32_16x16x32_bf16 v[92:95], v[124:127], v[108:111], v[92:95]
    s_waitcnt lgkmcnt(0)
    s_waitcnt vmcnt(10)
    s_waitcnt vmcnt(8)
    s_barrier
    v_mfma_f32_16x16x32_bf16 v[32:35], v[144:147], v[128:131], v[32:35]
    ds_read_b128 v[112:115], v15 offset:0
    ds_read_b128 v[116:119], v15 offset:1024
    v_mfma_f32_16x16x32_bf16 v[36:39], v[148:151], v[128:131], v[36:39]
    ds_read_b128 v[120:123], v15 offset:2048
    ds_read_b128 v[124:127], v15 offset:3072
    v_mfma_f32_16x16x32_bf16 v[40:43], v[152:155], v[128:131], v[40:43]
    ds_read_b128 v[96:99], v13 offset:32768
    ds_read_b128 v[100:103], v13 offset:34816
    v_mfma_f32_16x16x32_bf16 v[44:47], v[156:159], v[128:131], v[44:47]
    ds_read_b128 v[104:107], v13 offset:36864
    ds_read_b128 v[108:111], v13 offset:38912
    v_mfma_f32_16x16x32_bf16 v[48:51], v[144:147], v[132:135], v[48:51]
    s_add_u32 s36, s40, 4
    s_and_b32 s36, s36, 31
    v_mfma_f32_16x16x32_bf16 v[52:55], v[148:151], v[132:135], v[52:55]
    s_add_u32 m0, s38, 16384
    s_lshl_b32 s36, s36, 7
    v_mfma_f32_16x16x32_bf16 v[56:59], v[152:155], v[132:135], v[56:59]
    buffer_load_dwordx4 v8, s[8:11], s36 offen lds
    buffer_load_dwordx4 v9, s[8:11], s36 offen offset:1024 lds
    v_mfma_f32_16x16x32_bf16 v[60:63], v[156:159], v[132:135], v[60:63]
    s_add_u32 s37, s40, 3
    s_and_b32 s37, s37, 31
    v_mfma_f32_16x16x32_bf16 v[64:67], v[144:147], v[136:139], v[64:67]
    s_lshl_b32 s37, s37, 12
    s_add_u32 m0, s39, 71680
    v_mfma_f32_16x16x32_bf16 v[68:71], v[148:151], v[136:139], v[68:71]
    s_add_u32 s37, s37, s41
    buffer_load_dwordx4 v12, s[12:15], s37 offen offset:2048 lds
    v_mfma_f32_16x16x32_bf16 v[72:75], v[152:155], v[136:139], v[72:75]
    buffer_load_dwordx4 v12, s[12:15], s37 offen offset:3072 lds
    v_mfma_f32_16x16x32_bf16 v[76:79], v[156:159], v[136:139], v[76:79]
    v_mfma_f32_16x16x32_bf16 v[80:83], v[144:147], v[140:143], v[80:83]
    v_mfma_f32_16x16x32_bf16 v[84:87], v[148:151], v[140:143], v[84:87]
    v_mfma_f32_16x16x32_bf16 v[88:91], v[152:155], v[140:143], v[88:91]
    v_mfma_f32_16x16x32_bf16 v[92:95], v[156:159], v[140:143], v[92:95]
    s_waitcnt lgkmcnt(0)
    s_waitcnt vmcnt(8)
    s_barrier
    v_mfma_f32_16x16x32_bf16 v[32:35], v[112:115], v[96:99], v[32:35]
    ds_read_b128 v[144:147], v15 offset:8192
    ds_read_b128 v[148:151], v15 offset:9216
    v_mfma_f32_16x16x32_bf16 v[36:39], v[116:119], v[96:99], v[36:39]
    ds_read_b128 v[152:155], v15 offset:10240
    ds_read_b128 v[156:159], v15 offset:11264
    v_mfma_f32_16x16x32_bf16 v[40:43], v[120:123], v[96:99], v[40:43]
    ds_read_b128 v[128:131], v14 offset:32768
    ds_read_b128 v[132:135], v14 offset:34816
    v_mfma_f32_16x16x32_bf16 v[44:47], v[124:127], v[96:99], v[44:47]
    ds_read_b128 v[136:139], v14 offset:36864
    ds_read_b128 v[140:143], v14 offset:38912
    v_mfma_f32_16x16x32_bf16 v[48:51], v[112:115], v[100:103], v[48:51]
    s_add_u32 s36, s40, 4
    s_and_b32 s36, s36, 31
    v_mfma_f32_16x16x32_bf16 v[52:55], v[116:119], v[100:103], v[52:55]
    s_add_u32 m0, s38, 18432
    s_lshl_b32 s36, s36, 7
    v_mfma_f32_16x16x32_bf16 v[56:59], v[120:123], v[100:103], v[56:59]
    buffer_load_dwordx4 v10, s[8:11], s36 offen lds
    buffer_load_dwordx4 v11, s[8:11], s36 offen offset:1024 lds
    v_mfma_f32_16x16x32_bf16 v[60:63], v[124:127], v[100:103], v[60:63]
    s_add_u32 s37, s40, 4
    s_and_b32 s37, s37, 31
    v_mfma_f32_16x16x32_bf16 v[64:67], v[112:115], v[104:107], v[64:67]
    s_lshl_b32 s37, s37, 12
    s_add_u32 m0, s39, 49152
    v_mfma_f32_16x16x32_bf16 v[68:71], v[116:119], v[104:107], v[68:71]
    s_add_u32 s37, s37, s41
    buffer_load_dwordx4 v12, s[12:15], s37 offen offset:0 lds
    v_mfma_f32_16x16x32_bf16 v[72:75], v[120:123], v[104:107], v[72:75]
    buffer_load_dwordx4 v12, s[12:15], s37 offen offset:1024 lds
    v_mfma_f32_16x16x32_bf16 v[76:79], v[124:127], v[104:107], v[76:79]
    v_mfma_f32_16x16x32_bf16 v[80:83], v[112:115], v[108:111], v[80:83]
    v_mfma_f32_16x16x32_bf16 v[84:87], v[116:119], v[108:111], v[84:87]
    v_mfma_f32_16x16x32_bf16 v[88:91], v[120:123], v[108:111], v[88:91]
    v_mfma_f32_16x16x32_bf16 v[92:95], v[124:127], v[108:111], v[92:95]
    s_waitcnt lgkmcnt(0)
    s_waitcnt vmcnt(10)
    s_waitcnt vmcnt(8)
    s_barrier
    v_mfma_f32_16x16x32_bf16 v[32:35], v[144:147], v[128:131], v[32:35]
    ds_read_b128 v[112:115], v15 offset:16384
    ds_read_b128 v[116:119], v15 offset:17408
    v_mfma_f32_16x16x32_bf16 v[36:39], v[148:151], v[128:131], v[36:39]
    ds_read_b128 v[120:123], v15 offset:18432
    ds_read_b128 v[124:127], v15 offset:19456
    v_mfma_f32_16x16x32_bf16 v[40:43], v[152:155], v[128:131], v[40:43]
    ds_read_b128 v[96:99], v13 offset:0
    ds_read_b128 v[100:103], v13 offset:2048
    v_mfma_f32_16x16x32_bf16 v[44:47], v[156:159], v[128:131], v[44:47]
    ds_read_b128 v[104:107], v13 offset:4096
    ds_read_b128 v[108:111], v13 offset:6144
    v_mfma_f32_16x16x32_bf16 v[48:51], v[144:147], v[132:135], v[48:51]
    s_add_u32 s36, s40, 5
    s_and_b32 s36, s36, 31
    v_mfma_f32_16x16x32_bf16 v[52:55], v[148:151], v[132:135], v[52:55]
    s_add_u32 m0, s38, 32768
    s_lshl_b32 s36, s36, 7
    v_mfma_f32_16x16x32_bf16 v[56:59], v[152:155], v[132:135], v[56:59]
    buffer_load_dwordx4 v8, s[8:11], s36 offen lds
    buffer_load_dwordx4 v9, s[8:11], s36 offen offset:1024 lds
    v_mfma_f32_16x16x32_bf16 v[60:63], v[156:159], v[132:135], v[60:63]
    s_add_u32 s37, s40, 4
    s_and_b32 s37, s37, 31
    v_mfma_f32_16x16x32_bf16 v[64:67], v[144:147], v[136:139], v[64:67]
    s_lshl_b32 s37, s37, 12
    s_add_u32 m0, s39, 55296
    v_mfma_f32_16x16x32_bf16 v[68:71], v[148:151], v[136:139], v[68:71]
    s_add_u32 s37, s37, s41
    buffer_load_dwordx4 v12, s[12:15], s37 offen offset:2048 lds
    v_mfma_f32_16x16x32_bf16 v[72:75], v[152:155], v[136:139], v[72:75]
    buffer_load_dwordx4 v12, s[12:15], s37 offen offset:3072 lds
    v_mfma_f32_16x16x32_bf16 v[76:79], v[156:159], v[136:139], v[76:79]
    v_mfma_f32_16x16x32_bf16 v[80:83], v[144:147], v[140:143], v[80:83]
    v_mfma_f32_16x16x32_bf16 v[84:87], v[148:151], v[140:143], v[84:87]
    v_mfma_f32_16x16x32_bf16 v[88:91], v[152:155], v[140:143], v[88:91]
    v_mfma_f32_16x16x32_bf16 v[92:95], v[156:159], v[140:143], v[92:95]
    s_waitcnt lgkmcnt(0)
    s_waitcnt vmcnt(8)
    s_barrier
    v_mfma_f32_16x16x32_bf16 v[32:35], v[112:115], v[96:99], v[32:35]
    ds_read_b128 v[144:147], v15 offset:24576
    ds_read_b128 v[148:151], v15 offset:25600
    v_mfma_f32_16x16x32_bf16 v[36:39], v[116:119], v[96:99], v[36:39]
    ds_read_b128 v[152:155], v15 offset:26624
    ds_read_b128 v[156:159], v15 offset:27648
    v_mfma_f32_16x16x32_bf16 v[40:43], v[120:123], v[96:99], v[40:43]
    ds_read_b128 v[128:131], v14 offset:0
    ds_read_b128 v[132:135], v14 offset:2048
    v_mfma_f32_16x16x32_bf16 v[44:47], v[124:127], v[96:99], v[44:47]
    ds_read_b128 v[136:139], v14 offset:4096
    ds_read_b128 v[140:143], v14 offset:6144
    v_mfma_f32_16x16x32_bf16 v[48:51], v[112:115], v[100:103], v[48:51]
    s_add_u32 s36, s40, 5
    s_and_b32 s36, s36, 31
    v_mfma_f32_16x16x32_bf16 v[52:55], v[116:119], v[100:103], v[52:55]
    s_add_u32 m0, s38, 34816
    s_lshl_b32 s36, s36, 7
    v_mfma_f32_16x16x32_bf16 v[56:59], v[120:123], v[100:103], v[56:59]
    buffer_load_dwordx4 v10, s[8:11], s36 offen lds
    buffer_load_dwordx4 v11, s[8:11], s36 offen offset:1024 lds
    v_mfma_f32_16x16x32_bf16 v[60:63], v[124:127], v[100:103], v[60:63]
    s_add_u32 s37, s40, 5
    s_and_b32 s37, s37, 31
    v_mfma_f32_16x16x32_bf16 v[64:67], v[112:115], v[104:107], v[64:67]
    s_lshl_b32 s37, s37, 12
    s_add_u32 m0, s39, 65536
    v_mfma_f32_16x16x32_bf16 v[68:71], v[116:119], v[104:107], v[68:71]
    s_add_u32 s37, s37, s41
    buffer_load_dwordx4 v12, s[12:15], s37 offen offset:0 lds
    v_mfma_f32_16x16x32_bf16 v[72:75], v[120:123], v[104:107], v[72:75]
    buffer_load_dwordx4 v12, s[12:15], s37 offen offset:1024 lds
    v_mfma_f32_16x16x32_bf16 v[76:79], v[124:127], v[104:107], v[76:79]
    v_mfma_f32_16x16x32_bf16 v[80:83], v[112:115], v[108:111], v[80:83]
    v_mfma_f32_16x16x32_bf16 v[84:87], v[116:119], v[108:111], v[84:87]
    v_mfma_f32_16x16x32_bf16 v[88:91], v[120:123], v[108:111], v[88:91]
    v_mfma_f32_16x16x32_bf16 v[92:95], v[124:127], v[108:111], v[92:95]
    s_waitcnt lgkmcnt(0)
    s_waitcnt vmcnt(10)
    s_waitcnt vmcnt(8)
    s_barrier
    v_mfma_f32_16x16x32_bf16 v[32:35], v[144:147], v[128:131], v[32:35]
    ds_read_b128 v[112:115], v15 offset:0
    ds_read_b128 v[116:119], v15 offset:1024
    v_mfma_f32_16x16x32_bf16 v[36:39], v[148:151], v[128:131], v[36:39]
    ds_read_b128 v[120:123], v15 offset:2048
    ds_read_b128 v[124:127], v15 offset:3072
    v_mfma_f32_16x16x32_bf16 v[40:43], v[152:155], v[128:131], v[40:43]
    ds_read_b128 v[96:99], v13 offset:16384
    ds_read_b128 v[100:103], v13 offset:18432
    v_mfma_f32_16x16x32_bf16 v[44:47], v[156:159], v[128:131], v[44:47]
    ds_read_b128 v[104:107], v13 offset:20480
    ds_read_b128 v[108:111], v13 offset:22528
    v_mfma_f32_16x16x32_bf16 v[48:51], v[144:147], v[132:135], v[48:51]
    s_add_u32 s36, s40, 6
    s_and_b32 s36, s36, 31
    v_mfma_f32_16x16x32_bf16 v[52:55], v[148:151], v[132:135], v[52:55]
    s_add_u32 m0, s38, 0
    s_lshl_b32 s36, s36, 7
    v_mfma_f32_16x16x32_bf16 v[56:59], v[152:155], v[132:135], v[56:59]
    buffer_load_dwordx4 v8, s[8:11], s36 offen lds
    buffer_load_dwordx4 v9, s[8:11], s36 offen offset:1024 lds
    v_mfma_f32_16x16x32_bf16 v[60:63], v[156:159], v[132:135], v[60:63]
    s_add_u32 s37, s40, 5
    s_and_b32 s37, s37, 31
    v_mfma_f32_16x16x32_bf16 v[64:67], v[144:147], v[136:139], v[64:67]
    s_lshl_b32 s37, s37, 12
    s_add_u32 m0, s39, 71680
    v_mfma_f32_16x16x32_bf16 v[68:71], v[148:151], v[136:139], v[68:71]
    s_add_u32 s37, s37, s41
    buffer_load_dwordx4 v12, s[12:15], s37 offen offset:2048 lds
    v_mfma_f32_16x16x32_bf16 v[72:75], v[152:155], v[136:139], v[72:75]
    buffer_load_dwordx4 v12, s[12:15], s37 offen offset:3072 lds
    v_mfma_f32_16x16x32_bf16 v[76:79], v[156:159], v[136:139], v[76:79]
    v_mfma_f32_16x16x32_bf16 v[80:83], v[144:147], v[140:143], v[80:83]
    v_mfma_f32_16x16x32_bf16 v[84:87], v[148:151], v[140:143], v[84:87]
    v_mfma_f32_16x16x32_bf16 v[88:91], v[152:155], v[140:143], v[88:91]
    v_mfma_f32_16x16x32_bf16 v[92:95], v[156:159], v[140:143], v[92:95]
    s_waitcnt lgkmcnt(0)
    s_waitcnt vmcnt(8)
    s_barrier
    v_mfma_f32_16x16x32_bf16 v[32:35], v[112:115], v[96:99], v[32:35]
    ds_read_b128 v[144:147], v15 offset:8192
    ds_read_b128 v[148:151], v15 offset:9216
    v_mfma_f32_16x16x32_bf16 v[36:39], v[116:119], v[96:99], v[36:39]
    ds_read_b128 v[152:155], v15 offset:10240
    ds_read_b128 v[156:159], v15 offset:11264
    v_mfma_f32_16x16x32_bf16 v[40:43], v[120:123], v[96:99], v[40:43]
    ds_read_b128 v[128:131], v14 offset:16384
    ds_read_b128 v[132:135], v14 offset:18432
    v_mfma_f32_16x16x32_bf16 v[44:47], v[124:127], v[96:99], v[44:47]
    ds_read_b128 v[136:139], v14 offset:20480
    ds_read_b128 v[140:143], v14 offset:22528
    v_mfma_f32_16x16x32_bf16 v[48:51], v[112:115], v[100:103], v[48:51]
    s_add_u32 s36, s40, 6
    s_and_b32 s36, s36, 31
    v_mfma_f32_16x16x32_bf16 v[52:55], v[116:119], v[100:103], v[52:55]
    s_add_u32 m0, s38, 2048
    s_lshl_b32 s36, s36, 7
    v_mfma_f32_16x16x32_bf16 v[56:59], v[120:123], v[100:103], v[56:59]
    buffer_load_dwordx4 v10, s[8:11], s36 offen lds
    buffer_load_dwordx4 v11, s[8:11], s36 offen offset:1024 lds
    v_mfma_f32_16x16x32_bf16 v[60:63], v[124:127], v[100:103], v[60:63]
    s_add_u32 s37, s40, 6
    s_and_b32 s37, s37, 31
    v_mfma_f32_16x16x32_bf16 v[64:67], v[112:115], v[104:107], v[64:67]
    s_lshl_b32 s37, s37, 12
    s_add_u32 m0, s39, 49152
    v_mfma_f32_16x16x32_bf16 v[68:71], v[116:119], v[104:107], v[68:71]
    s_add_u32 s37, s37, s41
    buffer_load_dwordx4 v12, s[12:15], s37 offen offset:0 lds
    v_mfma_f32_16x16x32_bf16 v[72:75], v[120:123], v[104:107], v[72:75]
    buffer_load_dwordx4 v12, s[12:15], s37 offen offset:1024 lds
    v_mfma_f32_16x16x32_bf16 v[76:79], v[124:127], v[104:107], v[76:79]
    v_mfma_f32_16x16x32_bf16 v[80:83], v[112:115], v[108:111], v[80:83]
    v_mfma_f32_16x16x32_bf16 v[84:87], v[116:119], v[108:111], v[84:87]
    v_mfma_f32_16x16x32_bf16 v[88:91], v[120:123], v[108:111], v[88:91]
    v_mfma_f32_16x16x32_bf16 v[92:95], v[124:127], v[108:111], v[92:95]
    s_waitcnt lgkmcnt(0)
    s_waitcnt vmcnt(10)
    s_waitcnt vmcnt(8)
    s_barrier
    v_mfma_f32_16x16x32_bf16 v[32:35], v[144:147], v[128:131], v[32:35]
    ds_read_b128 v[112:115], v15 offset:16384
    ds_read_b128 v[116:119], v15 offset:17408
    v_mfma_f32_16x16x32_bf16 v[36:39], v[148:151], v[128:131], v[36:39]
    ds_read_b128 v[120:123], v15 offset:18432
    ds_read_b128 v[124:127], v15 offset:19456
    v_mfma_f32_16x16x32_bf16 v[40:43], v[152:155], v[128:131], v[40:43]
    ds_read_b128 v[96:99], v13 offset:32768
    ds_read_b128 v[100:103], v13 offset:34816
    v_mfma_f32_16x16x32_bf16 v[44:47], v[156:159], v[128:131], v[44:47]
    ds_read_b128 v[104:107], v13 offset:36864
    ds_read_b128 v[108:111], v13 offset:38912
    v_mfma_f32_16x16x32_bf16 v[48:51], v[144:147], v[132:135], v[48:51]
    s_add_u32 s36, s40, 7
    s_and_b32 s36, s36, 31
    v_mfma_f32_16x16x32_bf16 v[52:55], v[148:151], v[132:135], v[52:55]
    s_add_u32 m0, s38, 16384
    s_lshl_b32 s36, s36, 7
    v_mfma_f32_16x16x32_bf16 v[56:59], v[152:155], v[132:135], v[56:59]
    buffer_load_dwordx4 v8, s[8:11], s36 offen lds
    buffer_load_dwordx4 v9, s[8:11], s36 offen offset:1024 lds
    v_mfma_f32_16x16x32_bf16 v[60:63], v[156:159], v[132:135], v[60:63]
    s_add_u32 s37, s40, 6
    s_and_b32 s37, s37, 31
    v_mfma_f32_16x16x32_bf16 v[64:67], v[144:147], v[136:139], v[64:67]
    s_lshl_b32 s37, s37, 12
    s_add_u32 m0, s39, 55296
    v_mfma_f32_16x16x32_bf16 v[68:71], v[148:151], v[136:139], v[68:71]
    s_add_u32 s37, s37, s41
    buffer_load_dwordx4 v12, s[12:15], s37 offen offset:2048 lds
    v_mfma_f32_16x16x32_bf16 v[72:75], v[152:155], v[136:139], v[72:75]
    buffer_load_dwordx4 v12, s[12:15], s37 offen offset:3072 lds
    v_mfma_f32_16x16x32_bf16 v[76:79], v[156:159], v[136:139], v[76:79]
    v_mfma_f32_16x16x32_bf16 v[80:83], v[144:147], v[140:143], v[80:83]
    v_mfma_f32_16x16x32_bf16 v[84:87], v[148:151], v[140:143], v[84:87]
    v_mfma_f32_16x16x32_bf16 v[88:91], v[152:155], v[140:143], v[88:91]
    v_mfma_f32_16x16x32_bf16 v[92:95], v[156:159], v[140:143], v[92:95]
    s_waitcnt lgkmcnt(0)
    s_waitcnt vmcnt(8)
    s_barrier
    v_mfma_f32_16x16x32_bf16 v[32:35], v[112:115], v[96:99], v[32:35]
    ds_read_b128 v[144:147], v15 offset:24576
    ds_read_b128 v[148:151], v15 offset:25600
    v_mfma_f32_16x16x32_bf16 v[36:39], v[116:119], v[96:99], v[36:39]
    ds_read_b128 v[152:155], v15 offset:26624
    ds_read_b128 v[156:159], v15 offset:27648
    v_mfma_f32_16x16x32_bf16 v[40:43], v[120:123], v[96:99], v[40:43]
    ds_read_b128 v[128:131], v14 offset:32768
    ds_read_b128 v[132:135], v14 offset:34816
    v_mfma_f32_16x16x32_bf16 v[44:47], v[124:127], v[96:99], v[44:47]
    ds_read_b128 v[136:139], v14 offset:36864
    ds_read_b128 v[140:143], v14 offset:38912
    v_mfma_f32_16x16x32_bf16 v[48:51], v[112:115], v[100:103], v[48:51]
    s_add_u32 s36, s40, 7
    s_and_b32 s36, s36, 31
    v_mfma_f32_16x16x32_bf16 v[52:55], v[116:119], v[100:103], v[52:55]
    s_add_u32 m0, s38, 18432
    s_lshl_b32 s36, s36, 7
    v_mfma_f32_16x16x32_bf16 v[56:59], v[120:123], v[100:103], v[56:59]
    buffer_load_dwordx4 v10, s[8:11], s36 offen lds
    buffer_load_dwordx4 v11, s[8:11], s36 offen offset:1024 lds
    v_mfma_f32_16x16x32_bf16 v[60:63], v[124:127], v[100:103], v[60:63]
    s_add_u32 s37, s40, 7
    s_and_b32 s37, s37, 31
    v_mfma_f32_16x16x32_bf16 v[64:67], v[112:115], v[104:107], v[64:67]
    s_lshl_b32 s37, s37, 12
    s_add_u32 m0, s39, 65536
    v_mfma_f32_16x16x32_bf16 v[68:71], v[116:119], v[104:107], v[68:71]
    s_add_u32 s37, s37, s41
    buffer_load_dwordx4 v12, s[12:15], s37 offen offset:0 lds
    v_mfma_f32_16x16x32_bf16 v[72:75], v[120:123], v[104:107], v[72:75]
    buffer_load_dwordx4 v12, s[12:15], s37 offen offset:1024 lds
    v_mfma_f32_16x16x32_bf16 v[76:79], v[124:127], v[104:107], v[76:79]
    v_mfma_f32_16x16x32_bf16 v[80:83], v[112:115], v[108:111], v[80:83]
    v_mfma_f32_16x16x32_bf16 v[84:87], v[116:119], v[108:111], v[84:87]
    v_mfma_f32_16x16x32_bf16 v[88:91], v[120:123], v[108:111], v[88:91]
    v_mfma_f32_16x16x32_bf16 v[92:95], v[124:127], v[108:111], v[92:95]
    s_waitcnt lgkmcnt(0)
    s_waitcnt vmcnt(10)
    s_waitcnt vmcnt(8)
    s_barrier
    v_mfma_f32_16x16x32_bf16 v[32:35], v[144:147], v[128:131], v[32:35]
    ds_read_b128 v[112:115], v15 offset:0
    ds_read_b128 v[116:119], v15 offset:1024
    v_mfma_f32_16x16x32_bf16 v[36:39], v[148:151], v[128:131], v[36:39]
    ds_read_b128 v[120:123], v15 offset:2048
    ds_read_b128 v[124:127], v15 offset:3072
    v_mfma_f32_16x16x32_bf16 v[40:43], v[152:155], v[128:131], v[40:43]
    ds_read_b128 v[96:99], v13 offset:0
    ds_read_b128 v[100:103], v13 offset:2048
    v_mfma_f32_16x16x32_bf16 v[44:47], v[156:159], v[128:131], v[44:47]
    ds_read_b128 v[104:107], v13 offset:4096
    ds_read_b128 v[108:111], v13 offset:6144
    v_mfma_f32_16x16x32_bf16 v[48:51], v[144:147], v[132:135], v[48:51]
    s_add_u32 s36, s40, 8
    s_and_b32 s36, s36, 31
    v_mfma_f32_16x16x32_bf16 v[52:55], v[148:151], v[132:135], v[52:55]
    s_add_u32 m0, s38, 32768
    s_lshl_b32 s36, s36, 7
    v_mfma_f32_16x16x32_bf16 v[56:59], v[152:155], v[132:135], v[56:59]
    buffer_load_dwordx4 v8, s[8:11], s36 offen lds
    buffer_load_dwordx4 v9, s[8:11], s36 offen offset:1024 lds
    v_mfma_f32_16x16x32_bf16 v[60:63], v[156:159], v[132:135], v[60:63]
    s_add_u32 s37, s40, 7
    s_and_b32 s37, s37, 31
    v_mfma_f32_16x16x32_bf16 v[64:67], v[144:147], v[136:139], v[64:67]
    s_lshl_b32 s37, s37, 12
    s_add_u32 m0, s39, 71680
    v_mfma_f32_16x16x32_bf16 v[68:71], v[148:151], v[136:139], v[68:71]
    s_add_u32 s37, s37, s41
    buffer_load_dwordx4 v12, s[12:15], s37 offen offset:2048 lds
    v_mfma_f32_16x16x32_bf16 v[72:75], v[152:155], v[136:139], v[72:75]
    buffer_load_dwordx4 v12, s[12:15], s37 offen offset:3072 lds
    v_mfma_f32_16x16x32_bf16 v[76:79], v[156:159], v[136:139], v[76:79]
    v_mfma_f32_16x16x32_bf16 v[80:83], v[144:147], v[140:143], v[80:83]
    v_mfma_f32_16x16x32_bf16 v[84:87], v[148:151], v[140:143], v[84:87]
    v_mfma_f32_16x16x32_bf16 v[88:91], v[152:155], v[140:143], v[88:91]
    v_mfma_f32_16x16x32_bf16 v[92:95], v[156:159], v[140:143], v[92:95]
    s_waitcnt lgkmcnt(0)
    s_waitcnt vmcnt(8)
    s_barrier
    v_mfma_f32_16x16x32_bf16 v[32:35], v[112:115], v[96:99], v[32:35]
    ds_read_b128 v[144:147], v15 offset:8192
    ds_read_b128 v[148:151], v15 offset:9216
    v_mfma_f32_16x16x32_bf16 v[36:39], v[116:119], v[96:99], v[36:39]
    ds_read_b128 v[152:155], v15 offset:10240
    ds_read_b128 v[156:159], v15 offset:11264
    v_mfma_f32_16x16x32_bf16 v[40:43], v[120:123], v[96:99], v[40:43]
    ds_read_b128 v[128:131], v14 offset:0
    ds_read_b128 v[132:135], v14 offset:2048
    v_mfma_f32_16x16x32_bf16 v[44:47], v[124:127], v[96:99], v[44:47]
    ds_read_b128 v[136:139], v14 offset:4096
    ds_read_b128 v[140:143], v14 offset:6144
    v_mfma_f32_16x16x32_bf16 v[48:51], v[112:115], v[100:103], v[48:51]
    s_add_u32 s36, s40, 8
    s_and_b32 s36, s36, 31
    v_mfma_f32_16x16x32_bf16 v[52:55], v[116:119], v[100:103], v[52:55]
    s_add_u32 m0, s38, 34816
    s_lshl_b32 s36, s36, 7
    v_mfma_f32_16x16x32_bf16 v[56:59], v[120:123], v[100:103], v[56:59]
    buffer_load_dwordx4 v10, s[8:11], s36 offen lds
    buffer_load_dwordx4 v11, s[8:11], s36 offen offset:1024 lds
    v_mfma_f32_16x16x32_bf16 v[60:63], v[124:127], v[100:103], v[60:63]
    s_add_u32 s37, s40, 8
    s_and_b32 s37, s37, 31
    v_mfma_f32_16x16x32_bf16 v[64:67], v[112:115], v[104:107], v[64:67]
    s_lshl_b32 s37, s37, 12
    s_add_u32 m0, s39, 49152
    v_mfma_f32_16x16x32_bf16 v[68:71], v[116:119], v[104:107], v[68:71]
    s_add_u32 s37, s37, s41
    buffer_load_dwordx4 v12, s[12:15], s37 offen offset:0 lds
    v_mfma_f32_16x16x32_bf16 v[72:75], v[120:123], v[104:107], v[72:75]
    buffer_load_dwordx4 v12, s[12:15], s37 offen offset:1024 lds
    v_mfma_f32_16x16x32_bf16 v[76:79], v[124:127], v[104:107], v[76:79]
    v_mfma_f32_16x16x32_bf16 v[80:83], v[112:115], v[108:111], v[80:83]
    v_mfma_f32_16x16x32_bf16 v[84:87], v[116:119], v[108:111], v[84:87]
    v_mfma_f32_16x16x32_bf16 v[88:91], v[120:123], v[108:111], v[88:91]
    v_mfma_f32_16x16x32_bf16 v[92:95], v[124:127], v[108:111], v[92:95]
    s_waitcnt lgkmcnt(0)
    s_waitcnt vmcnt(10)
    s_waitcnt vmcnt(8)
    s_barrier
    v_mfma_f32_16x16x32_bf16 v[32:35], v[144:147], v[128:131], v[32:35]
    ds_read_b128 v[112:115], v15 offset:16384
    ds_read_b128 v[116:119], v15 offset:17408
    v_mfma_f32_16x16x32_bf16 v[36:39], v[148:151], v[128:131], v[36:39]
    ds_read_b128 v[120:123], v15 offset:18432
    ds_read_b128 v[124:127], v15 offset:19456
    v_mfma_f32_16x16x32_bf16 v[40:43], v[152:155], v[128:131], v[40:43]
    ds_read_b128 v[96:99], v13 offset:16384
    ds_read_b128 v[100:103], v13 offset:18432
    v_mfma_f32_16x16x32_bf16 v[44:47], v[156:159], v[128:131], v[44:47]
    ds_read_b128 v[104:107], v13 offset:20480
    ds_read_b128 v[108:111], v13 offset:22528
    v_mfma_f32_16x16x32_bf16 v[48:51], v[144:147], v[132:135], v[48:51]
    s_add_u32 s36, s40, 9
    s_and_b32 s36, s36, 31
    v_mfma_f32_16x16x32_bf16 v[52:55], v[148:151], v[132:135], v[52:55]
    s_add_u32 m0, s38, 0
    s_lshl_b32 s36, s36, 7
    v_mfma_f32_16x16x32_bf16 v[56:59], v[152:155], v[132:135], v[56:59]
    buffer_load_dwordx4 v8, s[8:11], s36 offen lds
    buffer_load_dwordx4 v9, s[8:11], s36 offen offset:1024 lds
    v_mfma_f32_16x16x32_bf16 v[60:63], v[156:159], v[132:135], v[60:63]
    s_add_u32 s37, s40, 8
    s_and_b32 s37, s37, 31
    v_mfma_f32_16x16x32_bf16 v[64:67], v[144:147], v[136:139], v[64:67]
    s_lshl_b32 s37, s37, 12
    s_add_u32 m0, s39, 55296
    v_mfma_f32_16x16x32_bf16 v[68:71], v[148:151], v[136:139], v[68:71]
    s_add_u32 s37, s37, s41
    buffer_load_dwordx4 v12, s[12:15], s37 offen offset:2048 lds
    v_mfma_f32_16x16x32_bf16 v[72:75], v[152:155], v[136:139], v[72:75]
    buffer_load_dwordx4 v12, s[12:15], s37 offen offset:3072 lds
    v_mfma_f32_16x16x32_bf16 v[76:79], v[156:159], v[136:139], v[76:79]
    v_mfma_f32_16x16x32_bf16 v[80:83], v[144:147], v[140:143], v[80:83]
    v_mfma_f32_16x16x32_bf16 v[84:87], v[148:151], v[140:143], v[84:87]
    v_mfma_f32_16x16x32_bf16 v[88:91], v[152:155], v[140:143], v[88:91]
    v_mfma_f32_16x16x32_bf16 v[92:95], v[156:159], v[140:143], v[92:95]
    s_waitcnt lgkmcnt(0)
    s_waitcnt vmcnt(8)
    s_barrier
    v_mfma_f32_16x16x32_bf16 v[32:35], v[112:115], v[96:99], v[32:35]
    ds_read_b128 v[144:147], v15 offset:24576
    ds_read_b128 v[148:151], v15 offset:25600
    v_mfma_f32_16x16x32_bf16 v[36:39], v[116:119], v[96:99], v[36:39]
    ds_read_b128 v[152:155], v15 offset:26624
    ds_read_b128 v[156:159], v15 offset:27648
    v_mfma_f32_16x16x32_bf16 v[40:43], v[120:123], v[96:99], v[40:43]
    ds_read_b128 v[128:131], v14 offset:16384
    ds_read_b128 v[132:135], v14 offset:18432
    v_mfma_f32_16x16x32_bf16 v[44:47], v[124:127], v[96:99], v[44:47]
    ds_read_b128 v[136:139], v14 offset:20480
    ds_read_b128 v[140:143], v14 offset:22528
    v_mfma_f32_16x16x32_bf16 v[48:51], v[112:115], v[100:103], v[48:51]
    s_add_u32 s36, s40, 9
    s_and_b32 s36, s36, 31
    v_mfma_f32_16x16x32_bf16 v[52:55], v[116:119], v[100:103], v[52:55]
    s_add_u32 m0, s38, 2048
    s_lshl_b32 s36, s36, 7
    v_mfma_f32_16x16x32_bf16 v[56:59], v[120:123], v[100:103], v[56:59]
    buffer_load_dwordx4 v10, s[8:11], s36 offen lds
    buffer_load_dwordx4 v11, s[8:11], s36 offen offset:1024 lds
    v_mfma_f32_16x16x32_bf16 v[60:63], v[124:127], v[100:103], v[60:63]
    s_add_u32 s37, s40, 9
    s_and_b32 s37, s37, 31
    v_mfma_f32_16x16x32_bf16 v[64:67], v[112:115], v[104:107], v[64:67]
    s_lshl_b32 s37, s37, 12
    s_add_u32 m0, s39, 65536
    v_mfma_f32_16x16x32_bf16 v[68:71], v[116:119], v[104:107], v[68:71]
    s_add_u32 s37, s37, s41
    buffer_load_dwordx4 v12, s[12:15], s37 offen offset:0 lds
    v_mfma_f32_16x16x32_bf16 v[72:75], v[120:123], v[104:107], v[72:75]
    buffer_load_dwordx4 v12, s[12:15], s37 offen offset:1024 lds
    v_mfma_f32_16x16x32_bf16 v[76:79], v[124:127], v[104:107], v[76:79]
    v_mfma_f32_16x16x32_bf16 v[80:83], v[112:115], v[108:111], v[80:83]
    v_mfma_f32_16x16x32_bf16 v[84:87], v[116:119], v[108:111], v[84:87]
    v_mfma_f32_16x16x32_bf16 v[88:91], v[120:123], v[108:111], v[88:91]
    v_mfma_f32_16x16x32_bf16 v[92:95], v[124:127], v[108:111], v[92:95]
    s_waitcnt lgkmcnt(0)
    s_waitcnt vmcnt(10)
    s_waitcnt vmcnt(8)
    s_barrier
    v_mfma_f32_16x16x32_bf16 v[32:35], v[144:147], v[128:131], v[32:35]
    ds_read_b128 v[112:115], v15 offset:0
    ds_read_b128 v[116:119], v15 offset:1024
    v_mfma_f32_16x16x32_bf16 v[36:39], v[148:151], v[128:131], v[36:39]
    ds_read_b128 v[120:123], v15 offset:2048
    ds_read_b128 v[124:127], v15 offset:3072
    v_mfma_f32_16x16x32_bf16 v[40:43], v[152:155], v[128:131], v[40:43]
    ds_read_b128 v[96:99], v13 offset:32768
    ds_read_b128 v[100:103], v13 offset:34816
    v_mfma_f32_16x16x32_bf16 v[44:47], v[156:159], v[128:131], v[44:47]
    ds_read_b128 v[104:107], v13 offset:36864
    ds_read_b128 v[108:111], v13 offset:38912
    v_mfma_f32_16x16x32_bf16 v[48:51], v[144:147], v[132:135], v[48:51]
    s_add_u32 s36, s40, 10
    s_and_b32 s36, s36, 31
    v_mfma_f32_16x16x32_bf16 v[52:55], v[148:151], v[132:135], v[52:55]
    s_add_u32 m0, s38, 16384
    s_lshl_b32 s36, s36, 7
    v_mfma_f32_16x16x32_bf16 v[56:59], v[152:155], v[132:135], v[56:59]
    buffer_load_dwordx4 v8, s[8:11], s36 offen lds
    buffer_load_dwordx4 v9, s[8:11], s36 offen offset:1024 lds
    v_mfma_f32_16x16x32_bf16 v[60:63], v[156:159], v[132:135], v[60:63]
    s_add_u32 s37, s40, 9
    s_and_b32 s37, s37, 31
    v_mfma_f32_16x16x32_bf16 v[64:67], v[144:147], v[136:139], v[64:67]
    s_lshl_b32 s37, s37, 12
    s_add_u32 m0, s39, 71680
    v_mfma_f32_16x16x32_bf16 v[68:71], v[148:151], v[136:139], v[68:71]
    s_add_u32 s37, s37, s41
    buffer_load_dwordx4 v12, s[12:15], s37 offen offset:2048 lds
    v_mfma_f32_16x16x32_bf16 v[72:75], v[152:155], v[136:139], v[72:75]
    buffer_load_dwordx4 v12, s[12:15], s37 offen offset:3072 lds
    v_mfma_f32_16x16x32_bf16 v[76:79], v[156:159], v[136:139], v[76:79]
    v_mfma_f32_16x16x32_bf16 v[80:83], v[144:147], v[140:143], v[80:83]
    v_mfma_f32_16x16x32_bf16 v[84:87], v[148:151], v[140:143], v[84:87]
    v_mfma_f32_16x16x32_bf16 v[88:91], v[152:155], v[140:143], v[88:91]
    v_mfma_f32_16x16x32_bf16 v[92:95], v[156:159], v[140:143], v[92:95]
    s_waitcnt lgkmcnt(0)
    s_waitcnt vmcnt(8)
    s_barrier
    v_mfma_f32_16x16x32_bf16 v[32:35], v[112:115], v[96:99], v[32:35]
    ds_read_b128 v[144:147], v15 offset:8192
    ds_read_b128 v[148:151], v15 offset:9216
    v_mfma_f32_16x16x32_bf16 v[36:39], v[116:119], v[96:99], v[36:39]
    ds_read_b128 v[152:155], v15 offset:10240
    ds_read_b128 v[156:159], v15 offset:11264
    v_mfma_f32_16x16x32_bf16 v[40:43], v[120:123], v[96:99], v[40:43]
    ds_read_b128 v[128:131], v14 offset:32768
    ds_read_b128 v[132:135], v14 offset:34816
    v_mfma_f32_16x16x32_bf16 v[44:47], v[124:127], v[96:99], v[44:47]
    ds_read_b128 v[136:139], v14 offset:36864
    ds_read_b128 v[140:143], v14 offset:38912
    v_mfma_f32_16x16x32_bf16 v[48:51], v[112:115], v[100:103], v[48:51]
    s_add_u32 s36, s40, 10
    s_and_b32 s36, s36, 31
    v_mfma_f32_16x16x32_bf16 v[52:55], v[116:119], v[100:103], v[52:55]
    s_add_u32 m0, s38, 18432
    s_lshl_b32 s36, s36, 7
    v_mfma_f32_16x16x32_bf16 v[56:59], v[120:123], v[100:103], v[56:59]
    buffer_load_dwordx4 v10, s[8:11], s36 offen lds
    buffer_load_dwordx4 v11, s[8:11], s36 offen offset:1024 lds
    v_mfma_f32_16x16x32_bf16 v[60:63], v[124:127], v[100:103], v[60:63]
    s_add_u32 s37, s40, 10
    s_and_b32 s37, s37, 31
    v_mfma_f32_16x16x32_bf16 v[64:67], v[112:115], v[104:107], v[64:67]
    s_lshl_b32 s37, s37, 12
    s_add_u32 m0, s39, 49152
    v_mfma_f32_16x16x32_bf16 v[68:71], v[116:119], v[104:107], v[68:71]
    s_add_u32 s37, s37, s41
    buffer_load_dwordx4 v12, s[12:15], s37 offen offset:0 lds
    v_mfma_f32_16x16x32_bf16 v[72:75], v[120:123], v[104:107], v[72:75]
    buffer_load_dwordx4 v12, s[12:15], s37 offen offset:1024 lds
    v_mfma_f32_16x16x32_bf16 v[76:79], v[124:127], v[104:107], v[76:79]
    v_mfma_f32_16x16x32_bf16 v[80:83], v[112:115], v[108:111], v[80:83]
    v_mfma_f32_16x16x32_bf16 v[84:87], v[116:119], v[108:111], v[84:87]
    v_mfma_f32_16x16x32_bf16 v[88:91], v[120:123], v[108:111], v[88:91]
    v_mfma_f32_16x16x32_bf16 v[92:95], v[124:127], v[108:111], v[92:95]
    s_waitcnt lgkmcnt(0)
    s_waitcnt vmcnt(10)
    s_waitcnt vmcnt(8)
    s_barrier
    v_mfma_f32_16x16x32_bf16 v[32:35], v[144:147], v[128:131], v[32:35]
    ds_read_b128 v[112:115], v15 offset:16384
    ds_read_b128 v[116:119], v15 offset:17408
    v_mfma_f32_16x16x32_bf16 v[36:39], v[148:151], v[128:131], v[36:39]
    ds_read_b128 v[120:123], v15 offset:18432
    ds_read_b128 v[124:127], v15 offset:19456
    v_mfma_f32_16x16x32_bf16 v[40:43], v[152:155], v[128:131], v[40:43]
    ds_read_b128 v[96:99], v13 offset:0
    ds_read_b128 v[100:103], v13 offset:2048
    v_mfma_f32_16x16x32_bf16 v[44:47], v[156:159], v[128:131], v[44:47]
    ds_read_b128 v[104:107], v13 offset:4096
    ds_read_b128 v[108:111], v13 offset:6144
    v_mfma_f32_16x16x32_bf16 v[48:51], v[144:147], v[132:135], v[48:51]
    s_add_u32 s36, s40, 11
    s_and_b32 s36, s36, 31
    v_mfma_f32_16x16x32_bf16 v[52:55], v[148:151], v[132:135], v[52:55]
    s_add_u32 m0, s38, 32768
    s_lshl_b32 s36, s36, 7
    v_mfma_f32_16x16x32_bf16 v[56:59], v[152:155], v[132:135], v[56:59]
    buffer_load_dwordx4 v8, s[8:11], s36 offen lds
    buffer_load_dwordx4 v9, s[8:11], s36 offen offset:1024 lds
    v_mfma_f32_16x16x32_bf16 v[60:63], v[156:159], v[132:135], v[60:63]
    s_add_u32 s37, s40, 10
    s_and_b32 s37, s37, 31
    v_mfma_f32_16x16x32_bf16 v[64:67], v[144:147], v[136:139], v[64:67]
    s_lshl_b32 s37, s37, 12
    s_add_u32 m0, s39, 55296
    v_mfma_f32_16x16x32_bf16 v[68:71], v[148:151], v[136:139], v[68:71]
    s_add_u32 s37, s37, s41
    buffer_load_dwordx4 v12, s[12:15], s37 offen offset:2048 lds
    v_mfma_f32_16x16x32_bf16 v[72:75], v[152:155], v[136:139], v[72:75]
    buffer_load_dwordx4 v12, s[12:15], s37 offen offset:3072 lds
    v_mfma_f32_16x16x32_bf16 v[76:79], v[156:159], v[136:139], v[76:79]
    v_mfma_f32_16x16x32_bf16 v[80:83], v[144:147], v[140:143], v[80:83]
    v_mfma_f32_16x16x32_bf16 v[84:87], v[148:151], v[140:143], v[84:87]
    v_mfma_f32_16x16x32_bf16 v[88:91], v[152:155], v[140:143], v[88:91]
    v_mfma_f32_16x16x32_bf16 v[92:95], v[156:159], v[140:143], v[92:95]
    s_waitcnt lgkmcnt(0)
    s_waitcnt vmcnt(8)
    s_barrier
    v_mfma_f32_16x16x32_bf16 v[32:35], v[112:115], v[96:99], v[32:35]
    ds_read_b128 v[144:147], v15 offset:24576
    ds_read_b128 v[148:151], v15 offset:25600
    v_mfma_f32_16x16x32_bf16 v[36:39], v[116:119], v[96:99], v[36:39]
    ds_read_b128 v[152:155], v15 offset:26624
    ds_read_b128 v[156:159], v15 offset:27648
    v_mfma_f32_16x16x32_bf16 v[40:43], v[120:123], v[96:99], v[40:43]
    ds_read_b128 v[128:131], v14 offset:0
    ds_read_b128 v[132:135], v14 offset:2048
    v_mfma_f32_16x16x32_bf16 v[44:47], v[124:127], v[96:99], v[44:47]
    ds_read_b128 v[136:139], v14 offset:4096
    ds_read_b128 v[140:143], v14 offset:6144
    v_mfma_f32_16x16x32_bf16 v[48:51], v[112:115], v[100:103], v[48:51]
    s_add_u32 s36, s40, 11
    s_and_b32 s36, s36, 31
    v_mfma_f32_16x16x32_bf16 v[52:55], v[116:119], v[100:103], v[52:55]
    s_add_u32 m0, s38, 34816
    s_lshl_b32 s36, s36, 7
    v_mfma_f32_16x16x32_bf16 v[56:59], v[120:123], v[100:103], v[56:59]
    buffer_load_dwordx4 v10, s[8:11], s36 offen lds
    buffer_load_dwordx4 v11, s[8:11], s36 offen offset:1024 lds
    v_mfma_f32_16x16x32_bf16 v[60:63], v[124:127], v[100:103], v[60:63]
    s_add_u32 s37, s40, 11
    s_and_b32 s37, s37, 31
    v_mfma_f32_16x16x32_bf16 v[64:67], v[112:115], v[104:107], v[64:67]
    s_lshl_b32 s37, s37, 12
    s_add_u32 m0, s39, 65536
    v_mfma_f32_16x16x32_bf16 v[68:71], v[116:119], v[104:107], v[68:71]
    s_add_u32 s37, s37, s41
    buffer_load_dwordx4 v12, s[12:15], s37 offen offset:0 lds
    v_mfma_f32_16x16x32_bf16 v[72:75], v[120:123], v[104:107], v[72:75]
    buffer_load_dwordx4 v12, s[12:15], s37 offen offset:1024 lds
    v_mfma_f32_16x16x32_bf16 v[76:79], v[124:127], v[104:107], v[76:79]
    v_mfma_f32_16x16x32_bf16 v[80:83], v[112:115], v[108:111], v[80:83]
    v_mfma_f32_16x16x32_bf16 v[84:87], v[116:119], v[108:111], v[84:87]
    v_mfma_f32_16x16x32_bf16 v[88:91], v[120:123], v[108:111], v[88:91]
    v_mfma_f32_16x16x32_bf16 v[92:95], v[124:127], v[108:111], v[92:95]
    s_waitcnt lgkmcnt(0)
    s_waitcnt vmcnt(10)
    s_waitcnt vmcnt(8)
    s_barrier
    v_mfma_f32_16x16x32_bf16 v[32:35], v[144:147], v[128:131], v[32:35]
    ds_read_b128 v[112:115], v15 offset:0
    ds_read_b128 v[116:119], v15 offset:1024
    v_mfma_f32_16x16x32_bf16 v[36:39], v[148:151], v[128:131], v[36:39]
    ds_read_b128 v[120:123], v15 offset:2048
    ds_read_b128 v[124:127], v15 offset:3072
    v_mfma_f32_16x16x32_bf16 v[40:43], v[152:155], v[128:131], v[40:43]
    ds_read_b128 v[96:99], v13 offset:16384
    ds_read_b128 v[100:103], v13 offset:18432
    v_mfma_f32_16x16x32_bf16 v[44:47], v[156:159], v[128:131], v[44:47]
    ds_read_b128 v[104:107], v13 offset:20480
    ds_read_b128 v[108:111], v13 offset:22528
    v_mfma_f32_16x16x32_bf16 v[48:51], v[144:147], v[132:135], v[48:51]
    s_add_u32 s36, s40, 12
    s_and_b32 s36, s36, 31
    v_mfma_f32_16x16x32_bf16 v[52:55], v[148:151], v[132:135], v[52:55]
    s_add_u32 m0, s38, 0
    s_lshl_b32 s36, s36, 7
    v_mfma_f32_16x16x32_bf16 v[56:59], v[152:155], v[132:135], v[56:59]
    buffer_load_dwordx4 v8, s[8:11], s36 offen lds
    buffer_load_dwordx4 v9, s[8:11], s36 offen offset:1024 lds
    v_mfma_f32_16x16x32_bf16 v[60:63], v[156:159], v[132:135], v[60:63]
    s_add_u32 s37, s40, 11
    s_and_b32 s37, s37, 31
    v_mfma_f32_16x16x32_bf16 v[64:67], v[144:147], v[136:139], v[64:67]
    s_lshl_b32 s37, s37, 12
    s_add_u32 m0, s39, 71680
    v_mfma_f32_16x16x32_bf16 v[68:71], v[148:151], v[136:139], v[68:71]
    s_add_u32 s37, s37, s41
    buffer_load_dwordx4 v12, s[12:15], s37 offen offset:2048 lds
    v_mfma_f32_16x16x32_bf16 v[72:75], v[152:155], v[136:139], v[72:75]
    buffer_load_dwordx4 v12, s[12:15], s37 offen offset:3072 lds
    v_mfma_f32_16x16x32_bf16 v[76:79], v[156:159], v[136:139], v[76:79]
    v_mfma_f32_16x16x32_bf16 v[80:83], v[144:147], v[140:143], v[80:83]
    v_mfma_f32_16x16x32_bf16 v[84:87], v[148:151], v[140:143], v[84:87]
    v_mfma_f32_16x16x32_bf16 v[88:91], v[152:155], v[140:143], v[88:91]
    v_mfma_f32_16x16x32_bf16 v[92:95], v[156:159], v[140:143], v[92:95]
    s_waitcnt lgkmcnt(0)
    s_waitcnt vmcnt(8)
    s_barrier
    v_mfma_f32_16x16x32_bf16 v[32:35], v[112:115], v[96:99], v[32:35]
    ds_read_b128 v[144:147], v15 offset:8192
    ds_read_b128 v[148:151], v15 offset:9216
    v_mfma_f32_16x16x32_bf16 v[36:39], v[116:119], v[96:99], v[36:39]
    ds_read_b128 v[152:155], v15 offset:10240
    ds_read_b128 v[156:159], v15 offset:11264
    v_mfma_f32_16x16x32_bf16 v[40:43], v[120:123], v[96:99], v[40:43]
    ds_read_b128 v[128:131], v14 offset:16384
    ds_read_b128 v[132:135], v14 offset:18432
    v_mfma_f32_16x16x32_bf16 v[44:47], v[124:127], v[96:99], v[44:47]
    ds_read_b128 v[136:139], v14 offset:20480
    ds_read_b128 v[140:143], v14 offset:22528
    v_mfma_f32_16x16x32_bf16 v[48:51], v[112:115], v[100:103], v[48:51]
    s_add_u32 s36, s40, 12
    s_and_b32 s36, s36, 31
    v_mfma_f32_16x16x32_bf16 v[52:55], v[116:119], v[100:103], v[52:55]
    s_add_u32 m0, s38, 2048
    s_lshl_b32 s36, s36, 7
    v_mfma_f32_16x16x32_bf16 v[56:59], v[120:123], v[100:103], v[56:59]
    buffer_load_dwordx4 v10, s[8:11], s36 offen lds
    buffer_load_dwordx4 v11, s[8:11], s36 offen offset:1024 lds
    v_mfma_f32_16x16x32_bf16 v[60:63], v[124:127], v[100:103], v[60:63]
    s_add_u32 s37, s40, 12
    s_and_b32 s37, s37, 31
    v_mfma_f32_16x16x32_bf16 v[64:67], v[112:115], v[104:107], v[64:67]
    s_lshl_b32 s37, s37, 12
    s_add_u32 m0, s39, 49152
    v_mfma_f32_16x16x32_bf16 v[68:71], v[116:119], v[104:107], v[68:71]
    s_add_u32 s37, s37, s41
    buffer_load_dwordx4 v12, s[12:15], s37 offen offset:0 lds
    v_mfma_f32_16x16x32_bf16 v[72:75], v[120:123], v[104:107], v[72:75]
    buffer_load_dwordx4 v12, s[12:15], s37 offen offset:1024 lds
    v_mfma_f32_16x16x32_bf16 v[76:79], v[124:127], v[104:107], v[76:79]
    v_mfma_f32_16x16x32_bf16 v[80:83], v[112:115], v[108:111], v[80:83]
    v_mfma_f32_16x16x32_bf16 v[84:87], v[116:119], v[108:111], v[84:87]
    v_mfma_f32_16x16x32_bf16 v[88:91], v[120:123], v[108:111], v[88:91]
    v_mfma_f32_16x16x32_bf16 v[92:95], v[124:127], v[108:111], v[92:95]
    s_waitcnt lgkmcnt(0)
    s_waitcnt vmcnt(10)
    s_waitcnt vmcnt(8)
    s_barrier
    v_mfma_f32_16x16x32_bf16 v[32:35], v[144:147], v[128:131], v[32:35]
    ds_read_b128 v[112:115], v15 offset:16384
    ds_read_b128 v[116:119], v15 offset:17408
    v_mfma_f32_16x16x32_bf16 v[36:39], v[148:151], v[128:131], v[36:39]
    ds_read_b128 v[120:123], v15 offset:18432
    ds_read_b128 v[124:127], v15 offset:19456
    v_mfma_f32_16x16x32_bf16 v[40:43], v[152:155], v[128:131], v[40:43]
    ds_read_b128 v[96:99], v13 offset:32768
    ds_read_b128 v[100:103], v13 offset:34816
    v_mfma_f32_16x16x32_bf16 v[44:47], v[156:159], v[128:131], v[44:47]
    ds_read_b128 v[104:107], v13 offset:36864
    ds_read_b128 v[108:111], v13 offset:38912
    v_mfma_f32_16x16x32_bf16 v[48:51], v[144:147], v[132:135], v[48:51]
    s_add_u32 s36, s40, 13
    s_and_b32 s36, s36, 31
    v_mfma_f32_16x16x32_bf16 v[52:55], v[148:151], v[132:135], v[52:55]
    s_add_u32 m0, s38, 16384
    s_lshl_b32 s36, s36, 7
    v_mfma_f32_16x16x32_bf16 v[56:59], v[152:155], v[132:135], v[56:59]
    buffer_load_dwordx4 v8, s[8:11], s36 offen lds
    buffer_load_dwordx4 v9, s[8:11], s36 offen offset:1024 lds
    v_mfma_f32_16x16x32_bf16 v[60:63], v[156:159], v[132:135], v[60:63]
    s_add_u32 s37, s40, 12
    s_and_b32 s37, s37, 31
    v_mfma_f32_16x16x32_bf16 v[64:67], v[144:147], v[136:139], v[64:67]
    s_lshl_b32 s37, s37, 12
    s_add_u32 m0, s39, 55296
    v_mfma_f32_16x16x32_bf16 v[68:71], v[148:151], v[136:139], v[68:71]
    s_add_u32 s37, s37, s41
    buffer_load_dwordx4 v12, s[12:15], s37 offen offset:2048 lds
    v_mfma_f32_16x16x32_bf16 v[72:75], v[152:155], v[136:139], v[72:75]
    buffer_load_dwordx4 v12, s[12:15], s37 offen offset:3072 lds
    v_mfma_f32_16x16x32_bf16 v[76:79], v[156:159], v[136:139], v[76:79]
    v_mfma_f32_16x16x32_bf16 v[80:83], v[144:147], v[140:143], v[80:83]
    v_mfma_f32_16x16x32_bf16 v[84:87], v[148:151], v[140:143], v[84:87]
    v_mfma_f32_16x16x32_bf16 v[88:91], v[152:155], v[140:143], v[88:91]
    v_mfma_f32_16x16x32_bf16 v[92:95], v[156:159], v[140:143], v[92:95]
    s_waitcnt lgkmcnt(0)
    s_waitcnt vmcnt(8)
    s_barrier
    v_mfma_f32_16x16x32_bf16 v[32:35], v[112:115], v[96:99], v[32:35]
    ds_read_b128 v[144:147], v15 offset:24576
    ds_read_b128 v[148:151], v15 offset:25600
    v_mfma_f32_16x16x32_bf16 v[36:39], v[116:119], v[96:99], v[36:39]
    ds_read_b128 v[152:155], v15 offset:26624
    ds_read_b128 v[156:159], v15 offset:27648
    v_mfma_f32_16x16x32_bf16 v[40:43], v[120:123], v[96:99], v[40:43]
    ds_read_b128 v[128:131], v14 offset:32768
    ds_read_b128 v[132:135], v14 offset:34816
    v_mfma_f32_16x16x32_bf16 v[44:47], v[124:127], v[96:99], v[44:47]
    ds_read_b128 v[136:139], v14 offset:36864
    ds_read_b128 v[140:143], v14 offset:38912
    v_mfma_f32_16x16x32_bf16 v[48:51], v[112:115], v[100:103], v[48:51]
    s_add_u32 s36, s40, 13
    s_and_b32 s36, s36, 31
    v_mfma_f32_16x16x32_bf16 v[52:55], v[116:119], v[100:103], v[52:55]
    s_add_u32 m0, s38, 18432
    s_lshl_b32 s36, s36, 7
    v_mfma_f32_16x16x32_bf16 v[56:59], v[120:123], v[100:103], v[56:59]
    buffer_load_dwordx4 v10, s[8:11], s36 offen lds
    buffer_load_dwordx4 v11, s[8:11], s36 offen offset:1024 lds
    v_mfma_f32_16x16x32_bf16 v[60:63], v[124:127], v[100:103], v[60:63]
    s_add_u32 s37, s40, 13
    s_and_b32 s37, s37, 31
    v_mfma_f32_16x16x32_bf16 v[64:67], v[112:115], v[104:107], v[64:67]
    s_lshl_b32 s37, s37, 12
    s_add_u32 m0, s39, 65536
    v_mfma_f32_16x16x32_bf16 v[68:71], v[116:119], v[104:107], v[68:71]
    s_add_u32 s37, s37, s41
    buffer_load_dwordx4 v12, s[12:15], s37 offen offset:0 lds
    v_mfma_f32_16x16x32_bf16 v[72:75], v[120:123], v[104:107], v[72:75]
    buffer_load_dwordx4 v12, s[12:15], s37 offen offset:1024 lds
    v_mfma_f32_16x16x32_bf16 v[76:79], v[124:127], v[104:107], v[76:79]
    v_mfma_f32_16x16x32_bf16 v[80:83], v[112:115], v[108:111], v[80:83]
    v_mfma_f32_16x16x32_bf16 v[84:87], v[116:119], v[108:111], v[84:87]
    v_mfma_f32_16x16x32_bf16 v[88:91], v[120:123], v[108:111], v[88:91]
    v_mfma_f32_16x16x32_bf16 v[92:95], v[124:127], v[108:111], v[92:95]
    s_waitcnt lgkmcnt(0)
    s_waitcnt vmcnt(10)
    s_waitcnt vmcnt(8)
    s_barrier
    v_mfma_f32_16x16x32_bf16 v[32:35], v[144:147], v[128:131], v[32:35]
    ds_read_b128 v[112:115], v15 offset:0
    ds_read_b128 v[116:119], v15 offset:1024
    v_mfma_f32_16x16x32_bf16 v[36:39], v[148:151], v[128:131], v[36:39]
    ds_read_b128 v[120:123], v15 offset:2048
    ds_read_b128 v[124:127], v15 offset:3072
    v_mfma_f32_16x16x32_bf16 v[40:43], v[152:155], v[128:131], v[40:43]
    ds_read_b128 v[96:99], v13 offset:0
    ds_read_b128 v[100:103], v13 offset:2048
    v_mfma_f32_16x16x32_bf16 v[44:47], v[156:159], v[128:131], v[44:47]
    ds_read_b128 v[104:107], v13 offset:4096
    ds_read_b128 v[108:111], v13 offset:6144
    v_mfma_f32_16x16x32_bf16 v[48:51], v[144:147], v[132:135], v[48:51]
    s_add_u32 s36, s40, 14
    s_and_b32 s36, s36, 31
    v_mfma_f32_16x16x32_bf16 v[52:55], v[148:151], v[132:135], v[52:55]
    s_add_u32 m0, s38, 32768
    s_lshl_b32 s36, s36, 7
    v_mfma_f32_16x16x32_bf16 v[56:59], v[152:155], v[132:135], v[56:59]
    buffer_load_dwordx4 v8, s[8:11], s36 offen lds
    buffer_load_dwordx4 v9, s[8:11], s36 offen offset:1024 lds
    v_mfma_f32_16x16x32_bf16 v[60:63], v[156:159], v[132:135], v[60:63]
    s_add_u32 s37, s40, 13
    s_and_b32 s37, s37, 31
    v_mfma_f32_16x16x32_bf16 v[64:67], v[144:147], v[136:139], v[64:67]
    s_lshl_b32 s37, s37, 12
    s_add_u32 m0, s39, 71680
    v_mfma_f32_16x16x32_bf16 v[68:71], v[148:151], v[136:139], v[68:71]
    s_add_u32 s37, s37, s41
    buffer_load_dwordx4 v12, s[12:15], s37 offen offset:2048 lds
    v_mfma_f32_16x16x32_bf16 v[72:75], v[152:155], v[136:139], v[72:75]
    buffer_load_dwordx4 v12, s[12:15], s37 offen offset:3072 lds
    v_mfma_f32_16x16x32_bf16 v[76:79], v[156:159], v[136:139], v[76:79]
    v_mfma_f32_16x16x32_bf16 v[80:83], v[144:147], v[140:143], v[80:83]
    v_mfma_f32_16x16x32_bf16 v[84:87], v[148:151], v[140:143], v[84:87]
    v_mfma_f32_16x16x32_bf16 v[88:91], v[152:155], v[140:143], v[88:91]
    v_mfma_f32_16x16x32_bf16 v[92:95], v[156:159], v[140:143], v[92:95]
    s_waitcnt lgkmcnt(0)
    s_waitcnt vmcnt(8)
    s_barrier
    v_mfma_f32_16x16x32_bf16 v[32:35], v[112:115], v[96:99], v[32:35]
    ds_read_b128 v[144:147], v15 offset:8192
    ds_read_b128 v[148:151], v15 offset:9216
    v_mfma_f32_16x16x32_bf16 v[36:39], v[116:119], v[96:99], v[36:39]
    ds_read_b128 v[152:155], v15 offset:10240
    ds_read_b128 v[156:159], v15 offset:11264
    v_mfma_f32_16x16x32_bf16 v[40:43], v[120:123], v[96:99], v[40:43]
    ds_read_b128 v[128:131], v14 offset:0
    ds_read_b128 v[132:135], v14 offset:2048
    v_mfma_f32_16x16x32_bf16 v[44:47], v[124:127], v[96:99], v[44:47]
    ds_read_b128 v[136:139], v14 offset:4096
    ds_read_b128 v[140:143], v14 offset:6144
    v_mfma_f32_16x16x32_bf16 v[48:51], v[112:115], v[100:103], v[48:51]
    s_add_u32 s36, s40, 14
    s_and_b32 s36, s36, 31
    v_mfma_f32_16x16x32_bf16 v[52:55], v[116:119], v[100:103], v[52:55]
    s_add_u32 m0, s38, 34816
    s_lshl_b32 s36, s36, 7
    v_mfma_f32_16x16x32_bf16 v[56:59], v[120:123], v[100:103], v[56:59]
    buffer_load_dwordx4 v10, s[8:11], s36 offen lds
    buffer_load_dwordx4 v11, s[8:11], s36 offen offset:1024 lds
    v_mfma_f32_16x16x32_bf16 v[60:63], v[124:127], v[100:103], v[60:63]
    s_add_u32 s37, s40, 14
    s_and_b32 s37, s37, 31
    v_mfma_f32_16x16x32_bf16 v[64:67], v[112:115], v[104:107], v[64:67]
    s_lshl_b32 s37, s37, 12
    s_add_u32 m0, s39, 49152
    v_mfma_f32_16x16x32_bf16 v[68:71], v[116:119], v[104:107], v[68:71]
    s_add_u32 s37, s37, s41
    buffer_load_dwordx4 v12, s[12:15], s37 offen offset:0 lds
    v_mfma_f32_16x16x32_bf16 v[72:75], v[120:123], v[104:107], v[72:75]
    buffer_load_dwordx4 v12, s[12:15], s37 offen offset:1024 lds
    v_mfma_f32_16x16x32_bf16 v[76:79], v[124:127], v[104:107], v[76:79]
    v_mfma_f32_16x16x32_bf16 v[80:83], v[112:115], v[108:111], v[80:83]
    v_mfma_f32_16x16x32_bf16 v[84:87], v[116:119], v[108:111], v[84:87]
    v_mfma_f32_16x16x32_bf16 v[88:91], v[120:123], v[108:111], v[88:91]
    v_mfma_f32_16x16x32_bf16 v[92:95], v[124:127], v[108:111], v[92:95]
    s_waitcnt lgkmcnt(0)
    s_waitcnt vmcnt(10)
    s_waitcnt vmcnt(8)
    s_barrier
    v_mfma_f32_16x16x32_bf16 v[32:35], v[144:147], v[128:131], v[32:35]
    ds_read_b128 v[112:115], v15 offset:16384
    ds_read_b128 v[116:119], v15 offset:17408
    v_mfma_f32_16x16x32_bf16 v[36:39], v[148:151], v[128:131], v[36:39]
    ds_read_b128 v[120:123], v15 offset:18432
    ds_read_b128 v[124:127], v15 offset:19456
    v_mfma_f32_16x16x32_bf16 v[40:43], v[152:155], v[128:131], v[40:43]
    ds_read_b128 v[96:99], v13 offset:16384
    ds_read_b128 v[100:103], v13 offset:18432
    v_mfma_f32_16x16x32_bf16 v[44:47], v[156:159], v[128:131], v[44:47]
    ds_read_b128 v[104:107], v13 offset:20480
    ds_read_b128 v[108:111], v13 offset:22528
    v_mfma_f32_16x16x32_bf16 v[48:51], v[144:147], v[132:135], v[48:51]
    s_add_u32 s36, s40, 15
    s_and_b32 s36, s36, 31
    v_mfma_f32_16x16x32_bf16 v[52:55], v[148:151], v[132:135], v[52:55]
    s_add_u32 m0, s38, 0
    s_lshl_b32 s36, s36, 7
    v_mfma_f32_16x16x32_bf16 v[56:59], v[152:155], v[132:135], v[56:59]
    buffer_load_dwordx4 v8, s[8:11], s36 offen lds
    buffer_load_dwordx4 v9, s[8:11], s36 offen offset:1024 lds
    v_mfma_f32_16x16x32_bf16 v[60:63], v[156:159], v[132:135], v[60:63]
    s_add_u32 s37, s40, 14
    s_and_b32 s37, s37, 31
    v_mfma_f32_16x16x32_bf16 v[64:67], v[144:147], v[136:139], v[64:67]
    s_lshl_b32 s37, s37, 12
    s_add_u32 m0, s39, 55296
    v_mfma_f32_16x16x32_bf16 v[68:71], v[148:151], v[136:139], v[68:71]
    s_add_u32 s37, s37, s41
    buffer_load_dwordx4 v12, s[12:15], s37 offen offset:2048 lds
    v_mfma_f32_16x16x32_bf16 v[72:75], v[152:155], v[136:139], v[72:75]
    buffer_load_dwordx4 v12, s[12:15], s37 offen offset:3072 lds
    v_mfma_f32_16x16x32_bf16 v[76:79], v[156:159], v[136:139], v[76:79]
    v_mfma_f32_16x16x32_bf16 v[80:83], v[144:147], v[140:143], v[80:83]
    v_mfma_f32_16x16x32_bf16 v[84:87], v[148:151], v[140:143], v[84:87]
    v_mfma_f32_16x16x32_bf16 v[88:91], v[152:155], v[140:143], v[88:91]
    v_mfma_f32_16x16x32_bf16 v[92:95], v[156:159], v[140:143], v[92:95]
    s_waitcnt lgkmcnt(0)
    s_waitcnt vmcnt(8)
    s_barrier
    v_mfma_f32_16x16x32_bf16 v[32:35], v[112:115], v[96:99], v[32:35]
    ds_read_b128 v[144:147], v15 offset:24576
    ds_read_b128 v[148:151], v15 offset:25600
    v_mfma_f32_16x16x32_bf16 v[36:39], v[116:119], v[96:99], v[36:39]
    ds_read_b128 v[152:155], v15 offset:26624
    ds_read_b128 v[156:159], v15 offset:27648
    v_mfma_f32_16x16x32_bf16 v[40:43], v[120:123], v[96:99], v[40:43]
    ds_read_b128 v[128:131], v14 offset:16384
    ds_read_b128 v[132:135], v14 offset:18432
    v_mfma_f32_16x16x32_bf16 v[44:47], v[124:127], v[96:99], v[44:47]
    ds_read_b128 v[136:139], v14 offset:20480
    ds_read_b128 v[140:143], v14 offset:22528
    v_mfma_f32_16x16x32_bf16 v[48:51], v[112:115], v[100:103], v[48:51]
    s_add_u32 s36, s40, 15
    s_and_b32 s36, s36, 31
    v_mfma_f32_16x16x32_bf16 v[52:55], v[116:119], v[100:103], v[52:55]
    s_add_u32 m0, s38, 2048
    s_lshl_b32 s36, s36, 7
    v_mfma_f32_16x16x32_bf16 v[56:59], v[120:123], v[100:103], v[56:59]
    buffer_load_dwordx4 v10, s[8:11], s36 offen lds
    buffer_load_dwordx4 v11, s[8:11], s36 offen offset:1024 lds
    v_mfma_f32_16x16x32_bf16 v[60:63], v[124:127], v[100:103], v[60:63]
    s_add_u32 s37, s40, 15
    s_and_b32 s37, s37, 31
    v_mfma_f32_16x16x32_bf16 v[64:67], v[112:115], v[104:107], v[64:67]
    s_lshl_b32 s37, s37, 12
    s_add_u32 m0, s39, 65536
    v_mfma_f32_16x16x32_bf16 v[68:71], v[116:119], v[104:107], v[68:71]
    s_add_u32 s37, s37, s41
    buffer_load_dwordx4 v12, s[12:15], s37 offen offset:0 lds
    v_mfma_f32_16x16x32_bf16 v[72:75], v[120:123], v[104:107], v[72:75]
    buffer_load_dwordx4 v12, s[12:15], s37 offen offset:1024 lds
    v_mfma_f32_16x16x32_bf16 v[76:79], v[124:127], v[104:107], v[76:79]
    v_mfma_f32_16x16x32_bf16 v[80:83], v[112:115], v[108:111], v[80:83]
    v_mfma_f32_16x16x32_bf16 v[84:87], v[116:119], v[108:111], v[84:87]
    v_mfma_f32_16x16x32_bf16 v[88:91], v[120:123], v[108:111], v[88:91]
    v_mfma_f32_16x16x32_bf16 v[92:95], v[124:127], v[108:111], v[92:95]
    s_waitcnt lgkmcnt(0)
    s_waitcnt vmcnt(10)
    s_waitcnt vmcnt(8)
    s_barrier
    v_mfma_f32_16x16x32_bf16 v[32:35], v[144:147], v[128:131], v[32:35]
    ds_read_b128 v[112:115], v15 offset:0
    ds_read_b128 v[116:119], v15 offset:1024
    v_mfma_f32_16x16x32_bf16 v[36:39], v[148:151], v[128:131], v[36:39]
    ds_read_b128 v[120:123], v15 offset:2048
    ds_read_b128 v[124:127], v15 offset:3072
    v_mfma_f32_16x16x32_bf16 v[40:43], v[152:155], v[128:131], v[40:43]
    ds_read_b128 v[96:99], v13 offset:32768
    ds_read_b128 v[100:103], v13 offset:34816
    v_mfma_f32_16x16x32_bf16 v[44:47], v[156:159], v[128:131], v[44:47]
    ds_read_b128 v[104:107], v13 offset:36864
    ds_read_b128 v[108:111], v13 offset:38912
    v_mfma_f32_16x16x32_bf16 v[48:51], v[144:147], v[132:135], v[48:51]
    s_add_u32 s36, s40, 16
    s_and_b32 s36, s36, 31
    v_mfma_f32_16x16x32_bf16 v[52:55], v[148:151], v[132:135], v[52:55]
    s_add_u32 m0, s38, 16384
    s_lshl_b32 s36, s36, 7
    v_mfma_f32_16x16x32_bf16 v[56:59], v[152:155], v[132:135], v[56:59]
    buffer_load_dwordx4 v8, s[8:11], s36 offen lds
    buffer_load_dwordx4 v9, s[8:11], s36 offen offset:1024 lds
    v_mfma_f32_16x16x32_bf16 v[60:63], v[156:159], v[132:135], v[60:63]
    s_add_u32 s37, s40, 15
    s_and_b32 s37, s37, 31
    v_mfma_f32_16x16x32_bf16 v[64:67], v[144:147], v[136:139], v[64:67]
    s_lshl_b32 s37, s37, 12
    s_add_u32 m0, s39, 71680
    v_mfma_f32_16x16x32_bf16 v[68:71], v[148:151], v[136:139], v[68:71]
    s_add_u32 s37, s37, s41
    buffer_load_dwordx4 v12, s[12:15], s37 offen offset:2048 lds
    v_mfma_f32_16x16x32_bf16 v[72:75], v[152:155], v[136:139], v[72:75]
    buffer_load_dwordx4 v12, s[12:15], s37 offen offset:3072 lds
    v_mfma_f32_16x16x32_bf16 v[76:79], v[156:159], v[136:139], v[76:79]
    v_mfma_f32_16x16x32_bf16 v[80:83], v[144:147], v[140:143], v[80:83]
    v_mfma_f32_16x16x32_bf16 v[84:87], v[148:151], v[140:143], v[84:87]
    v_mfma_f32_16x16x32_bf16 v[88:91], v[152:155], v[140:143], v[88:91]
    v_mfma_f32_16x16x32_bf16 v[92:95], v[156:159], v[140:143], v[92:95]
    s_waitcnt lgkmcnt(0)
    s_waitcnt vmcnt(8)
    s_barrier
    v_mfma_f32_16x16x32_bf16 v[32:35], v[112:115], v[96:99], v[32:35]
    ds_read_b128 v[144:147], v15 offset:8192
    ds_read_b128 v[148:151], v15 offset:9216
    v_mfma_f32_16x16x32_bf16 v[36:39], v[116:119], v[96:99], v[36:39]
    ds_read_b128 v[152:155], v15 offset:10240
    ds_read_b128 v[156:159], v15 offset:11264
    v_mfma_f32_16x16x32_bf16 v[40:43], v[120:123], v[96:99], v[40:43]
    ds_read_b128 v[128:131], v14 offset:32768
    ds_read_b128 v[132:135], v14 offset:34816
    v_mfma_f32_16x16x32_bf16 v[44:47], v[124:127], v[96:99], v[44:47]
    ds_read_b128 v[136:139], v14 offset:36864
    ds_read_b128 v[140:143], v14 offset:38912
    v_mfma_f32_16x16x32_bf16 v[48:51], v[112:115], v[100:103], v[48:51]
    s_add_u32 s36, s40, 16
    s_and_b32 s36, s36, 31
    v_mfma_f32_16x16x32_bf16 v[52:55], v[116:119], v[100:103], v[52:55]
    s_add_u32 m0, s38, 18432
    s_lshl_b32 s36, s36, 7
    v_mfma_f32_16x16x32_bf16 v[56:59], v[120:123], v[100:103], v[56:59]
    buffer_load_dwordx4 v10, s[8:11], s36 offen lds
    buffer_load_dwordx4 v11, s[8:11], s36 offen offset:1024 lds
    v_mfma_f32_16x16x32_bf16 v[60:63], v[124:127], v[100:103], v[60:63]
    s_add_u32 s37, s40, 16
    s_and_b32 s37, s37, 31
    v_mfma_f32_16x16x32_bf16 v[64:67], v[112:115], v[104:107], v[64:67]
    s_lshl_b32 s37, s37, 12
    s_add_u32 m0, s39, 49152
    v_mfma_f32_16x16x32_bf16 v[68:71], v[116:119], v[104:107], v[68:71]
    s_add_u32 s37, s37, s41
    buffer_load_dwordx4 v12, s[12:15], s37 offen offset:0 lds
    v_mfma_f32_16x16x32_bf16 v[72:75], v[120:123], v[104:107], v[72:75]
    buffer_load_dwordx4 v12, s[12:15], s37 offen offset:1024 lds
    v_mfma_f32_16x16x32_bf16 v[76:79], v[124:127], v[104:107], v[76:79]
    v_mfma_f32_16x16x32_bf16 v[80:83], v[112:115], v[108:111], v[80:83]
    v_mfma_f32_16x16x32_bf16 v[84:87], v[116:119], v[108:111], v[84:87]
    v_mfma_f32_16x16x32_bf16 v[88:91], v[120:123], v[108:111], v[88:91]
    v_mfma_f32_16x16x32_bf16 v[92:95], v[124:127], v[108:111], v[92:95]
    s_waitcnt lgkmcnt(0)
    s_waitcnt vmcnt(10)
    s_waitcnt vmcnt(8)
    s_barrier
    v_mfma_f32_16x16x32_bf16 v[32:35], v[144:147], v[128:131], v[32:35]
    ds_read_b128 v[112:115], v15 offset:16384
    ds_read_b128 v[116:119], v15 offset:17408
    v_mfma_f32_16x16x32_bf16 v[36:39], v[148:151], v[128:131], v[36:39]
    ds_read_b128 v[120:123], v15 offset:18432
    ds_read_b128 v[124:127], v15 offset:19456
    v_mfma_f32_16x16x32_bf16 v[40:43], v[152:155], v[128:131], v[40:43]
    ds_read_b128 v[96:99], v13 offset:0
    ds_read_b128 v[100:103], v13 offset:2048
    v_mfma_f32_16x16x32_bf16 v[44:47], v[156:159], v[128:131], v[44:47]
    ds_read_b128 v[104:107], v13 offset:4096
    ds_read_b128 v[108:111], v13 offset:6144
    v_mfma_f32_16x16x32_bf16 v[48:51], v[144:147], v[132:135], v[48:51]
    s_add_u32 s36, s40, 17
    s_and_b32 s36, s36, 31
    v_mfma_f32_16x16x32_bf16 v[52:55], v[148:151], v[132:135], v[52:55]
    s_add_u32 m0, s38, 32768
    s_lshl_b32 s36, s36, 7
    v_mfma_f32_16x16x32_bf16 v[56:59], v[152:155], v[132:135], v[56:59]
    buffer_load_dwordx4 v8, s[8:11], s36 offen lds
    buffer_load_dwordx4 v9, s[8:11], s36 offen offset:1024 lds
    v_mfma_f32_16x16x32_bf16 v[60:63], v[156:159], v[132:135], v[60:63]
    s_add_u32 s37, s40, 16
    s_and_b32 s37, s37, 31
    v_mfma_f32_16x16x32_bf16 v[64:67], v[144:147], v[136:139], v[64:67]
    s_lshl_b32 s37, s37, 12
    s_add_u32 m0, s39, 55296
    v_mfma_f32_16x16x32_bf16 v[68:71], v[148:151], v[136:139], v[68:71]
    s_add_u32 s37, s37, s41
    buffer_load_dwordx4 v12, s[12:15], s37 offen offset:2048 lds
    v_mfma_f32_16x16x32_bf16 v[72:75], v[152:155], v[136:139], v[72:75]
    buffer_load_dwordx4 v12, s[12:15], s37 offen offset:3072 lds
    v_mfma_f32_16x16x32_bf16 v[76:79], v[156:159], v[136:139], v[76:79]
    v_mfma_f32_16x16x32_bf16 v[80:83], v[144:147], v[140:143], v[80:83]
    v_mfma_f32_16x16x32_bf16 v[84:87], v[148:151], v[140:143], v[84:87]
    v_mfma_f32_16x16x32_bf16 v[88:91], v[152:155], v[140:143], v[88:91]
    v_mfma_f32_16x16x32_bf16 v[92:95], v[156:159], v[140:143], v[92:95]
    s_waitcnt lgkmcnt(0)
    s_waitcnt vmcnt(8)
    s_barrier
    v_mfma_f32_16x16x32_bf16 v[32:35], v[112:115], v[96:99], v[32:35]
    ds_read_b128 v[144:147], v15 offset:24576
    ds_read_b128 v[148:151], v15 offset:25600
    v_mfma_f32_16x16x32_bf16 v[36:39], v[116:119], v[96:99], v[36:39]
    ds_read_b128 v[152:155], v15 offset:26624
    ds_read_b128 v[156:159], v15 offset:27648
    v_mfma_f32_16x16x32_bf16 v[40:43], v[120:123], v[96:99], v[40:43]
    ds_read_b128 v[128:131], v14 offset:0
    ds_read_b128 v[132:135], v14 offset:2048
    v_mfma_f32_16x16x32_bf16 v[44:47], v[124:127], v[96:99], v[44:47]
    ds_read_b128 v[136:139], v14 offset:4096
    ds_read_b128 v[140:143], v14 offset:6144
    v_mfma_f32_16x16x32_bf16 v[48:51], v[112:115], v[100:103], v[48:51]
    s_add_u32 s36, s40, 17
    s_and_b32 s36, s36, 31
    v_mfma_f32_16x16x32_bf16 v[52:55], v[116:119], v[100:103], v[52:55]
    s_add_u32 m0, s38, 34816
    s_lshl_b32 s36, s36, 7
    v_mfma_f32_16x16x32_bf16 v[56:59], v[120:123], v[100:103], v[56:59]
    buffer_load_dwordx4 v10, s[8:11], s36 offen lds
    buffer_load_dwordx4 v11, s[8:11], s36 offen offset:1024 lds
    v_mfma_f32_16x16x32_bf16 v[60:63], v[124:127], v[100:103], v[60:63]
    s_add_u32 s37, s40, 17
    s_and_b32 s37, s37, 31
    v_mfma_f32_16x16x32_bf16 v[64:67], v[112:115], v[104:107], v[64:67]
    s_lshl_b32 s37, s37, 12
    s_add_u32 m0, s39, 65536
    v_mfma_f32_16x16x32_bf16 v[68:71], v[116:119], v[104:107], v[68:71]
    s_add_u32 s37, s37, s41
    buffer_load_dwordx4 v12, s[12:15], s37 offen offset:0 lds
    v_mfma_f32_16x16x32_bf16 v[72:75], v[120:123], v[104:107], v[72:75]
    buffer_load_dwordx4 v12, s[12:15], s37 offen offset:1024 lds
    v_mfma_f32_16x16x32_bf16 v[76:79], v[124:127], v[104:107], v[76:79]
    v_mfma_f32_16x16x32_bf16 v[80:83], v[112:115], v[108:111], v[80:83]
    v_mfma_f32_16x16x32_bf16 v[84:87], v[116:119], v[108:111], v[84:87]
    v_mfma_f32_16x16x32_bf16 v[88:91], v[120:123], v[108:111], v[88:91]
    v_mfma_f32_16x16x32_bf16 v[92:95], v[124:127], v[108:111], v[92:95]
    s_waitcnt lgkmcnt(0)
    s_waitcnt vmcnt(10)
    s_waitcnt vmcnt(8)
    s_barrier
    v_mfma_f32_16x16x32_bf16 v[32:35], v[144:147], v[128:131], v[32:35]
    ds_read_b128 v[112:115], v15 offset:0
    ds_read_b128 v[116:119], v15 offset:1024
    v_mfma_f32_16x16x32_bf16 v[36:39], v[148:151], v[128:131], v[36:39]
    ds_read_b128 v[120:123], v15 offset:2048
    ds_read_b128 v[124:127], v15 offset:3072
    v_mfma_f32_16x16x32_bf16 v[40:43], v[152:155], v[128:131], v[40:43]
    ds_read_b128 v[96:99], v13 offset:16384
    ds_read_b128 v[100:103], v13 offset:18432
    v_mfma_f32_16x16x32_bf16 v[44:47], v[156:159], v[128:131], v[44:47]
    ds_read_b128 v[104:107], v13 offset:20480
    ds_read_b128 v[108:111], v13 offset:22528
    v_mfma_f32_16x16x32_bf16 v[48:51], v[144:147], v[132:135], v[48:51]
    s_add_u32 s36, s40, 18
    s_and_b32 s36, s36, 31
    v_mfma_f32_16x16x32_bf16 v[52:55], v[148:151], v[132:135], v[52:55]
    s_add_u32 m0, s38, 0
    s_lshl_b32 s36, s36, 7
    v_mfma_f32_16x16x32_bf16 v[56:59], v[152:155], v[132:135], v[56:59]
    buffer_load_dwordx4 v8, s[8:11], s36 offen lds
    buffer_load_dwordx4 v9, s[8:11], s36 offen offset:1024 lds
    v_mfma_f32_16x16x32_bf16 v[60:63], v[156:159], v[132:135], v[60:63]
    s_add_u32 s37, s40, 17
    s_and_b32 s37, s37, 31
    v_mfma_f32_16x16x32_bf16 v[64:67], v[144:147], v[136:139], v[64:67]
    s_lshl_b32 s37, s37, 12
    s_add_u32 m0, s39, 71680
    v_mfma_f32_16x16x32_bf16 v[68:71], v[148:151], v[136:139], v[68:71]
    s_add_u32 s37, s37, s41
    buffer_load_dwordx4 v12, s[12:15], s37 offen offset:2048 lds
    v_mfma_f32_16x16x32_bf16 v[72:75], v[152:155], v[136:139], v[72:75]
    buffer_load_dwordx4 v12, s[12:15], s37 offen offset:3072 lds
    v_mfma_f32_16x16x32_bf16 v[76:79], v[156:159], v[136:139], v[76:79]
    v_mfma_f32_16x16x32_bf16 v[80:83], v[144:147], v[140:143], v[80:83]
    v_mfma_f32_16x16x32_bf16 v[84:87], v[148:151], v[140:143], v[84:87]
    v_mfma_f32_16x16x32_bf16 v[88:91], v[152:155], v[140:143], v[88:91]
    v_mfma_f32_16x16x32_bf16 v[92:95], v[156:159], v[140:143], v[92:95]
    s_waitcnt lgkmcnt(0)
    s_waitcnt vmcnt(8)
    s_barrier
    v_mfma_f32_16x16x32_bf16 v[32:35], v[112:115], v[96:99], v[32:35]
    ds_read_b128 v[144:147], v15 offset:8192
    ds_read_b128 v[148:151], v15 offset:9216
    v_mfma_f32_16x16x32_bf16 v[36:39], v[116:119], v[96:99], v[36:39]
    ds_read_b128 v[152:155], v15 offset:10240
    ds_read_b128 v[156:159], v15 offset:11264
    v_mfma_f32_16x16x32_bf16 v[40:43], v[120:123], v[96:99], v[40:43]
    ds_read_b128 v[128:131], v14 offset:16384
    ds_read_b128 v[132:135], v14 offset:18432
    v_mfma_f32_16x16x32_bf16 v[44:47], v[124:127], v[96:99], v[44:47]
    ds_read_b128 v[136:139], v14 offset:20480
    ds_read_b128 v[140:143], v14 offset:22528
    v_mfma_f32_16x16x32_bf16 v[48:51], v[112:115], v[100:103], v[48:51]
    s_add_u32 s36, s40, 18
    s_and_b32 s36, s36, 31
    v_mfma_f32_16x16x32_bf16 v[52:55], v[116:119], v[100:103], v[52:55]
    s_add_u32 m0, s38, 2048
    s_lshl_b32 s36, s36, 7
    v_mfma_f32_16x16x32_bf16 v[56:59], v[120:123], v[100:103], v[56:59]
    buffer_load_dwordx4 v10, s[8:11], s36 offen lds
    buffer_load_dwordx4 v11, s[8:11], s36 offen offset:1024 lds
    v_mfma_f32_16x16x32_bf16 v[60:63], v[124:127], v[100:103], v[60:63]
    s_add_u32 s37, s40, 18
    s_and_b32 s37, s37, 31
    v_mfma_f32_16x16x32_bf16 v[64:67], v[112:115], v[104:107], v[64:67]
    s_lshl_b32 s37, s37, 12
    s_add_u32 m0, s39, 49152
    v_mfma_f32_16x16x32_bf16 v[68:71], v[116:119], v[104:107], v[68:71]
    s_add_u32 s37, s37, s41
    buffer_load_dwordx4 v12, s[12:15], s37 offen offset:0 lds
    v_mfma_f32_16x16x32_bf16 v[72:75], v[120:123], v[104:107], v[72:75]
    buffer_load_dwordx4 v12, s[12:15], s37 offen offset:1024 lds
    v_mfma_f32_16x16x32_bf16 v[76:79], v[124:127], v[104:107], v[76:79]
    v_mfma_f32_16x16x32_bf16 v[80:83], v[112:115], v[108:111], v[80:83]
    v_mfma_f32_16x16x32_bf16 v[84:87], v[116:119], v[108:111], v[84:87]
    v_mfma_f32_16x16x32_bf16 v[88:91], v[120:123], v[108:111], v[88:91]
    v_mfma_f32_16x16x32_bf16 v[92:95], v[124:127], v[108:111], v[92:95]
    s_waitcnt lgkmcnt(0)
    s_waitcnt vmcnt(10)
    s_waitcnt vmcnt(8)
    s_barrier
    v_mfma_f32_16x16x32_bf16 v[32:35], v[144:147], v[128:131], v[32:35]
    ds_read_b128 v[112:115], v15 offset:16384
    ds_read_b128 v[116:119], v15 offset:17408
    v_mfma_f32_16x16x32_bf16 v[36:39], v[148:151], v[128:131], v[36:39]
    ds_read_b128 v[120:123], v15 offset:18432
    ds_read_b128 v[124:127], v15 offset:19456
    v_mfma_f32_16x16x32_bf16 v[40:43], v[152:155], v[128:131], v[40:43]
    ds_read_b128 v[96:99], v13 offset:32768
    ds_read_b128 v[100:103], v13 offset:34816
    v_mfma_f32_16x16x32_bf16 v[44:47], v[156:159], v[128:131], v[44:47]
    ds_read_b128 v[104:107], v13 offset:36864
    ds_read_b128 v[108:111], v13 offset:38912
    v_mfma_f32_16x16x32_bf16 v[48:51], v[144:147], v[132:135], v[48:51]
    s_add_u32 s36, s40, 19
    s_and_b32 s36, s36, 31
    v_mfma_f32_16x16x32_bf16 v[52:55], v[148:151], v[132:135], v[52:55]
    s_add_u32 m0, s38, 16384
    s_lshl_b32 s36, s36, 7
    v_mfma_f32_16x16x32_bf16 v[56:59], v[152:155], v[132:135], v[56:59]
    buffer_load_dwordx4 v8, s[8:11], s36 offen lds
    buffer_load_dwordx4 v9, s[8:11], s36 offen offset:1024 lds
    v_mfma_f32_16x16x32_bf16 v[60:63], v[156:159], v[132:135], v[60:63]
    s_add_u32 s37, s40, 18
    s_and_b32 s37, s37, 31
    v_mfma_f32_16x16x32_bf16 v[64:67], v[144:147], v[136:139], v[64:67]
    s_lshl_b32 s37, s37, 12
    s_add_u32 m0, s39, 55296
    v_mfma_f32_16x16x32_bf16 v[68:71], v[148:151], v[136:139], v[68:71]
    s_add_u32 s37, s37, s41
    buffer_load_dwordx4 v12, s[12:15], s37 offen offset:2048 lds
    v_mfma_f32_16x16x32_bf16 v[72:75], v[152:155], v[136:139], v[72:75]
    buffer_load_dwordx4 v12, s[12:15], s37 offen offset:3072 lds
    v_mfma_f32_16x16x32_bf16 v[76:79], v[156:159], v[136:139], v[76:79]
    v_mfma_f32_16x16x32_bf16 v[80:83], v[144:147], v[140:143], v[80:83]
    v_mfma_f32_16x16x32_bf16 v[84:87], v[148:151], v[140:143], v[84:87]
    v_mfma_f32_16x16x32_bf16 v[88:91], v[152:155], v[140:143], v[88:91]
    v_mfma_f32_16x16x32_bf16 v[92:95], v[156:159], v[140:143], v[92:95]
    s_waitcnt lgkmcnt(0)
    s_waitcnt vmcnt(8)
    s_barrier
    v_mfma_f32_16x16x32_bf16 v[32:35], v[112:115], v[96:99], v[32:35]
    ds_read_b128 v[144:147], v15 offset:24576
    ds_read_b128 v[148:151], v15 offset:25600
    v_mfma_f32_16x16x32_bf16 v[36:39], v[116:119], v[96:99], v[36:39]
    ds_read_b128 v[152:155], v15 offset:26624
    ds_read_b128 v[156:159], v15 offset:27648
    v_mfma_f32_16x16x32_bf16 v[40:43], v[120:123], v[96:99], v[40:43]
    ds_read_b128 v[128:131], v14 offset:32768
    ds_read_b128 v[132:135], v14 offset:34816
    v_mfma_f32_16x16x32_bf16 v[44:47], v[124:127], v[96:99], v[44:47]
    ds_read_b128 v[136:139], v14 offset:36864
    ds_read_b128 v[140:143], v14 offset:38912
    v_mfma_f32_16x16x32_bf16 v[48:51], v[112:115], v[100:103], v[48:51]
    s_add_u32 s36, s40, 19
    s_and_b32 s36, s36, 31
    v_mfma_f32_16x16x32_bf16 v[52:55], v[116:119], v[100:103], v[52:55]
    s_add_u32 m0, s38, 18432
    s_lshl_b32 s36, s36, 7
    v_mfma_f32_16x16x32_bf16 v[56:59], v[120:123], v[100:103], v[56:59]
    buffer_load_dwordx4 v10, s[8:11], s36 offen lds
    buffer_load_dwordx4 v11, s[8:11], s36 offen offset:1024 lds
    v_mfma_f32_16x16x32_bf16 v[60:63], v[124:127], v[100:103], v[60:63]
    s_add_u32 s37, s40, 19
    s_and_b32 s37, s37, 31
    v_mfma_f32_16x16x32_bf16 v[64:67], v[112:115], v[104:107], v[64:67]
    s_lshl_b32 s37, s37, 12
    s_add_u32 m0, s39, 65536
    v_mfma_f32_16x16x32_bf16 v[68:71], v[116:119], v[104:107], v[68:71]
    s_add_u32 s37, s37, s41
    buffer_load_dwordx4 v12, s[12:15], s37 offen offset:0 lds
    v_mfma_f32_16x16x32_bf16 v[72:75], v[120:123], v[104:107], v[72:75]
    buffer_load_dwordx4 v12, s[12:15], s37 offen offset:1024 lds
    v_mfma_f32_16x16x32_bf16 v[76:79], v[124:127], v[104:107], v[76:79]
    v_mfma_f32_16x16x32_bf16 v[80:83], v[112:115], v[108:111], v[80:83]
    v_mfma_f32_16x16x32_bf16 v[84:87], v[116:119], v[108:111], v[84:87]
    v_mfma_f32_16x16x32_bf16 v[88:91], v[120:123], v[108:111], v[88:91]
    v_mfma_f32_16x16x32_bf16 v[92:95], v[124:127], v[108:111], v[92:95]
    s_waitcnt lgkmcnt(0)
    s_waitcnt vmcnt(10)
    s_waitcnt vmcnt(8)
    s_barrier
    v_mfma_f32_16x16x32_bf16 v[32:35], v[144:147], v[128:131], v[32:35]
    ds_read_b128 v[112:115], v15 offset:0
    ds_read_b128 v[116:119], v15 offset:1024
    v_mfma_f32_16x16x32_bf16 v[36:39], v[148:151], v[128:131], v[36:39]
    ds_read_b128 v[120:123], v15 offset:2048
    ds_read_b128 v[124:127], v15 offset:3072
    v_mfma_f32_16x16x32_bf16 v[40:43], v[152:155], v[128:131], v[40:43]
    ds_read_b128 v[96:99], v13 offset:0
    ds_read_b128 v[100:103], v13 offset:2048
    v_mfma_f32_16x16x32_bf16 v[44:47], v[156:159], v[128:131], v[44:47]
    ds_read_b128 v[104:107], v13 offset:4096
    ds_read_b128 v[108:111], v13 offset:6144
    v_mfma_f32_16x16x32_bf16 v[48:51], v[144:147], v[132:135], v[48:51]
    s_add_u32 s36, s40, 20
    s_and_b32 s36, s36, 31
    v_mfma_f32_16x16x32_bf16 v[52:55], v[148:151], v[132:135], v[52:55]
    s_add_u32 m0, s38, 32768
    s_lshl_b32 s36, s36, 7
    v_mfma_f32_16x16x32_bf16 v[56:59], v[152:155], v[132:135], v[56:59]
    buffer_load_dwordx4 v8, s[8:11], s36 offen lds
    buffer_load_dwordx4 v9, s[8:11], s36 offen offset:1024 lds
    v_mfma_f32_16x16x32_bf16 v[60:63], v[156:159], v[132:135], v[60:63]
    s_add_u32 s37, s40, 19
    s_and_b32 s37, s37, 31
    v_mfma_f32_16x16x32_bf16 v[64:67], v[144:147], v[136:139], v[64:67]
    s_lshl_b32 s37, s37, 12
    s_add_u32 m0, s39, 71680
    v_mfma_f32_16x16x32_bf16 v[68:71], v[148:151], v[136:139], v[68:71]
    s_add_u32 s37, s37, s41
    buffer_load_dwordx4 v12, s[12:15], s37 offen offset:2048 lds
    v_mfma_f32_16x16x32_bf16 v[72:75], v[152:155], v[136:139], v[72:75]
    buffer_load_dwordx4 v12, s[12:15], s37 offen offset:3072 lds
    v_mfma_f32_16x16x32_bf16 v[76:79], v[156:159], v[136:139], v[76:79]
    v_mfma_f32_16x16x32_bf16 v[80:83], v[144:147], v[140:143], v[80:83]
    v_mfma_f32_16x16x32_bf16 v[84:87], v[148:151], v[140:143], v[84:87]
    v_mfma_f32_16x16x32_bf16 v[88:91], v[152:155], v[140:143], v[88:91]
    v_mfma_f32_16x16x32_bf16 v[92:95], v[156:159], v[140:143], v[92:95]
    s_waitcnt lgkmcnt(0)
    s_waitcnt vmcnt(8)
    s_barrier
    v_mfma_f32_16x16x32_bf16 v[32:35], v[112:115], v[96:99], v[32:35]
    ds_read_b128 v[144:147], v15 offset:8192
    ds_read_b128 v[148:151], v15 offset:9216
    v_mfma_f32_16x16x32_bf16 v[36:39], v[116:119], v[96:99], v[36:39]
    ds_read_b128 v[152:155], v15 offset:10240
    ds_read_b128 v[156:159], v15 offset:11264
    v_mfma_f32_16x16x32_bf16 v[40:43], v[120:123], v[96:99], v[40:43]
    ds_read_b128 v[128:131], v14 offset:0
    ds_read_b128 v[132:135], v14 offset:2048
    v_mfma_f32_16x16x32_bf16 v[44:47], v[124:127], v[96:99], v[44:47]
    ds_read_b128 v[136:139], v14 offset:4096
    ds_read_b128 v[140:143], v14 offset:6144
    v_mfma_f32_16x16x32_bf16 v[48:51], v[112:115], v[100:103], v[48:51]
    s_add_u32 s36, s40, 20
    s_and_b32 s36, s36, 31
    v_mfma_f32_16x16x32_bf16 v[52:55], v[116:119], v[100:103], v[52:55]
    s_add_u32 m0, s38, 34816
    s_lshl_b32 s36, s36, 7
    v_mfma_f32_16x16x32_bf16 v[56:59], v[120:123], v[100:103], v[56:59]
    buffer_load_dwordx4 v10, s[8:11], s36 offen lds
    buffer_load_dwordx4 v11, s[8:11], s36 offen offset:1024 lds
    v_mfma_f32_16x16x32_bf16 v[60:63], v[124:127], v[100:103], v[60:63]
    s_add_u32 s37, s40, 20
    s_and_b32 s37, s37, 31
    v_mfma_f32_16x16x32_bf16 v[64:67], v[112:115], v[104:107], v[64:67]
    s_lshl_b32 s37, s37, 12
    s_add_u32 m0, s39, 49152
    v_mfma_f32_16x16x32_bf16 v[68:71], v[116:119], v[104:107], v[68:71]
    s_add_u32 s37, s37, s41
    buffer_load_dwordx4 v12, s[12:15], s37 offen offset:0 lds
    v_mfma_f32_16x16x32_bf16 v[72:75], v[120:123], v[104:107], v[72:75]
    buffer_load_dwordx4 v12, s[12:15], s37 offen offset:1024 lds
    v_mfma_f32_16x16x32_bf16 v[76:79], v[124:127], v[104:107], v[76:79]
    v_mfma_f32_16x16x32_bf16 v[80:83], v[112:115], v[108:111], v[80:83]
    v_mfma_f32_16x16x32_bf16 v[84:87], v[116:119], v[108:111], v[84:87]
    v_mfma_f32_16x16x32_bf16 v[88:91], v[120:123], v[108:111], v[88:91]
    v_mfma_f32_16x16x32_bf16 v[92:95], v[124:127], v[108:111], v[92:95]
    s_waitcnt lgkmcnt(0)
    s_waitcnt vmcnt(10)
    s_waitcnt vmcnt(8)
    s_barrier
    v_mfma_f32_16x16x32_bf16 v[32:35], v[144:147], v[128:131], v[32:35]
    ds_read_b128 v[112:115], v15 offset:16384
    ds_read_b128 v[116:119], v15 offset:17408
    v_mfma_f32_16x16x32_bf16 v[36:39], v[148:151], v[128:131], v[36:39]
    ds_read_b128 v[120:123], v15 offset:18432
    ds_read_b128 v[124:127], v15 offset:19456
    v_mfma_f32_16x16x32_bf16 v[40:43], v[152:155], v[128:131], v[40:43]
    ds_read_b128 v[96:99], v13 offset:16384
    ds_read_b128 v[100:103], v13 offset:18432
    v_mfma_f32_16x16x32_bf16 v[44:47], v[156:159], v[128:131], v[44:47]
    ds_read_b128 v[104:107], v13 offset:20480
    ds_read_b128 v[108:111], v13 offset:22528
    v_mfma_f32_16x16x32_bf16 v[48:51], v[144:147], v[132:135], v[48:51]
    s_add_u32 s36, s40, 21
    s_and_b32 s36, s36, 31
    v_mfma_f32_16x16x32_bf16 v[52:55], v[148:151], v[132:135], v[52:55]
    s_add_u32 m0, s38, 0
    s_lshl_b32 s36, s36, 7
    v_mfma_f32_16x16x32_bf16 v[56:59], v[152:155], v[132:135], v[56:59]
    buffer_load_dwordx4 v8, s[8:11], s36 offen lds
    buffer_load_dwordx4 v9, s[8:11], s36 offen offset:1024 lds
    v_mfma_f32_16x16x32_bf16 v[60:63], v[156:159], v[132:135], v[60:63]
    s_add_u32 s37, s40, 20
    s_and_b32 s37, s37, 31
    v_mfma_f32_16x16x32_bf16 v[64:67], v[144:147], v[136:139], v[64:67]
    s_lshl_b32 s37, s37, 12
    s_add_u32 m0, s39, 55296
    v_mfma_f32_16x16x32_bf16 v[68:71], v[148:151], v[136:139], v[68:71]
    s_add_u32 s37, s37, s41
    buffer_load_dwordx4 v12, s[12:15], s37 offen offset:2048 lds
    v_mfma_f32_16x16x32_bf16 v[72:75], v[152:155], v[136:139], v[72:75]
    buffer_load_dwordx4 v12, s[12:15], s37 offen offset:3072 lds
    v_mfma_f32_16x16x32_bf16 v[76:79], v[156:159], v[136:139], v[76:79]
    v_mfma_f32_16x16x32_bf16 v[80:83], v[144:147], v[140:143], v[80:83]
    v_mfma_f32_16x16x32_bf16 v[84:87], v[148:151], v[140:143], v[84:87]
    v_mfma_f32_16x16x32_bf16 v[88:91], v[152:155], v[140:143], v[88:91]
    v_mfma_f32_16x16x32_bf16 v[92:95], v[156:159], v[140:143], v[92:95]
    s_waitcnt lgkmcnt(0)
    s_waitcnt vmcnt(8)
    s_barrier
    v_mfma_f32_16x16x32_bf16 v[32:35], v[112:115], v[96:99], v[32:35]
    ds_read_b128 v[144:147], v15 offset:24576
    ds_read_b128 v[148:151], v15 offset:25600
    v_mfma_f32_16x16x32_bf16 v[36:39], v[116:119], v[96:99], v[36:39]
    ds_read_b128 v[152:155], v15 offset:26624
    ds_read_b128 v[156:159], v15 offset:27648
    v_mfma_f32_16x16x32_bf16 v[40:43], v[120:123], v[96:99], v[40:43]
    ds_read_b128 v[128:131], v14 offset:16384
    ds_read_b128 v[132:135], v14 offset:18432
    v_mfma_f32_16x16x32_bf16 v[44:47], v[124:127], v[96:99], v[44:47]
    ds_read_b128 v[136:139], v14 offset:20480
    ds_read_b128 v[140:143], v14 offset:22528
    v_mfma_f32_16x16x32_bf16 v[48:51], v[112:115], v[100:103], v[48:51]
    s_add_u32 s36, s40, 21
    s_and_b32 s36, s36, 31
    v_mfma_f32_16x16x32_bf16 v[52:55], v[116:119], v[100:103], v[52:55]
    s_add_u32 m0, s38, 2048
    s_lshl_b32 s36, s36, 7
    v_mfma_f32_16x16x32_bf16 v[56:59], v[120:123], v[100:103], v[56:59]
    buffer_load_dwordx4 v10, s[8:11], s36 offen lds
    buffer_load_dwordx4 v11, s[8:11], s36 offen offset:1024 lds
    v_mfma_f32_16x16x32_bf16 v[60:63], v[124:127], v[100:103], v[60:63]
    s_add_u32 s37, s40, 21
    s_and_b32 s37, s37, 31
    v_mfma_f32_16x16x32_bf16 v[64:67], v[112:115], v[104:107], v[64:67]
    s_lshl_b32 s37, s37, 12
    s_add_u32 m0, s39, 65536
    v_mfma_f32_16x16x32_bf16 v[68:71], v[116:119], v[104:107], v[68:71]
    s_add_u32 s37, s37, s41
    buffer_load_dwordx4 v12, s[12:15], s37 offen offset:0 lds
    v_mfma_f32_16x16x32_bf16 v[72:75], v[120:123], v[104:107], v[72:75]
    buffer_load_dwordx4 v12, s[12:15], s37 offen offset:1024 lds
    v_mfma_f32_16x16x32_bf16 v[76:79], v[124:127], v[104:107], v[76:79]
    v_mfma_f32_16x16x32_bf16 v[80:83], v[112:115], v[108:111], v[80:83]
    v_mfma_f32_16x16x32_bf16 v[84:87], v[116:119], v[108:111], v[84:87]
    v_mfma_f32_16x16x32_bf16 v[88:91], v[120:123], v[108:111], v[88:91]
    v_mfma_f32_16x16x32_bf16 v[92:95], v[124:127], v[108:111], v[92:95]
    s_waitcnt lgkmcnt(0)
    s_waitcnt vmcnt(10)
    s_waitcnt vmcnt(8)
    s_barrier
    v_mfma_f32_16x16x32_bf16 v[32:35], v[144:147], v[128:131], v[32:35]
    ds_read_b128 v[112:115], v15 offset:0
    ds_read_b128 v[116:119], v15 offset:1024
    v_mfma_f32_16x16x32_bf16 v[36:39], v[148:151], v[128:131], v[36:39]
    ds_read_b128 v[120:123], v15 offset:2048
    ds_read_b128 v[124:127], v15 offset:3072
    v_mfma_f32_16x16x32_bf16 v[40:43], v[152:155], v[128:131], v[40:43]
    ds_read_b128 v[96:99], v13 offset:32768
    ds_read_b128 v[100:103], v13 offset:34816
    v_mfma_f32_16x16x32_bf16 v[44:47], v[156:159], v[128:131], v[44:47]
    ds_read_b128 v[104:107], v13 offset:36864
    ds_read_b128 v[108:111], v13 offset:38912
    v_mfma_f32_16x16x32_bf16 v[48:51], v[144:147], v[132:135], v[48:51]
    s_add_u32 s36, s40, 22
    s_and_b32 s36, s36, 31
    v_mfma_f32_16x16x32_bf16 v[52:55], v[148:151], v[132:135], v[52:55]
    s_add_u32 m0, s38, 16384
    s_lshl_b32 s36, s36, 7
    v_mfma_f32_16x16x32_bf16 v[56:59], v[152:155], v[132:135], v[56:59]
    buffer_load_dwordx4 v8, s[8:11], s36 offen lds
    buffer_load_dwordx4 v9, s[8:11], s36 offen offset:1024 lds
    v_mfma_f32_16x16x32_bf16 v[60:63], v[156:159], v[132:135], v[60:63]
    s_add_u32 s37, s40, 21
    s_and_b32 s37, s37, 31
    v_mfma_f32_16x16x32_bf16 v[64:67], v[144:147], v[136:139], v[64:67]
    s_lshl_b32 s37, s37, 12
    s_add_u32 m0, s39, 71680
    v_mfma_f32_16x16x32_bf16 v[68:71], v[148:151], v[136:139], v[68:71]
    s_add_u32 s37, s37, s41
    buffer_load_dwordx4 v12, s[12:15], s37 offen offset:2048 lds
    v_mfma_f32_16x16x32_bf16 v[72:75], v[152:155], v[136:139], v[72:75]
    buffer_load_dwordx4 v12, s[12:15], s37 offen offset:3072 lds
    v_mfma_f32_16x16x32_bf16 v[76:79], v[156:159], v[136:139], v[76:79]
    v_mfma_f32_16x16x32_bf16 v[80:83], v[144:147], v[140:143], v[80:83]
    v_mfma_f32_16x16x32_bf16 v[84:87], v[148:151], v[140:143], v[84:87]
    v_mfma_f32_16x16x32_bf16 v[88:91], v[152:155], v[140:143], v[88:91]
    v_mfma_f32_16x16x32_bf16 v[92:95], v[156:159], v[140:143], v[92:95]
    s_waitcnt lgkmcnt(0)
    s_waitcnt vmcnt(8)
    s_barrier
    v_mfma_f32_16x16x32_bf16 v[32:35], v[112:115], v[96:99], v[32:35]
    ds_read_b128 v[144:147], v15 offset:8192
    ds_read_b128 v[148:151], v15 offset:9216
    v_mfma_f32_16x16x32_bf16 v[36:39], v[116:119], v[96:99], v[36:39]
    ds_read_b128 v[152:155], v15 offset:10240
    ds_read_b128 v[156:159], v15 offset:11264
    v_mfma_f32_16x16x32_bf16 v[40:43], v[120:123], v[96:99], v[40:43]
    ds_read_b128 v[128:131], v14 offset:32768
    ds_read_b128 v[132:135], v14 offset:34816
    v_mfma_f32_16x16x32_bf16 v[44:47], v[124:127], v[96:99], v[44:47]
    ds_read_b128 v[136:139], v14 offset:36864
    ds_read_b128 v[140:143], v14 offset:38912
    v_mfma_f32_16x16x32_bf16 v[48:51], v[112:115], v[100:103], v[48:51]
    s_add_u32 s36, s40, 22
    s_and_b32 s36, s36, 31
    v_mfma_f32_16x16x32_bf16 v[52:55], v[116:119], v[100:103], v[52:55]
    s_add_u32 m0, s38, 18432
    s_lshl_b32 s36, s36, 7
    v_mfma_f32_16x16x32_bf16 v[56:59], v[120:123], v[100:103], v[56:59]
    buffer_load_dwordx4 v10, s[8:11], s36 offen lds
    buffer_load_dwordx4 v11, s[8:11], s36 offen offset:1024 lds
    v_mfma_f32_16x16x32_bf16 v[60:63], v[124:127], v[100:103], v[60:63]
    s_add_u32 s37, s40, 22
    s_and_b32 s37, s37, 31
    v_mfma_f32_16x16x32_bf16 v[64:67], v[112:115], v[104:107], v[64:67]
    s_lshl_b32 s37, s37, 12
    s_add_u32 m0, s39, 49152
    v_mfma_f32_16x16x32_bf16 v[68:71], v[116:119], v[104:107], v[68:71]
    s_add_u32 s37, s37, s41
    buffer_load_dwordx4 v12, s[12:15], s37 offen offset:0 lds
    v_mfma_f32_16x16x32_bf16 v[72:75], v[120:123], v[104:107], v[72:75]
    buffer_load_dwordx4 v12, s[12:15], s37 offen offset:1024 lds
    v_mfma_f32_16x16x32_bf16 v[76:79], v[124:127], v[104:107], v[76:79]
    v_mfma_f32_16x16x32_bf16 v[80:83], v[112:115], v[108:111], v[80:83]
    v_mfma_f32_16x16x32_bf16 v[84:87], v[116:119], v[108:111], v[84:87]
    v_mfma_f32_16x16x32_bf16 v[88:91], v[120:123], v[108:111], v[88:91]
    v_mfma_f32_16x16x32_bf16 v[92:95], v[124:127], v[108:111], v[92:95]
    s_waitcnt lgkmcnt(0)
    s_waitcnt vmcnt(10)
    s_waitcnt vmcnt(8)
    s_barrier
    v_mfma_f32_16x16x32_bf16 v[32:35], v[144:147], v[128:131], v[32:35]
    ds_read_b128 v[112:115], v15 offset:16384
    ds_read_b128 v[116:119], v15 offset:17408
    v_mfma_f32_16x16x32_bf16 v[36:39], v[148:151], v[128:131], v[36:39]
    ds_read_b128 v[120:123], v15 offset:18432
    ds_read_b128 v[124:127], v15 offset:19456
    v_mfma_f32_16x16x32_bf16 v[40:43], v[152:155], v[128:131], v[40:43]
    ds_read_b128 v[96:99], v13 offset:0
    ds_read_b128 v[100:103], v13 offset:2048
    v_mfma_f32_16x16x32_bf16 v[44:47], v[156:159], v[128:131], v[44:47]
    ds_read_b128 v[104:107], v13 offset:4096
    ds_read_b128 v[108:111], v13 offset:6144
    v_mfma_f32_16x16x32_bf16 v[48:51], v[144:147], v[132:135], v[48:51]
    s_add_u32 s36, s40, 23
    s_and_b32 s36, s36, 31
    v_mfma_f32_16x16x32_bf16 v[52:55], v[148:151], v[132:135], v[52:55]
    s_add_u32 m0, s38, 32768
    s_lshl_b32 s36, s36, 7
    v_mfma_f32_16x16x32_bf16 v[56:59], v[152:155], v[132:135], v[56:59]
    buffer_load_dwordx4 v8, s[8:11], s36 offen lds
    buffer_load_dwordx4 v9, s[8:11], s36 offen offset:1024 lds
    v_mfma_f32_16x16x32_bf16 v[60:63], v[156:159], v[132:135], v[60:63]
    s_add_u32 s37, s40, 22
    s_and_b32 s37, s37, 31
    v_mfma_f32_16x16x32_bf16 v[64:67], v[144:147], v[136:139], v[64:67]
    s_lshl_b32 s37, s37, 12
    s_add_u32 m0, s39, 55296
    v_mfma_f32_16x16x32_bf16 v[68:71], v[148:151], v[136:139], v[68:71]
    s_add_u32 s37, s37, s41
    buffer_load_dwordx4 v12, s[12:15], s37 offen offset:2048 lds
    v_mfma_f32_16x16x32_bf16 v[72:75], v[152:155], v[136:139], v[72:75]
    buffer_load_dwordx4 v12, s[12:15], s37 offen offset:3072 lds
    v_mfma_f32_16x16x32_bf16 v[76:79], v[156:159], v[136:139], v[76:79]
    v_mfma_f32_16x16x32_bf16 v[80:83], v[144:147], v[140:143], v[80:83]
    v_mfma_f32_16x16x32_bf16 v[84:87], v[148:151], v[140:143], v[84:87]
    v_mfma_f32_16x16x32_bf16 v[88:91], v[152:155], v[140:143], v[88:91]
    v_mfma_f32_16x16x32_bf16 v[92:95], v[156:159], v[140:143], v[92:95]
    s_waitcnt lgkmcnt(0)
    s_waitcnt vmcnt(8)
    s_barrier
    v_mfma_f32_16x16x32_bf16 v[32:35], v[112:115], v[96:99], v[32:35]
    ds_read_b128 v[144:147], v15 offset:24576
    ds_read_b128 v[148:151], v15 offset:25600
    v_mfma_f32_16x16x32_bf16 v[36:39], v[116:119], v[96:99], v[36:39]
    ds_read_b128 v[152:155], v15 offset:26624
    ds_read_b128 v[156:159], v15 offset:27648
    v_mfma_f32_16x16x32_bf16 v[40:43], v[120:123], v[96:99], v[40:43]
    ds_read_b128 v[128:131], v14 offset:0
    ds_read_b128 v[132:135], v14 offset:2048
    v_mfma_f32_16x16x32_bf16 v[44:47], v[124:127], v[96:99], v[44:47]
    ds_read_b128 v[136:139], v14 offset:4096
    ds_read_b128 v[140:143], v14 offset:6144
    v_mfma_f32_16x16x32_bf16 v[48:51], v[112:115], v[100:103], v[48:51]
    s_add_u32 s36, s40, 23
    s_and_b32 s36, s36, 31
    v_mfma_f32_16x16x32_bf16 v[52:55], v[116:119], v[100:103], v[52:55]
    s_add_u32 m0, s38, 34816
    s_lshl_b32 s36, s36, 7
    v_mfma_f32_16x16x32_bf16 v[56:59], v[120:123], v[100:103], v[56:59]
    buffer_load_dwordx4 v10, s[8:11], s36 offen lds
    buffer_load_dwordx4 v11, s[8:11], s36 offen offset:1024 lds
    v_mfma_f32_16x16x32_bf16 v[60:63], v[124:127], v[100:103], v[60:63]
    s_add_u32 s37, s40, 23
    s_and_b32 s37, s37, 31
    v_mfma_f32_16x16x32_bf16 v[64:67], v[112:115], v[104:107], v[64:67]
    s_lshl_b32 s37, s37, 12
    s_add_u32 m0, s39, 65536
    v_mfma_f32_16x16x32_bf16 v[68:71], v[116:119], v[104:107], v[68:71]
    s_add_u32 s37, s37, s41
    buffer_load_dwordx4 v12, s[12:15], s37 offen offset:0 lds
    v_mfma_f32_16x16x32_bf16 v[72:75], v[120:123], v[104:107], v[72:75]
    buffer_load_dwordx4 v12, s[12:15], s37 offen offset:1024 lds
    v_mfma_f32_16x16x32_bf16 v[76:79], v[124:127], v[104:107], v[76:79]
    v_mfma_f32_16x16x32_bf16 v[80:83], v[112:115], v[108:111], v[80:83]
    v_mfma_f32_16x16x32_bf16 v[84:87], v[116:119], v[108:111], v[84:87]
    v_mfma_f32_16x16x32_bf16 v[88:91], v[120:123], v[108:111], v[88:91]
    v_mfma_f32_16x16x32_bf16 v[92:95], v[124:127], v[108:111], v[92:95]
    s_waitcnt lgkmcnt(0)
    s_waitcnt vmcnt(10)
    s_waitcnt vmcnt(8)
    s_barrier
    v_mfma_f32_16x16x32_bf16 v[32:35], v[144:147], v[128:131], v[32:35]
    ds_read_b128 v[112:115], v15 offset:0
    ds_read_b128 v[116:119], v15 offset:1024
    v_mfma_f32_16x16x32_bf16 v[36:39], v[148:151], v[128:131], v[36:39]
    ds_read_b128 v[120:123], v15 offset:2048
    ds_read_b128 v[124:127], v15 offset:3072
    v_mfma_f32_16x16x32_bf16 v[40:43], v[152:155], v[128:131], v[40:43]
    ds_read_b128 v[96:99], v13 offset:16384
    ds_read_b128 v[100:103], v13 offset:18432
    v_mfma_f32_16x16x32_bf16 v[44:47], v[156:159], v[128:131], v[44:47]
    ds_read_b128 v[104:107], v13 offset:20480
    ds_read_b128 v[108:111], v13 offset:22528
    v_mfma_f32_16x16x32_bf16 v[48:51], v[144:147], v[132:135], v[48:51]
    s_add_u32 s36, s40, 24
    s_and_b32 s36, s36, 31
    v_mfma_f32_16x16x32_bf16 v[52:55], v[148:151], v[132:135], v[52:55]
    s_add_u32 m0, s38, 0
    s_lshl_b32 s36, s36, 7
    v_mfma_f32_16x16x32_bf16 v[56:59], v[152:155], v[132:135], v[56:59]
    buffer_load_dwordx4 v8, s[8:11], s36 offen lds
    buffer_load_dwordx4 v9, s[8:11], s36 offen offset:1024 lds
    v_mfma_f32_16x16x32_bf16 v[60:63], v[156:159], v[132:135], v[60:63]
    s_add_u32 s37, s40, 23
    s_and_b32 s37, s37, 31
    v_mfma_f32_16x16x32_bf16 v[64:67], v[144:147], v[136:139], v[64:67]
    s_lshl_b32 s37, s37, 12
    s_add_u32 m0, s39, 71680
    v_mfma_f32_16x16x32_bf16 v[68:71], v[148:151], v[136:139], v[68:71]
    s_add_u32 s37, s37, s41
    buffer_load_dwordx4 v12, s[12:15], s37 offen offset:2048 lds
    v_mfma_f32_16x16x32_bf16 v[72:75], v[152:155], v[136:139], v[72:75]
    buffer_load_dwordx4 v12, s[12:15], s37 offen offset:3072 lds
    v_mfma_f32_16x16x32_bf16 v[76:79], v[156:159], v[136:139], v[76:79]
    v_mfma_f32_16x16x32_bf16 v[80:83], v[144:147], v[140:143], v[80:83]
    v_mfma_f32_16x16x32_bf16 v[84:87], v[148:151], v[140:143], v[84:87]
    v_mfma_f32_16x16x32_bf16 v[88:91], v[152:155], v[140:143], v[88:91]
    v_mfma_f32_16x16x32_bf16 v[92:95], v[156:159], v[140:143], v[92:95]
    s_waitcnt lgkmcnt(0)
    s_waitcnt vmcnt(8)
    s_barrier
    v_mfma_f32_16x16x32_bf16 v[32:35], v[112:115], v[96:99], v[32:35]
    ds_read_b128 v[144:147], v15 offset:8192
    ds_read_b128 v[148:151], v15 offset:9216
    v_mfma_f32_16x16x32_bf16 v[36:39], v[116:119], v[96:99], v[36:39]
    ds_read_b128 v[152:155], v15 offset:10240
    ds_read_b128 v[156:159], v15 offset:11264
    v_mfma_f32_16x16x32_bf16 v[40:43], v[120:123], v[96:99], v[40:43]
    ds_read_b128 v[128:131], v14 offset:16384
    ds_read_b128 v[132:135], v14 offset:18432
    v_mfma_f32_16x16x32_bf16 v[44:47], v[124:127], v[96:99], v[44:47]
    ds_read_b128 v[136:139], v14 offset:20480
    ds_read_b128 v[140:143], v14 offset:22528
    v_mfma_f32_16x16x32_bf16 v[48:51], v[112:115], v[100:103], v[48:51]
    s_add_u32 s36, s40, 24
    s_and_b32 s36, s36, 31
    v_mfma_f32_16x16x32_bf16 v[52:55], v[116:119], v[100:103], v[52:55]
    s_add_u32 m0, s38, 2048
    s_lshl_b32 s36, s36, 7
    v_mfma_f32_16x16x32_bf16 v[56:59], v[120:123], v[100:103], v[56:59]
    buffer_load_dwordx4 v10, s[8:11], s36 offen lds
    buffer_load_dwordx4 v11, s[8:11], s36 offen offset:1024 lds
    v_mfma_f32_16x16x32_bf16 v[60:63], v[124:127], v[100:103], v[60:63]
    s_add_u32 s37, s40, 24
    s_and_b32 s37, s37, 31
    v_mfma_f32_16x16x32_bf16 v[64:67], v[112:115], v[104:107], v[64:67]
    s_lshl_b32 s37, s37, 12
    s_add_u32 m0, s39, 49152
    v_mfma_f32_16x16x32_bf16 v[68:71], v[116:119], v[104:107], v[68:71]
    s_add_u32 s37, s37, s41
    buffer_load_dwordx4 v12, s[12:15], s37 offen offset:0 lds
    v_mfma_f32_16x16x32_bf16 v[72:75], v[120:123], v[104:107], v[72:75]
    buffer_load_dwordx4 v12, s[12:15], s37 offen offset:1024 lds
    v_mfma_f32_16x16x32_bf16 v[76:79], v[124:127], v[104:107], v[76:79]
    v_mfma_f32_16x16x32_bf16 v[80:83], v[112:115], v[108:111], v[80:83]
    v_mfma_f32_16x16x32_bf16 v[84:87], v[116:119], v[108:111], v[84:87]
    v_mfma_f32_16x16x32_bf16 v[88:91], v[120:123], v[108:111], v[88:91]
    v_mfma_f32_16x16x32_bf16 v[92:95], v[124:127], v[108:111], v[92:95]
    s_waitcnt lgkmcnt(0)
    s_waitcnt vmcnt(10)
    s_waitcnt vmcnt(8)
    s_barrier
    v_mfma_f32_16x16x32_bf16 v[32:35], v[144:147], v[128:131], v[32:35]
    ds_read_b128 v[112:115], v15 offset:16384
    ds_read_b128 v[116:119], v15 offset:17408
    v_mfma_f32_16x16x32_bf16 v[36:39], v[148:151], v[128:131], v[36:39]
    ds_read_b128 v[120:123], v15 offset:18432
    ds_read_b128 v[124:127], v15 offset:19456
    v_mfma_f32_16x16x32_bf16 v[40:43], v[152:155], v[128:131], v[40:43]
    ds_read_b128 v[96:99], v13 offset:32768
    ds_read_b128 v[100:103], v13 offset:34816
    v_mfma_f32_16x16x32_bf16 v[44:47], v[156:159], v[128:131], v[44:47]
    ds_read_b128 v[104:107], v13 offset:36864
    ds_read_b128 v[108:111], v13 offset:38912
    v_mfma_f32_16x16x32_bf16 v[48:51], v[144:147], v[132:135], v[48:51]
    s_add_u32 s36, s40, 25
    s_and_b32 s36, s36, 31
    v_mfma_f32_16x16x32_bf16 v[52:55], v[148:151], v[132:135], v[52:55]
    s_add_u32 m0, s38, 16384
    s_lshl_b32 s36, s36, 7
    v_mfma_f32_16x16x32_bf16 v[56:59], v[152:155], v[132:135], v[56:59]
    buffer_load_dwordx4 v8, s[8:11], s36 offen lds
    buffer_load_dwordx4 v9, s[8:11], s36 offen offset:1024 lds
    v_mfma_f32_16x16x32_bf16 v[60:63], v[156:159], v[132:135], v[60:63]
    s_add_u32 s37, s40, 24
    s_and_b32 s37, s37, 31
    v_mfma_f32_16x16x32_bf16 v[64:67], v[144:147], v[136:139], v[64:67]
    s_lshl_b32 s37, s37, 12
    s_add_u32 m0, s39, 55296
    v_mfma_f32_16x16x32_bf16 v[68:71], v[148:151], v[136:139], v[68:71]
    s_add_u32 s37, s37, s41
    buffer_load_dwordx4 v12, s[12:15], s37 offen offset:2048 lds
    v_mfma_f32_16x16x32_bf16 v[72:75], v[152:155], v[136:139], v[72:75]
    buffer_load_dwordx4 v12, s[12:15], s37 offen offset:3072 lds
    v_mfma_f32_16x16x32_bf16 v[76:79], v[156:159], v[136:139], v[76:79]
    v_mfma_f32_16x16x32_bf16 v[80:83], v[144:147], v[140:143], v[80:83]
    v_mfma_f32_16x16x32_bf16 v[84:87], v[148:151], v[140:143], v[84:87]
    v_mfma_f32_16x16x32_bf16 v[88:91], v[152:155], v[140:143], v[88:91]
    v_mfma_f32_16x16x32_bf16 v[92:95], v[156:159], v[140:143], v[92:95]
    s_waitcnt lgkmcnt(0)
    s_waitcnt vmcnt(8)
    s_barrier
    v_mfma_f32_16x16x32_bf16 v[32:35], v[112:115], v[96:99], v[32:35]
    ds_read_b128 v[144:147], v15 offset:24576
    ds_read_b128 v[148:151], v15 offset:25600
    v_mfma_f32_16x16x32_bf16 v[36:39], v[116:119], v[96:99], v[36:39]
    ds_read_b128 v[152:155], v15 offset:26624
    ds_read_b128 v[156:159], v15 offset:27648
    v_mfma_f32_16x16x32_bf16 v[40:43], v[120:123], v[96:99], v[40:43]
    ds_read_b128 v[128:131], v14 offset:32768
    ds_read_b128 v[132:135], v14 offset:34816
    v_mfma_f32_16x16x32_bf16 v[44:47], v[124:127], v[96:99], v[44:47]
    ds_read_b128 v[136:139], v14 offset:36864
    ds_read_b128 v[140:143], v14 offset:38912
    v_mfma_f32_16x16x32_bf16 v[48:51], v[112:115], v[100:103], v[48:51]
    s_add_u32 s36, s40, 25
    s_and_b32 s36, s36, 31
    v_mfma_f32_16x16x32_bf16 v[52:55], v[116:119], v[100:103], v[52:55]
    s_add_u32 m0, s38, 18432
    s_lshl_b32 s36, s36, 7
    v_mfma_f32_16x16x32_bf16 v[56:59], v[120:123], v[100:103], v[56:59]
    buffer_load_dwordx4 v10, s[8:11], s36 offen lds
    buffer_load_dwordx4 v11, s[8:11], s36 offen offset:1024 lds
    v_mfma_f32_16x16x32_bf16 v[60:63], v[124:127], v[100:103], v[60:63]
    s_add_u32 s37, s40, 25
    s_and_b32 s37, s37, 31
    v_mfma_f32_16x16x32_bf16 v[64:67], v[112:115], v[104:107], v[64:67]
    s_lshl_b32 s37, s37, 12
    s_add_u32 m0, s39, 65536
    v_mfma_f32_16x16x32_bf16 v[68:71], v[116:119], v[104:107], v[68:71]
    s_add_u32 s37, s37, s41
    buffer_load_dwordx4 v12, s[12:15], s37 offen offset:0 lds
    v_mfma_f32_16x16x32_bf16 v[72:75], v[120:123], v[104:107], v[72:75]
    buffer_load_dwordx4 v12, s[12:15], s37 offen offset:1024 lds
    v_mfma_f32_16x16x32_bf16 v[76:79], v[124:127], v[104:107], v[76:79]
    v_mfma_f32_16x16x32_bf16 v[80:83], v[112:115], v[108:111], v[80:83]
    v_mfma_f32_16x16x32_bf16 v[84:87], v[116:119], v[108:111], v[84:87]
    v_mfma_f32_16x16x32_bf16 v[88:91], v[120:123], v[108:111], v[88:91]
    v_mfma_f32_16x16x32_bf16 v[92:95], v[124:127], v[108:111], v[92:95]
    s_waitcnt lgkmcnt(0)
    s_waitcnt vmcnt(10)
    s_waitcnt vmcnt(8)
    s_barrier
    v_mfma_f32_16x16x32_bf16 v[32:35], v[144:147], v[128:131], v[32:35]
    ds_read_b128 v[112:115], v15 offset:0
    ds_read_b128 v[116:119], v15 offset:1024
    v_mfma_f32_16x16x32_bf16 v[36:39], v[148:151], v[128:131], v[36:39]
    ds_read_b128 v[120:123], v15 offset:2048
    ds_read_b128 v[124:127], v15 offset:3072
    v_mfma_f32_16x16x32_bf16 v[40:43], v[152:155], v[128:131], v[40:43]
    ds_read_b128 v[96:99], v13 offset:0
    ds_read_b128 v[100:103], v13 offset:2048
    v_mfma_f32_16x16x32_bf16 v[44:47], v[156:159], v[128:131], v[44:47]
    ds_read_b128 v[104:107], v13 offset:4096
    ds_read_b128 v[108:111], v13 offset:6144
    v_mfma_f32_16x16x32_bf16 v[48:51], v[144:147], v[132:135], v[48:51]
    s_add_u32 s36, s40, 26
    s_and_b32 s36, s36, 31
    v_mfma_f32_16x16x32_bf16 v[52:55], v[148:151], v[132:135], v[52:55]
    s_add_u32 m0, s38, 32768
    s_lshl_b32 s36, s36, 7
    v_mfma_f32_16x16x32_bf16 v[56:59], v[152:155], v[132:135], v[56:59]
    buffer_load_dwordx4 v8, s[8:11], s36 offen lds
    buffer_load_dwordx4 v9, s[8:11], s36 offen offset:1024 lds
    v_mfma_f32_16x16x32_bf16 v[60:63], v[156:159], v[132:135], v[60:63]
    s_add_u32 s37, s40, 25
    s_and_b32 s37, s37, 31
    v_mfma_f32_16x16x32_bf16 v[64:67], v[144:147], v[136:139], v[64:67]
    s_lshl_b32 s37, s37, 12
    s_add_u32 m0, s39, 71680
    v_mfma_f32_16x16x32_bf16 v[68:71], v[148:151], v[136:139], v[68:71]
    s_add_u32 s37, s37, s41
    buffer_load_dwordx4 v12, s[12:15], s37 offen offset:2048 lds
    v_mfma_f32_16x16x32_bf16 v[72:75], v[152:155], v[136:139], v[72:75]
    buffer_load_dwordx4 v12, s[12:15], s37 offen offset:3072 lds
    v_mfma_f32_16x16x32_bf16 v[76:79], v[156:159], v[136:139], v[76:79]
    v_mfma_f32_16x16x32_bf16 v[80:83], v[144:147], v[140:143], v[80:83]
    v_mfma_f32_16x16x32_bf16 v[84:87], v[148:151], v[140:143], v[84:87]
    v_mfma_f32_16x16x32_bf16 v[88:91], v[152:155], v[140:143], v[88:91]
    v_mfma_f32_16x16x32_bf16 v[92:95], v[156:159], v[140:143], v[92:95]
    s_waitcnt lgkmcnt(0)
    s_waitcnt vmcnt(8)
    s_barrier
    v_mfma_f32_16x16x32_bf16 v[32:35], v[112:115], v[96:99], v[32:35]
    ds_read_b128 v[144:147], v15 offset:8192
    ds_read_b128 v[148:151], v15 offset:9216
    v_mfma_f32_16x16x32_bf16 v[36:39], v[116:119], v[96:99], v[36:39]
    ds_read_b128 v[152:155], v15 offset:10240
    ds_read_b128 v[156:159], v15 offset:11264
    v_mfma_f32_16x16x32_bf16 v[40:43], v[120:123], v[96:99], v[40:43]
    ds_read_b128 v[128:131], v14 offset:0
    ds_read_b128 v[132:135], v14 offset:2048
    v_mfma_f32_16x16x32_bf16 v[44:47], v[124:127], v[96:99], v[44:47]
    ds_read_b128 v[136:139], v14 offset:4096
    ds_read_b128 v[140:143], v14 offset:6144
    v_mfma_f32_16x16x32_bf16 v[48:51], v[112:115], v[100:103], v[48:51]
    s_add_u32 s36, s40, 26
    s_and_b32 s36, s36, 31
    v_mfma_f32_16x16x32_bf16 v[52:55], v[116:119], v[100:103], v[52:55]
    s_add_u32 m0, s38, 34816
    s_lshl_b32 s36, s36, 7
    v_mfma_f32_16x16x32_bf16 v[56:59], v[120:123], v[100:103], v[56:59]
    buffer_load_dwordx4 v10, s[8:11], s36 offen lds
    buffer_load_dwordx4 v11, s[8:11], s36 offen offset:1024 lds
    v_mfma_f32_16x16x32_bf16 v[60:63], v[124:127], v[100:103], v[60:63]
    s_add_u32 s37, s40, 26
    s_and_b32 s37, s37, 31
    v_mfma_f32_16x16x32_bf16 v[64:67], v[112:115], v[104:107], v[64:67]
    s_lshl_b32 s37, s37, 12
    s_add_u32 m0, s39, 49152
    v_mfma_f32_16x16x32_bf16 v[68:71], v[116:119], v[104:107], v[68:71]
    s_add_u32 s37, s37, s41
    buffer_load_dwordx4 v12, s[12:15], s37 offen offset:0 lds
    v_mfma_f32_16x16x32_bf16 v[72:75], v[120:123], v[104:107], v[72:75]
    buffer_load_dwordx4 v12, s[12:15], s37 offen offset:1024 lds
    v_mfma_f32_16x16x32_bf16 v[76:79], v[124:127], v[104:107], v[76:79]
    v_mfma_f32_16x16x32_bf16 v[80:83], v[112:115], v[108:111], v[80:83]
    v_mfma_f32_16x16x32_bf16 v[84:87], v[116:119], v[108:111], v[84:87]
    v_mfma_f32_16x16x32_bf16 v[88:91], v[120:123], v[108:111], v[88:91]
    v_mfma_f32_16x16x32_bf16 v[92:95], v[124:127], v[108:111], v[92:95]
    s_waitcnt lgkmcnt(0)
    s_waitcnt vmcnt(10)
    s_waitcnt vmcnt(8)
    s_barrier
    v_mfma_f32_16x16x32_bf16 v[32:35], v[144:147], v[128:131], v[32:35]
    ds_read_b128 v[112:115], v15 offset:16384
    ds_read_b128 v[116:119], v15 offset:17408
    v_mfma_f32_16x16x32_bf16 v[36:39], v[148:151], v[128:131], v[36:39]
    ds_read_b128 v[120:123], v15 offset:18432
    ds_read_b128 v[124:127], v15 offset:19456
    v_mfma_f32_16x16x32_bf16 v[40:43], v[152:155], v[128:131], v[40:43]
    ds_read_b128 v[96:99], v13 offset:16384
    ds_read_b128 v[100:103], v13 offset:18432
    v_mfma_f32_16x16x32_bf16 v[44:47], v[156:159], v[128:131], v[44:47]
    ds_read_b128 v[104:107], v13 offset:20480
    ds_read_b128 v[108:111], v13 offset:22528
    v_mfma_f32_16x16x32_bf16 v[48:51], v[144:147], v[132:135], v[48:51]
    s_add_u32 s36, s40, 27
    s_and_b32 s36, s36, 31
    v_mfma_f32_16x16x32_bf16 v[52:55], v[148:151], v[132:135], v[52:55]
    s_add_u32 m0, s38, 0
    s_lshl_b32 s36, s36, 7
    v_mfma_f32_16x16x32_bf16 v[56:59], v[152:155], v[132:135], v[56:59]
    buffer_load_dwordx4 v8, s[8:11], s36 offen lds
    buffer_load_dwordx4 v9, s[8:11], s36 offen offset:1024 lds
    v_mfma_f32_16x16x32_bf16 v[60:63], v[156:159], v[132:135], v[60:63]
    s_add_u32 s37, s40, 26
    s_and_b32 s37, s37, 31
    v_mfma_f32_16x16x32_bf16 v[64:67], v[144:147], v[136:139], v[64:67]
    s_lshl_b32 s37, s37, 12
    s_add_u32 m0, s39, 55296
    v_mfma_f32_16x16x32_bf16 v[68:71], v[148:151], v[136:139], v[68:71]
    s_add_u32 s37, s37, s41
    buffer_load_dwordx4 v12, s[12:15], s37 offen offset:2048 lds
    v_mfma_f32_16x16x32_bf16 v[72:75], v[152:155], v[136:139], v[72:75]
    buffer_load_dwordx4 v12, s[12:15], s37 offen offset:3072 lds
    v_mfma_f32_16x16x32_bf16 v[76:79], v[156:159], v[136:139], v[76:79]
    v_mfma_f32_16x16x32_bf16 v[80:83], v[144:147], v[140:143], v[80:83]
    v_mfma_f32_16x16x32_bf16 v[84:87], v[148:151], v[140:143], v[84:87]
    v_mfma_f32_16x16x32_bf16 v[88:91], v[152:155], v[140:143], v[88:91]
    v_mfma_f32_16x16x32_bf16 v[92:95], v[156:159], v[140:143], v[92:95]
    s_waitcnt lgkmcnt(0)
    s_waitcnt vmcnt(8)
    s_barrier
    v_mfma_f32_16x16x32_bf16 v[32:35], v[112:115], v[96:99], v[32:35]
    ds_read_b128 v[144:147], v15 offset:24576
    ds_read_b128 v[148:151], v15 offset:25600
    v_mfma_f32_16x16x32_bf16 v[36:39], v[116:119], v[96:99], v[36:39]
    ds_read_b128 v[152:155], v15 offset:26624
    ds_read_b128 v[156:159], v15 offset:27648
    v_mfma_f32_16x16x32_bf16 v[40:43], v[120:123], v[96:99], v[40:43]
    ds_read_b128 v[128:131], v14 offset:16384
    ds_read_b128 v[132:135], v14 offset:18432
    v_mfma_f32_16x16x32_bf16 v[44:47], v[124:127], v[96:99], v[44:47]
    ds_read_b128 v[136:139], v14 offset:20480
    ds_read_b128 v[140:143], v14 offset:22528
    v_mfma_f32_16x16x32_bf16 v[48:51], v[112:115], v[100:103], v[48:51]
    s_add_u32 s36, s40, 27
    s_and_b32 s36, s36, 31
    v_mfma_f32_16x16x32_bf16 v[52:55], v[116:119], v[100:103], v[52:55]
    s_add_u32 m0, s38, 2048
    s_lshl_b32 s36, s36, 7
    v_mfma_f32_16x16x32_bf16 v[56:59], v[120:123], v[100:103], v[56:59]
    buffer_load_dwordx4 v10, s[8:11], s36 offen lds
    buffer_load_dwordx4 v11, s[8:11], s36 offen offset:1024 lds
    v_mfma_f32_16x16x32_bf16 v[60:63], v[124:127], v[100:103], v[60:63]
    s_add_u32 s37, s40, 27
    s_and_b32 s37, s37, 31
    v_mfma_f32_16x16x32_bf16 v[64:67], v[112:115], v[104:107], v[64:67]
    s_lshl_b32 s37, s37, 12
    s_add_u32 m0, s39, 65536
    v_mfma_f32_16x16x32_bf16 v[68:71], v[116:119], v[104:107], v[68:71]
    s_add_u32 s37, s37, s41
    buffer_load_dwordx4 v12, s[12:15], s37 offen offset:0 lds
    v_mfma_f32_16x16x32_bf16 v[72:75], v[120:123], v[104:107], v[72:75]
    buffer_load_dwordx4 v12, s[12:15], s37 offen offset:1024 lds
    v_mfma_f32_16x16x32_bf16 v[76:79], v[124:127], v[104:107], v[76:79]
    v_mfma_f32_16x16x32_bf16 v[80:83], v[112:115], v[108:111], v[80:83]
    v_mfma_f32_16x16x32_bf16 v[84:87], v[116:119], v[108:111], v[84:87]
    v_mfma_f32_16x16x32_bf16 v[88:91], v[120:123], v[108:111], v[88:91]
    v_mfma_f32_16x16x32_bf16 v[92:95], v[124:127], v[108:111], v[92:95]
    s_waitcnt lgkmcnt(0)
    s_waitcnt vmcnt(10)
    s_waitcnt vmcnt(8)
    s_barrier
    v_mfma_f32_16x16x32_bf16 v[32:35], v[144:147], v[128:131], v[32:35]
    ds_read_b128 v[112:115], v15 offset:0
    ds_read_b128 v[116:119], v15 offset:1024
    v_mfma_f32_16x16x32_bf16 v[36:39], v[148:151], v[128:131], v[36:39]
    ds_read_b128 v[120:123], v15 offset:2048
    ds_read_b128 v[124:127], v15 offset:3072
    v_mfma_f32_16x16x32_bf16 v[40:43], v[152:155], v[128:131], v[40:43]
    ds_read_b128 v[96:99], v13 offset:32768
    ds_read_b128 v[100:103], v13 offset:34816
    v_mfma_f32_16x16x32_bf16 v[44:47], v[156:159], v[128:131], v[44:47]
    ds_read_b128 v[104:107], v13 offset:36864
    ds_read_b128 v[108:111], v13 offset:38912
    v_mfma_f32_16x16x32_bf16 v[48:51], v[144:147], v[132:135], v[48:51]
    s_add_u32 s36, s40, 28
    s_and_b32 s36, s36, 31
    v_mfma_f32_16x16x32_bf16 v[52:55], v[148:151], v[132:135], v[52:55]
    s_add_u32 m0, s38, 16384
    s_lshl_b32 s36, s36, 7
    v_mfma_f32_16x16x32_bf16 v[56:59], v[152:155], v[132:135], v[56:59]
    buffer_load_dwordx4 v8, s[8:11], s36 offen lds
    buffer_load_dwordx4 v9, s[8:11], s36 offen offset:1024 lds
    v_mfma_f32_16x16x32_bf16 v[60:63], v[156:159], v[132:135], v[60:63]
    s_add_u32 s37, s40, 27
    s_and_b32 s37, s37, 31
    v_mfma_f32_16x16x32_bf16 v[64:67], v[144:147], v[136:139], v[64:67]
    s_lshl_b32 s37, s37, 12
    s_add_u32 m0, s39, 71680
    v_mfma_f32_16x16x32_bf16 v[68:71], v[148:151], v[136:139], v[68:71]
    s_add_u32 s37, s37, s41
    buffer_load_dwordx4 v12, s[12:15], s37 offen offset:2048 lds
    v_mfma_f32_16x16x32_bf16 v[72:75], v[152:155], v[136:139], v[72:75]
    buffer_load_dwordx4 v12, s[12:15], s37 offen offset:3072 lds
    v_mfma_f32_16x16x32_bf16 v[76:79], v[156:159], v[136:139], v[76:79]
    v_mfma_f32_16x16x32_bf16 v[80:83], v[144:147], v[140:143], v[80:83]
    v_mfma_f32_16x16x32_bf16 v[84:87], v[148:151], v[140:143], v[84:87]
    v_mfma_f32_16x16x32_bf16 v[88:91], v[152:155], v[140:143], v[88:91]
    v_mfma_f32_16x16x32_bf16 v[92:95], v[156:159], v[140:143], v[92:95]
    s_waitcnt lgkmcnt(0)
    s_waitcnt vmcnt(8)
    s_barrier
    v_mfma_f32_16x16x32_bf16 v[32:35], v[112:115], v[96:99], v[32:35]
    ds_read_b128 v[144:147], v15 offset:8192
    ds_read_b128 v[148:151], v15 offset:9216
    v_mfma_f32_16x16x32_bf16 v[36:39], v[116:119], v[96:99], v[36:39]
    ds_read_b128 v[152:155], v15 offset:10240
    ds_read_b128 v[156:159], v15 offset:11264
    v_mfma_f32_16x16x32_bf16 v[40:43], v[120:123], v[96:99], v[40:43]
    ds_read_b128 v[128:131], v14 offset:32768
    ds_read_b128 v[132:135], v14 offset:34816
    v_mfma_f32_16x16x32_bf16 v[44:47], v[124:127], v[96:99], v[44:47]
    ds_read_b128 v[136:139], v14 offset:36864
    ds_read_b128 v[140:143], v14 offset:38912
    v_mfma_f32_16x16x32_bf16 v[48:51], v[112:115], v[100:103], v[48:51]
    s_add_u32 s36, s40, 28
    s_and_b32 s36, s36, 31
    v_mfma_f32_16x16x32_bf16 v[52:55], v[116:119], v[100:103], v[52:55]
    s_add_u32 m0, s38, 18432
    s_lshl_b32 s36, s36, 7
    v_mfma_f32_16x16x32_bf16 v[56:59], v[120:123], v[100:103], v[56:59]
    buffer_load_dwordx4 v10, s[8:11], s36 offen lds
    buffer_load_dwordx4 v11, s[8:11], s36 offen offset:1024 lds
    v_mfma_f32_16x16x32_bf16 v[60:63], v[124:127], v[100:103], v[60:63]
    s_add_u32 s37, s40, 28
    s_and_b32 s37, s37, 31
    v_mfma_f32_16x16x32_bf16 v[64:67], v[112:115], v[104:107], v[64:67]
    s_lshl_b32 s37, s37, 12
    s_add_u32 m0, s39, 49152
    v_mfma_f32_16x16x32_bf16 v[68:71], v[116:119], v[104:107], v[68:71]
    s_add_u32 s37, s37, s41
    buffer_load_dwordx4 v12, s[12:15], s37 offen offset:0 lds
    v_mfma_f32_16x16x32_bf16 v[72:75], v[120:123], v[104:107], v[72:75]
    buffer_load_dwordx4 v12, s[12:15], s37 offen offset:1024 lds
    v_mfma_f32_16x16x32_bf16 v[76:79], v[124:127], v[104:107], v[76:79]
    v_mfma_f32_16x16x32_bf16 v[80:83], v[112:115], v[108:111], v[80:83]
    v_mfma_f32_16x16x32_bf16 v[84:87], v[116:119], v[108:111], v[84:87]
    v_mfma_f32_16x16x32_bf16 v[88:91], v[120:123], v[108:111], v[88:91]
    v_mfma_f32_16x16x32_bf16 v[92:95], v[124:127], v[108:111], v[92:95]
    s_waitcnt lgkmcnt(0)
    s_waitcnt vmcnt(10)
    s_waitcnt vmcnt(8)
    s_barrier
    v_mfma_f32_16x16x32_bf16 v[32:35], v[144:147], v[128:131], v[32:35]
    ds_read_b128 v[112:115], v15 offset:16384
    ds_read_b128 v[116:119], v15 offset:17408
    v_mfma_f32_16x16x32_bf16 v[36:39], v[148:151], v[128:131], v[36:39]
    ds_read_b128 v[120:123], v15 offset:18432
    ds_read_b128 v[124:127], v15 offset:19456
    v_mfma_f32_16x16x32_bf16 v[40:43], v[152:155], v[128:131], v[40:43]
    ds_read_b128 v[96:99], v13 offset:0
    ds_read_b128 v[100:103], v13 offset:2048
    v_mfma_f32_16x16x32_bf16 v[44:47], v[156:159], v[128:131], v[44:47]
    ds_read_b128 v[104:107], v13 offset:4096
    ds_read_b128 v[108:111], v13 offset:6144
    v_mfma_f32_16x16x32_bf16 v[48:51], v[144:147], v[132:135], v[48:51]
    s_add_u32 s36, s40, 29
    s_and_b32 s36, s36, 31
    v_mfma_f32_16x16x32_bf16 v[52:55], v[148:151], v[132:135], v[52:55]
    s_add_u32 m0, s38, 32768
    s_lshl_b32 s36, s36, 7
    v_mfma_f32_16x16x32_bf16 v[56:59], v[152:155], v[132:135], v[56:59]
    buffer_load_dwordx4 v8, s[8:11], s36 offen lds
    buffer_load_dwordx4 v9, s[8:11], s36 offen offset:1024 lds
    v_mfma_f32_16x16x32_bf16 v[60:63], v[156:159], v[132:135], v[60:63]
    s_add_u32 s37, s40, 28
    s_and_b32 s37, s37, 31
    v_mfma_f32_16x16x32_bf16 v[64:67], v[144:147], v[136:139], v[64:67]
    s_lshl_b32 s37, s37, 12
    s_add_u32 m0, s39, 55296
    v_mfma_f32_16x16x32_bf16 v[68:71], v[148:151], v[136:139], v[68:71]
    s_add_u32 s37, s37, s41
    buffer_load_dwordx4 v12, s[12:15], s37 offen offset:2048 lds
    v_mfma_f32_16x16x32_bf16 v[72:75], v[152:155], v[136:139], v[72:75]
    buffer_load_dwordx4 v12, s[12:15], s37 offen offset:3072 lds
    v_mfma_f32_16x16x32_bf16 v[76:79], v[156:159], v[136:139], v[76:79]
    v_mfma_f32_16x16x32_bf16 v[80:83], v[144:147], v[140:143], v[80:83]
    v_mfma_f32_16x16x32_bf16 v[84:87], v[148:151], v[140:143], v[84:87]
    v_mfma_f32_16x16x32_bf16 v[88:91], v[152:155], v[140:143], v[88:91]
    v_mfma_f32_16x16x32_bf16 v[92:95], v[156:159], v[140:143], v[92:95]
    s_waitcnt lgkmcnt(0)
    s_waitcnt vmcnt(8)
    s_barrier
    v_mfma_f32_16x16x32_bf16 v[32:35], v[112:115], v[96:99], v[32:35]
    ds_read_b128 v[144:147], v15 offset:24576
    ds_read_b128 v[148:151], v15 offset:25600
    v_mfma_f32_16x16x32_bf16 v[36:39], v[116:119], v[96:99], v[36:39]
    ds_read_b128 v[152:155], v15 offset:26624
    ds_read_b128 v[156:159], v15 offset:27648
    v_mfma_f32_16x16x32_bf16 v[40:43], v[120:123], v[96:99], v[40:43]
    ds_read_b128 v[128:131], v14 offset:0
    ds_read_b128 v[132:135], v14 offset:2048
    v_mfma_f32_16x16x32_bf16 v[44:47], v[124:127], v[96:99], v[44:47]
    ds_read_b128 v[136:139], v14 offset:4096
    ds_read_b128 v[140:143], v14 offset:6144
    v_mfma_f32_16x16x32_bf16 v[48:51], v[112:115], v[100:103], v[48:51]
    s_add_u32 s36, s40, 29
    s_and_b32 s36, s36, 31
    v_mfma_f32_16x16x32_bf16 v[52:55], v[116:119], v[100:103], v[52:55]
    s_add_u32 m0, s38, 34816
    s_lshl_b32 s36, s36, 7
    v_mfma_f32_16x16x32_bf16 v[56:59], v[120:123], v[100:103], v[56:59]
    buffer_load_dwordx4 v10, s[8:11], s36 offen lds
    buffer_load_dwordx4 v11, s[8:11], s36 offen offset:1024 lds
    v_mfma_f32_16x16x32_bf16 v[60:63], v[124:127], v[100:103], v[60:63]
    s_add_u32 s37, s40, 29
    s_and_b32 s37, s37, 31
    v_mfma_f32_16x16x32_bf16 v[64:67], v[112:115], v[104:107], v[64:67]
    s_lshl_b32 s37, s37, 12
    s_add_u32 m0, s39, 65536
    v_mfma_f32_16x16x32_bf16 v[68:71], v[116:119], v[104:107], v[68:71]
    s_add_u32 s37, s37, s41
    buffer_load_dwordx4 v12, s[12:15], s37 offen offset:0 lds
    v_mfma_f32_16x16x32_bf16 v[72:75], v[120:123], v[104:107], v[72:75]
    buffer_load_dwordx4 v12, s[12:15], s37 offen offset:1024 lds
    v_mfma_f32_16x16x32_bf16 v[76:79], v[124:127], v[104:107], v[76:79]
    v_mfma_f32_16x16x32_bf16 v[80:83], v[112:115], v[108:111], v[80:83]
    v_mfma_f32_16x16x32_bf16 v[84:87], v[116:119], v[108:111], v[84:87]
    v_mfma_f32_16x16x32_bf16 v[88:91], v[120:123], v[108:111], v[88:91]
    v_mfma_f32_16x16x32_bf16 v[92:95], v[124:127], v[108:111], v[92:95]
    s_waitcnt lgkmcnt(0)
    s_waitcnt vmcnt(10)
    s_waitcnt vmcnt(8)
    s_barrier
    v_mfma_f32_16x16x32_bf16 v[32:35], v[144:147], v[128:131], v[32:35]
    ds_read_b128 v[112:115], v15 offset:0
    ds_read_b128 v[116:119], v15 offset:1024
    v_mfma_f32_16x16x32_bf16 v[36:39], v[148:151], v[128:131], v[36:39]
    ds_read_b128 v[120:123], v15 offset:2048
    ds_read_b128 v[124:127], v15 offset:3072
    v_mfma_f32_16x16x32_bf16 v[40:43], v[152:155], v[128:131], v[40:43]
    ds_read_b128 v[96:99], v13 offset:16384
    ds_read_b128 v[100:103], v13 offset:18432
    v_mfma_f32_16x16x32_bf16 v[44:47], v[156:159], v[128:131], v[44:47]
    ds_read_b128 v[104:107], v13 offset:20480
    ds_read_b128 v[108:111], v13 offset:22528
    v_mfma_f32_16x16x32_bf16 v[48:51], v[144:147], v[132:135], v[48:51]
    s_add_u32 s36, s40, 30
    s_and_b32 s36, s36, 31
    v_mfma_f32_16x16x32_bf16 v[52:55], v[148:151], v[132:135], v[52:55]
    s_add_u32 m0, s38, 0
    s_lshl_b32 s36, s36, 7
    v_mfma_f32_16x16x32_bf16 v[56:59], v[152:155], v[132:135], v[56:59]
    buffer_load_dwordx4 v8, s[8:11], s36 offen lds
    buffer_load_dwordx4 v9, s[8:11], s36 offen offset:1024 lds
    v_mfma_f32_16x16x32_bf16 v[60:63], v[156:159], v[132:135], v[60:63]
    s_add_u32 s37, s40, 29
    s_and_b32 s37, s37, 31
    v_mfma_f32_16x16x32_bf16 v[64:67], v[144:147], v[136:139], v[64:67]
    s_lshl_b32 s37, s37, 12
    s_add_u32 m0, s39, 71680
    v_mfma_f32_16x16x32_bf16 v[68:71], v[148:151], v[136:139], v[68:71]
    s_add_u32 s37, s37, s41
    buffer_load_dwordx4 v12, s[12:15], s37 offen offset:2048 lds
    v_mfma_f32_16x16x32_bf16 v[72:75], v[152:155], v[136:139], v[72:75]
    buffer_load_dwordx4 v12, s[12:15], s37 offen offset:3072 lds
    v_mfma_f32_16x16x32_bf16 v[76:79], v[156:159], v[136:139], v[76:79]
    v_mfma_f32_16x16x32_bf16 v[80:83], v[144:147], v[140:143], v[80:83]
    v_mfma_f32_16x16x32_bf16 v[84:87], v[148:151], v[140:143], v[84:87]
    v_mfma_f32_16x16x32_bf16 v[88:91], v[152:155], v[140:143], v[88:91]
    v_mfma_f32_16x16x32_bf16 v[92:95], v[156:159], v[140:143], v[92:95]
    s_waitcnt lgkmcnt(0)
    s_waitcnt vmcnt(8)
    s_barrier
    v_mfma_f32_16x16x32_bf16 v[32:35], v[112:115], v[96:99], v[32:35]
    ds_read_b128 v[144:147], v15 offset:8192
    ds_read_b128 v[148:151], v15 offset:9216
    v_mfma_f32_16x16x32_bf16 v[36:39], v[116:119], v[96:99], v[36:39]
    ds_read_b128 v[152:155], v15 offset:10240
    ds_read_b128 v[156:159], v15 offset:11264
    v_mfma_f32_16x16x32_bf16 v[40:43], v[120:123], v[96:99], v[40:43]
    ds_read_b128 v[128:131], v14 offset:16384
    ds_read_b128 v[132:135], v14 offset:18432
    v_mfma_f32_16x16x32_bf16 v[44:47], v[124:127], v[96:99], v[44:47]
    ds_read_b128 v[136:139], v14 offset:20480
    ds_read_b128 v[140:143], v14 offset:22528
    v_mfma_f32_16x16x32_bf16 v[48:51], v[112:115], v[100:103], v[48:51]
    s_add_u32 s36, s40, 30
    s_and_b32 s36, s36, 31
    v_mfma_f32_16x16x32_bf16 v[52:55], v[116:119], v[100:103], v[52:55]
    s_add_u32 m0, s38, 2048
    s_lshl_b32 s36, s36, 7
    v_mfma_f32_16x16x32_bf16 v[56:59], v[120:123], v[100:103], v[56:59]
    buffer_load_dwordx4 v10, s[8:11], s36 offen lds
    buffer_load_dwordx4 v11, s[8:11], s36 offen offset:1024 lds
    v_mfma_f32_16x16x32_bf16 v[60:63], v[124:127], v[100:103], v[60:63]
    s_add_u32 s37, s40, 30
    s_and_b32 s37, s37, 31
    v_mfma_f32_16x16x32_bf16 v[64:67], v[112:115], v[104:107], v[64:67]
    s_lshl_b32 s37, s37, 12
    s_add_u32 m0, s39, 49152
    v_mfma_f32_16x16x32_bf16 v[68:71], v[116:119], v[104:107], v[68:71]
    s_add_u32 s37, s37, s41
    buffer_load_dwordx4 v12, s[12:15], s37 offen offset:0 lds
    v_mfma_f32_16x16x32_bf16 v[72:75], v[120:123], v[104:107], v[72:75]
    buffer_load_dwordx4 v12, s[12:15], s37 offen offset:1024 lds
    v_mfma_f32_16x16x32_bf16 v[76:79], v[124:127], v[104:107], v[76:79]
    v_mfma_f32_16x16x32_bf16 v[80:83], v[112:115], v[108:111], v[80:83]
    v_mfma_f32_16x16x32_bf16 v[84:87], v[116:119], v[108:111], v[84:87]
    v_mfma_f32_16x16x32_bf16 v[88:91], v[120:123], v[108:111], v[88:91]
    v_mfma_f32_16x16x32_bf16 v[92:95], v[124:127], v[108:111], v[92:95]
    s_waitcnt lgkmcnt(0)
    s_waitcnt vmcnt(10)
    s_waitcnt vmcnt(8)
    s_barrier
    v_mfma_f32_16x16x32_bf16 v[32:35], v[144:147], v[128:131], v[32:35]
    ds_read_b128 v[112:115], v15 offset:16384
    ds_read_b128 v[116:119], v15 offset:17408
    v_mfma_f32_16x16x32_bf16 v[36:39], v[148:151], v[128:131], v[36:39]
    ds_read_b128 v[120:123], v15 offset:18432
    ds_read_b128 v[124:127], v15 offset:19456
    v_mfma_f32_16x16x32_bf16 v[40:43], v[152:155], v[128:131], v[40:43]
    ds_read_b128 v[96:99], v13 offset:32768
    ds_read_b128 v[100:103], v13 offset:34816
    v_mfma_f32_16x16x32_bf16 v[44:47], v[156:159], v[128:131], v[44:47]
    ds_read_b128 v[104:107], v13 offset:36864
    ds_read_b128 v[108:111], v13 offset:38912
    v_mfma_f32_16x16x32_bf16 v[48:51], v[144:147], v[132:135], v[48:51]
    s_add_u32 s36, s40, 31
    s_and_b32 s36, s36, 31
    v_mfma_f32_16x16x32_bf16 v[52:55], v[148:151], v[132:135], v[52:55]
    s_add_u32 m0, s38, 16384
    s_lshl_b32 s36, s36, 7
    v_mfma_f32_16x16x32_bf16 v[56:59], v[152:155], v[132:135], v[56:59]
    buffer_load_dwordx4 v8, s[8:11], s36 offen lds
    buffer_load_dwordx4 v9, s[8:11], s36 offen offset:1024 lds
    v_mfma_f32_16x16x32_bf16 v[60:63], v[156:159], v[132:135], v[60:63]
    s_add_u32 s37, s40, 30
    s_and_b32 s37, s37, 31
    v_mfma_f32_16x16x32_bf16 v[64:67], v[144:147], v[136:139], v[64:67]
    s_lshl_b32 s37, s37, 12
    s_add_u32 m0, s39, 55296
    v_mfma_f32_16x16x32_bf16 v[68:71], v[148:151], v[136:139], v[68:71]
    s_add_u32 s37, s37, s41
    buffer_load_dwordx4 v12, s[12:15], s37 offen offset:2048 lds
    v_mfma_f32_16x16x32_bf16 v[72:75], v[152:155], v[136:139], v[72:75]
    buffer_load_dwordx4 v12, s[12:15], s37 offen offset:3072 lds
    v_mfma_f32_16x16x32_bf16 v[76:79], v[156:159], v[136:139], v[76:79]
    v_mfma_f32_16x16x32_bf16 v[80:83], v[144:147], v[140:143], v[80:83]
    v_mfma_f32_16x16x32_bf16 v[84:87], v[148:151], v[140:143], v[84:87]
    v_mfma_f32_16x16x32_bf16 v[88:91], v[152:155], v[140:143], v[88:91]
    v_mfma_f32_16x16x32_bf16 v[92:95], v[156:159], v[140:143], v[92:95]
    s_waitcnt lgkmcnt(0)
    s_waitcnt vmcnt(8)
    s_barrier
    v_mfma_f32_16x16x32_bf16 v[32:35], v[112:115], v[96:99], v[32:35]
    ds_read_b128 v[144:147], v15 offset:24576
    ds_read_b128 v[148:151], v15 offset:25600
    v_mfma_f32_16x16x32_bf16 v[36:39], v[116:119], v[96:99], v[36:39]
    ds_read_b128 v[152:155], v15 offset:26624
    ds_read_b128 v[156:159], v15 offset:27648
    v_mfma_f32_16x16x32_bf16 v[40:43], v[120:123], v[96:99], v[40:43]
    ds_read_b128 v[128:131], v14 offset:32768
    ds_read_b128 v[132:135], v14 offset:34816
    v_mfma_f32_16x16x32_bf16 v[44:47], v[124:127], v[96:99], v[44:47]
    ds_read_b128 v[136:139], v14 offset:36864
    ds_read_b128 v[140:143], v14 offset:38912
    v_mfma_f32_16x16x32_bf16 v[48:51], v[112:115], v[100:103], v[48:51]
    s_add_u32 s36, s40, 31
    s_and_b32 s36, s36, 31
    v_mfma_f32_16x16x32_bf16 v[52:55], v[116:119], v[100:103], v[52:55]
    s_add_u32 m0, s38, 18432
    s_lshl_b32 s36, s36, 7
    v_mfma_f32_16x16x32_bf16 v[56:59], v[120:123], v[100:103], v[56:59]
    buffer_load_dwordx4 v10, s[8:11], s36 offen lds
    buffer_load_dwordx4 v11, s[8:11], s36 offen offset:1024 lds
    v_mfma_f32_16x16x32_bf16 v[60:63], v[124:127], v[100:103], v[60:63]
    s_add_u32 s37, s40, 31
    s_and_b32 s37, s37, 31
    v_mfma_f32_16x16x32_bf16 v[64:67], v[112:115], v[104:107], v[64:67]
    s_lshl_b32 s37, s37, 12
    s_add_u32 m0, s39, 65536
    v_mfma_f32_16x16x32_bf16 v[68:71], v[116:119], v[104:107], v[68:71]
    s_add_u32 s37, s37, s41
    buffer_load_dwordx4 v12, s[12:15], s37 offen offset:0 lds
    v_mfma_f32_16x16x32_bf16 v[72:75], v[120:123], v[104:107], v[72:75]
    buffer_load_dwordx4 v12, s[12:15], s37 offen offset:1024 lds
    v_mfma_f32_16x16x32_bf16 v[76:79], v[124:127], v[104:107], v[76:79]
    v_mfma_f32_16x16x32_bf16 v[80:83], v[112:115], v[108:111], v[80:83]
    v_mfma_f32_16x16x32_bf16 v[84:87], v[116:119], v[108:111], v[84:87]
    v_mfma_f32_16x16x32_bf16 v[88:91], v[120:123], v[108:111], v[88:91]
    v_mfma_f32_16x16x32_bf16 v[92:95], v[124:127], v[108:111], v[92:95]
    s_waitcnt lgkmcnt(0)
    s_waitcnt vmcnt(10)
    s_waitcnt vmcnt(8)
    s_barrier
    v_mfma_f32_16x16x32_bf16 v[32:35], v[144:147], v[128:131], v[32:35]
    ds_read_b128 v[112:115], v15 offset:0
    ds_read_b128 v[116:119], v15 offset:1024
    v_mfma_f32_16x16x32_bf16 v[36:39], v[148:151], v[128:131], v[36:39]
    ds_read_b128 v[120:123], v15 offset:2048
    ds_read_b128 v[124:127], v15 offset:3072
    v_mfma_f32_16x16x32_bf16 v[40:43], v[152:155], v[128:131], v[40:43]
    ds_read_b128 v[96:99], v13 offset:0
    ds_read_b128 v[100:103], v13 offset:2048
    v_mfma_f32_16x16x32_bf16 v[44:47], v[156:159], v[128:131], v[44:47]
    ds_read_b128 v[104:107], v13 offset:4096
    ds_read_b128 v[108:111], v13 offset:6144
    v_mfma_f32_16x16x32_bf16 v[48:51], v[144:147], v[132:135], v[48:51]
    s_add_u32 s37, s40, 31
    s_and_b32 s37, s37, 31
    v_mfma_f32_16x16x32_bf16 v[52:55], v[148:151], v[132:135], v[52:55]
    s_lshl_b32 s37, s37, 12
    s_add_u32 m0, s39, 71680
    v_mfma_f32_16x16x32_bf16 v[56:59], v[152:155], v[132:135], v[56:59]
    s_add_u32 s37, s37, s41
    buffer_load_dwordx4 v12, s[12:15], s37 offen offset:2048 lds
    v_mfma_f32_16x16x32_bf16 v[60:63], v[156:159], v[132:135], v[60:63]
    buffer_load_dwordx4 v12, s[12:15], s37 offen offset:3072 lds
    v_mfma_f32_16x16x32_bf16 v[64:67], v[144:147], v[136:139], v[64:67]
    v_mfma_f32_16x16x32_bf16 v[68:71], v[148:151], v[136:139], v[68:71]
    v_mfma_f32_16x16x32_bf16 v[72:75], v[152:155], v[136:139], v[72:75]
    v_mfma_f32_16x16x32_bf16 v[76:79], v[156:159], v[136:139], v[76:79]
    v_mfma_f32_16x16x32_bf16 v[80:83], v[144:147], v[140:143], v[80:83]
    v_mfma_f32_16x16x32_bf16 v[84:87], v[148:151], v[140:143], v[84:87]
    v_mfma_f32_16x16x32_bf16 v[88:91], v[152:155], v[140:143], v[88:91]
    v_mfma_f32_16x16x32_bf16 v[92:95], v[156:159], v[140:143], v[92:95]
    s_waitcnt lgkmcnt(0)
    s_waitcnt vmcnt(6)
    s_barrier
    v_mfma_f32_16x16x32_bf16 v[32:35], v[112:115], v[96:99], v[32:35]
    ds_read_b128 v[144:147], v15 offset:8192
    ds_read_b128 v[148:151], v15 offset:9216
    v_mfma_f32_16x16x32_bf16 v[36:39], v[116:119], v[96:99], v[36:39]
    ds_read_b128 v[152:155], v15 offset:10240
    ds_read_b128 v[156:159], v15 offset:11264
    v_mfma_f32_16x16x32_bf16 v[40:43], v[120:123], v[96:99], v[40:43]
    ds_read_b128 v[128:131], v14 offset:0
    ds_read_b128 v[132:135], v14 offset:2048
    v_mfma_f32_16x16x32_bf16 v[44:47], v[124:127], v[96:99], v[44:47]
    ds_read_b128 v[136:139], v14 offset:4096
    ds_read_b128 v[140:143], v14 offset:6144
    v_mfma_f32_16x16x32_bf16 v[48:51], v[112:115], v[100:103], v[48:51]
    v_mfma_f32_16x16x32_bf16 v[52:55], v[116:119], v[100:103], v[52:55]
    v_mfma_f32_16x16x32_bf16 v[56:59], v[120:123], v[100:103], v[56:59]
    v_mfma_f32_16x16x32_bf16 v[60:63], v[124:127], v[100:103], v[60:63]
    v_mfma_f32_16x16x32_bf16 v[64:67], v[112:115], v[104:107], v[64:67]
    v_mfma_f32_16x16x32_bf16 v[68:71], v[116:119], v[104:107], v[68:71]
    v_mfma_f32_16x16x32_bf16 v[72:75], v[120:123], v[104:107], v[72:75]
    v_mfma_f32_16x16x32_bf16 v[76:79], v[124:127], v[104:107], v[76:79]
    v_mfma_f32_16x16x32_bf16 v[80:83], v[112:115], v[108:111], v[80:83]
    v_mfma_f32_16x16x32_bf16 v[84:87], v[116:119], v[108:111], v[84:87]
    v_mfma_f32_16x16x32_bf16 v[88:91], v[120:123], v[108:111], v[88:91]
    v_mfma_f32_16x16x32_bf16 v[92:95], v[124:127], v[108:111], v[92:95]
    s_waitcnt lgkmcnt(0)
    s_waitcnt vmcnt(4)
    s_waitcnt vmcnt(2)
    s_barrier
    v_mfma_f32_16x16x32_bf16 v[32:35], v[144:147], v[128:131], v[32:35]
    ds_read_b128 v[112:115], v15 offset:16384
    ds_read_b128 v[116:119], v15 offset:17408
    v_mfma_f32_16x16x32_bf16 v[36:39], v[148:151], v[128:131], v[36:39]
    ds_read_b128 v[120:123], v15 offset:18432
    ds_read_b128 v[124:127], v15 offset:19456
    v_mfma_f32_16x16x32_bf16 v[40:43], v[152:155], v[128:131], v[40:43]
    ds_read_b128 v[96:99], v13 offset:16384
    ds_read_b128 v[100:103], v13 offset:18432
    v_mfma_f32_16x16x32_bf16 v[44:47], v[156:159], v[128:131], v[44:47]
    ds_read_b128 v[104:107], v13 offset:20480
    ds_read_b128 v[108:111], v13 offset:22528
    v_mfma_f32_16x16x32_bf16 v[48:51], v[144:147], v[132:135], v[48:51]
    v_mfma_f32_16x16x32_bf16 v[52:55], v[148:151], v[132:135], v[52:55]
    v_mfma_f32_16x16x32_bf16 v[56:59], v[152:155], v[132:135], v[56:59]
    v_mfma_f32_16x16x32_bf16 v[60:63], v[156:159], v[132:135], v[60:63]
    v_mfma_f32_16x16x32_bf16 v[64:67], v[144:147], v[136:139], v[64:67]
    v_mfma_f32_16x16x32_bf16 v[68:71], v[148:151], v[136:139], v[68:71]
    v_mfma_f32_16x16x32_bf16 v[72:75], v[152:155], v[136:139], v[72:75]
    v_mfma_f32_16x16x32_bf16 v[76:79], v[156:159], v[136:139], v[76:79]
    v_mfma_f32_16x16x32_bf16 v[80:83], v[144:147], v[140:143], v[80:83]
    v_mfma_f32_16x16x32_bf16 v[84:87], v[148:151], v[140:143], v[84:87]
    v_mfma_f32_16x16x32_bf16 v[88:91], v[152:155], v[140:143], v[88:91]
    v_mfma_f32_16x16x32_bf16 v[92:95], v[156:159], v[140:143], v[92:95]
    s_waitcnt lgkmcnt(0)
    s_waitcnt vmcnt(0)
    s_barrier
    v_mfma_f32_16x16x32_bf16 v[32:35], v[112:115], v[96:99], v[32:35]
    ds_read_b128 v[144:147], v15 offset:24576
    ds_read_b128 v[148:151], v15 offset:25600
    v_mfma_f32_16x16x32_bf16 v[36:39], v[116:119], v[96:99], v[36:39]
    ds_read_b128 v[152:155], v15 offset:26624
    ds_read_b128 v[156:159], v15 offset:27648
    v_mfma_f32_16x16x32_bf16 v[40:43], v[120:123], v[96:99], v[40:43]
    ds_read_b128 v[128:131], v14 offset:16384
    ds_read_b128 v[132:135], v14 offset:18432
    v_mfma_f32_16x16x32_bf16 v[44:47], v[124:127], v[96:99], v[44:47]
    ds_read_b128 v[136:139], v14 offset:20480
    ds_read_b128 v[140:143], v14 offset:22528
    v_mfma_f32_16x16x32_bf16 v[48:51], v[112:115], v[100:103], v[48:51]
    v_mfma_f32_16x16x32_bf16 v[52:55], v[116:119], v[100:103], v[52:55]
    v_mfma_f32_16x16x32_bf16 v[56:59], v[120:123], v[100:103], v[56:59]
    v_mfma_f32_16x16x32_bf16 v[60:63], v[124:127], v[100:103], v[60:63]
    v_mfma_f32_16x16x32_bf16 v[64:67], v[112:115], v[104:107], v[64:67]
    v_mfma_f32_16x16x32_bf16 v[68:71], v[116:119], v[104:107], v[68:71]
    v_mfma_f32_16x16x32_bf16 v[72:75], v[120:123], v[104:107], v[72:75]
    v_mfma_f32_16x16x32_bf16 v[76:79], v[124:127], v[104:107], v[76:79]
    v_mfma_f32_16x16x32_bf16 v[80:83], v[112:115], v[108:111], v[80:83]
    v_mfma_f32_16x16x32_bf16 v[84:87], v[116:119], v[108:111], v[84:87]
    v_mfma_f32_16x16x32_bf16 v[88:91], v[120:123], v[108:111], v[88:91]
    v_mfma_f32_16x16x32_bf16 v[92:95], v[124:127], v[108:111], v[92:95]
    s_waitcnt lgkmcnt(0)
    v_mfma_f32_16x16x32_bf16 v[32:35], v[144:147], v[128:131], v[32:35]
    v_mfma_f32_16x16x32_bf16 v[36:39], v[148:151], v[128:131], v[36:39]
    v_mfma_f32_16x16x32_bf16 v[40:43], v[152:155], v[128:131], v[40:43]
    v_mfma_f32_16x16x32_bf16 v[44:47], v[156:159], v[128:131], v[44:47]
    v_mfma_f32_16x16x32_bf16 v[48:51], v[144:147], v[132:135], v[48:51]
    v_mfma_f32_16x16x32_bf16 v[52:55], v[148:151], v[132:135], v[52:55]
    v_mfma_f32_16x16x32_bf16 v[56:59], v[152:155], v[132:135], v[56:59]
    v_mfma_f32_16x16x32_bf16 v[60:63], v[156:159], v[132:135], v[60:63]
    v_mfma_f32_16x16x32_bf16 v[64:67], v[144:147], v[136:139], v[64:67]
    v_mfma_f32_16x16x32_bf16 v[68:71], v[148:151], v[136:139], v[68:71]
    v_mfma_f32_16x16x32_bf16 v[72:75], v[152:155], v[136:139], v[72:75]
    v_mfma_f32_16x16x32_bf16 v[76:79], v[156:159], v[136:139], v[76:79]
    v_mfma_f32_16x16x32_bf16 v[80:83], v[144:147], v[140:143], v[80:83]
    v_mfma_f32_16x16x32_bf16 v[84:87], v[148:151], v[140:143], v[84:87]
    v_mfma_f32_16x16x32_bf16 v[88:91], v[152:155], v[140:143], v[88:91]
    v_mfma_f32_16x16x32_bf16 v[92:95], v[156:159], v[140:143], v[92:95]
    s_and_b32 s44, s32, 1
    s_lshl_b32 s44, s44, 1
    s_lshl_b32 s45, s34, 2
    s_add_u32 s44, s44, s45
    s_lshl_b32 s45, s33, 6
    s_add_u32 s44, s44, s45
    s_lshl_b32 s44, s44, 5
    s_lshr_b32 s45, s32, 1
    s_lshl_b32 s45, s45, 1
    s_add_u32 s44, s44, s45
    s_lshl_b32 s45, s35, 2
    s_add_u32 s44, s44, s45
    s_lshl_b32 s44, s44, 11
    s_add_u32 s44, s44, 29360128
    s_add_u32 s45, s44, 65536
    s_nop 7
    v_cvt_pk_bf16_f32 v160, v32, v33
    v_cvt_pk_bf16_f32 v161, v34, v35
    v_cvt_pk_bf16_f32 v162, v36, v37
    v_cvt_pk_bf16_f32 v163, v38, v39
    buffer_store_dwordx4 v[160:163], v16, s[12:15], s44 offen offset:0 sc1
    v_cvt_pk_bf16_f32 v164, v40, v41
    v_cvt_pk_bf16_f32 v165, v42, v43
    v_cvt_pk_bf16_f32 v166, v44, v45
    v_cvt_pk_bf16_f32 v167, v46, v47
    buffer_store_dwordx4 v[164:167], v16, s[12:15], s44 offen offset:2048 sc1
    v_cvt_pk_bf16_f32 v168, v48, v49
    v_cvt_pk_bf16_f32 v169, v50, v51
    v_cvt_pk_bf16_f32 v170, v52, v53
    v_cvt_pk_bf16_f32 v171, v54, v55
    buffer_store_dwordx4 v[168:171], v16, s[12:15], s44 offen offset:256 sc1
    v_cvt_pk_bf16_f32 v172, v56, v57
    v_cvt_pk_bf16_f32 v173, v58, v59
    v_cvt_pk_bf16_f32 v174, v60, v61
    v_cvt_pk_bf16_f32 v175, v62, v63
    buffer_store_dwordx4 v[172:175], v16, s[12:15], s44 offen offset:2304 sc1
    v_cvt_pk_bf16_f32 v176, v64, v65
    v_cvt_pk_bf16_f32 v177, v66, v67
    v_cvt_pk_bf16_f32 v178, v68, v69
    v_cvt_pk_bf16_f32 v179, v70, v71
    buffer_store_dwordx4 v[176:179], v16, s[12:15], s45 offen offset:0 sc1
    v_cvt_pk_bf16_f32 v180, v72, v73
    v_cvt_pk_bf16_f32 v181, v74, v75
    v_cvt_pk_bf16_f32 v182, v76, v77
    v_cvt_pk_bf16_f32 v183, v78, v79
    buffer_store_dwordx4 v[180:183], v16, s[12:15], s45 offen offset:2048 sc1
    v_cvt_pk_bf16_f32 v184, v80, v81
    v_cvt_pk_bf16_f32 v185, v82, v83
    v_cvt_pk_bf16_f32 v186, v84, v85
    v_cvt_pk_bf16_f32 v187, v86, v87
    buffer_store_dwordx4 v[184:187], v16, s[12:15], s45 offen offset:256 sc1
    v_cvt_pk_bf16_f32 v188, v88, v89
    v_cvt_pk_bf16_f32 v189, v90, v91
    v_cvt_pk_bf16_f32 v190, v92, v93
    v_cvt_pk_bf16_f32 v191, v94, v95
    buffer_store_dwordx4 v[188:191], v16, s[12:15], s45 offen offset:2304 sc1
    s_waitcnt vmcnt(0)
    s_endpgm
K23_END:
    s_endpgm
    .globl k4_out_kernel
    .p2align 8
    .type k4_out_kernel,@function
k4_out_kernel:
    s_cmp_ge_u32 s2, 256
    s_cbranch_scc1 K4_END
    s_load_dwordx2 s[48:49], s[0:1], 56
    s_load_dwordx2 s[50:51], s[0:1], 72
    s_load_dwordx2 s[60:61], s[0:1], 88
    v_and_b32 v1, 63, v0
    v_lshrrev_b32 v2, 6, v0
    v_lshlrev_b32 v10, 4, v1
    v_readfirstlane_b32 s32, v2
    s_and_b32 s34, s2, 3
    s_lshl_b32 s34, s34, 2
    s_bfe_u32 s44, s2, 0x20003
    s_add_u32 s34, s34, s44
    s_bfe_u32 s35, s2, 0x10002
    s_lshl_b32 s35, s35, 3
    s_lshr_b32 s44, s2, 5
    s_add_u32 s35, s35, s44
    s_lshl_b32 s46, s34, 2
    s_add_u32 s46, s46, s32
    s_lshl_b32 s36, s46, 16
    s_add_u32 s36, s36, 25165824
    s_add_u32 s38, s36, 32768
    v_lshrrev_b32 v2, 2, v1
    s_lshl_b32 s44, s32, 4
    v_add_u32 v2, s44, v2
    v_lshlrev_b32 v2, 11, v2
    v_and_b32 v3, 3, v1
    v_bfe_u32 v4, v1, 4, 1
    v_lshlrev_b32 v4, 1, v4
    v_xor_b32 v3, v3, v4
    v_lshl_add_u32 v2, v3, 4, v2
    s_lshl_b32 s44, s35, 7
    v_add_u32 v8, s44, v2
    v_add_u32 v9, 64, v8
    s_lshl_b32 s39, s32, 10
    s_waitcnt lgkmcnt(0)
    s_mov_b32 s16, s48
    s_and_b32 s17, s49, 0xffff
    s_mov_b32 s18, 2097152
    s_mov_b32 s19, 0x00020000
    s_mov_b32 s12, s60
    s_and_b32 s13, s61, 0xffff
    s_mov_b32 s14, 37748736
    s_mov_b32 s15, 0x00020000
    s_mov_b32 s37, 0
    s_add_u32 m0, s39, 0
    s_nop 0
    buffer_load_dwordx4 v8, s[16:19], s37 offen lds
    s_add_u32 m0, s39, 4096
    s_nop 0
    buffer_load_dwordx4 v9, s[16:19], s37 offen lds
    s_mov_b32 s37, 131072
    s_add_u32 m0, s39, 8192
    s_nop 0
    buffer_load_dwordx4 v8, s[16:19], s37 offen lds
    s_add_u32 m0, s39, 12288
    s_nop 0
    buffer_load_dwordx4 v9, s[16:19], s37 offen lds
    buffer_load_dwordx4 v[116:119], v10, s[12:15], s36 offen offset:0
    buffer_load_dwordx4 v[120:123], v10, s[12:15], s38 offen offset:0
    buffer_load_dwordx4 v[124:127], v10, s[12:15], s36 offen offset:1024
    buffer_load_dwordx4 v[128:131], v10, s[12:15], s38 offen offset:1024
    buffer_load_dwordx4 v[132:135], v10, s[12:15], s36 offen offset:2048
    buffer_load_dwordx4 v[136:139], v10, s[12:15], s38 offen offset:2048
    buffer_load_dwordx4 v[140:143], v10, s[12:15], s36 offen offset:3072
    buffer_load_dwordx4 v[144:147], v10, s[12:15], s38 offen offset:3072
    s_mov_b32 s8, s50
    s_and_b32 s9, s51, 0xffff
    s_mov_b32 s10, 4194304
    s_mov_b32 s11, 0x00020000
    v_and_b32 v2, 15, v1
    v_lshrrev_b32 v3, 4, v1
    v_bfe_u32 v4, v1, 2, 2
    v_lshl_add_u32 v4, v3, 2, v4
    v_lshlrev_b32 v4, 6, v4
    v_and_b32 v5, 3, v1
    v_lshl_add_u32 v4, v5, 3, v4
    v_and_b32 v5, 1, v3
    v_lshl_add_u32 v13, v5, 5, v4
    v_xor_b32 v14, 32, v13
    v_add_u32 v15, 65536, v13
    v_add_u32 v16, 65536, v14
    v_lshlrev_b32 v17, 11, v2
    v_lshl_add_u32 v17, v5, 5, v17
    v_lshrrev_b32 v5, 1, v3
    v_lshl_add_u32 v17, v5, 4, v17
    v_lshlrev_b32 v5, 4, v2
    v_lshl_add_u32 v18, v3, 9, v5
    v_lshlrev_b32 v7, 2, v2
    s_mov_b32 s37, 262144
    s_add_u32 m0, s39, 16384
    s_nop 0
    buffer_load_dwordx4 v8, s[16:19], s37 offen lds
    s_add_u32 m0, s39, 20480
    s_nop 0
    buffer_load_dwordx4 v9, s[16:19], s37 offen lds
    s_mov_b32 s37, 393216
    s_add_u32 m0, s39, 24576
    s_nop 0
    buffer_load_dwordx4 v8, s[16:19], s37 offen lds
    s_add_u32 m0, s39, 28672
    s_nop 0
    buffer_load_dwordx4 v9, s[16:19], s37 offen lds
    s_add_u32 s36, s36, 4096
    s_add_u32 s38, s38, 4096
    buffer_load_dwordx4 v[148:151], v10, s[12:15], s36 offen offset:0
    buffer_load_dwordx4 v[152:155], v10, s[12:15], s38 offen offset:0
    buffer_load_dwordx4 v[156:159], v10, s[12:15], s36 offen offset:1024
    buffer_load_dwordx4 v[160:163], v10, s[12:15], s38 offen offset:1024
    buffer_load_dwordx4 v[164:167], v10, s[12:15], s36 offen offset:2048
    buffer_load_dwordx4 v[168:171], v10, s[12:15], s38 offen offset:2048
    buffer_load_dwordx4 v[172:175], v10, s[12:15], s36 offen offset:3072
    buffer_load_dwordx4 v[176:179], v10, s[12:15], s38 offen offset:3072
    s_waitcnt vmcnt(20)
    s_barrier
    ds_read_b64_tr_b16 v[52:53], v13 offset:0
    ds_read_b64_tr_b16 v[54:55], v13 offset:1024
    ds_read_b64_tr_b16 v[56:57], v14 offset:0
    ds_read_b64_tr_b16 v[58:59], v14 offset:1024
    ds_read_b64_tr_b16 v[60:61], v13 offset:4096
    ds_read_b64_tr_b16 v[62:63], v13 offset:5120
    ds_read_b64_tr_b16 v[64:65], v14 offset:4096
    ds_read_b64_tr_b16 v[66:67], v14 offset:5120
    ds_read_b64_tr_b16 v[68:69], v13 offset:2048
    ds_read_b64_tr_b16 v[70:71], v13 offset:3072
    ds_read_b64_tr_b16 v[72:73], v14 offset:2048
    ds_read_b64_tr_b16 v[74:75], v14 offset:3072
    ds_read_b64_tr_b16 v[76:77], v13 offset:6144
    ds_read_b64_tr_b16 v[78:79], v13 offset:7168
    ds_read_b64_tr_b16 v[80:81], v14 offset:6144
    ds_read_b64_tr_b16 v[82:83], v14 offset:7168
    s_waitcnt vmcnt(18)
    s_waitcnt lgkmcnt(8)
    v_mfma_f32_16x16x32_bf16 v[20:23], v[52:55], v[116:119], 0
    v_mfma_f32_16x16x32_bf16 v[24:27], v[56:59], v[116:119], 0
    v_mfma_f32_16x16x32_bf16 v[28:31], v[60:63], v[116:119], 0
    v_mfma_f32_16x16x32_bf16 v[32:35], v[64:67], v[116:119], 0
    v_mfma_f32_16x16x32_bf16 v[36:39], v[52:55], v[120:123], 0
    v_mfma_f32_16x16x32_bf16 v[40:43], v[56:59], v[120:123], 0
    v_mfma_f32_16x16x32_bf16 v[44:47], v[60:63], v[120:123], 0
    v_mfma_f32_16x16x32_bf16 v[48:51], v[64:67], v[120:123], 0
    s_mov_b32 s37, 524288
    s_add_u32 m0, s39, 32768
    s_nop 0
    buffer_load_dwordx4 v8, s[16:19], s37 offen lds
    s_add_u32 m0, s39, 36864
    s_nop 0
    buffer_load_dwordx4 v9, s[16:19], s37 offen lds
    s_mov_b32 s37, 655360
    s_add_u32 m0, s39, 40960
    s_nop 0
    buffer_load_dwordx4 v8, s[16:19], s37 offen lds
    s_add_u32 m0, s39, 45056
    s_nop 0
    buffer_load_dwordx4 v9, s[16:19], s37 offen lds
    s_add_u32 s36, s36, 4096
    s_add_u32 s38, s38, 4096
    buffer_load_dwordx4 v[116:119], v10, s[12:15], s36 offen offset:0
    buffer_load_dwordx4 v[120:123], v10, s[12:15], s38 offen offset:0
    ds_read_b64_tr_b16 v[52:53], v13 offset:8192
    ds_read_b64_tr_b16 v[54:55], v13 offset:9216
    ds_read_b64_tr_b16 v[56:57], v14 offset:8192
    ds_read_b64_tr_b16 v[58:59], v14 offset:9216
    ds_read_b64_tr_b16 v[60:61], v13 offset:12288
    ds_read_b64_tr_b16 v[62:63], v13 offset:13312
    ds_read_b64_tr_b16 v[64:65], v14 offset:12288
    ds_read_b64_tr_b16 v[66:67], v14 offset:13312
    s_waitcnt vmcnt(22)
    s_waitcnt lgkmcnt(8)
    v_mfma_f32_16x16x32_bf16 v[20:23], v[68:71], v[124:127], v[20:23]
    v_mfma_f32_16x16x32_bf16 v[24:27], v[72:75], v[124:127], v[24:27]
    v_mfma_f32_16x16x32_bf16 v[28:31], v[76:79], v[124:127], v[28:31]
    v_mfma_f32_16x16x32_bf16 v[32:35], v[80:83], v[124:127], v[32:35]
    v_mfma_f32_16x16x32_bf16 v[36:39], v[68:71], v[128:131], v[36:39]
    v_mfma_f32_16x16x32_bf16 v[40:43], v[72:75], v[128:131], v[40:43]
    v_mfma_f32_16x16x32_bf16 v[44:47], v[76:79], v[128:131], v[44:47]
    v_mfma_f32_16x16x32_bf16 v[48:51], v[80:83], v[128:131], v[48:51]
    buffer_load_dwordx4 v[124:127], v10, s[12:15], s36 offen offset:1024
    buffer_load_dwordx4 v[128:131], v10, s[12:15], s38 offen offset:1024
    ds_read_b64_tr_b16 v[68:69], v13 offset:10240
    ds_read_b64_tr_b16 v[70:71], v13 offset:11264
    ds_read_b64_tr_b16 v[72:73], v14 offset:10240
    ds_read_b64_tr_b16 v[74:75], v14 offset:11264
    ds_read_b64_tr_b16 v[76:77], v13 offset:14336
    ds_read_b64_tr_b16 v[78:79], v13 offset:15360
    ds_read_b64_tr_b16 v[80:81], v14 offset:14336
    ds_read_b64_tr_b16 v[82:83], v14 offset:15360
    s_waitcnt vmcnt(22)
    s_waitcnt lgkmcnt(8)
    v_mfma_f32_16x16x32_bf16 v[20:23], v[52:55], v[132:135], v[20:23]
    v_mfma_f32_16x16x32_bf16 v[24:27], v[56:59], v[132:135], v[24:27]
    v_mfma_f32_16x16x32_bf16 v[28:31], v[60:63], v[132:135], v[28:31]
    v_mfma_f32_16x16x32_bf16 v[32:35], v[64:67], v[132:135], v[32:35]
    v_mfma_f32_16x16x32_bf16 v[36:39], v[52:55], v[136:139], v[36:39]
    v_mfma_f32_16x16x32_bf16 v[40:43], v[56:59], v[136:139], v[40:43]
    v_mfma_f32_16x16x32_bf16 v[44:47], v[60:63], v[136:139], v[44:47]
    v_mfma_f32_16x16x32_bf16 v[48:51], v[64:67], v[136:139], v[48:51]
    buffer_load_dwordx4 v[132:135], v10, s[12:15], s36 offen offset:2048
    buffer_load_dwordx4 v[136:139], v10, s[12:15], s38 offen offset:2048
    s_waitcnt vmcnt(22)
    s_waitcnt lgkmcnt(0)
    v_mfma_f32_16x16x32_bf16 v[20:23], v[68:71], v[140:143], v[20:23]
    v_mfma_f32_16x16x32_bf16 v[24:27], v[72:75], v[140:143], v[24:27]
    v_mfma_f32_16x16x32_bf16 v[28:31], v[76:79], v[140:143], v[28:31]
    v_mfma_f32_16x16x32_bf16 v[32:35], v[80:83], v[140:143], v[32:35]
    v_mfma_f32_16x16x32_bf16 v[36:39], v[68:71], v[144:147], v[36:39]
    v_mfma_f32_16x16x32_bf16 v[40:43], v[72:75], v[144:147], v[40:43]
    v_mfma_f32_16x16x32_bf16 v[44:47], v[76:79], v[144:147], v[44:47]
    v_mfma_f32_16x16x32_bf16 v[48:51], v[80:83], v[144:147], v[48:51]
    buffer_load_dwordx4 v[140:143], v10, s[12:15], s36 offen offset:3072
    buffer_load_dwordx4 v[144:147], v10, s[12:15], s38 offen offset:3072
    s_waitcnt vmcnt(20)
    s_barrier
    ds_read_b64_tr_b16 v[52:53], v13 offset:16384
    ds_read_b64_tr_b16 v[54:55], v13 offset:17408
    ds_read_b64_tr_b16 v[56:57], v14 offset:16384
    ds_read_b64_tr_b16 v[58:59], v14 offset:17408
    ds_read_b64_tr_b16 v[60:61], v13 offset:20480
    ds_read_b64_tr_b16 v[62:63], v13 offset:21504
    ds_read_b64_tr_b16 v[64:65], v14 offset:20480
    ds_read_b64_tr_b16 v[66:67], v14 offset:21504
    ds_read_b64_tr_b16 v[68:69], v13 offset:18432
    ds_read_b64_tr_b16 v[70:71], v13 offset:19456
    ds_read_b64_tr_b16 v[72:73], v14 offset:18432
    ds_read_b64_tr_b16 v[74:75], v14 offset:19456
    ds_read_b64_tr_b16 v[76:77], v13 offset:22528
    ds_read_b64_tr_b16 v[78:79], v13 offset:23552
    ds_read_b64_tr_b16 v[80:81], v14 offset:22528
    ds_read_b64_tr_b16 v[82:83], v14 offset:23552
    s_waitcnt vmcnt(18)
    s_waitcnt lgkmcnt(8)
    v_mfma_f32_16x16x32_bf16 v[20:23], v[52:55], v[148:151], v[20:23]
    v_mfma_f32_16x16x32_bf16 v[24:27], v[56:59], v[148:151], v[24:27]
    v_mfma_f32_16x16x32_bf16 v[28:31], v[60:63], v[148:151], v[28:31]
    v_mfma_f32_16x16x32_bf16 v[32:35], v[64:67], v[148:151], v[32:35]
    v_mfma_f32_16x16x32_bf16 v[36:39], v[52:55], v[152:155], v[36:39]
    v_mfma_f32_16x16x32_bf16 v[40:43], v[56:59], v[152:155], v[40:43]
    v_mfma_f32_16x16x32_bf16 v[44:47], v[60:63], v[152:155], v[44:47]
    v_mfma_f32_16x16x32_bf16 v[48:51], v[64:67], v[152:155], v[48:51]
    s_mov_b32 s37, 786432
    s_add_u32 m0, s39, 49152
    s_nop 0
    buffer_load_dwordx4 v8, s[16:19], s37 offen lds
    s_add_u32 m0, s39, 53248
    s_nop 0
    buffer_load_dwordx4 v9, s[16:19], s37 offen lds
    s_mov_b32 s37, 917504
    s_add_u32 m0, s39, 57344
    s_nop 0
    buffer_load_dwordx4 v8, s[16:19], s37 offen lds
    s_add_u32 m0, s39, 61440
    s_nop 0
    buffer_load_dwordx4 v9, s[16:19], s37 offen lds
    s_add_u32 s36, s36, 4096
    s_add_u32 s38, s38, 4096
    buffer_load_dwordx4 v[148:151], v10, s[12:15], s36 offen offset:0
    buffer_load_dwordx4 v[152:155], v10, s[12:15], s38 offen offset:0
    ds_read_b64_tr_b16 v[52:53], v13 offset:24576
    ds_read_b64_tr_b16 v[54:55], v13 offset:25600
    ds_read_b64_tr_b16 v[56:57], v14 offset:24576
    ds_read_b64_tr_b16 v[58:59], v14 offset:25600
    ds_read_b64_tr_b16 v[60:61], v13 offset:28672
    ds_read_b64_tr_b16 v[62:63], v13 offset:29696
    ds_read_b64_tr_b16 v[64:65], v14 offset:28672
    ds_read_b64_tr_b16 v[66:67], v14 offset:29696
    s_waitcnt vmcnt(22)
    s_waitcnt lgkmcnt(8)
    v_mfma_f32_16x16x32_bf16 v[20:23], v[68:71], v[156:159], v[20:23]
    v_mfma_f32_16x16x32_bf16 v[24:27], v[72:75], v[156:159], v[24:27]
    v_mfma_f32_16x16x32_bf16 v[28:31], v[76:79], v[156:159], v[28:31]
    v_mfma_f32_16x16x32_bf16 v[32:35], v[80:83], v[156:159], v[32:35]
    v_mfma_f32_16x16x32_bf16 v[36:39], v[68:71], v[160:163], v[36:39]
    v_mfma_f32_16x16x32_bf16 v[40:43], v[72:75], v[160:163], v[40:43]
    v_mfma_f32_16x16x32_bf16 v[44:47], v[76:79], v[160:163], v[44:47]
    v_mfma_f32_16x16x32_bf16 v[48:51], v[80:83], v[160:163], v[48:51]
    buffer_load_dwordx4 v[156:159], v10, s[12:15], s36 offen offset:1024
    buffer_load_dwordx4 v[160:163], v10, s[12:15], s38 offen offset:1024
    ds_read_b64_tr_b16 v[68:69], v13 offset:26624
    ds_read_b64_tr_b16 v[70:71], v13 offset:27648
    ds_read_b64_tr_b16 v[72:73], v14 offset:26624
    ds_read_b64_tr_b16 v[74:75], v14 offset:27648
    ds_read_b64_tr_b16 v[76:77], v13 offset:30720
    ds_read_b64_tr_b16 v[78:79], v13 offset:31744
    ds_read_b64_tr_b16 v[80:81], v14 offset:30720
    ds_read_b64_tr_b16 v[82:83], v14 offset:31744
    s_waitcnt vmcnt(22)
    s_waitcnt lgkmcnt(8)
    v_mfma_f32_16x16x32_bf16 v[20:23], v[52:55], v[164:167], v[20:23]
    v_mfma_f32_16x16x32_bf16 v[24:27], v[56:59], v[164:167], v[24:27]
    v_mfma_f32_16x16x32_bf16 v[28:31], v[60:63], v[164:167], v[28:31]
    v_mfma_f32_16x16x32_bf16 v[32:35], v[64:67], v[164:167], v[32:35]
    v_mfma_f32_16x16x32_bf16 v[36:39], v[52:55], v[168:171], v[36:39]
    v_mfma_f32_16x16x32_bf16 v[40:43], v[56:59], v[168:171], v[40:43]
    v_mfma_f32_16x16x32_bf16 v[44:47], v[60:63], v[168:171], v[44:47]
    v_mfma_f32_16x16x32_bf16 v[48:51], v[64:67], v[168:171], v[48:51]
    buffer_load_dwordx4 v[164:167], v10, s[12:15], s36 offen offset:2048
    buffer_load_dwordx4 v[168:171], v10, s[12:15], s38 offen offset:2048
    s_waitcnt vmcnt(22)
    s_waitcnt lgkmcnt(0)
    v_mfma_f32_16x16x32_bf16 v[20:23], v[68:71], v[172:175], v[20:23]
    v_mfma_f32_16x16x32_bf16 v[24:27], v[72:75], v[172:175], v[24:27]
    v_mfma_f32_16x16x32_bf16 v[28:31], v[76:79], v[172:175], v[28:31]
    v_mfma_f32_16x16x32_bf16 v[32:35], v[80:83], v[172:175], v[32:35]
    v_mfma_f32_16x16x32_bf16 v[36:39], v[68:71], v[176:179], v[36:39]
    v_mfma_f32_16x16x32_bf16 v[40:43], v[72:75], v[176:179], v[40:43]
    v_mfma_f32_16x16x32_bf16 v[44:47], v[76:79], v[176:179], v[44:47]
    v_mfma_f32_16x16x32_bf16 v[48:51], v[80:83], v[176:179], v[48:51]
    buffer_load_dwordx4 v[172:175], v10, s[12:15], s36 offen offset:3072
    buffer_load_dwordx4 v[176:179], v10, s[12:15], s38 offen offset:3072
    s_waitcnt vmcnt(20)
    s_barrier
    ds_read_b64_tr_b16 v[52:53], v13 offset:32768
    ds_read_b64_tr_b16 v[54:55], v13 offset:33792
    ds_read_b64_tr_b16 v[56:57], v14 offset:32768
    ds_read_b64_tr_b16 v[58:59], v14 offset:33792
    ds_read_b64_tr_b16 v[60:61], v13 offset:36864
    ds_read_b64_tr_b16 v[62:63], v13 offset:37888
    ds_read_b64_tr_b16 v[64:65], v14 offset:36864
    ds_read_b64_tr_b16 v[66:67], v14 offset:37888
    ds_read_b64_tr_b16 v[68:69], v13 offset:34816
    ds_read_b64_tr_b16 v[70:71], v13 offset:35840
    ds_read_b64_tr_b16 v[72:73], v14 offset:34816
    ds_read_b64_tr_b16 v[74:75], v14 offset:35840
    ds_read_b64_tr_b16 v[76:77], v13 offset:38912
    ds_read_b64_tr_b16 v[78:79], v13 offset:39936
    ds_read_b64_tr_b16 v[80:81], v14 offset:38912
    ds_read_b64_tr_b16 v[82:83], v14 offset:39936
    s_waitcnt vmcnt(18)
    s_waitcnt lgkmcnt(8)
    v_mfma_f32_16x16x32_bf16 v[20:23], v[52:55], v[116:119], v[20:23]
    v_mfma_f32_16x16x32_bf16 v[24:27], v[56:59], v[116:119], v[24:27]
    v_mfma_f32_16x16x32_bf16 v[28:31], v[60:63], v[116:119], v[28:31]
    v_mfma_f32_16x16x32_bf16 v[32:35], v[64:67], v[116:119], v[32:35]
    v_mfma_f32_16x16x32_bf16 v[36:39], v[52:55], v[120:123], v[36:39]
    v_mfma_f32_16x16x32_bf16 v[40:43], v[56:59], v[120:123], v[40:43]
    v_mfma_f32_16x16x32_bf16 v[44:47], v[60:63], v[120:123], v[44:47]
    v_mfma_f32_16x16x32_bf16 v[48:51], v[64:67], v[120:123], v[48:51]
    s_mov_b32 s37, 1048576
    s_add_u32 m0, s39, 65536
    s_nop 0
    buffer_load_dwordx4 v8, s[16:19], s37 offen lds
    s_add_u32 m0, s39, 69632
    s_nop 0
    buffer_load_dwordx4 v9, s[16:19], s37 offen lds
    s_mov_b32 s37, 1179648
    s_add_u32 m0, s39, 73728
    s_nop 0
    buffer_load_dwordx4 v8, s[16:19], s37 offen lds
    s_add_u32 m0, s39, 77824
    s_nop 0
    buffer_load_dwordx4 v9, s[16:19], s37 offen lds
    s_add_u32 s36, s36, 4096
    s_add_u32 s38, s38, 4096
    buffer_load_dwordx4 v[116:119], v10, s[12:15], s36 offen offset:0
    buffer_load_dwordx4 v[120:123], v10, s[12:15], s38 offen offset:0
    ds_read_b64_tr_b16 v[52:53], v13 offset:40960
    ds_read_b64_tr_b16 v[54:55], v13 offset:41984
    ds_read_b64_tr_b16 v[56:57], v14 offset:40960
    ds_read_b64_tr_b16 v[58:59], v14 offset:41984
    ds_read_b64_tr_b16 v[60:61], v13 offset:45056
    ds_read_b64_tr_b16 v[62:63], v13 offset:46080
    ds_read_b64_tr_b16 v[64:65], v14 offset:45056
    ds_read_b64_tr_b16 v[66:67], v14 offset:46080
    s_waitcnt vmcnt(22)
    s_waitcnt lgkmcnt(8)
    v_mfma_f32_16x16x32_bf16 v[20:23], v[68:71], v[124:127], v[20:23]
    v_mfma_f32_16x16x32_bf16 v[24:27], v[72:75], v[124:127], v[24:27]
    v_mfma_f32_16x16x32_bf16 v[28:31], v[76:79], v[124:127], v[28:31]
    v_mfma_f32_16x16x32_bf16 v[32:35], v[80:83], v[124:127], v[32:35]
    v_mfma_f32_16x16x32_bf16 v[36:39], v[68:71], v[128:131], v[36:39]
    v_mfma_f32_16x16x32_bf16 v[40:43], v[72:75], v[128:131], v[40:43]
    v_mfma_f32_16x16x32_bf16 v[44:47], v[76:79], v[128:131], v[44:47]
    v_mfma_f32_16x16x32_bf16 v[48:51], v[80:83], v[128:131], v[48:51]
    buffer_load_dwordx4 v[124:127], v10, s[12:15], s36 offen offset:1024
    buffer_load_dwordx4 v[128:131], v10, s[12:15], s38 offen offset:1024
    ds_read_b64_tr_b16 v[68:69], v13 offset:43008
    ds_read_b64_tr_b16 v[70:71], v13 offset:44032
    ds_read_b64_tr_b16 v[72:73], v14 offset:43008
    ds_read_b64_tr_b16 v[74:75], v14 offset:44032
    ds_read_b64_tr_b16 v[76:77], v13 offset:47104
    ds_read_b64_tr_b16 v[78:79], v13 offset:48128
    ds_read_b64_tr_b16 v[80:81], v14 offset:47104
    ds_read_b64_tr_b16 v[82:83], v14 offset:48128
    s_waitcnt vmcnt(22)
    s_waitcnt lgkmcnt(8)
    v_mfma_f32_16x16x32_bf16 v[20:23], v[52:55], v[132:135], v[20:23]
    v_mfma_f32_16x16x32_bf16 v[24:27], v[56:59], v[132:135], v[24:27]
    v_mfma_f32_16x16x32_bf16 v[28:31], v[60:63], v[132:135], v[28:31]
    v_mfma_f32_16x16x32_bf16 v[32:35], v[64:67], v[132:135], v[32:35]
    v_mfma_f32_16x16x32_bf16 v[36:39], v[52:55], v[136:139], v[36:39]
    v_mfma_f32_16x16x32_bf16 v[40:43], v[56:59], v[136:139], v[40:43]
    v_mfma_f32_16x16x32_bf16 v[44:47], v[60:63], v[136:139], v[44:47]
    v_mfma_f32_16x16x32_bf16 v[48:51], v[64:67], v[136:139], v[48:51]
    buffer_load_dwordx4 v[132:135], v10, s[12:15], s36 offen offset:2048
    buffer_load_dwordx4 v[136:139], v10, s[12:15], s38 offen offset:2048
    s_waitcnt vmcnt(22)
    s_waitcnt lgkmcnt(0)
    v_mfma_f32_16x16x32_bf16 v[20:23], v[68:71], v[140:143], v[20:23]
    v_mfma_f32_16x16x32_bf16 v[24:27], v[72:75], v[140:143], v[24:27]
    v_mfma_f32_16x16x32_bf16 v[28:31], v[76:79], v[140:143], v[28:31]
    v_mfma_f32_16x16x32_bf16 v[32:35], v[80:83], v[140:143], v[32:35]
    v_mfma_f32_16x16x32_bf16 v[36:39], v[68:71], v[144:147], v[36:39]
    v_mfma_f32_16x16x32_bf16 v[40:43], v[72:75], v[144:147], v[40:43]
    v_mfma_f32_16x16x32_bf16 v[44:47], v[76:79], v[144:147], v[44:47]
    v_mfma_f32_16x16x32_bf16 v[48:51], v[80:83], v[144:147], v[48:51]
    buffer_load_dwordx4 v[140:143], v10, s[12:15], s36 offen offset:3072
    buffer_load_dwordx4 v[144:147], v10, s[12:15], s38 offen offset:3072
    s_waitcnt vmcnt(20)
    s_barrier
    ds_read_b64_tr_b16 v[52:53], v13 offset:49152
    ds_read_b64_tr_b16 v[54:55], v13 offset:50176
    ds_read_b64_tr_b16 v[56:57], v14 offset:49152
    ds_read_b64_tr_b16 v[58:59], v14 offset:50176
    ds_read_b64_tr_b16 v[60:61], v13 offset:53248
    ds_read_b64_tr_b16 v[62:63], v13 offset:54272
    ds_read_b64_tr_b16 v[64:65], v14 offset:53248
    ds_read_b64_tr_b16 v[66:67], v14 offset:54272
    ds_read_b64_tr_b16 v[68:69], v13 offset:51200
    ds_read_b64_tr_b16 v[70:71], v13 offset:52224
    ds_read_b64_tr_b16 v[72:73], v14 offset:51200
    ds_read_b64_tr_b16 v[74:75], v14 offset:52224
    ds_read_b64_tr_b16 v[76:77], v13 offset:55296
    ds_read_b64_tr_b16 v[78:79], v13 offset:56320
    ds_read_b64_tr_b16 v[80:81], v14 offset:55296
    ds_read_b64_tr_b16 v[82:83], v14 offset:56320
    s_waitcnt vmcnt(18)
    s_waitcnt lgkmcnt(8)
    v_mfma_f32_16x16x32_bf16 v[20:23], v[52:55], v[148:151], v[20:23]
    v_mfma_f32_16x16x32_bf16 v[24:27], v[56:59], v[148:151], v[24:27]
    v_mfma_f32_16x16x32_bf16 v[28:31], v[60:63], v[148:151], v[28:31]
    v_mfma_f32_16x16x32_bf16 v[32:35], v[64:67], v[148:151], v[32:35]
    v_mfma_f32_16x16x32_bf16 v[36:39], v[52:55], v[152:155], v[36:39]
    v_mfma_f32_16x16x32_bf16 v[40:43], v[56:59], v[152:155], v[40:43]
    v_mfma_f32_16x16x32_bf16 v[44:47], v[60:63], v[152:155], v[44:47]
    v_mfma_f32_16x16x32_bf16 v[48:51], v[64:67], v[152:155], v[48:51]
    s_mov_b32 s37, 1310720
    s_add_u32 m0, s39, 81920
    s_nop 0
    buffer_load_dwordx4 v8, s[16:19], s37 offen lds
    s_add_u32 m0, s39, 86016
    s_nop 0
    buffer_load_dwordx4 v9, s[16:19], s37 offen lds
    s_mov_b32 s37, 1441792
    s_add_u32 m0, s39, 90112
    s_nop 0
    buffer_load_dwordx4 v8, s[16:19], s37 offen lds
    s_add_u32 m0, s39, 94208
    s_nop 0
    buffer_load_dwordx4 v9, s[16:19], s37 offen lds
    s_add_u32 s36, s36, 4096
    s_add_u32 s38, s38, 4096
    buffer_load_dwordx4 v[148:151], v10, s[12:15], s36 offen offset:0
    buffer_load_dwordx4 v[152:155], v10, s[12:15], s38 offen offset:0
    ds_read_b64_tr_b16 v[52:53], v13 offset:57344
    ds_read_b64_tr_b16 v[54:55], v13 offset:58368
    ds_read_b64_tr_b16 v[56:57], v14 offset:57344
    ds_read_b64_tr_b16 v[58:59], v14 offset:58368
    ds_read_b64_tr_b16 v[60:61], v13 offset:61440
    ds_read_b64_tr_b16 v[62:63], v13 offset:62464
    ds_read_b64_tr_b16 v[64:65], v14 offset:61440
    ds_read_b64_tr_b16 v[66:67], v14 offset:62464
    s_waitcnt vmcnt(22)
    s_waitcnt lgkmcnt(8)
    v_mfma_f32_16x16x32_bf16 v[20:23], v[68:71], v[156:159], v[20:23]
    v_mfma_f32_16x16x32_bf16 v[24:27], v[72:75], v[156:159], v[24:27]
    v_mfma_f32_16x16x32_bf16 v[28:31], v[76:79], v[156:159], v[28:31]
    v_mfma_f32_16x16x32_bf16 v[32:35], v[80:83], v[156:159], v[32:35]
    v_mfma_f32_16x16x32_bf16 v[36:39], v[68:71], v[160:163], v[36:39]
    v_mfma_f32_16x16x32_bf16 v[40:43], v[72:75], v[160:163], v[40:43]
    v_mfma_f32_16x16x32_bf16 v[44:47], v[76:79], v[160:163], v[44:47]
    v_mfma_f32_16x16x32_bf16 v[48:51], v[80:83], v[160:163], v[48:51]
    buffer_load_dwordx4 v[156:159], v10, s[12:15], s36 offen offset:1024
    buffer_load_dwordx4 v[160:163], v10, s[12:15], s38 offen offset:1024
    ds_read_b64_tr_b16 v[68:69], v13 offset:59392
    ds_read_b64_tr_b16 v[70:71], v13 offset:60416
    ds_read_b64_tr_b16 v[72:73], v14 offset:59392
    ds_read_b64_tr_b16 v[74:75], v14 offset:60416
    ds_read_b64_tr_b16 v[76:77], v13 offset:63488
    ds_read_b64_tr_b16 v[78:79], v13 offset:64512
    ds_read_b64_tr_b16 v[80:81], v14 offset:63488
    ds_read_b64_tr_b16 v[82:83], v14 offset:64512
    s_waitcnt vmcnt(22)
    s_waitcnt lgkmcnt(8)
    v_mfma_f32_16x16x32_bf16 v[20:23], v[52:55], v[164:167], v[20:23]
    v_mfma_f32_16x16x32_bf16 v[24:27], v[56:59], v[164:167], v[24:27]
    v_mfma_f32_16x16x32_bf16 v[28:31], v[60:63], v[164:167], v[28:31]
    v_mfma_f32_16x16x32_bf16 v[32:35], v[64:67], v[164:167], v[32:35]
    v_mfma_f32_16x16x32_bf16 v[36:39], v[52:55], v[168:171], v[36:39]
    v_mfma_f32_16x16x32_bf16 v[40:43], v[56:59], v[168:171], v[40:43]
    v_mfma_f32_16x16x32_bf16 v[44:47], v[60:63], v[168:171], v[44:47]
    v_mfma_f32_16x16x32_bf16 v[48:51], v[64:67], v[168:171], v[48:51]
    buffer_load_dwordx4 v[164:167], v10, s[12:15], s36 offen offset:2048
    buffer_load_dwordx4 v[168:171], v10, s[12:15], s38 offen offset:2048
    s_waitcnt vmcnt(22)
    s_waitcnt lgkmcnt(0)
    v_mfma_f32_16x16x32_bf16 v[20:23], v[68:71], v[172:175], v[20:23]
    v_mfma_f32_16x16x32_bf16 v[24:27], v[72:75], v[172:175], v[24:27]
    v_mfma_f32_16x16x32_bf16 v[28:31], v[76:79], v[172:175], v[28:31]
    v_mfma_f32_16x16x32_bf16 v[32:35], v[80:83], v[172:175], v[32:35]
    v_mfma_f32_16x16x32_bf16 v[36:39], v[68:71], v[176:179], v[36:39]
    v_mfma_f32_16x16x32_bf16 v[40:43], v[72:75], v[176:179], v[40:43]
    v_mfma_f32_16x16x32_bf16 v[44:47], v[76:79], v[176:179], v[44:47]
    v_mfma_f32_16x16x32_bf16 v[48:51], v[80:83], v[176:179], v[48:51]
    buffer_load_dwordx4 v[172:175], v10, s[12:15], s36 offen offset:3072
    buffer_load_dwordx4 v[176:179], v10, s[12:15], s38 offen offset:3072
    s_lshl_b32 s44, s46, 5
    s_lshl_b32 s45, s35, 1
    s_add_u32 s44, s44, s45
    s_lshl_b32 s44, s44, 11
    s_add_u32 s44, s44, 29360128
    s_add_u32 s45, s44, 4194304
    buffer_load_dwordx4 v[84:87], v18, s[12:15], s44 offen offset:0
    buffer_load_dwordx4 v[88:91], v18, s[12:15], s44 offen offset:256
    buffer_load_dwordx4 v[92:95], v18, s[12:15], s44 offen offset:2048
    buffer_load_dwordx4 v[96:99], v18, s[12:15], s44 offen offset:2304
    buffer_load_dwordx4 v[100:103], v18, s[12:15], s45 offen offset:0
    buffer_load_dwordx4 v[104:107], v18, s[12:15], s45 offen offset:256
    buffer_load_dwordx4 v[108:111], v18, s[12:15], s45 offen offset:2048
    buffer_load_dwordx4 v[112:115], v18, s[12:15], s45 offen offset:2304
    s_lshl_b32 s44, s46, 7
    s_add_u32 s44, s44, 20971520
    buffer_load_dword v11, v7, s[12:15], s44 offen offset:0
    buffer_load_dword v12, v7, s[12:15], s44 offen offset:64
    s_lshl_b32 s47, s46, 16
    s_lshl_b32 s44, s35, 7
    s_add_u32 s47, s47, s44
    s_add_u32 s43, s47, 32768
    s_waitcnt vmcnt(30)
    s_barrier
    ds_read_b64_tr_b16 v[52:53], v15 offset:0
    ds_read_b64_tr_b16 v[54:55], v15 offset:1024
    ds_read_b64_tr_b16 v[56:57], v16 offset:0
    ds_read_b64_tr_b16 v[58:59], v16 offset:1024
    ds_read_b64_tr_b16 v[60:61], v15 offset:4096
    ds_read_b64_tr_b16 v[62:63], v15 offset:5120
    ds_read_b64_tr_b16 v[64:65], v16 offset:4096
    ds_read_b64_tr_b16 v[66:67], v16 offset:5120
    ds_read_b64_tr_b16 v[68:69], v15 offset:2048
    ds_read_b64_tr_b16 v[70:71], v15 offset:3072
    ds_read_b64_tr_b16 v[72:73], v16 offset:2048
    ds_read_b64_tr_b16 v[74:75], v16 offset:3072
    ds_read_b64_tr_b16 v[76:77], v15 offset:6144
    ds_read_b64_tr_b16 v[78:79], v15 offset:7168
    ds_read_b64_tr_b16 v[80:81], v16 offset:6144
    ds_read_b64_tr_b16 v[82:83], v16 offset:7168
    s_waitcnt vmcnt(28)
    s_waitcnt lgkmcnt(8)
    v_mfma_f32_16x16x32_bf16 v[20:23], v[52:55], v[116:119], v[20:23]
    v_mfma_f32_16x16x32_bf16 v[24:27], v[56:59], v[116:119], v[24:27]
    v_mfma_f32_16x16x32_bf16 v[28:31], v[60:63], v[116:119], v[28:31]
    v_mfma_f32_16x16x32_bf16 v[32:35], v[64:67], v[116:119], v[32:35]
    v_mfma_f32_16x16x32_bf16 v[36:39], v[52:55], v[120:123], v[36:39]
    v_mfma_f32_16x16x32_bf16 v[40:43], v[56:59], v[120:123], v[40:43]
    v_mfma_f32_16x16x32_bf16 v[44:47], v[60:63], v[120:123], v[44:47]
    v_mfma_f32_16x16x32_bf16 v[48:51], v[64:67], v[120:123], v[48:51]
    s_mov_b32 s37, 1572864
    s_add_u32 m0, s39, 98304
    s_nop 0
    buffer_load_dwordx4 v8, s[16:19], s37 offen lds
    s_add_u32 m0, s39, 102400
    s_nop 0
    buffer_load_dwordx4 v9, s[16:19], s37 offen lds
    s_mov_b32 s37, 1703936
    s_add_u32 m0, s39, 106496
    s_nop 0
    buffer_load_dwordx4 v8, s[16:19], s37 offen lds
    s_add_u32 m0, s39, 110592
    s_nop 0
    buffer_load_dwordx4 v9, s[16:19], s37 offen lds
    s_add_u32 s36, s36, 4096
    s_add_u32 s38, s38, 4096
    buffer_load_dwordx4 v[116:119], v10, s[12:15], s36 offen offset:0
    buffer_load_dwordx4 v[120:123], v10, s[12:15], s38 offen offset:0
    ds_read_b64_tr_b16 v[52:53], v15 offset:8192
    ds_read_b64_tr_b16 v[54:55], v15 offset:9216
    ds_read_b64_tr_b16 v[56:57], v16 offset:8192
    ds_read_b64_tr_b16 v[58:59], v16 offset:9216
    ds_read_b64_tr_b16 v[60:61], v15 offset:12288
    ds_read_b64_tr_b16 v[62:63], v15 offset:13312
    ds_read_b64_tr_b16 v[64:65], v16 offset:12288
    ds_read_b64_tr_b16 v[66:67], v16 offset:13312
    s_waitcnt vmcnt(32)
    s_waitcnt lgkmcnt(8)
    v_mfma_f32_16x16x32_bf16 v[20:23], v[68:71], v[124:127], v[20:23]
    v_mfma_f32_16x16x32_bf16 v[24:27], v[72:75], v[124:127], v[24:27]
    v_mfma_f32_16x16x32_bf16 v[28:31], v[76:79], v[124:127], v[28:31]
    v_mfma_f32_16x16x32_bf16 v[32:35], v[80:83], v[124:127], v[32:35]
    v_mfma_f32_16x16x32_bf16 v[36:39], v[68:71], v[128:131], v[36:39]
    v_mfma_f32_16x16x32_bf16 v[40:43], v[72:75], v[128:131], v[40:43]
    v_mfma_f32_16x16x32_bf16 v[44:47], v[76:79], v[128:131], v[44:47]
    v_mfma_f32_16x16x32_bf16 v[48:51], v[80:83], v[128:131], v[48:51]
    buffer_load_dwordx4 v[124:127], v10, s[12:15], s36 offen offset:1024
    buffer_load_dwordx4 v[128:131], v10, s[12:15], s38 offen offset:1024
    ds_read_b64_tr_b16 v[68:69], v15 offset:10240
    ds_read_b64_tr_b16 v[70:71], v15 offset:11264
    ds_read_b64_tr_b16 v[72:73], v16 offset:10240
    ds_read_b64_tr_b16 v[74:75], v16 offset:11264
    ds_read_b64_tr_b16 v[76:77], v15 offset:14336
    ds_read_b64_tr_b16 v[78:79], v15 offset:15360
    ds_read_b64_tr_b16 v[80:81], v16 offset:14336
    ds_read_b64_tr_b16 v[82:83], v16 offset:15360
    s_waitcnt vmcnt(32)
    s_waitcnt lgkmcnt(8)
    v_mfma_f32_16x16x32_bf16 v[20:23], v[52:55], v[132:135], v[20:23]
    v_mfma_f32_16x16x32_bf16 v[24:27], v[56:59], v[132:135], v[24:27]
    v_mfma_f32_16x16x32_bf16 v[28:31], v[60:63], v[132:135], v[28:31]
    v_mfma_f32_16x16x32_bf16 v[32:35], v[64:67], v[132:135], v[32:35]
    v_mfma_f32_16x16x32_bf16 v[36:39], v[52:55], v[136:139], v[36:39]
    v_mfma_f32_16x16x32_bf16 v[40:43], v[56:59], v[136:139], v[40:43]
    v_mfma_f32_16x16x32_bf16 v[44:47], v[60:63], v[136:139], v[44:47]
    v_mfma_f32_16x16x32_bf16 v[48:51], v[64:67], v[136:139], v[48:51]
    buffer_load_dwordx4 v[132:135], v10, s[12:15], s36 offen offset:2048
    buffer_load_dwordx4 v[136:139], v10, s[12:15], s38 offen offset:2048
    s_waitcnt vmcnt(32)
    s_waitcnt lgkmcnt(0)
    v_mfma_f32_16x16x32_bf16 v[20:23], v[68:71], v[140:143], v[20:23]
    v_mfma_f32_16x16x32_bf16 v[24:27], v[72:75], v[140:143], v[24:27]
    v_mfma_f32_16x16x32_bf16 v[28:31], v[76:79], v[140:143], v[28:31]
    v_mfma_f32_16x16x32_bf16 v[32:35], v[80:83], v[140:143], v[32:35]
    v_mfma_f32_16x16x32_bf16 v[36:39], v[68:71], v[144:147], v[36:39]
    v_mfma_f32_16x16x32_bf16 v[40:43], v[72:75], v[144:147], v[40:43]
    v_mfma_f32_16x16x32_bf16 v[44:47], v[76:79], v[144:147], v[44:47]
    v_mfma_f32_16x16x32_bf16 v[48:51], v[80:83], v[144:147], v[48:51]
    buffer_load_dwordx4 v[140:143], v10, s[12:15], s36 offen offset:3072
    buffer_load_dwordx4 v[144:147], v10, s[12:15], s38 offen offset:3072
    s_waitcnt vmcnt(30)
    s_barrier
    ds_read_b64_tr_b16 v[52:53], v15 offset:16384
    ds_read_b64_tr_b16 v[54:55], v15 offset:17408
    ds_read_b64_tr_b16 v[56:57], v16 offset:16384
    ds_read_b64_tr_b16 v[58:59], v16 offset:17408
    ds_read_b64_tr_b16 v[60:61], v15 offset:20480
    ds_read_b64_tr_b16 v[62:63], v15 offset:21504
    ds_read_b64_tr_b16 v[64:65], v16 offset:20480
    ds_read_b64_tr_b16 v[66:67], v16 offset:21504
    ds_read_b64_tr_b16 v[68:69], v15 offset:18432
    ds_read_b64_tr_b16 v[70:71], v15 offset:19456
    ds_read_b64_tr_b16 v[72:73], v16 offset:18432
    ds_read_b64_tr_b16 v[74:75], v16 offset:19456
    ds_read_b64_tr_b16 v[76:77], v15 offset:22528
    ds_read_b64_tr_b16 v[78:79], v15 offset:23552
    ds_read_b64_tr_b16 v[80:81], v16 offset:22528
    ds_read_b64_tr_b16 v[82:83], v16 offset:23552
    s_waitcnt vmcnt(28)
    s_waitcnt lgkmcnt(8)
    v_mfma_f32_16x16x32_bf16 v[20:23], v[52:55], v[148:151], v[20:23]
    v_mfma_f32_16x16x32_bf16 v[24:27], v[56:59], v[148:151], v[24:27]
    v_mfma_f32_16x16x32_bf16 v[28:31], v[60:63], v[148:151], v[28:31]
    v_mfma_f32_16x16x32_bf16 v[32:35], v[64:67], v[148:151], v[32:35]
    v_mfma_f32_16x16x32_bf16 v[36:39], v[52:55], v[152:155], v[36:39]
    v_mfma_f32_16x16x32_bf16 v[40:43], v[56:59], v[152:155], v[40:43]
    v_mfma_f32_16x16x32_bf16 v[44:47], v[60:63], v[152:155], v[44:47]
    v_mfma_f32_16x16x32_bf16 v[48:51], v[64:67], v[152:155], v[48:51]
    s_mov_b32 s37, 1835008
    s_add_u32 m0, s39, 114688
    s_nop 0
    buffer_load_dwordx4 v8, s[16:19], s37 offen lds
    s_add_u32 m0, s39, 118784
    s_nop 0
    buffer_load_dwordx4 v9, s[16:19], s37 offen lds
    s_mov_b32 s37, 1966080
    s_add_u32 m0, s39, 122880
    s_nop 0
    buffer_load_dwordx4 v8, s[16:19], s37 offen lds
    s_add_u32 m0, s39, 126976
    s_nop 0
    buffer_load_dwordx4 v9, s[16:19], s37 offen lds
    s_add_u32 s36, s36, 4096
    s_add_u32 s38, s38, 4096
    buffer_load_dwordx4 v[148:151], v10, s[12:15], s36 offen offset:0
    buffer_load_dwordx4 v[152:155], v10, s[12:15], s38 offen offset:0
    ds_read_b64_tr_b16 v[52:53], v15 offset:24576
    ds_read_b64_tr_b16 v[54:55], v15 offset:25600
    ds_read_b64_tr_b16 v[56:57], v16 offset:24576
    ds_read_b64_tr_b16 v[58:59], v16 offset:25600
    ds_read_b64_tr_b16 v[60:61], v15 offset:28672
    ds_read_b64_tr_b16 v[62:63], v15 offset:29696
    ds_read_b64_tr_b16 v[64:65], v16 offset:28672
    ds_read_b64_tr_b16 v[66:67], v16 offset:29696
    s_waitcnt vmcnt(32)
    s_waitcnt lgkmcnt(8)
    v_mfma_f32_16x16x32_bf16 v[20:23], v[68:71], v[156:159], v[20:23]
    v_mfma_f32_16x16x32_bf16 v[24:27], v[72:75], v[156:159], v[24:27]
    v_mfma_f32_16x16x32_bf16 v[28:31], v[76:79], v[156:159], v[28:31]
    v_mfma_f32_16x16x32_bf16 v[32:35], v[80:83], v[156:159], v[32:35]
    v_mfma_f32_16x16x32_bf16 v[36:39], v[68:71], v[160:163], v[36:39]
    v_mfma_f32_16x16x32_bf16 v[40:43], v[72:75], v[160:163], v[40:43]
    v_mfma_f32_16x16x32_bf16 v[44:47], v[76:79], v[160:163], v[44:47]
    v_mfma_f32_16x16x32_bf16 v[48:51], v[80:83], v[160:163], v[48:51]
    buffer_load_dwordx4 v[156:159], v10, s[12:15], s36 offen offset:1024
    buffer_load_dwordx4 v[160:163], v10, s[12:15], s38 offen offset:1024
    ds_read_b64_tr_b16 v[68:69], v15 offset:26624
    ds_read_b64_tr_b16 v[70:71], v15 offset:27648
    ds_read_b64_tr_b16 v[72:73], v16 offset:26624
    ds_read_b64_tr_b16 v[74:75], v16 offset:27648
    ds_read_b64_tr_b16 v[76:77], v15 offset:30720
    ds_read_b64_tr_b16 v[78:79], v15 offset:31744
    ds_read_b64_tr_b16 v[80:81], v16 offset:30720
    ds_read_b64_tr_b16 v[82:83], v16 offset:31744
    s_waitcnt vmcnt(32)
    s_waitcnt lgkmcnt(8)
    v_mfma_f32_16x16x32_bf16 v[20:23], v[52:55], v[164:167], v[20:23]
    v_mfma_f32_16x16x32_bf16 v[24:27], v[56:59], v[164:167], v[24:27]
    v_mfma_f32_16x16x32_bf16 v[28:31], v[60:63], v[164:167], v[28:31]
    v_mfma_f32_16x16x32_bf16 v[32:35], v[64:67], v[164:167], v[32:35]
    v_mfma_f32_16x16x32_bf16 v[36:39], v[52:55], v[168:171], v[36:39]
    v_mfma_f32_16x16x32_bf16 v[40:43], v[56:59], v[168:171], v[40:43]
    v_mfma_f32_16x16x32_bf16 v[44:47], v[60:63], v[168:171], v[44:47]
    v_mfma_f32_16x16x32_bf16 v[48:51], v[64:67], v[168:171], v[48:51]
    buffer_load_dwordx4 v[164:167], v10, s[12:15], s36 offen offset:2048
    buffer_load_dwordx4 v[168:171], v10, s[12:15], s38 offen offset:2048
    s_waitcnt vmcnt(32)
    s_waitcnt lgkmcnt(0)
    v_mfma_f32_16x16x32_bf16 v[20:23], v[68:71], v[172:175], v[20:23]
    v_mfma_f32_16x16x32_bf16 v[24:27], v[72:75], v[172:175], v[24:27]
    v_mfma_f32_16x16x32_bf16 v[28:31], v[76:79], v[172:175], v[28:31]
    v_mfma_f32_16x16x32_bf16 v[32:35], v[80:83], v[172:175], v[32:35]
    v_mfma_f32_16x16x32_bf16 v[36:39], v[68:71], v[176:179], v[36:39]
    v_mfma_f32_16x16x32_bf16 v[40:43], v[72:75], v[176:179], v[40:43]
    v_mfma_f32_16x16x32_bf16 v[44:47], v[76:79], v[176:179], v[44:47]
    v_mfma_f32_16x16x32_bf16 v[48:51], v[80:83], v[176:179], v[48:51]
    buffer_load_dwordx4 v[172:175], v10, s[12:15], s36 offen offset:3072
    buffer_load_dwordx4 v[176:179], v10, s[12:15], s38 offen offset:3072
    s_waitcnt vmcnt(20)
    s_barrier
    ds_read_b64_tr_b16 v[52:53], v15 offset:32768
    ds_read_b64_tr_b16 v[54:55], v15 offset:33792
    ds_read_b64_tr_b16 v[56:57], v16 offset:32768
    ds_read_b64_tr_b16 v[58:59], v16 offset:33792
    ds_read_b64_tr_b16 v[60:61], v15 offset:36864
    ds_read_b64_tr_b16 v[62:63], v15 offset:37888
    ds_read_b64_tr_b16 v[64:65], v16 offset:36864
    ds_read_b64_tr_b16 v[66:67], v16 offset:37888
    ds_read_b64_tr_b16 v[68:69], v15 offset:34816
    ds_read_b64_tr_b16 v[70:71], v15 offset:35840
    ds_read_b64_tr_b16 v[72:73], v16 offset:34816
    ds_read_b64_tr_b16 v[74:75], v16 offset:35840
    ds_read_b64_tr_b16 v[76:77], v15 offset:38912
    ds_read_b64_tr_b16 v[78:79], v15 offset:39936
    ds_read_b64_tr_b16 v[80:81], v16 offset:38912
    ds_read_b64_tr_b16 v[82:83], v16 offset:39936
    s_waitcnt vmcnt(18)
    s_waitcnt lgkmcnt(8)
    v_mfma_f32_16x16x32_bf16 v[20:23], v[52:55], v[116:119], v[20:23]
    v_mfma_f32_16x16x32_bf16 v[24:27], v[56:59], v[116:119], v[24:27]
    v_mfma_f32_16x16x32_bf16 v[28:31], v[60:63], v[116:119], v[28:31]
    v_mfma_f32_16x16x32_bf16 v[32:35], v[64:67], v[116:119], v[32:35]
    v_mfma_f32_16x16x32_bf16 v[36:39], v[52:55], v[120:123], v[36:39]
    v_mfma_f32_16x16x32_bf16 v[40:43], v[56:59], v[120:123], v[40:43]
    v_mfma_f32_16x16x32_bf16 v[44:47], v[60:63], v[120:123], v[44:47]
    v_mfma_f32_16x16x32_bf16 v[48:51], v[64:67], v[120:123], v[48:51]
    ds_read_b64_tr_b16 v[52:53], v15 offset:40960
    ds_read_b64_tr_b16 v[54:55], v15 offset:41984
    ds_read_b64_tr_b16 v[56:57], v16 offset:40960
    ds_read_b64_tr_b16 v[58:59], v16 offset:41984
    ds_read_b64_tr_b16 v[60:61], v15 offset:45056
    ds_read_b64_tr_b16 v[62:63], v15 offset:46080
    ds_read_b64_tr_b16 v[64:65], v16 offset:45056
    ds_read_b64_tr_b16 v[66:67], v16 offset:46080
    s_waitcnt vmcnt(16)
    s_waitcnt lgkmcnt(8)
    v_mfma_f32_16x16x32_bf16 v[20:23], v[68:71], v[124:127], v[20:23]
    v_mfma_f32_16x16x32_bf16 v[24:27], v[72:75], v[124:127], v[24:27]
    v_mfma_f32_16x16x32_bf16 v[28:31], v[76:79], v[124:127], v[28:31]
    v_mfma_f32_16x16x32_bf16 v[32:35], v[80:83], v[124:127], v[32:35]
    v_mfma_f32_16x16x32_bf16 v[36:39], v[68:71], v[128:131], v[36:39]
    v_mfma_f32_16x16x32_bf16 v[40:43], v[72:75], v[128:131], v[40:43]
    v_mfma_f32_16x16x32_bf16 v[44:47], v[76:79], v[128:131], v[44:47]
    v_mfma_f32_16x16x32_bf16 v[48:51], v[80:83], v[128:131], v[48:51]
    ds_read_b64_tr_b16 v[68:69], v15 offset:43008
    ds_read_b64_tr_b16 v[70:71], v15 offset:44032
    ds_read_b64_tr_b16 v[72:73], v16 offset:43008
    ds_read_b64_tr_b16 v[74:75], v16 offset:44032
    ds_read_b64_tr_b16 v[76:77], v15 offset:47104
    ds_read_b64_tr_b16 v[78:79], v15 offset:48128
    ds_read_b64_tr_b16 v[80:81], v16 offset:47104
    ds_read_b64_tr_b16 v[82:83], v16 offset:48128
    s_waitcnt vmcnt(14)
    s_waitcnt lgkmcnt(8)
    v_mfma_f32_16x16x32_bf16 v[20:23], v[52:55], v[132:135], v[20:23]
    v_mfma_f32_16x16x32_bf16 v[24:27], v[56:59], v[132:135], v[24:27]
    v_mfma_f32_16x16x32_bf16 v[28:31], v[60:63], v[132:135], v[28:31]
    v_mfma_f32_16x16x32_bf16 v[32:35], v[64:67], v[132:135], v[32:35]
    v_mfma_f32_16x16x32_bf16 v[36:39], v[52:55], v[136:139], v[36:39]
    v_mfma_f32_16x16x32_bf16 v[40:43], v[56:59], v[136:139], v[40:43]
    v_mfma_f32_16x16x32_bf16 v[44:47], v[60:63], v[136:139], v[44:47]
    v_mfma_f32_16x16x32_bf16 v[48:51], v[64:67], v[136:139], v[48:51]
    s_waitcnt vmcnt(12)
    s_waitcnt lgkmcnt(0)
    v_mfma_f32_16x16x32_bf16 v[20:23], v[68:71], v[140:143], v[20:23]
    v_mfma_f32_16x16x32_bf16 v[24:27], v[72:75], v[140:143], v[24:27]
    v_mfma_f32_16x16x32_bf16 v[28:31], v[76:79], v[140:143], v[28:31]
    v_mfma_f32_16x16x32_bf16 v[32:35], v[80:83], v[140:143], v[32:35]
    v_mfma_f32_16x16x32_bf16 v[36:39], v[68:71], v[144:147], v[36:39]
    v_mfma_f32_16x16x32_bf16 v[40:43], v[72:75], v[144:147], v[40:43]
    v_mfma_f32_16x16x32_bf16 v[44:47], v[76:79], v[144:147], v[44:47]
    v_mfma_f32_16x16x32_bf16 v[48:51], v[80:83], v[144:147], v[48:51]
    s_waitcnt vmcnt(8)
    s_barrier
    ds_read_b64_tr_b16 v[52:53], v15 offset:49152
    ds_read_b64_tr_b16 v[54:55], v15 offset:50176
    ds_read_b64_tr_b16 v[56:57], v16 offset:49152
    ds_read_b64_tr_b16 v[58:59], v16 offset:50176
    ds_read_b64_tr_b16 v[60:61], v15 offset:53248
    ds_read_b64_tr_b16 v[62:63], v15 offset:54272
    ds_read_b64_tr_b16 v[64:65], v16 offset:53248
    ds_read_b64_tr_b16 v[66:67], v16 offset:54272
    ds_read_b64_tr_b16 v[68:69], v15 offset:51200
    ds_read_b64_tr_b16 v[70:71], v15 offset:52224
    ds_read_b64_tr_b16 v[72:73], v16 offset:51200
    ds_read_b64_tr_b16 v[74:75], v16 offset:52224
    ds_read_b64_tr_b16 v[76:77], v15 offset:55296
    ds_read_b64_tr_b16 v[78:79], v15 offset:56320
    ds_read_b64_tr_b16 v[80:81], v16 offset:55296
    ds_read_b64_tr_b16 v[82:83], v16 offset:56320
    s_waitcnt vmcnt(6)
    s_waitcnt lgkmcnt(8)
    v_mfma_f32_16x16x32_bf16 v[20:23], v[52:55], v[148:151], v[20:23]
    v_mfma_f32_16x16x32_bf16 v[24:27], v[56:59], v[148:151], v[24:27]
    v_mfma_f32_16x16x32_bf16 v[28:31], v[60:63], v[148:151], v[28:31]
    v_mfma_f32_16x16x32_bf16 v[32:35], v[64:67], v[148:151], v[32:35]
    v_mfma_f32_16x16x32_bf16 v[36:39], v[52:55], v[152:155], v[36:39]
    v_mfma_f32_16x16x32_bf16 v[40:43], v[56:59], v[152:155], v[40:43]
    v_mfma_f32_16x16x32_bf16 v[44:47], v[60:63], v[152:155], v[44:47]
    v_mfma_f32_16x16x32_bf16 v[48:51], v[64:67], v[152:155], v[48:51]
    ds_read_b64_tr_b16 v[52:53], v15 offset:57344
    ds_read_b64_tr_b16 v[54:55], v15 offset:58368
    ds_read_b64_tr_b16 v[56:57], v16 offset:57344
    ds_read_b64_tr_b16 v[58:59], v16 offset:58368
    ds_read_b64_tr_b16 v[60:61], v15 offset:61440
    ds_read_b64_tr_b16 v[62:63], v15 offset:62464
    ds_read_b64_tr_b16 v[64:65], v16 offset:61440
    ds_read_b64_tr_b16 v[66:67], v16 offset:62464
    s_waitcnt vmcnt(4)
    s_waitcnt lgkmcnt(8)
    v_mfma_f32_16x16x32_bf16 v[20:23], v[68:71], v[156:159], v[20:23]
    v_mfma_f32_16x16x32_bf16 v[24:27], v[72:75], v[156:159], v[24:27]
    v_mfma_f32_16x16x32_bf16 v[28:31], v[76:79], v[156:159], v[28:31]
    v_mfma_f32_16x16x32_bf16 v[32:35], v[80:83], v[156:159], v[32:35]
    v_mfma_f32_16x16x32_bf16 v[36:39], v[68:71], v[160:163], v[36:39]
    v_mfma_f32_16x16x32_bf16 v[40:43], v[72:75], v[160:163], v[40:43]
    v_mfma_f32_16x16x32_bf16 v[44:47], v[76:79], v[160:163], v[44:47]
    v_mfma_f32_16x16x32_bf16 v[48:51], v[80:83], v[160:163], v[48:51]
    ds_read_b64_tr_b16 v[68:69], v15 offset:59392
    ds_read_b64_tr_b16 v[70:71], v15 offset:60416
    ds_read_b64_tr_b16 v[72:73], v16 offset:59392
    ds_read_b64_tr_b16 v[74:75], v16 offset:60416
    ds_read_b64_tr_b16 v[76:77], v15 offset:63488
    ds_read_b64_tr_b16 v[78:79], v15 offset:64512
    ds_read_b64_tr_b16 v[80:81], v16 offset:63488
    ds_read_b64_tr_b16 v[82:83], v16 offset:64512
    s_waitcnt vmcnt(2)
    s_waitcnt lgkmcnt(8)
    v_mfma_f32_16x16x32_bf16 v[20:23], v[52:55], v[164:167], v[20:23]
    v_mfma_f32_16x16x32_bf16 v[24:27], v[56:59], v[164:167], v[24:27]
    v_mfma_f32_16x16x32_bf16 v[28:31], v[60:63], v[164:167], v[28:31]
    v_mfma_f32_16x16x32_bf16 v[32:35], v[64:67], v[164:167], v[32:35]
    v_mfma_f32_16x16x32_bf16 v[36:39], v[52:55], v[168:171], v[36:39]
    v_mfma_f32_16x16x32_bf16 v[40:43], v[56:59], v[168:171], v[40:43]
    v_mfma_f32_16x16x32_bf16 v[44:47], v[60:63], v[168:171], v[44:47]
    v_mfma_f32_16x16x32_bf16 v[48:51], v[64:67], v[168:171], v[48:51]
    s_waitcnt vmcnt(0)
    s_waitcnt lgkmcnt(0)
    v_mfma_f32_16x16x32_bf16 v[20:23], v[68:71], v[172:175], v[20:23]
    v_mfma_f32_16x16x32_bf16 v[24:27], v[72:75], v[172:175], v[24:27]
    v_mfma_f32_16x16x32_bf16 v[28:31], v[76:79], v[172:175], v[28:31]
    v_mfma_f32_16x16x32_bf16 v[32:35], v[80:83], v[172:175], v[32:35]
    v_mfma_f32_16x16x32_bf16 v[36:39], v[68:71], v[176:179], v[36:39]
    v_mfma_f32_16x16x32_bf16 v[40:43], v[72:75], v[176:179], v[40:43]
    v_mfma_f32_16x16x32_bf16 v[44:47], v[76:79], v[176:179], v[44:47]
    v_mfma_f32_16x16x32_bf16 v[48:51], v[80:83], v[176:179], v[48:51]
    s_waitcnt vmcnt(24)
    v_lshlrev_b32 v116, 16, v84
    v_and_b32 v117, 0xffff0000, v84
    v_lshlrev_b32 v84, 16, v100
    v_and_b32 v100, 0xffff0000, v100
    v_add_f32 v116, v116, v84
    v_add_f32 v117, v117, v100
    v_lshlrev_b32 v118, 16, v85
    v_and_b32 v119, 0xffff0000, v85
    v_lshlrev_b32 v85, 16, v101
    v_and_b32 v101, 0xffff0000, v101
    v_add_f32 v118, v118, v85
    v_add_f32 v119, v119, v101
    v_lshlrev_b32 v120, 16, v86
    v_and_b32 v121, 0xffff0000, v86
    v_lshlrev_b32 v86, 16, v102
    v_and_b32 v102, 0xffff0000, v102
    v_add_f32 v120, v120, v86
    v_add_f32 v121, v121, v102
    v_lshlrev_b32 v122, 16, v87
    v_and_b32 v123, 0xffff0000, v87
    v_lshlrev_b32 v87, 16, v103
    v_and_b32 v103, 0xffff0000, v103
    v_add_f32 v122, v122, v87
    v_add_f32 v123, v123, v103
    v_lshlrev_b32 v132, 16, v88
    v_and_b32 v133, 0xffff0000, v88
    v_lshlrev_b32 v88, 16, v104
    v_and_b32 v104, 0xffff0000, v104
    v_add_f32 v132, v132, v88
    v_add_f32 v133, v133, v104
    v_lshlrev_b32 v134, 16, v89
    v_and_b32 v135, 0xffff0000, v89
    v_lshlrev_b32 v89, 16, v105
    v_and_b32 v105, 0xffff0000, v105
    v_add_f32 v134, v134, v89
    v_add_f32 v135, v135, v105
    v_lshlrev_b32 v136, 16, v90
    v_and_b32 v137, 0xffff0000, v90
    v_lshlrev_b32 v90, 16, v106
    v_and_b32 v106, 0xffff0000, v106
    v_add_f32 v136, v136, v90
    v_add_f32 v137, v137, v106
    v_lshlrev_b32 v138, 16, v91
    v_and_b32 v139, 0xffff0000, v91
    v_lshlrev_b32 v91, 16, v107
    v_and_b32 v107, 0xffff0000, v107
    v_add_f32 v138, v138, v91
    v_add_f32 v139, v139, v107
    v_lshlrev_b32 v124, 16, v92
    v_and_b32 v125, 0xffff0000, v92
    v_lshlrev_b32 v92, 16, v108
    v_and_b32 v108, 0xffff0000, v108
    v_add_f32 v124, v124, v92
    v_add_f32 v125, v125, v108
    v_lshlrev_b32 v126, 16, v93
    v_and_b32 v127, 0xffff0000, v93
    v_lshlrev_b32 v93, 16, v109
    v_and_b32 v109, 0xffff0000, v109
    v_add_f32 v126, v126, v93
    v_add_f32 v127, v127, v109
    v_lshlrev_b32 v128, 16, v94
    v_and_b32 v129, 0xffff0000, v94
    v_lshlrev_b32 v94, 16, v110
    v_and_b32 v110, 0xffff0000, v110
    v_add_f32 v128, v128, v94
    v_add_f32 v129, v129, v110
    v_lshlrev_b32 v130, 16, v95
    v_and_b32 v131, 0xffff0000, v95
    v_lshlrev_b32 v95, 16, v111
    v_and_b32 v111, 0xffff0000, v111
    v_add_f32 v130, v130, v95
    v_add_f32 v131, v131, v111
    v_lshlrev_b32 v140, 16, v96
    v_and_b32 v141, 0xffff0000, v96
    v_lshlrev_b32 v96, 16, v112
    v_and_b32 v112, 0xffff0000, v112
    v_add_f32 v140, v140, v96
    v_add_f32 v141, v141, v112
    v_lshlrev_b32 v142, 16, v97
    v_and_b32 v143, 0xffff0000, v97
    v_lshlrev_b32 v97, 16, v113
    v_and_b32 v113, 0xffff0000, v113
    v_add_f32 v142, v142, v97
    v_add_f32 v143, v143, v113
    v_lshlrev_b32 v144, 16, v98
    v_and_b32 v145, 0xffff0000, v98
    v_lshlrev_b32 v98, 16, v114
    v_and_b32 v114, 0xffff0000, v114
    v_add_f32 v144, v144, v98
    v_add_f32 v145, v145, v114
    v_lshlrev_b32 v146, 16, v99
    v_and_b32 v147, 0xffff0000, v99
    v_lshlrev_b32 v99, 16, v115
    v_and_b32 v115, 0xffff0000, v115
    v_add_f32 v146, v146, v99
    v_add_f32 v147, v147, v115
    v_fma_f32 v20, v11, v116, v20
    v_fma_f32 v21, v11, v117, v21
    v_fma_f32 v22, v11, v118, v22
    v_fma_f32 v23, v11, v119, v23
    v_fma_f32 v24, v11, v120, v24
    v_fma_f32 v25, v11, v121, v25
    v_fma_f32 v26, v11, v122, v26
    v_fma_f32 v27, v11, v123, v27
    v_fma_f32 v28, v11, v124, v28
    v_fma_f32 v29, v11, v125, v29
    v_fma_f32 v30, v11, v126, v30
    v_fma_f32 v31, v11, v127, v31
    v_fma_f32 v32, v11, v128, v32
    v_fma_f32 v33, v11, v129, v33
    v_fma_f32 v34, v11, v130, v34
    v_fma_f32 v35, v11, v131, v35
    v_cvt_pk_bf16_f32 v84, v20, v21
    v_cvt_pk_bf16_f32 v85, v22, v23
    v_cvt_pk_bf16_f32 v86, v24, v25
    v_cvt_pk_bf16_f32 v87, v26, v27
    v_cvt_pk_bf16_f32 v88, v28, v29
    v_cvt_pk_bf16_f32 v89, v30, v31
    v_cvt_pk_bf16_f32 v90, v32, v33
    v_cvt_pk_bf16_f32 v91, v34, v35
    s_nop 1
    v_permlane16_swap_b32 v84, v86
    v_permlane16_swap_b32 v85, v87
    v_permlane16_swap_b32 v88, v90
    v_permlane16_swap_b32 v89, v91
    buffer_store_dwordx4 v[84:87], v17, s[8:11], s47 offen offset:0
    buffer_store_dwordx4 v[88:91], v17, s[8:11], s47 offen offset:64
    v_fma_f32 v36, v12, v132, v36
    v_fma_f32 v37, v12, v133, v37
    v_fma_f32 v38, v12, v134, v38
    v_fma_f32 v39, v12, v135, v39
    v_fma_f32 v40, v12, v136, v40
    v_fma_f32 v41, v12, v137, v41
    v_fma_f32 v42, v12, v138, v42
    v_fma_f32 v43, v12, v139, v43
    v_fma_f32 v44, v12, v140, v44
    v_fma_f32 v45, v12, v141, v45
    v_fma_f32 v46, v12, v142, v46
    v_fma_f32 v47, v12, v143, v47
    v_fma_f32 v48, v12, v144, v48
    v_fma_f32 v49, v12, v145, v49
    v_fma_f32 v50, v12, v146, v50
    v_fma_f32 v51, v12, v147, v51
    v_cvt_pk_bf16_f32 v92, v36, v37
    v_cvt_pk_bf16_f32 v93, v38, v39
    v_cvt_pk_bf16_f32 v94, v40, v41
    v_cvt_pk_bf16_f32 v95, v42, v43
    v_cvt_pk_bf16_f32 v96, v44, v45
    v_cvt_pk_bf16_f32 v97, v46, v47
    v_cvt_pk_bf16_f32 v98, v48, v49
    v_cvt_pk_bf16_f32 v99, v50, v51
    s_nop 1
    v_permlane16_swap_b32 v92, v94
    v_permlane16_swap_b32 v93, v95
    v_permlane16_swap_b32 v96, v98
    v_permlane16_swap_b32 v97, v99
    buffer_store_dwordx4 v[92:95], v17, s[8:11], s43 offen offset:0
    buffer_store_dwordx4 v[96:99], v17, s[8:11], s43 offen offset:64
    s_waitcnt vmcnt(0)
K4_END:
    s_endpgm
.section .rodata,"a"
.p2align 6

.amdhsa_kernel k1_proj_kernel
  .amdhsa_next_free_vgpr 424
  .amdhsa_next_free_sgpr 102
  .amdhsa_accum_offset 256
  .amdhsa_group_segment_fixed_size 0
  .amdhsa_kernarg_size 96
  .amdhsa_user_sgpr_count 2
  .amdhsa_user_sgpr_kernarg_segment_ptr 1
  .amdhsa_system_sgpr_workgroup_id_x 1
.end_amdhsa_kernel
.p2align 6

.amdhsa_kernel k2_attn_seqdft_kernel
  .amdhsa_next_free_vgpr 192
  .amdhsa_next_free_sgpr 102
  .amdhsa_accum_offset 192
  .amdhsa_group_segment_fixed_size 0
  .amdhsa_kernarg_size 96
  .amdhsa_user_sgpr_count 2
  .amdhsa_user_sgpr_kernarg_segment_ptr 1
  .amdhsa_system_sgpr_workgroup_id_x 1
.end_amdhsa_kernel
.p2align 6

.amdhsa_kernel k4_out_kernel
  .amdhsa_next_free_vgpr 180
  .amdhsa_next_free_sgpr 102
  .amdhsa_accum_offset 180
  .amdhsa_group_segment_fixed_size 0
  .amdhsa_kernarg_size 96
  .amdhsa_user_sgpr_count 2
  .amdhsa_user_sgpr_kernarg_segment_ptr 1
  .amdhsa_system_sgpr_workgroup_id_x 1
.end_amdhsa_kernel
.p2align 6
```
